```python
import torch

def _softmax(x, axis=-1):
    return torch.softmax(x, dim=axis)
def _gelu(x):
    return torch.nn.functional.gelu(x, approximate="tanh")
def _silu(x):
    return torch.nn.functional.silu(x)
def _sigmoid(x):
    return torch.sigmoid(x)
def _layernorm(x, axis=-1, eps=1e-5):
    m = x.mean(dim=axis, keepdim=True)
    v = x.var(dim=axis, keepdim=True, unbiased=False)
    return (x - m) / torch.sqrt(v + eps)
def _scatter_add(tgt, idx, src, axis=0):
    return tgt.clone().index_add_(axis, idx, src)
def _segment_sum(src, seg, n):
    out = torch.zeros((n,) + src.shape[1:], dtype=src.dtype)
    return out.index_add_(0, seg, src)
def _pad(x, pw):
    flat = tuple(v for pair in reversed(pw) for v in pair)
    return torch.nn.functional.pad(x, flat)

kernel_name = 'sequential_preLN__sliding_local_dilated__glu_gated_glu__prompt'

def setup_inputs():

    _w = (lambda a: (lambda t: t.to(torch.bfloat16) if t.is_floating_point() else t)(torch.as_tensor(a)))
    def _A_setup():
        B, S, D = 1, 2048, 1024
        return {
            "x": _w((lambda *s: torch.randn(*s, dtype=torch.bfloat16) * 0.05)(B, S, D)),
            "wqkv": _w((lambda *s: torch.randn(*s, dtype=torch.bfloat16) * 0.05)(D, 3 * D)),
            "wo": _w((lambda *s: torch.randn(*s, dtype=torch.bfloat16) * 0.05)(D, D)),
        }
    _A_in = _A_setup()

    def _B_setup():
        B, S, D, F = 1, 2048, 1024, 3584
        return {
            "x": _w((lambda *s: torch.randn(*s, dtype=torch.bfloat16) * 0.05)(B, S, D)),
            "w_gate": _w((lambda *s: torch.randn(*s, dtype=torch.bfloat16) * 0.05)(D, F)),
            "w_up": _w((lambda *s: torch.randn(*s, dtype=torch.bfloat16) * 0.05)(D, F)),
            "w_down": _w((lambda *s: torch.randn(*s, dtype=torch.bfloat16) * 0.05)(F, D)),
        }
    _B_in = _B_setup()

    return {
        "A_x": _A_in["x"],
        "A_wqkv": _A_in["wqkv"],
        "A_wo": _A_in["wo"],
        "B_x": _B_in["x"],
        "B_w_gate": _B_in["w_gate"],
        "B_w_up": _B_in["w_up"],
        "B_w_down": _B_in["w_down"],
    }

def reference(A_x, A_wqkv, A_wo, B_x, B_w_gate, B_w_up, B_w_down):
    def _A_ref(x, wqkv, wo):
        B, S, D = x.shape
        H = 32; Dh = D // H
        W, dil = 8, 2
        qkv = (lambda x, *d: x.permute(*d))((x @ wqkv).reshape(B, S, 3, H, Dh), 2, 0, 3, 1, 4)
        q, k, v = qkv[0], qkv[1], qkv[2]
        scale = Dh ** -0.5
        pos = torch.arange(S)
        off = torch.arange(W) * dil
        idx = pos[:, None] - off[None, :]
        mask = idx >= 0
        idx_c = torch.where(mask, idx, 0).reshape(-1)
        kg = k[:, :, idx_c, :].reshape(B, H, S, W, Dh)
        vg = v[:, :, idx_c, :].reshape(B, H, S, W, Dh)
        logits = torch.einsum("bhsd,bhswd->bhsw", q, kg) * scale
        logits = torch.where(mask[None, None, :, :], logits, -1e9)
        attn = _softmax(logits, axis=-1)
        o = torch.einsum("bhsw,bhswd->bhsd", attn, vg)
        return (lambda x, *d: x.permute(*d))(o, 0, 2, 1, 3).reshape(B, S, D) @ wo

    def _B_ref(x, w_gate, w_up, w_down):
        g = torch.einsum("bsd,df->bsf", x, w_gate)
        u = torch.einsum("bsd,df->bsf", x, w_up)
        h = _sigmoid(g) * u
        return torch.einsum("bsf,fd->bsd", h, w_down)

    x = A_x
    h = x + _A_ref(_layernorm(x, axis=-1), A_wqkv, A_wo)
    h2 = h + _B_ref(_layernorm(h, axis=-1), B_w_gate, B_w_up, B_w_down)
    return h2
```

```asm
; @launch kernel=sequential_preLN__sliding_local_dilated__glu_gated_glu__prompt_kernel grid=(256,1,1) block=(256,1,1) lds=163840
.amdgcn_target "amdgcn-amd-amdhsa--gfx950"
.text
.globl sequential_preLN__sliding_local_dilated__glu_gated_glu__prompt_kernel
.p2align 12
.type sequential_preLN__sliding_local_dilated__glu_gated_glu__prompt_kernel,@function
sequential_preLN__sliding_local_dilated__glu_gated_glu__prompt_kernel:
 s_cmp_ge_u32 s2, 256
 s_cbranch_scc1 L_done
 s_load_dwordx16 s[64:79], s[0:1], 0
 s_load_dwordx4 s[80:83], s[0:1], 64
 s_memrealtime s[8:9]
 v_and_b32 v129, 7, v0
 v_lshrrev_b32 v130, 6, v0
 v_bfe_u32 v131, v0, 3, 3
 v_readfirstlane_b32 s10, v130
 v_lshl_add_u32 v131, v130, 5, v131
 s_lshl_b32 s11, s2, 3
 v_add_u32 v132, s11, v129
 v_and_b32 v0, 63, v0
 v_lshrrev_b32 v135, 3, v0
 v_xor_b32 v192, v135, v129
 v_add_u32 v133, s11, v135
 v_lshlrev_b32 v133, 11, v133
 v_lshl_add_u32 v133, v192, 4, v133
 v_lshl_add_u32 v133, v130, 9, v133
 s_lshl_b32 s55, s10, 12
 s_add_u32 s55, s55, 0x20000
 s_lshl_b32 s48, s2, 2
 s_add_u32 s48, s48, s10
 s_mul_i32 s50, s48, 6144
 v_min_u32 v193, 47, v0
 v_lshlrev_b32 v194, 7, v193
 v_lshrrev_b32 v195, 3, v193
 v_and_b32 v193, 7, v193
 v_lshlrev_b32 v193, 4, v193
 v_lshl_add_u32 v196, v195, 10, v193
 v_add_u32 v196, 384, v196
 v_mov_b32 v197, 16
 s_waitcnt lgkmcnt(0)
 s_mov_b32 s84, s64
 s_mov_b32 s85, s65
 s_mov_b32 s86, 4194304
 s_mov_b32 s87, 0x20000
 s_add_u32 m0, s55, 0
 s_nop 0
 buffer_load_dwordx4 v133, s[84:87], 0 offen offset:0  lds
 s_add_u32 m0, s55, 896
 s_nop 0
 buffer_load_dwordx4 v133, s[84:87], 0 offen offset:128  lds
 s_add_u32 m0, s55, 1792
 s_nop 0
 buffer_load_dwordx4 v133, s[84:87], 0 offen offset:256  lds
 s_add_u32 m0, s55, 2688
 s_nop 0
 buffer_load_dwordx4 v133, s[84:87], 0 offen offset:384  lds
 s_mov_b32 s4, s80
 s_mov_b32 s5, s81
 s_mov_b32 s6, 256
 s_mov_b32 s7, 0x20000
 s_cmp_lg_u32 s48, 0
 s_cbranch_scc1 L_notag
 s_or_b32 s8, s8, 1
 v_mov_b32 v200, s8
 v_mov_b32 v201, s9
 buffer_store_dwordx2 v[200:201], v197, s[4:7], 0 offen sc1
L_notag:
 s_mov_b32 s96, s82
 s_mov_b32 s97, s83
 s_mov_b32 s98, 50331648
 s_mov_b32 s99, 0x20000
 s_mov_b32 s92, s66
 s_mov_b32 s93, s67
 s_mov_b32 s94, 6291456
 s_mov_b32 s95, 0x20000
 buffer_load_dwordx4 v[208:211], v196, s[92:95], s50 offen
 s_cmp_eq_u32 s10, 0
 s_cbranch_scc1 m_ret_p0
 s_cmp_eq_u32 s10, 1
 s_cbranch_scc1 m_pad_p0_0
 s_cmp_eq_u32 s10, 2
 s_cbranch_scc1 m_pad_p0_1
 s_branch m_pad_p0_2
m_ret_p0:
 s_getpc_b64 s[60:61]
pc_p0:
 s_lshr_b32 s62, s2, 3
 s_lshl_b32 s62, s62, 2
 s_add_u32 s62, s62, s10
 s_lshl_b32 s62, s62, 9
 s_add_u32 s62, s62, 0
 s_min_u32 s62, s62, L_done-pc_p0-512
 v_and_b32 v212, 3, v0
 v_lshl_add_u32 v212, v212, 7, s62
 v_add_co_u32 v212, vcc, s60, v212
 v_mov_b32 v213, s61
 s_nop 0
 v_addc_co_u32 v213, vcc, 0, v213, vcc
 global_load_dword v214, v[212:213], off
 s_mov_b32 s94, 6291456
 buffer_load_dword v215, v194, s[92:95], s50 offen
 v_lshrrev_b32 v134, 4, v132
 v_lshlrev_b32 v134, 15, v134
 v_lshl_add_u32 v134, v131, 8, v134
 v_and_b32 v135, 15, v132
 v_lshl_add_u32 v134, v135, 4, v134
 v_add_u32 v136, 4096, v134
 v_lshlrev_b32 v137, 3, v129
 v_add_u32 v137, 163584, v137
 v_lshl_add_u32 v138, v130, 6, v137
 v_lshlrev_b32 v192, 4, v192
 v_lshl_add_u32 v192, v129, 7, v192
 v_add_u32 v192, s55, v192
 v_lshlrev_b32 v132, 2, v132
 v_and_b32 v198, 1, v195
 v_mul_u32_u24 v198, 393216, v198
 v_lshrrev_b32 v195, 1, v195
 v_lshl_add_u32 v198, v195, 11, v198
 v_add_u32 v198, v198, v193
 s_lshr_b32 s51, s48, 4
 s_mul_i32 s51, s51, 6144
 s_and_b32 s52, s48, 15
 s_lshl_b32 s52, s52, 7
 s_add_u32 s51, s51, s52
 s_add_u32 s51, s51, 0x2300000
 v_cmp_gt_u32 vcc, 8, v0
 v_mov_b32 v195, 0x40000000
 s_mov_b32 s54, 0x2040000
 v_cndmask_b32 v132, v195, v132, vcc
 s_cmp_eq_u32 s10, 0
 s_cselect_b32 s54, s54, 0x40000000
 s_lshl_b32 s57, s2, 2
 s_add_u32 s57, s57, s10
 v_min_u32 v14, 55, v0
 s_mul_i32 s56, s57, 7
 v_lshrrev_b32 v30, 3, v14
 v_add_u32 v30, s56, v30
 v_and_b32 v14, 7, v14
 v_lshlrev_b32 v14, 4, v14
 v_lshl_add_u32 v31, v30, 7, v14
 v_lshl_add_u32 v30, v30, 11, v14
 s_cmp_ge_u32 s57, 512
 s_cselect_b32 s56, 4287628288, 0
 s_add_u32 s56, s56, 384
 v_add_u32 v30, s56, v30
 s_mov_b32 s88, s68
 s_mov_b32 s89, s69
 s_mov_b32 s90, 2097152
 s_mov_b32 s91, 0x20000
 s_lshl_b32 s49, s57, 11
 v_lshlrev_b32 v6, 4, v0
 s_waitcnt vmcnt(3)
 ds_read_b128 v[144:147], v192 offset:0
 ds_read_b128 v[148:151], v192 offset:1024
 ds_read_b128 v[152:155], v192 offset:2048
 ds_read_b128 v[156:159], v192 offset:3072
 s_waitcnt lgkmcnt(3)
 v_lshlrev_b32 v160, 16, v144
 v_and_b32 v161, 0xffff0000, v144
 v_lshlrev_b32 v162, 16, v145
 v_and_b32 v163, 0xffff0000, v145
 v_lshlrev_b32 v164, 16, v146
 v_and_b32 v165, 0xffff0000, v146
 v_lshlrev_b32 v166, 16, v147
 v_and_b32 v167, 0xffff0000, v147
 s_waitcnt lgkmcnt(2)
 v_lshlrev_b32 v168, 16, v148
 v_and_b32 v169, 0xffff0000, v148
 v_lshlrev_b32 v170, 16, v149
 v_and_b32 v171, 0xffff0000, v149
 v_lshlrev_b32 v172, 16, v150
 v_and_b32 v173, 0xffff0000, v150
 s_branch m_ps_p0_0
m_pad_p0_0:
 s_branch m_ret_p0
m_ps_p0_0:
 v_lshlrev_b32 v174, 16, v151
 v_and_b32 v175, 0xffff0000, v151
 s_waitcnt lgkmcnt(1)
 v_lshlrev_b32 v176, 16, v152
 v_and_b32 v177, 0xffff0000, v152
 v_lshlrev_b32 v178, 16, v153
 v_and_b32 v179, 0xffff0000, v153
 v_lshlrev_b32 v180, 16, v154
 v_and_b32 v181, 0xffff0000, v154
 v_lshlrev_b32 v182, 16, v155
 v_and_b32 v183, 0xffff0000, v155
 s_waitcnt lgkmcnt(0)
 v_lshlrev_b32 v184, 16, v156
 v_and_b32 v185, 0xffff0000, v156
 v_lshlrev_b32 v186, 16, v157
 v_and_b32 v187, 0xffff0000, v157
 v_lshlrev_b32 v188, 16, v158
 v_and_b32 v189, 0xffff0000, v158
 v_lshlrev_b32 v190, 16, v159
 v_and_b32 v191, 0xffff0000, v159
 v_pk_add_f32 v[140:141], v[160:161], v[162:163]
 v_pk_add_f32 v[142:143], v[164:165], v[166:167]
 v_pk_add_f32 v[140:141], v[140:141], v[168:169]
 v_pk_add_f32 v[142:143], v[142:143], v[170:171]
 v_pk_add_f32 v[140:141], v[140:141], v[172:173]
 v_pk_add_f32 v[142:143], v[142:143], v[174:175]
 v_pk_add_f32 v[140:141], v[140:141], v[176:177]
 v_pk_add_f32 v[142:143], v[142:143], v[178:179]
 v_pk_add_f32 v[140:141], v[140:141], v[180:181]
 v_pk_add_f32 v[142:143], v[142:143], v[182:183]
 v_pk_add_f32 v[140:141], v[140:141], v[184:185]
 v_pk_add_f32 v[142:143], v[142:143], v[186:187]
 v_pk_add_f32 v[140:141], v[140:141], v[188:189]
 v_pk_add_f32 v[142:143], v[142:143], v[190:191]
 v_pk_add_f32 v[140:141], v[140:141], v[142:143]
 v_add_f32 v202, v140, v141
 s_nop 1
 v_add_f32_dpp v202, v202, v202 row_ror:8 row_mask:0xf bank_mask:0xf
 v_mov_b32 v140, v202
 s_nop 1
 v_permlane16_swap_b32 v202, v140
 v_add_f32 v202, v202, v140
 v_mov_b32 v140, v202
 s_nop 1
 v_permlane32_swap_b32 v202, v140
 v_add_f32 v202, v202, v140
 v_mul_f32 v204, 0xbb800000, v202
 v_mul_f32 v205, 0xbb800000, v202
 v_pk_add_f32 v[160:161], v[160:161], v[204:205]
 v_pk_add_f32 v[162:163], v[162:163], v[204:205]
 v_pk_add_f32 v[164:165], v[164:165], v[204:205]
 v_pk_add_f32 v[166:167], v[166:167], v[204:205]
 v_pk_add_f32 v[168:169], v[168:169], v[204:205]
 v_pk_add_f32 v[170:171], v[170:171], v[204:205]
 v_pk_add_f32 v[172:173], v[172:173], v[204:205]
 v_pk_add_f32 v[174:175], v[174:175], v[204:205]
 v_pk_add_f32 v[176:177], v[176:177], v[204:205]
 v_pk_add_f32 v[178:179], v[178:179], v[204:205]
 v_pk_add_f32 v[180:181], v[180:181], v[204:205]
 v_pk_add_f32 v[182:183], v[182:183], v[204:205]
 v_pk_add_f32 v[184:185], v[184:185], v[204:205]
 v_pk_add_f32 v[186:187], v[186:187], v[204:205]
 v_pk_add_f32 v[188:189], v[188:189], v[204:205]
 v_pk_add_f32 v[190:191], v[190:191], v[204:205]
 v_pk_mul_f32 v[140:141], v[160:161], v[160:161]
 v_pk_mul_f32 v[142:143], v[162:163], v[162:163]
 v_pk_fma_f32 v[140:141], v[164:165], v[164:165], v[140:141]
 v_pk_fma_f32 v[142:143], v[166:167], v[166:167], v[142:143]
 v_pk_fma_f32 v[140:141], v[168:169], v[168:169], v[140:141]
 v_pk_fma_f32 v[142:143], v[170:171], v[170:171], v[142:143]
 v_pk_fma_f32 v[140:141], v[172:173], v[172:173], v[140:141]
 v_pk_fma_f32 v[142:143], v[174:175], v[174:175], v[142:143]
 v_pk_fma_f32 v[140:141], v[176:177], v[176:177], v[140:141]
 v_pk_fma_f32 v[142:143], v[178:179], v[178:179], v[142:143]
 v_pk_fma_f32 v[140:141], v[180:181], v[180:181], v[140:141]
 v_pk_fma_f32 v[142:143], v[182:183], v[182:183], v[142:143]
 v_pk_fma_f32 v[140:141], v[184:185], v[184:185], v[140:141]
 v_pk_fma_f32 v[142:143], v[186:187], v[186:187], v[142:143]
 v_pk_fma_f32 v[140:141], v[188:189], v[188:189], v[140:141]
 v_pk_fma_f32 v[142:143], v[190:191], v[190:191], v[142:143]
 v_pk_add_f32 v[140:141], v[140:141], v[142:143]
 v_add_f32 v203, v140, v141
 s_nop 1
 v_add_f32_dpp v203, v203, v203 row_ror:8 row_mask:0xf bank_mask:0xf
 v_mov_b32 v140, v203
 s_nop 1
 v_permlane16_swap_b32 v203, v140
 v_add_f32 v203, v203, v140
 v_mov_b32 v140, v203
 s_nop 1
 v_permlane32_swap_b32 v203, v140
 v_add_f32 v203, v203, v140
 ds_write_b64 v138, v[202:203]
 s_waitcnt lgkmcnt(0)
 s_barrier
 ds_read_b64 v[144:145], v137
 ds_read_b64 v[146:147], v137 offset:64
 ds_read_b64 v[148:149], v137 offset:128
 ds_read_b64 v[150:151], v137 offset:192
 s_lshl_b32 s58, s2, 7
 s_waitcnt lgkmcnt(0)
 v_pk_add_f32 v[140:141], v[144:145], v[146:147]
 v_pk_add_f32 v[142:143], v[148:149], v[150:151]
 v_pk_add_f32 v[140:141], v[140:141], v[142:143]
 v_mul_f32 v143, 0x3a800000, v140
 v_mov_b32 v142, 0x3b800000
 v_fma_f32 v144, v144, v142, -v143
 v_fma_f32 v146, v146, v142, -v143
 v_fma_f32 v148, v148, v142, -v143
 v_fma_f32 v150, v150, v142, -v143
 v_mul_f32 v144, v144, v144
 v_fmac_f32 v144, v146, v146
 v_fmac_f32 v144, v148, v148
 v_fmac_f32 v144, v150, v150
 v_fmac_f32 v141, 0x43800000, v144
 v_mov_b32 v140, 0x3727c5ac
 v_fmac_f32 v140, 0x3a800000, v141
 v_rsq_f32 v140, v140
 v_sub_f32 v204, -v204, v143
 v_mov_b32 v141, v140
 v_mul_f32 v204, v204, v140
 v_mov_b32 v205, v204
 v_pk_fma_f32 v[160:161], v[160:161], v[140:141], v[204:205]
 v_pk_fma_f32 v[162:163], v[162:163], v[140:141], v[204:205]
 v_pk_fma_f32 v[164:165], v[164:165], v[140:141], v[204:205]
 v_pk_fma_f32 v[166:167], v[166:167], v[140:141], v[204:205]
 v_pk_fma_f32 v[168:169], v[168:169], v[140:141], v[204:205]
 v_pk_fma_f32 v[170:171], v[170:171], v[140:141], v[204:205]
 v_pk_fma_f32 v[172:173], v[172:173], v[140:141], v[204:205]
 v_pk_fma_f32 v[174:175], v[174:175], v[140:141], v[204:205]
 v_pk_fma_f32 v[176:177], v[176:177], v[140:141], v[204:205]
 v_pk_fma_f32 v[178:179], v[178:179], v[140:141], v[204:205]
 v_pk_fma_f32 v[180:181], v[180:181], v[140:141], v[204:205]
 s_branch m_ps_p0_1
m_pad_p0_1:
 s_branch m_ret_p0
m_ps_p0_1:
 v_pk_fma_f32 v[182:183], v[182:183], v[140:141], v[204:205]
 v_pk_fma_f32 v[184:185], v[184:185], v[140:141], v[204:205]
 v_pk_fma_f32 v[186:187], v[186:187], v[140:141], v[204:205]
 v_pk_fma_f32 v[188:189], v[188:189], v[140:141], v[204:205]
 v_pk_fma_f32 v[190:191], v[190:191], v[140:141], v[204:205]
 v_cvt_pk_bf16_f32 v144, v160, v161
 v_cvt_pk_bf16_f32 v145, v162, v163
 v_cvt_pk_bf16_f32 v146, v164, v165
 v_cvt_pk_bf16_f32 v147, v166, v167
 buffer_store_dwordx4 v[144:147], v134, s[96:99], 0 offen offset:0 sc1
 v_cvt_pk_bf16_f32 v148, v168, v169
 v_cvt_pk_bf16_f32 v149, v170, v171
 v_cvt_pk_bf16_f32 v150, v172, v173
 v_cvt_pk_bf16_f32 v151, v174, v175
 buffer_store_dwordx4 v[148:151], v134, s[96:99], 0 offen offset:2048 sc1
 v_cvt_pk_bf16_f32 v152, v176, v177
 v_cvt_pk_bf16_f32 v153, v178, v179
 v_cvt_pk_bf16_f32 v154, v180, v181
 v_cvt_pk_bf16_f32 v155, v182, v183
 buffer_store_dwordx4 v[152:155], v136, s[96:99], 0 offen offset:0 sc1
 v_cvt_pk_bf16_f32 v156, v184, v185
 v_cvt_pk_bf16_f32 v157, v186, v187
 v_cvt_pk_bf16_f32 v158, v188, v189
 v_cvt_pk_bf16_f32 v159, v190, v191
 buffer_store_dwordx4 v[156:159], v136, s[96:99], 0 offen offset:2048 sc1
 buffer_store_dword v143, v132, s[96:99], s54 offen sc1
 buffer_load_dwordx2 v[200:201], v197, s[4:7], 0 offen sc1
 s_waitcnt vmcnt(8)
 buffer_store_dwordx4 v[208:211], v198, s[96:99], s51 offen sc1
 buffer_load_dwordx4 a[96:99], v6, s[88:91], s49 offen
 buffer_load_dwordx4 a[100:103], v6, s[88:91], s49 offen offset:1024
 s_mov_b32 s84, s76
 s_mov_b32 s85, s77
 s_mov_b32 s86, 7340032
 s_mov_b32 s87, 0x20000
 buffer_load_dwordx4 a[104:107], v30, s[84:87], 0 offen
 s_and_b32 s11, s2, 7
 s_lshr_b32 s28, s2, 3
 s_and_b32 s29, s11, 1
 s_xor_b32 s29, s29, 1
 s_lshl_b32 s29, s29, 3
 s_and_b32 s30, s28, 7
 s_add_u32 s29, s29, s30
 s_lshr_b32 s30, s11, 1
 s_lshl_b32 s30, s30, 2
 s_lshr_b32 s31, s28, 3
 s_add_u32 s30, s30, s31
 s_lshl_b32 s35, s30, 7
 s_sub_u32 s39, s35, 1024
 s_subb_u32 s43, 0, 0
 s_add_u32 s20, s66, s39
 s_addc_u32 s21, s67, s43
 s_sub_u32 s22, 6292480, s35
 s_mov_b32 s23, 0x20000
 v_lshrrev_b32 v14, 5, v0
 v_lshlrev_b32 v14, 3, v14
 v_bfe_u32 v15, v0, 3, 2
 v_add_u32 v14, v14, v15
 v_bfe_u32 v15, v0, 4, 2
 v_lshlrev_b32 v15, 1, v15
 v_and_b32 v16, 7, v0
 v_xor_b32 v15, v15, v16
 v_lshlrev_b32 v15, 4, v15
 s_mul_i32 s32, s10, 98304
 v_mul_u32_u24 v11, 6144, v14
 v_add3_u32 v11, v11, v15, s32
 v_add_u32 v10, 1024, v11
 v_add_u32 v11, 24576, v11
 v_add_u32 v12, 4096, v10
 v_add_u32 v13, 4096, v11
 s_mul_i32 s38, s10, 6144
 s_lshr_b32 s34, s30, 3
 s_mul_i32 s34, s34, 393216
 s_add_u32 s34, s34, 0x22ffc00
 s_add_u32 s12, s82, s34
 s_addc_u32 s13, s83, 0
 s_movk_i32 s33, 6144
 s_mov_b32 s32, 98304
 s_and_b32 s31, s30, 7
 s_cmp_eq_u32 s31, 3
 s_cselect_b32 s32, s33, s32
 s_cselect_b32 s33, 128, s33
 s_cselect_b32 s12, s12, s20
 s_cselect_b32 s13, s13, s21
 s_mov_b32 s14, s22
 s_mov_b32 s15, 0x20000
 s_lshl_b32 s41, s32, 2
 s_mul_i32 s32, s32, s10
 v_mul_u32_u24 v3, s33, v14
 v_add3_u32 v3, v3, v15, s32
 v_add_u32 v2, 1024, v3
 s_lshl_b32 s32, s33, 2
 v_add_u32 v3, s32, v3
 v_add_u32 v4, 4096, v2
 v_add_u32 v5, 4096, v3
 v_add_u32 v7, 0x8000, v6
 s_lshl_b32 s36, s29, 3
 s_lshl_b32 s37, s10, 1
 s_add_u32 s36, s36, s37
 s_lshl_b32 s37, s36, 15
 s_lshl_b32 s33, s29, 18
 s_sub_u32 s34, s33, 0x8000
 s_cmp_eq_u32 s29, 0
 s_cselect_b32 s34, 0, s34
 s_cselect_b32 s26, 0, 0x8000
 s_lshl_b32 s47, s10, 10
 v_add_u32 v8, s47, v6
 s_add_u32 s16, s82, s37
 s_addc_u32 s17, s83, 0
 s_mov_b32 s18, 65536
 s_mov_b32 s19, 0x20000
 s_add_u32 s24, s82, s34
 s_addc_u32 s25, s83, 0
 s_mov_b32 s27, 0x20000
 v_lshrrev_b32 v14, 5, v0
 v_mul_u32_u24 v14, 6144, v14
 v_bfe_u32 v15, v0, 2, 3
 v_lshl_add_u32 v14, v15, 7, v14
 v_and_b32 v15, 3, v0
 v_lshl_add_u32 v14, v15, 3, v14
 v_bfe_u32 v15, v0, 3, 2
 v_xor_b32 v15, s10, v15
 v_add_u32 v24, 122880, v6
 v_xor_b32 v25, 0, v15
 v_lshl_add_u32 v16, v25, 5, v14
 v_add_u32 v20, 0x10000, v16
 v_xor_b32 v25, 1, v15
 v_lshl_add_u32 v17, v25, 5, v14
 v_add_u32 v21, 0x10000, v17
 v_xor_b32 v25, 2, v15
 v_lshl_add_u32 v18, v25, 5, v14
 v_add_u32 v22, 0x10000, v18
 v_xor_b32 v25, 3, v15
 v_lshl_add_u32 v19, v25, 5, v14
 v_add_u32 v23, 0x10000, v19
 s_and_b32 s57, s10, 1
 s_lshl_b32 s57, s57, 8
 s_add_u32 s57, s57, s2
 s_lshl_b32 s57, s57, 6
 v_add_u32 v9, s57, v0
 v_lshlrev_b32 v9, 7, v9
 s_getpc_b64 s[60:61]
pc_p1:
 s_lshr_b32 s62, s2, 3
 s_lshl_b32 s62, s62, 2
 s_add_u32 s62, s62, s10
 s_lshl_b32 s62, s62, 9
 s_add_u32 s62, s62, 12288
 s_min_u32 s62, s62, L_done-pc_p1-512
 s_branch m_ps_p0_2
m_pad_p0_2:
 s_branch m_ret_p0
m_ps_p0_2:
 v_and_b32 v26, 3, v0
 v_lshl_add_u32 v26, v26, 7, s62
 v_add_co_u32 v26, vcc, s60, v26
 v_mov_b32 v27, s61
 s_nop 0
 v_addc_co_u32 v27, vcc, 0, v27, vcc
 s_lshl_b32 s59, s29, 11
 s_sub_u32 s59, s59, 256
 s_lshl_b32 s56, s10, 13
 v_lshl_add_u32 v29, v0, 7, s56
 s_cmp_eq_u32 s31, 3
 s_cselect_b32 s3, 0, 0x40000000
 s_add_u32 s60, s82, 0x2080000
 s_addc_u32 s61, s83, 0
 s_mov_b32 s62, 262144
 s_mov_b32 s63, 0x20000
 v_cmp_eq_u32 vcc, 0, v0
 v_mov_b32 v129, 0x40000000
 s_nop 0
 v_cndmask_b32 v129, v129, 0, vcc
 s_cmp_eq_u32 s10, 1
 s_cbranch_scc1 m_pad_p1_0
 s_cmp_eq_u32 s10, 2
 s_cbranch_scc1 m_pad_p1_1
 s_cmp_eq_u32 s10, 3
 s_cbranch_scc1 m_pad_p1_2
 s_branch m_pad_p1_3
m_reta_p1:
 s_waitcnt vmcnt(3)
 s_barrier
 s_mov_b32 s57, 0
L_tag:
 v_readfirstlane_b32 s8, v200
 v_readfirstlane_b32 s9, v201
 s_add_u32 s57, s57, 1
 s_cmp_lg_u32 s8, 0
 s_cbranch_scc1 L_tagok
 s_cmp_gt_u32 s57, 0x40000
 s_cbranch_scc1 L_tagok
 buffer_load_dwordx2 v[200:201], v197, s[4:7], 0 offen sc1
 s_waitcnt vmcnt(0)
 s_branch L_tag
L_tagok:
 s_cmp_lg_u32 s10, 0
 s_cbranch_scc1 L_pub_p1
 v_mov_b32 v130, s8
 v_mov_b32 v131, s9
 buffer_store_dwordx2 v[130:131], v129, s[60:63], s58 offen sc1
L_pub_p1:
 s_mov_b32 s40, 0
 s_add_u32 m0, s38, 0
 s_nop 0
 buffer_load_dwordx4 v10, s[20:23], s40 offen offset:0 sc1 lds
 buffer_load_dwordx4 v11, s[20:23], s40 offen offset:1024 sc1 lds
 buffer_load_dwordx4 v10, s[20:23], s40 offen offset:2048 sc1 lds
 buffer_load_dwordx4 v11, s[20:23], s40 offen offset:3072 sc1 lds
 s_add_u32 m0, s38, 4096
 s_nop 0
 buffer_load_dwordx4 v12, s[20:23], s40 offen offset:0 sc1 lds
 buffer_load_dwordx4 v13, s[20:23], s40 offen offset:1024 sc1 lds
 s_mov_b32 s40, 393216
 s_add_u32 m0, s38, 24576
 s_nop 0
 buffer_load_dwordx4 v10, s[20:23], s40 offen offset:0 sc1 lds
 buffer_load_dwordx4 v11, s[20:23], s40 offen offset:1024 sc1 lds
 buffer_load_dwordx4 v10, s[20:23], s40 offen offset:2048 sc1 lds
 buffer_load_dwordx4 v11, s[20:23], s40 offen offset:3072 sc1 lds
 s_add_u32 m0, s38, 28672
 s_nop 0
 buffer_load_dwordx4 v12, s[20:23], s40 offen offset:0 sc1 lds
 buffer_load_dwordx4 v13, s[20:23], s40 offen offset:1024 sc1 lds
 s_mov_b32 s40, 786432
 s_add_u32 m0, s38, 49152
 s_nop 0
 buffer_load_dwordx4 v10, s[20:23], s40 offen offset:0 sc1 lds
 buffer_load_dwordx4 v11, s[20:23], s40 offen offset:1024 sc1 lds
 buffer_load_dwordx4 v10, s[20:23], s40 offen offset:2048 sc1 lds
 buffer_load_dwordx4 v11, s[20:23], s40 offen offset:3072 sc1 lds
 s_add_u32 m0, s38, 53248
 s_nop 0
 buffer_load_dwordx4 v12, s[20:23], s40 offen offset:0 sc1 lds
 buffer_load_dwordx4 v13, s[20:23], s40 offen offset:1024 sc1 lds
 s_add_u32 s60, s82, 0x2080000
 s_addc_u32 s61, s83, 0
 s_mov_b32 s62, 262144
 s_mov_b32 s63, 0x20000
 s_cmp_lg_u32 s10, 0
 s_cbranch_scc1 L_warm_p1
 v_min_u32 v128, 17, v0
 v_lshlrev_b32 v128, 7, v128
 v_add_u32 v128, s59, v128
 v_max_i32 v128, 0, v128
 s_mov_b32 s57, 0
L_poll_p1:
 buffer_load_dwordx2 v[130:131], v128, s[60:63], 0 offen sc1
 s_waitcnt vmcnt(0)
 v_cmp_ne_u64 vcc, s[8:9], v[130:131]
 s_add_u32 s57, s57, 1
 s_cbranch_vccz L_go_p1
 s_sleep 1
 s_cmp_gt_u32 s57, 0x40000
 s_cbranch_scc0 L_poll_p1
 s_branch L_go_p1
L_warm_p1:
 s_cmp_eq_u32 s10, 1
 s_cbranch_scc1 m_pad_p1_4
 s_cmp_eq_u32 s10, 2
 s_cbranch_scc1 m_ret_p1
 s_branch m_ret_p1
m_ret_p1:
 s_waitcnt vmcnt(0)
L_go_p1:
 s_barrier
 s_mov_b32 s46, 0
 s_add_u32 m0, s47, 122880
 s_nop 0
 buffer_load_dwordx4 v8, s[24:27], s46 offen sc1 lds
 s_mov_b32 s42, 0
 buffer_load_dwordx4 a[0:3], v6, s[16:19], s42 offen offset:0 sc1
 buffer_load_dwordx4 a[4:7], v7, s[16:19], s42 offen offset:0 sc1
 buffer_load_dwordx4 a[8:11], v6, s[16:19], s42 offen offset:1024 sc1
 buffer_load_dwordx4 a[12:15], v7, s[16:19], s42 offen offset:1024 sc1
 buffer_load_dwordx4 a[16:19], v6, s[16:19], s42 offen offset:2048 sc1
 buffer_load_dwordx4 a[20:23], v7, s[16:19], s42 offen offset:2048 sc1
 s_waitcnt vmcnt(6)
 s_barrier
 ds_read_b64_tr_b16 v[136:137], v16 offset:0
 ds_read_b64_tr_b16 v[138:139], v16 offset:1024
 ds_read_b64_tr_b16 v[140:141], v17 offset:0
 ds_read_b64_tr_b16 v[142:143], v17 offset:1024
 ds_read_b64_tr_b16 v[144:145], v18 offset:0
 ds_read_b64_tr_b16 v[146:147], v18 offset:1024
 ds_read_b64_tr_b16 v[148:149], v19 offset:0
 ds_read_b64_tr_b16 v[150:151], v19 offset:1024
 ds_read_b64_tr_b16 v[152:153], v16 offset:2048
 ds_read_b64_tr_b16 v[154:155], v16 offset:3072
 ds_read_b64_tr_b16 v[156:157], v17 offset:2048
 ds_read_b64_tr_b16 v[158:159], v17 offset:3072
 ds_read_b128 v[168:171], v24
 s_waitcnt vmcnt(4) lgkmcnt(9)
 v_mfma_f32_16x16x32_bf16 v[32:35], v[136:139], a[0:3], 0
 ds_read_b64_tr_b16 v[160:161], v18 offset:2048
 ds_read_b64_tr_b16 v[162:163], v18 offset:3072
 v_mfma_f32_16x16x32_bf16 v[36:39], v[136:139], a[4:7], 0
 buffer_load_dwordx4 a[24:27], v6, s[16:19], s42 offen offset:3072 sc1
 v_mfma_f32_16x16x32_bf16 v[44:47], v[140:143], a[4:7], 0
 ds_read_b64_tr_b16 v[164:165], v19 offset:2048
 ds_read_b64_tr_b16 v[166:167], v19 offset:3072
 v_mfma_f32_16x16x32_bf16 v[40:43], v[140:143], a[0:3], 0
 s_waitcnt lgkmcnt(9)
 v_mfma_f32_16x16x32_bf16 v[48:51], v[144:147], a[0:3], 0
 ds_read_b64_tr_b16 v[136:137], v16 offset:4096
 ds_read_b64_tr_b16 v[138:139], v16 offset:5120
 v_mfma_f32_16x16x32_bf16 v[52:55], v[144:147], a[4:7], 0
 buffer_load_dwordx4 a[28:31], v7, s[16:19], s42 offen offset:3072 sc1
 s_mov_b32 s46, 4096
 s_add_u32 m0, s47, 126976
 v_mfma_f32_16x16x32_bf16 v[60:63], v[148:151], a[4:7], 0
 ds_read_b64_tr_b16 v[140:141], v17 offset:4096
 ds_read_b64_tr_b16 v[142:143], v17 offset:5120
 v_mfma_f32_16x16x32_bf16 v[56:59], v[148:151], a[0:3], 0
 buffer_load_dwordx4 v8, s[24:27], s46 offen sc1 lds
 s_waitcnt lgkmcnt(8)
 v_mfma_f32_16x16x32_bf16 v[64:67], v[152:155], a[0:3], 0
 ds_read_b64_tr_b16 v[144:145], v18 offset:4096
 ds_read_b64_tr_b16 v[146:147], v18 offset:5120
 v_mfma_f32_16x16x32_bf16 v[128:131], v[152:155], v[168:171], 0
 s_mov_b32 s42, 4096
 v_mfma_f32_16x16x32_bf16 v[68:71], v[152:155], a[4:7], 0
 buffer_load_dwordx4 a[32:35], v6, s[16:19], s42 offen offset:0 sc1
 v_mfma_f32_16x16x32_bf16 v[76:79], v[156:159], a[4:7], 0
 ds_read_b64_tr_b16 v[148:149], v19 offset:4096
 ds_read_b64_tr_b16 v[150:151], v19 offset:5120
 v_mfma_f32_16x16x32_bf16 v[72:75], v[156:159], a[0:3], 0
 s_waitcnt lgkmcnt(8)
 v_mfma_f32_16x16x32_bf16 v[80:83], v[160:163], a[0:3], 0
 ds_read_b64_tr_b16 v[152:153], v16 offset:12288
 ds_read_b64_tr_b16 v[154:155], v16 offset:13312
 v_mfma_f32_16x16x32_bf16 v[84:87], v[160:163], a[4:7], 0
 buffer_load_dwordx2 v[196:197], v29, s[60:63], s3 offen sc1
 v_mfma_f32_16x16x32_bf16 v[92:95], v[164:167], a[4:7], 0
 ds_read_b64_tr_b16 v[156:157], v17 offset:12288
 ds_read_b64_tr_b16 v[158:159], v17 offset:13312
 v_mfma_f32_16x16x32_bf16 v[88:91], v[164:167], a[0:3], 0
 buffer_load_dwordx4 a[36:39], v7, s[16:19], s42 offen offset:0 sc1
 s_waitcnt lgkmcnt(8)
 v_mfma_f32_16x16x32_bf16 v[96:99], a[0:3], v[136:139], 0
 ds_read_b64_tr_b16 v[160:161], v18 offset:12288
 ds_read_b64_tr_b16 v[162:163], v18 offset:13312
 v_mfma_f32_16x16x32_bf16 v[132:135], v[168:171], v[136:139], 0
 v_mfma_f32_16x16x32_bf16 v[100:103], a[4:7], v[136:139], 0
 ds_read_b128 v[172:175], v24 offset:1024
 buffer_load_dwordx4 a[40:43], v6, s[16:19], s42 offen offset:1024 sc1
 v_mfma_f32_16x16x32_bf16 v[108:111], a[4:7], v[140:143], 0
 ds_read_b64_tr_b16 v[164:165], v19 offset:12288
 ds_read_b64_tr_b16 v[166:167], v19 offset:13312
 v_mfma_f32_16x16x32_bf16 v[104:107], a[0:3], v[140:143], 0
 s_waitcnt lgkmcnt(9)
 v_mfma_f32_16x16x32_bf16 v[112:115], a[0:3], v[144:147], 0
 ds_read_b64_tr_b16 v[136:137], v16 offset:14336
 ds_read_b64_tr_b16 v[138:139], v16 offset:15360
 v_mfma_f32_16x16x32_bf16 v[116:119], a[4:7], v[144:147], 0
 buffer_load_dwordx4 a[44:47], v7, s[16:19], s42 offen offset:1024 sc1
 s_mov_b32 s40, 1179648
 s_add_u32 m0, s38, 73728
 v_mfma_f32_16x16x32_bf16 v[124:127], a[4:7], v[148:151], 0
 ds_read_b64_tr_b16 v[140:141], v17 offset:14336
 ds_read_b64_tr_b16 v[142:143], v17 offset:15360
 v_mfma_f32_16x16x32_bf16 v[120:123], a[0:3], v[148:151], 0
 buffer_load_dwordx4 v10, s[20:23], s40 offen offset:0 sc1 lds
 s_waitcnt vmcnt(11) lgkmcnt(9)
 v_mfma_f32_16x16x32_bf16 v[32:35], v[152:155], a[8:11], v[32:35]
 ds_read_b64_tr_b16 v[144:145], v18 offset:14336
 ds_read_b64_tr_b16 v[146:147], v18 offset:15360
 v_mfma_f32_16x16x32_bf16 v[36:39], v[152:155], a[12:15], v[36:39]
 s_mov_b32 s88, s82
 s_mov_b32 s89, s83
 s_mov_b32 s90, 50331648
 s_mov_b32 s91, 0x20000
 v_mfma_f32_16x16x32_bf16 v[44:47], v[156:159], a[12:15], v[44:47]
 ds_read_b64_tr_b16 v[148:149], v19 offset:14336
 ds_read_b64_tr_b16 v[150:151], v19 offset:15360
 s_branch m_ps_p1_0
m_pad_p1_0:
 s_branch m_reta_p1
m_ps_p1_0:
 v_mfma_f32_16x16x32_bf16 v[40:43], v[156:159], a[8:11], v[40:43]
 buffer_load_dwordx4 v11, s[20:23], s40 offen offset:1024 sc1 lds
 s_waitcnt lgkmcnt(8)
 v_mfma_f32_16x16x32_bf16 v[48:51], v[160:163], a[8:11], v[48:51]
 ds_read_b64_tr_b16 v[152:153], v16 offset:16384
 ds_read_b64_tr_b16 v[154:155], v16 offset:17408
 v_mfma_f32_16x16x32_bf16 v[52:55], v[160:163], a[12:15], v[52:55]
 v_mfma_f32_16x16x32_bf16 v[60:63], v[164:167], a[12:15], v[60:63]
 ds_read_b64_tr_b16 v[156:157], v17 offset:16384
 ds_read_b64_tr_b16 v[158:159], v17 offset:17408
 v_mfma_f32_16x16x32_bf16 v[56:59], v[164:167], a[8:11], v[56:59]
 buffer_load_dwordx4 v10, s[20:23], s40 offen offset:2048 sc1 lds
 s_waitcnt lgkmcnt(8)
 v_mfma_f32_16x16x32_bf16 v[64:67], v[136:139], a[8:11], v[64:67]
 ds_read_b64_tr_b16 v[160:161], v18 offset:16384
 ds_read_b64_tr_b16 v[162:163], v18 offset:17408
 v_mfma_f32_16x16x32_bf16 v[128:131], v[136:139], v[172:175], v[128:131]
 v_mfma_f32_16x16x32_bf16 v[68:71], v[136:139], a[12:15], v[68:71]
 v_mfma_f32_16x16x32_bf16 v[76:79], v[140:143], a[12:15], v[76:79]
 ds_read_b64_tr_b16 v[164:165], v19 offset:16384
 ds_read_b64_tr_b16 v[166:167], v19 offset:17408
 v_mfma_f32_16x16x32_bf16 v[72:75], v[140:143], a[8:11], v[72:75]
 buffer_load_dwordx4 v11, s[20:23], s40 offen offset:3072 sc1 lds
 s_waitcnt lgkmcnt(8)
 v_mfma_f32_16x16x32_bf16 v[80:83], v[144:147], a[8:11], v[80:83]
 ds_read_b64_tr_b16 v[136:137], v16 offset:24576
 ds_read_b64_tr_b16 v[138:139], v16 offset:25600
 v_mfma_f32_16x16x32_bf16 v[84:87], v[144:147], a[12:15], v[84:87]
 s_add_u32 m0, s38, 77824
 v_mfma_f32_16x16x32_bf16 v[92:95], v[148:151], a[12:15], v[92:95]
 ds_read_b64_tr_b16 v[140:141], v17 offset:24576
 ds_read_b64_tr_b16 v[142:143], v17 offset:25600
 v_mfma_f32_16x16x32_bf16 v[88:91], v[148:151], a[8:11], v[88:91]
 buffer_load_dwordx4 v12, s[20:23], s40 offen offset:0 sc1 lds
 s_waitcnt lgkmcnt(8)
 v_mfma_f32_16x16x32_bf16 v[96:99], a[8:11], v[152:155], v[96:99]
 ds_read_b64_tr_b16 v[144:145], v18 offset:24576
 ds_read_b64_tr_b16 v[146:147], v18 offset:25600
 v_mfma_f32_16x16x32_bf16 v[132:135], v[172:175], v[152:155], v[132:135]
 v_mfma_f32_16x16x32_bf16 v[100:103], a[12:15], v[152:155], v[100:103]
 ds_read_b128 v[168:171], v24 offset:2048
 v_mfma_f32_16x16x32_bf16 v[108:111], a[12:15], v[156:159], v[108:111]
 ds_read_b64_tr_b16 v[148:149], v19 offset:24576
 ds_read_b64_tr_b16 v[150:151], v19 offset:25600
 v_mfma_f32_16x16x32_bf16 v[104:107], a[8:11], v[156:159], v[104:107]
 buffer_load_dwordx4 v13, s[20:23], s40 offen offset:1024 sc1 lds
 s_waitcnt lgkmcnt(9)
 v_mfma_f32_16x16x32_bf16 v[112:115], a[8:11], v[160:163], v[112:115]
 ds_read_b64_tr_b16 v[152:153], v16 offset:26624
 ds_read_b64_tr_b16 v[154:155], v16 offset:27648
 v_mfma_f32_16x16x32_bf16 v[116:119], a[12:15], v[160:163], v[116:119]
 v_mfma_f32_16x16x32_bf16 v[124:127], a[12:15], v[164:167], v[124:127]
 ds_read_b64_tr_b16 v[156:157], v17 offset:26624
 ds_read_b64_tr_b16 v[158:159], v17 offset:27648
 v_mfma_f32_16x16x32_bf16 v[120:123], a[8:11], v[164:167], v[120:123]
 buffer_load_dwordx4 a[48:51], v6, s[16:19], s42 offen offset:2048 sc1
 s_waitcnt vmcnt(15) lgkmcnt(9)
 v_mfma_f32_16x16x32_bf16 v[32:35], v[136:139], a[16:19], v[32:35]
 ds_read_b64_tr_b16 v[160:161], v18 offset:26624
 ds_read_b64_tr_b16 v[162:163], v18 offset:27648
 v_mfma_f32_16x16x32_bf16 v[36:39], v[136:139], a[20:23], v[36:39]
 v_mfma_f32_16x16x32_bf16 v[44:47], v[140:143], a[20:23], v[44:47]
 ds_read_b64_tr_b16 v[164:165], v19 offset:26624
 ds_read_b64_tr_b16 v[166:167], v19 offset:27648
 v_mfma_f32_16x16x32_bf16 v[40:43], v[140:143], a[16:19], v[40:43]
 buffer_load_dwordx4 a[52:55], v7, s[16:19], s42 offen offset:2048 sc1
 s_waitcnt lgkmcnt(8)
 v_mfma_f32_16x16x32_bf16 v[48:51], v[144:147], a[16:19], v[48:51]
 ds_read_b64_tr_b16 v[136:137], v16 offset:28672
 ds_read_b64_tr_b16 v[138:139], v16 offset:29696
 v_mfma_f32_16x16x32_bf16 v[52:55], v[144:147], a[20:23], v[52:55]
 v_mfma_f32_16x16x32_bf16 v[60:63], v[148:151], a[20:23], v[60:63]
 ds_read_b64_tr_b16 v[140:141], v17 offset:28672
 ds_read_b64_tr_b16 v[142:143], v17 offset:29696
 v_mfma_f32_16x16x32_bf16 v[56:59], v[148:151], a[16:19], v[56:59]
 buffer_load_dwordx4 a[56:59], v6, s[16:19], s42 offen offset:3072 sc1
 s_waitcnt lgkmcnt(8)
 v_mfma_f32_16x16x32_bf16 v[64:67], v[152:155], a[16:19], v[64:67]
 ds_read_b64_tr_b16 v[144:145], v18 offset:28672
 ds_read_b64_tr_b16 v[146:147], v18 offset:29696
 v_mfma_f32_16x16x32_bf16 v[128:131], v[152:155], v[168:171], v[128:131]
 v_mfma_f32_16x16x32_bf16 v[68:71], v[152:155], a[20:23], v[68:71]
 v_mfma_f32_16x16x32_bf16 v[76:79], v[156:159], a[20:23], v[76:79]
 ds_read_b64_tr_b16 v[148:149], v19 offset:28672
 ds_read_b64_tr_b16 v[150:151], v19 offset:29696
 v_mfma_f32_16x16x32_bf16 v[72:75], v[156:159], a[16:19], v[72:75]
 buffer_load_dwordx4 a[60:63], v7, s[16:19], s42 offen offset:3072 sc1
 s_waitcnt lgkmcnt(8)
 v_mfma_f32_16x16x32_bf16 v[80:83], v[160:163], a[16:19], v[80:83]
 ds_read_b64_tr_b16 v[152:153], v16 offset:36864
 ds_read_b64_tr_b16 v[154:155], v16 offset:37888
 v_mfma_f32_16x16x32_bf16 v[84:87], v[160:163], a[20:23], v[84:87]
 s_mov_b32 s46, 8192
 s_add_u32 m0, s47, 131072
 v_mfma_f32_16x16x32_bf16 v[92:95], v[164:167], a[20:23], v[92:95]
 ds_read_b64_tr_b16 v[156:157], v17 offset:36864
 ds_read_b64_tr_b16 v[158:159], v17 offset:37888
 v_mfma_f32_16x16x32_bf16 v[88:91], v[164:167], a[16:19], v[88:91]
 buffer_load_dwordx4 v8, s[24:27], s46 offen sc1 lds
 s_waitcnt lgkmcnt(8)
 v_mfma_f32_16x16x32_bf16 v[96:99], a[16:19], v[136:139], v[96:99]
 ds_read_b64_tr_b16 v[160:161], v18 offset:36864
 ds_read_b64_tr_b16 v[162:163], v18 offset:37888
 v_mfma_f32_16x16x32_bf16 v[132:135], v[168:171], v[136:139], v[132:135]
 s_mov_b32 s40, 1572864
 s_add_u32 m0, s38, 98304
 v_mfma_f32_16x16x32_bf16 v[100:103], a[20:23], v[136:139], v[100:103]
 ds_read_b128 v[172:175], v24 offset:3072
 v_mfma_f32_16x16x32_bf16 v[108:111], a[20:23], v[140:143], v[108:111]
 ds_read_b64_tr_b16 v[164:165], v19 offset:36864
 ds_read_b64_tr_b16 v[166:167], v19 offset:37888
 v_mfma_f32_16x16x32_bf16 v[104:107], a[16:19], v[140:143], v[104:107]
 buffer_load_dwordx4 v10, s[20:23], s40 offen offset:0 sc1 lds
 s_waitcnt lgkmcnt(9)
 v_mfma_f32_16x16x32_bf16 v[112:115], a[16:19], v[144:147], v[112:115]
 ds_read_b64_tr_b16 v[136:137], v16 offset:38912
 ds_read_b64_tr_b16 v[138:139], v16 offset:39936
 v_mfma_f32_16x16x32_bf16 v[116:119], a[20:23], v[144:147], v[116:119]
 v_mfma_f32_16x16x32_bf16 v[124:127], a[20:23], v[148:151], v[124:127]
 ds_read_b64_tr_b16 v[140:141], v17 offset:38912
 ds_read_b64_tr_b16 v[142:143], v17 offset:39936
 v_mfma_f32_16x16x32_bf16 v[120:123], a[16:19], v[148:151], v[120:123]
 buffer_load_dwordx4 v11, s[20:23], s40 offen offset:1024 sc1 lds
 s_waitcnt vmcnt(19) lgkmcnt(9)
 v_mfma_f32_16x16x32_bf16 v[32:35], v[152:155], a[24:27], v[32:35]
 ds_read_b64_tr_b16 v[144:145], v18 offset:38912
 ds_read_b64_tr_b16 v[146:147], v18 offset:39936
 v_mfma_f32_16x16x32_bf16 v[36:39], v[152:155], a[28:31], v[36:39]
 s_mov_b32 s49, 0x2100000
 v_mfma_f32_16x16x32_bf16 v[44:47], v[156:159], a[28:31], v[44:47]
 ds_read_b64_tr_b16 v[148:149], v19 offset:38912
 ds_read_b64_tr_b16 v[150:151], v19 offset:39936
 v_mfma_f32_16x16x32_bf16 v[40:43], v[156:159], a[24:27], v[40:43]
 buffer_store_dwordx4 a[104:107], v31, s[88:91], s49 offen sc1
 s_waitcnt lgkmcnt(8)
 v_mfma_f32_16x16x32_bf16 v[48:51], v[160:163], a[24:27], v[48:51]
 ds_read_b64_tr_b16 v[152:153], v16 offset:40960
 ds_read_b64_tr_b16 v[154:155], v16 offset:41984
 v_mfma_f32_16x16x32_bf16 v[52:55], v[160:163], a[28:31], v[52:55]
 buffer_load_dwordx4 v10, s[20:23], s40 offen offset:2048 sc1 lds
 v_mfma_f32_16x16x32_bf16 v[60:63], v[164:167], a[28:31], v[60:63]
 ds_read_b64_tr_b16 v[156:157], v17 offset:40960
 ds_read_b64_tr_b16 v[158:159], v17 offset:41984
 v_mfma_f32_16x16x32_bf16 v[56:59], v[164:167], a[24:27], v[56:59]
 s_waitcnt lgkmcnt(8)
 v_mfma_f32_16x16x32_bf16 v[64:67], v[136:139], a[24:27], v[64:67]
 ds_read_b64_tr_b16 v[160:161], v18 offset:40960
 ds_read_b64_tr_b16 v[162:163], v18 offset:41984
 v_mfma_f32_16x16x32_bf16 v[128:131], v[136:139], v[172:175], v[128:131]
 buffer_load_dwordx4 v11, s[20:23], s40 offen offset:3072 sc1 lds
 v_mfma_f32_16x16x32_bf16 v[68:71], v[136:139], a[28:31], v[68:71]
 v_mfma_f32_16x16x32_bf16 v[76:79], v[140:143], a[28:31], v[76:79]
 ds_read_b64_tr_b16 v[164:165], v19 offset:40960
 ds_read_b64_tr_b16 v[166:167], v19 offset:41984
 v_mfma_f32_16x16x32_bf16 v[72:75], v[140:143], a[24:27], v[72:75]
 s_waitcnt vmcnt(19)
 s_cmp_lg_u32 s3, 0
 s_cbranch_scc1 L_ok_g0
 v_cmp_ne_u64 vcc, s[8:9], v[196:197]
 s_mov_b32 s57, 0
 s_cbranch_vccz L_ok_g0
L_re_g0:
 buffer_load_dwordx2 v[196:197], v29, s[60:63], s3 offen sc1
 s_add_u32 s57, s57, 1
 s_waitcnt vmcnt(0)
 v_cmp_ne_u64 vcc, s[8:9], v[196:197]
 s_cmp_gt_u32 s57, 0x40000
 s_cbranch_vccz L_ok_g0
 s_cbranch_scc0 L_re_g0
L_ok_g0:
 s_add_u32 m0, s38, 102400
 s_waitcnt lgkmcnt(8)
 v_mfma_f32_16x16x32_bf16 v[80:83], v[144:147], a[24:27], v[80:83]
 s_barrier
 ds_read_b64_tr_b16 v[136:137], v16 offset:49152
 v_mfma_f32_16x16x32_bf16 v[84:87], v[144:147], a[28:31], v[84:87]
 ds_read_b64_tr_b16 v[138:139], v16 offset:50176
 buffer_load_dwordx4 v12, s[20:23], s40 offen offset:0 sc1 lds
 v_mfma_f32_16x16x32_bf16 v[92:95], v[148:151], a[28:31], v[92:95]
 ds_read_b64_tr_b16 v[140:141], v17 offset:49152
 ds_read_b64_tr_b16 v[142:143], v17 offset:50176
 v_mfma_f32_16x16x32_bf16 v[88:91], v[148:151], a[24:27], v[88:91]
 s_waitcnt lgkmcnt(8)
 v_mfma_f32_16x16x32_bf16 v[96:99], a[24:27], v[152:155], v[96:99]
 ds_read_b64_tr_b16 v[144:145], v18 offset:49152
 ds_read_b64_tr_b16 v[146:147], v18 offset:50176
 v_mfma_f32_16x16x32_bf16 v[132:135], v[172:175], v[152:155], v[132:135]
 buffer_load_dwordx4 v13, s[20:23], s40 offen offset:1024 sc1 lds
 v_mfma_f32_16x16x32_bf16 v[100:103], a[28:31], v[152:155], v[100:103]
 ds_read_b128 v[168:171], v24 offset:4096
 v_mfma_f32_16x16x32_bf16 v[108:111], a[28:31], v[156:159], v[108:111]
 ds_read_b64_tr_b16 v[148:149], v19 offset:49152
 ds_read_b64_tr_b16 v[150:151], v19 offset:50176
 v_mfma_f32_16x16x32_bf16 v[104:107], a[24:27], v[156:159], v[104:107]
 s_mov_b32 s42, 8192
 s_waitcnt lgkmcnt(9)
 v_mfma_f32_16x16x32_bf16 v[112:115], a[24:27], v[160:163], v[112:115]
 ds_read_b64_tr_b16 v[152:153], v16 offset:51200
 ds_read_b64_tr_b16 v[154:155], v16 offset:52224
 v_mfma_f32_16x16x32_bf16 v[116:119], a[28:31], v[160:163], v[116:119]
 buffer_load_dwordx4 a[64:67], v6, s[16:19], s42 offen offset:0 sc1
 v_mfma_f32_16x16x32_bf16 v[124:127], a[28:31], v[164:167], v[124:127]
 ds_read_b64_tr_b16 v[156:157], v17 offset:51200
 ds_read_b64_tr_b16 v[158:159], v17 offset:52224
 v_mfma_f32_16x16x32_bf16 v[120:123], a[24:27], v[164:167], v[120:123]
 s_waitcnt vmcnt(21) lgkmcnt(9)
 v_mfma_f32_16x16x32_bf16 v[32:35], v[136:139], a[32:35], v[32:35]
 ds_read_b64_tr_b16 v[160:161], v18 offset:51200
 ds_read_b64_tr_b16 v[162:163], v18 offset:52224
 buffer_load_dwordx4 a[68:71], v7, s[16:19], s42 offen offset:0 sc1
 v_mfma_f32_16x16x32_bf16 v[36:39], v[136:139], a[36:39], v[36:39]
 s_cmp_ge_u32 s10, 2
 s_cselect_b32 s92, s74, s72
 s_cselect_b32 s93, s75, s73
 s_mov_b32 s94, 7340032
 s_mov_b32 s95, 0x20000
 v_mfma_f32_16x16x32_bf16 v[44:47], v[140:143], a[36:39], v[44:47]
 ds_read_b64_tr_b16 v[164:165], v19 offset:51200
 ds_read_b64_tr_b16 v[166:167], v19 offset:52224
 v_mfma_f32_16x16x32_bf16 v[40:43], v[140:143], a[32:35], v[40:43]
 s_waitcnt lgkmcnt(8)
 v_mfma_f32_16x16x32_bf16 v[48:51], v[144:147], a[32:35], v[48:51]
 ds_read_b64_tr_b16 v[136:137], v16 offset:53248
 ds_read_b64_tr_b16 v[138:139], v16 offset:54272
 v_mfma_f32_16x16x32_bf16 v[52:55], v[144:147], a[36:39], v[52:55]
 buffer_load_dwordx4 a[72:75], v6, s[16:19], s42 offen offset:1024 sc1
 v_accvgpr_read_b32 v177, a96
 v_mfma_f32_16x16x32_bf16 v[60:63], v[148:151], a[36:39], v[60:63]
 ds_read_b64_tr_b16 v[140:141], v17 offset:53248
 ds_read_b64_tr_b16 v[142:143], v17 offset:54272
 v_lshlrev_b32 v176, 16, v177
 v_mfma_f32_16x16x32_bf16 v[56:59], v[148:151], a[32:35], v[56:59]
 v_and_b32 v177, 0xffff0000, v177
 s_waitcnt lgkmcnt(8)
 v_mfma_f32_16x16x32_bf16 v[64:67], v[152:155], a[32:35], v[64:67]
 ds_read_b64_tr_b16 v[144:145], v18 offset:53248
 ds_read_b64_tr_b16 v[146:147], v18 offset:54272
 v_accvgpr_read_b32 v179, a97
 v_mfma_f32_16x16x32_bf16 v[128:131], v[152:155], v[168:171], v[128:131]
 buffer_load_dwordx4 a[76:79], v7, s[16:19], s42 offen offset:1024 sc1
 v_lshlrev_b32 v178, 16, v179
 v_mfma_f32_16x16x32_bf16 v[68:71], v[152:155], a[36:39], v[68:71]
 v_and_b32 v179, 0xffff0000, v179
 v_accvgpr_read_b32 v181, a98
 v_mfma_f32_16x16x32_bf16 v[76:79], v[156:159], a[36:39], v[76:79]
 ds_read_b64_tr_b16 v[148:149], v19 offset:53248
 ds_read_b64_tr_b16 v[150:151], v19 offset:54272
 s_add_u32 m0, s38, 0
 v_mfma_f32_16x16x32_bf16 v[72:75], v[156:159], a[32:35], v[72:75]
 s_mul_i32 s40, s41, 5
 s_waitcnt lgkmcnt(8)
 v_mfma_f32_16x16x32_bf16 v[80:83], v[160:163], a[32:35], v[80:83]
 ds_read_b64_tr_b16 v[152:153], v16 offset:61440
 ds_read_b64_tr_b16 v[154:155], v16 offset:62464
 v_lshlrev_b32 v180, 16, v181
 v_mfma_f32_16x16x32_bf16 v[84:87], v[160:163], a[36:39], v[84:87]
 buffer_load_dwordx4 v2, s[12:15], s40 offen offset:0 sc1 lds
 v_and_b32 v181, 0xffff0000, v181
 v_mfma_f32_16x16x32_bf16 v[92:95], v[164:167], a[36:39], v[92:95]
 ds_read_b64_tr_b16 v[156:157], v17 offset:61440
 ds_read_b64_tr_b16 v[158:159], v17 offset:62464
 v_mfma_f32_16x16x32_bf16 v[88:91], v[164:167], a[32:35], v[88:91]
 v_accvgpr_read_b32 v183, a99
 v_lshlrev_b32 v182, 16, v183
 s_waitcnt lgkmcnt(8)
 v_mfma_f32_16x16x32_bf16 v[96:99], a[32:35], v[136:139], v[96:99]
 ds_read_b64_tr_b16 v[160:161], v18 offset:61440
 ds_read_b64_tr_b16 v[162:163], v18 offset:62464
 v_mfma_f32_16x16x32_bf16 v[132:135], v[168:171], v[136:139], v[132:135]
 buffer_load_dwordx4 v3, s[12:15], s40 offen offset:1024 sc1 lds
 v_and_b32 v183, 0xffff0000, v183
 v_accvgpr_read_b32 v185, a100
 v_mfma_f32_16x16x32_bf16 v[100:103], a[36:39], v[136:139], v[100:103]
 ds_read_b128 v[172:175], v24 offset:5120
 v_lshlrev_b32 v184, 16, v185
 v_mfma_f32_16x16x32_bf16 v[108:111], a[36:39], v[140:143], v[108:111]
 ds_read_b64_tr_b16 v[164:165], v19 offset:61440
 ds_read_b64_tr_b16 v[166:167], v19 offset:62464
 v_mfma_f32_16x16x32_bf16 v[104:107], a[32:35], v[140:143], v[104:107]
 v_and_b32 v185, 0xffff0000, v185
 v_accvgpr_read_b32 v187, a101
 s_waitcnt lgkmcnt(9)
 v_mfma_f32_16x16x32_bf16 v[112:115], a[32:35], v[144:147], v[112:115]
 ds_read_b64_tr_b16 v[136:137], v16 offset:63488
 ds_read_b64_tr_b16 v[138:139], v16 offset:64512
 v_mfma_f32_16x16x32_bf16 v[116:119], a[36:39], v[144:147], v[116:119]
 buffer_load_dwordx4 v2, s[12:15], s40 offen offset:2048 sc1 lds
 v_lshlrev_b32 v186, 16, v187
 v_and_b32 v187, 0xffff0000, v187
 v_mfma_f32_16x16x32_bf16 v[124:127], a[36:39], v[148:151], v[124:127]
 ds_read_b64_tr_b16 v[140:141], v17 offset:63488
 ds_read_b64_tr_b16 v[142:143], v17 offset:64512
 v_mfma_f32_16x16x32_bf16 v[120:123], a[32:35], v[148:151], v[120:123]
 v_accvgpr_read_b32 v189, a102
 s_waitcnt vmcnt(25) lgkmcnt(9)
 v_mfma_f32_16x16x32_bf16 v[32:35], v[152:155], a[40:43], v[32:35]
 ds_read_b64_tr_b16 v[144:145], v18 offset:63488
 ds_read_b64_tr_b16 v[146:147], v18 offset:64512
 v_lshlrev_b32 v188, 16, v189
 v_mfma_f32_16x16x32_bf16 v[36:39], v[152:155], a[44:47], v[36:39]
 buffer_load_dwordx4 v3, s[12:15], s40 offen offset:3072 sc1 lds
 v_and_b32 v189, 0xffff0000, v189
 v_mfma_f32_16x16x32_bf16 v[44:47], v[156:159], a[44:47], v[44:47]
 ds_read_b64_tr_b16 v[148:149], v19 offset:63488
 ds_read_b64_tr_b16 v[150:151], v19 offset:64512
 v_accvgpr_read_b32 v191, a103
 v_mfma_f32_16x16x32_bf16 v[40:43], v[156:159], a[40:43], v[40:43]
 v_lshlrev_b32 v190, 16, v191
 s_waitcnt lgkmcnt(8)
 v_mfma_f32_16x16x32_bf16 v[48:51], v[160:163], a[40:43], v[48:51]
 ds_read_b64_tr_b16 v[152:153], v20 offset:0
 ds_read_b64_tr_b16 v[154:155], v20 offset:1024
 v_mfma_f32_16x16x32_bf16 v[52:55], v[160:163], a[44:47], v[52:55]
 s_add_u32 m0, s38, 4096
 v_and_b32 v191, 0xffff0000, v191
 v_add_f32 v176, v176, v178
 v_mfma_f32_16x16x32_bf16 v[60:63], v[164:167], a[44:47], v[60:63]
 ds_read_b64_tr_b16 v[156:157], v21 offset:0
 ds_read_b64_tr_b16 v[158:159], v21 offset:1024
 v_mfma_f32_16x16x32_bf16 v[56:59], v[164:167], a[40:43], v[56:59]
 buffer_load_dwordx4 v4, s[12:15], s40 offen offset:0 sc1 lds
 v_add_f32 v177, v177, v179
 s_waitcnt lgkmcnt(8)
 v_mfma_f32_16x16x32_bf16 v[64:67], v[136:139], a[40:43], v[64:67]
 ds_read_b64_tr_b16 v[160:161], v22 offset:0
 ds_read_b64_tr_b16 v[162:163], v22 offset:1024
 v_mfma_f32_16x16x32_bf16 v[128:131], v[136:139], v[172:175], v[128:131]
 v_add_f32 v176, v176, v180
 v_add_f32 v177, v177, v181
 v_mfma_f32_16x16x32_bf16 v[68:71], v[136:139], a[44:47], v[68:71]
 buffer_load_dwordx4 v5, s[12:15], s40 offen offset:1024 sc1 lds
 v_add_f32 v176, v176, v182
 v_add_f32 v177, v177, v183
 v_mfma_f32_16x16x32_bf16 v[76:79], v[140:143], a[44:47], v[76:79]
 ds_read_b64_tr_b16 v[164:165], v23 offset:0
 ds_read_b64_tr_b16 v[166:167], v23 offset:1024
 v_mfma_f32_16x16x32_bf16 v[72:75], v[140:143], a[40:43], v[72:75]
 v_add_f32 v176, v176, v184
 v_add_f32 v177, v177, v185
 s_waitcnt lgkmcnt(8)
 v_mfma_f32_16x16x32_bf16 v[80:83], v[144:147], a[40:43], v[80:83]
 s_waitcnt vmcnt(22)
 s_barrier
 ds_read_b64_tr_b16 v[136:137], v20 offset:8192
 v_mfma_f32_16x16x32_bf16 v[84:87], v[144:147], a[44:47], v[84:87]
 ds_read_b64_tr_b16 v[138:139], v20 offset:9216
 v_mfma_f32_16x16x32_bf16 v[92:95], v[148:151], a[44:47], v[92:95]
 ds_read_b64_tr_b16 v[140:141], v21 offset:8192
 ds_read_b64_tr_b16 v[142:143], v21 offset:9216
 v_add_f32 v176, v176, v186
 v_mfma_f32_16x16x32_bf16 v[88:91], v[148:151], a[40:43], v[88:91]
 buffer_load_dwordx4 a[80:83], v6, s[16:19], s42 offen offset:2048 sc1
 s_waitcnt lgkmcnt(8)
 v_mfma_f32_16x16x32_bf16 v[96:99], a[40:43], v[152:155], v[96:99]
 ds_read_b64_tr_b16 v[144:145], v22 offset:8192
 ds_read_b64_tr_b16 v[146:147], v22 offset:9216
 v_add_f32 v177, v177, v187
 v_mfma_f32_16x16x32_bf16 v[132:135], v[172:175], v[152:155], v[132:135]
 v_add_f32 v176, v176, v188
 v_add_f32 v177, v177, v189
 v_mfma_f32_16x16x32_bf16 v[100:103], a[44:47], v[152:155], v[100:103]
 ds_read_b128 v[168:171], v24 offset:6144
 buffer_load_dwordx4 a[84:87], v7, s[16:19], s42 offen offset:2048 sc1
 v_mfma_f32_16x16x32_bf16 v[108:111], a[44:47], v[156:159], v[108:111]
 ds_read_b64_tr_b16 v[148:149], v23 offset:8192
 ds_read_b64_tr_b16 v[150:151], v23 offset:9216
 v_add_f32 v176, v176, v190
 v_mfma_f32_16x16x32_bf16 v[104:107], a[40:43], v[156:159], v[104:107]
 v_add_f32 v177, v177, v191
 s_waitcnt lgkmcnt(9)
 v_mfma_f32_16x16x32_bf16 v[112:115], a[40:43], v[160:163], v[112:115]
 ds_read_b64_tr_b16 v[152:153], v20 offset:10240
 ds_read_b64_tr_b16 v[154:155], v20 offset:11264
 v_add_f32 v184, v176, v177
 v_mfma_f32_16x16x32_bf16 v[116:119], a[44:47], v[160:163], v[116:119]
 s_nop 1
 v_mfma_f32_16x16x32_bf16 v[124:127], a[44:47], v[164:167], v[124:127]
 ds_read_b64_tr_b16 v[156:157], v21 offset:10240
 ds_read_b64_tr_b16 v[158:159], v21 offset:11264
 v_mfma_f32_16x16x32_bf16 v[120:123], a[40:43], v[164:167], v[120:123]
 buffer_load_dwordx4 a[88:91], v6, s[16:19], s42 offen offset:3072 sc1
 v_add_f32_dpp v184, v184, v184 row_ror:1 row_mask:0xf bank_mask:0xf
 s_waitcnt vmcnt(23) lgkmcnt(9)
 v_mfma_f32_16x16x32_bf16 v[32:35], v[136:139], a[48:51], v[32:35]
 ds_read_b64_tr_b16 v[160:161], v22 offset:10240
 ds_read_b64_tr_b16 v[162:163], v22 offset:11264
 v_mfma_f32_16x16x32_bf16 v[36:39], v[136:139], a[52:55], v[36:39]
 s_nop 1
 v_add_f32_dpp v184, v184, v184 row_ror:2 row_mask:0xf bank_mask:0xf
 v_mfma_f32_16x16x32_bf16 v[44:47], v[140:143], a[52:55], v[44:47]
 ds_read_b64_tr_b16 v[164:165], v23 offset:10240
 ds_read_b64_tr_b16 v[166:167], v23 offset:11264
 v_mfma_f32_16x16x32_bf16 v[40:43], v[140:143], a[48:51], v[40:43]
 buffer_load_dwordx4 a[92:95], v7, s[16:19], s42 offen offset:3072 sc1
 s_waitcnt lgkmcnt(8)
 v_mfma_f32_16x16x32_bf16 v[48:51], v[144:147], a[48:51], v[48:51]
 ds_read_b64_tr_b16 v[136:137], v20 offset:12288
 ds_read_b64_tr_b16 v[138:139], v20 offset:13312
 v_mfma_f32_16x16x32_bf16 v[52:55], v[144:147], a[52:55], v[52:55]
 s_mov_b32 s46, 12288
 s_add_u32 m0, s47, 135168
 v_mfma_f32_16x16x32_bf16 v[60:63], v[148:151], a[52:55], v[60:63]
 ds_read_b64_tr_b16 v[140:141], v21 offset:12288
 ds_read_b64_tr_b16 v[142:143], v21 offset:13312
 v_mfma_f32_16x16x32_bf16 v[56:59], v[148:151], a[48:51], v[56:59]
 buffer_load_dwordx4 v8, s[24:27], s46 offen sc1 lds
 s_waitcnt lgkmcnt(8)
 v_mfma_f32_16x16x32_bf16 v[64:67], v[152:155], a[48:51], v[64:67]
 ds_read_b64_tr_b16 v[144:145], v22 offset:12288
 ds_read_b64_tr_b16 v[146:147], v22 offset:13312
 v_mfma_f32_16x16x32_bf16 v[128:131], v[152:155], v[168:171], v[128:131]
 s_add_u32 s40, s40, s41
 s_add_u32 m0, s38, 24576
 v_mfma_f32_16x16x32_bf16 v[68:71], v[152:155], a[52:55], v[68:71]
 s_nop 1
 v_add_f32_dpp v184, v184, v184 row_ror:4 row_mask:0xf bank_mask:0xf
 v_mfma_f32_16x16x32_bf16 v[76:79], v[156:159], a[52:55], v[76:79]
 ds_read_b64_tr_b16 v[148:149], v23 offset:12288
 ds_read_b64_tr_b16 v[150:151], v23 offset:13312
 v_mfma_f32_16x16x32_bf16 v[72:75], v[156:159], a[48:51], v[72:75]
 buffer_load_dwordx4 v2, s[12:15], s40 offen offset:0 sc1 lds
 s_waitcnt lgkmcnt(8)
 v_mfma_f32_16x16x32_bf16 v[80:83], v[160:163], a[48:51], v[80:83]
 ds_read_b64_tr_b16 v[152:153], v20 offset:20480
 ds_read_b64_tr_b16 v[154:155], v20 offset:21504
 v_mfma_f32_16x16x32_bf16 v[84:87], v[160:163], a[52:55], v[84:87]
 s_nop 1
 v_add_f32_dpp v184, v184, v184 row_ror:8 row_mask:0xf bank_mask:0xf
 v_mfma_f32_16x16x32_bf16 v[92:95], v[164:167], a[52:55], v[92:95]
 ds_read_b64_tr_b16 v[156:157], v21 offset:20480
 ds_read_b64_tr_b16 v[158:159], v21 offset:21504
 v_mov_b32 v185, v184
 v_mfma_f32_16x16x32_bf16 v[88:91], v[164:167], a[48:51], v[88:91]
 buffer_load_dwordx4 v3, s[12:15], s40 offen offset:1024 sc1 lds
 s_waitcnt lgkmcnt(8)
 v_mfma_f32_16x16x32_bf16 v[96:99], a[48:51], v[136:139], v[96:99]
 ds_read_b64_tr_b16 v[160:161], v22 offset:20480
 ds_read_b64_tr_b16 v[162:163], v22 offset:21504
 v_mfma_f32_16x16x32_bf16 v[132:135], v[168:171], v[136:139], v[132:135]
 s_nop 1
 v_permlane16_swap_b32 v184, v185
 v_mfma_f32_16x16x32_bf16 v[100:103], a[52:55], v[136:139], v[100:103]
 ds_read_b128 v[172:175], v24 offset:7168
 v_add_f32 v184, v184, v185
 v_mfma_f32_16x16x32_bf16 v[108:111], a[52:55], v[140:143], v[108:111]
 ds_read_b64_tr_b16 v[164:165], v23 offset:20480
 ds_read_b64_tr_b16 v[166:167], v23 offset:21504
 v_mov_b32 v185, v184
 v_mfma_f32_16x16x32_bf16 v[104:107], a[48:51], v[140:143], v[104:107]
 buffer_load_dwordx4 v2, s[12:15], s40 offen offset:2048 sc1 lds
 s_waitcnt lgkmcnt(9)
 v_mfma_f32_16x16x32_bf16 v[112:115], a[48:51], v[144:147], v[112:115]
 ds_read_b64_tr_b16 v[136:137], v20 offset:22528
 ds_read_b64_tr_b16 v[138:139], v20 offset:23552
 v_mfma_f32_16x16x32_bf16 v[116:119], a[52:55], v[144:147], v[116:119]
 s_nop 1
 v_permlane32_swap_b32 v184, v185
 v_mfma_f32_16x16x32_bf16 v[124:127], a[52:55], v[148:151], v[124:127]
 ds_read_b64_tr_b16 v[140:141], v21 offset:22528
 ds_read_b64_tr_b16 v[142:143], v21 offset:23552
 v_mfma_f32_16x16x32_bf16 v[120:123], a[48:51], v[148:151], v[120:123]
 buffer_load_dwordx4 v3, s[12:15], s40 offen offset:3072 sc1 lds
 v_add_f32 v184, v184, v185
 s_waitcnt vmcnt(27) lgkmcnt(9)
 v_mfma_f32_16x16x32_bf16 v[32:35], v[152:155], a[56:59], v[32:35]
 ds_read_b64_tr_b16 v[144:145], v22 offset:22528
 ds_read_b64_tr_b16 v[146:147], v22 offset:23552
 v_mfma_f32_16x16x32_bf16 v[36:39], v[152:155], a[60:63], v[36:39]
 s_add_u32 m0, s38, 28672
 v_mov_b32 v185, 0x3a800000
 v_readfirstlane_b32 s53, v184
 v_mfma_f32_16x16x32_bf16 v[44:47], v[156:159], a[60:63], v[44:47]
 ds_read_b64_tr_b16 v[148:149], v23 offset:22528
 ds_read_b64_tr_b16 v[150:151], v23 offset:23552
 v_mfma_f32_16x16x32_bf16 v[40:43], v[156:159], a[56:59], v[40:43]
 buffer_load_dwordx4 v4, s[12:15], s40 offen offset:0 sc1 lds
 s_waitcnt lgkmcnt(8)
 v_mfma_f32_16x16x32_bf16 v[48:51], v[160:163], a[56:59], v[48:51]
 ds_read_b64_tr_b16 v[152:153], v20 offset:24576
 ds_read_b64_tr_b16 v[154:155], v20 offset:25600
 s_lshl_b32 s52, s10, 1
 v_mfma_f32_16x16x32_bf16 v[52:55], v[160:163], a[60:63], v[52:55]
 s_add_u32 s52, s52, 163568
 v_mul_f32 v184, s53, v185
 v_mfma_f32_16x16x32_bf16 v[60:63], v[164:167], a[60:63], v[60:63]
 ds_read_b64_tr_b16 v[156:157], v21 offset:24576
 ds_read_b64_tr_b16 v[158:159], v21 offset:25600
 v_cvt_pk_bf16_f32 v185, v184, v184
 v_mfma_f32_16x16x32_bf16 v[56:59], v[164:167], a[56:59], v[56:59]
 v_lshlrev_b32 v186, 16, v185
 s_waitcnt lgkmcnt(8)
 v_mfma_f32_16x16x32_bf16 v[64:67], v[136:139], a[56:59], v[64:67]
 ds_read_b64_tr_b16 v[160:161], v22 offset:24576
 ds_read_b64_tr_b16 v[162:163], v22 offset:25600
 v_mfma_f32_16x16x32_bf16 v[128:131], v[136:139], v[172:175], v[128:131]
 buffer_load_dwordx4 v5, s[12:15], s40 offen offset:1024 sc1 lds
 v_sub_f32 v186, v184, v186
 v_cvt_pk_bf16_f32 v186, v186, v186
 v_mfma_f32_16x16x32_bf16 v[68:71], v[136:139], a[60:63], v[68:71]
 s_mov_b32 s42, 12288
 v_mov_b32 v187, s52
 v_mfma_f32_16x16x32_bf16 v[76:79], v[140:143], a[60:63], v[76:79]
 ds_read_b64_tr_b16 v[164:165], v23 offset:24576
 ds_read_b64_tr_b16 v[166:167], v23 offset:25600
 v_mov_b32 v188, 163568
 v_mfma_f32_16x16x32_bf16 v[72:75], v[140:143], a[56:59], v[72:75]
 buffer_load_dwordx4 a[0:3], v6, s[16:19], s42 offen offset:0 sc1
 s_waitcnt lgkmcnt(8)
 v_mfma_f32_16x16x32_bf16 v[80:83], v[144:147], a[56:59], v[80:83]
 s_waitcnt vmcnt(22)
 s_barrier
 ds_read_b64_tr_b16 v[136:137], v20 offset:32768
 v_mfma_f32_16x16x32_bf16 v[84:87], v[144:147], a[60:63], v[84:87]
 ds_read_b64_tr_b16 v[138:139], v20 offset:33792
 v_cmp_eq_u32 vcc, 0, v0
 v_mfma_f32_16x16x32_bf16 v[92:95], v[148:151], a[60:63], v[92:95]
 ds_read_b64_tr_b16 v[140:141], v21 offset:32768
 ds_read_b64_tr_b16 v[142:143], v21 offset:33792
 v_mfma_f32_16x16x32_bf16 v[88:91], v[148:151], a[56:59], v[88:91]
 v_mov_b32 v189, 0x40000000
 v_mov_b32 v190, s8
 s_waitcnt lgkmcnt(8)
 v_mfma_f32_16x16x32_bf16 v[96:99], a[56:59], v[152:155], v[96:99]
 ds_read_b64_tr_b16 v[144:145], v22 offset:32768
 ds_read_b64_tr_b16 v[146:147], v22 offset:33792
 v_mfma_f32_16x16x32_bf16 v[132:135], v[172:175], v[152:155], v[132:135]
 buffer_load_dwordx4 a[4:7], v7, s[16:19], s42 offen offset:0 sc1
 v_cndmask_b32 v189, v189, 0, vcc
 v_mfma_f32_16x16x32_bf16 v[100:103], a[60:63], v[152:155], v[100:103]
 ds_read_b128 v[168:171], v24 offset:8192
 v_mov_b32 v191, s9
 s_min_u32 s53, s10, 1
 v_mfma_f32_16x16x32_bf16 v[108:111], a[60:63], v[156:159], v[108:111]
 ds_read_b64_tr_b16 v[148:149], v23 offset:32768
 ds_read_b64_tr_b16 v[150:151], v23 offset:33792
 v_mfma_f32_16x16x32_bf16 v[104:107], a[56:59], v[156:159], v[104:107]
 buffer_load_dwordx4 a[8:11], v6, s[16:19], s42 offen offset:1024 sc1
 s_lshl_b32 s53, s53, 30
 s_waitcnt lgkmcnt(9)
 v_mfma_f32_16x16x32_bf16 v[112:115], a[56:59], v[160:163], v[112:115]
 ds_read_b64_tr_b16 v[152:153], v20 offset:34816
 ds_read_b64_tr_b16 v[154:155], v20 offset:35840
 v_mfma_f32_16x16x32_bf16 v[116:119], a[60:63], v[160:163], v[116:119]
 s_lshl_b32 s52, s2, 4
 s_add_u32 s52, s52, 0x2060000
 v_mfma_f32_16x16x32_bf16 v[124:127], a[60:63], v[164:167], v[124:127]
 ds_read_b64_tr_b16 v[156:157], v21 offset:34816
 ds_read_b64_tr_b16 v[158:159], v21 offset:35840
 s_add_u32 s52, s52, s53
 v_mfma_f32_16x16x32_bf16 v[120:123], a[56:59], v[164:167], v[120:123]
 s_lshl_b32 s51, s2, 5
 s_waitcnt vmcnt(22) lgkmcnt(9)
 v_mfma_f32_16x16x32_bf16 v[32:35], v[136:139], a[64:67], v[32:35]
 ds_read_b64_tr_b16 v[160:161], v22 offset:34816
 ds_read_b64_tr_b16 v[162:163], v22 offset:35840
 v_lshrrev_b32 v198, 2, v29
 s_add_u32 s53, s53, s51
 s_add_u32 s53, s53, 0x20000
 v_mfma_f32_16x16x32_bf16 v[36:39], v[136:139], a[68:71], v[36:39]
 buffer_load_dwordx4 a[12:15], v7, s[16:19], s42 offen offset:1024 sc1
 v_mfma_f32_16x16x32_bf16 v[44:47], v[140:143], a[68:71], v[44:47]
 ds_read_b64_tr_b16 v[164:165], v23 offset:34816
 ds_read_b64_tr_b16 v[166:167], v23 offset:35840
 s_add_u32 m0, s38, 49152
 ds_write_b16 v187, v185
 v_mfma_f32_16x16x32_bf16 v[40:43], v[140:143], a[64:67], v[40:43]
 s_add_u32 s40, s40, s41
 s_waitcnt lgkmcnt(9)
 v_mfma_f32_16x16x32_bf16 v[48:51], v[144:147], a[64:67], v[48:51]
 ds_read_b64_tr_b16 v[136:137], v20 offset:36864
 ds_read_b64_tr_b16 v[138:139], v20 offset:37888
 ds_write_b16 v187, v186 offset:8
 s_branch m_ps_p1_1
m_pad_p1_1:
 s_branch m_reta_p1
m_ps_p1_1:
 v_mfma_f32_16x16x32_bf16 v[52:55], v[144:147], a[68:71], v[52:55]
 buffer_load_dwordx4 v2, s[12:15], s40 offen offset:0 sc1 lds
 v_mfma_f32_16x16x32_bf16 v[60:63], v[148:151], a[68:71], v[60:63]
 ds_read_b64_tr_b16 v[140:141], v21 offset:36864
 ds_read_b64_tr_b16 v[142:143], v21 offset:37888
 v_mfma_f32_16x16x32_bf16 v[56:59], v[148:151], a[64:67], v[56:59]
 s_waitcnt lgkmcnt(10)
 v_mfma_f32_16x16x32_bf16 v[64:67], v[152:155], a[64:67], v[64:67]
 ds_read_b64_tr_b16 v[144:145], v22 offset:36864
 ds_read_b64_tr_b16 v[146:147], v22 offset:37888
 v_mfma_f32_16x16x32_bf16 v[128:131], v[152:155], v[168:171], v[128:131]
 buffer_load_dwordx4 v3, s[12:15], s40 offen offset:1024 sc1 lds
 v_mfma_f32_16x16x32_bf16 v[68:71], v[152:155], a[68:71], v[68:71]
 v_mfma_f32_16x16x32_bf16 v[76:79], v[156:159], a[68:71], v[76:79]
 ds_read_b64_tr_b16 v[148:149], v23 offset:36864
 ds_read_b64_tr_b16 v[150:151], v23 offset:37888
 v_mfma_f32_16x16x32_bf16 v[72:75], v[156:159], a[64:67], v[72:75]
 s_waitcnt lgkmcnt(10)
 v_mfma_f32_16x16x32_bf16 v[80:83], v[160:163], a[64:67], v[80:83]
 ds_read_b64_tr_b16 v[152:153], v20 offset:45056
 ds_read_b64_tr_b16 v[154:155], v20 offset:46080
 v_mfma_f32_16x16x32_bf16 v[84:87], v[160:163], a[68:71], v[84:87]
 buffer_load_dwordx4 v2, s[12:15], s40 offen offset:2048 sc1 lds
 v_mfma_f32_16x16x32_bf16 v[92:95], v[164:167], a[68:71], v[92:95]
 ds_read_b64_tr_b16 v[156:157], v21 offset:45056
 ds_read_b64_tr_b16 v[158:159], v21 offset:46080
 v_mfma_f32_16x16x32_bf16 v[88:91], v[164:167], a[64:67], v[88:91]
 s_waitcnt lgkmcnt(8)
 v_mfma_f32_16x16x32_bf16 v[96:99], a[64:67], v[136:139], v[96:99]
 ds_read_b64_tr_b16 v[160:161], v22 offset:45056
 ds_read_b64_tr_b16 v[162:163], v22 offset:46080
 v_mfma_f32_16x16x32_bf16 v[132:135], v[168:171], v[136:139], v[132:135]
 buffer_load_dwordx4 v3, s[12:15], s40 offen offset:3072 sc1 lds
 v_mfma_f32_16x16x32_bf16 v[100:103], a[68:71], v[136:139], v[100:103]
 ds_read_b128 v[172:175], v24 offset:9216
 v_mfma_f32_16x16x32_bf16 v[108:111], a[68:71], v[140:143], v[108:111]
 ds_read_b64_tr_b16 v[164:165], v23 offset:45056
 ds_read_b64_tr_b16 v[166:167], v23 offset:46080
 v_mfma_f32_16x16x32_bf16 v[104:107], a[64:67], v[140:143], v[104:107]
 s_add_u32 m0, s38, 53248
 s_waitcnt lgkmcnt(9)
 v_mfma_f32_16x16x32_bf16 v[112:115], a[64:67], v[144:147], v[112:115]
 ds_read_b64_tr_b16 v[136:137], v20 offset:47104
 ds_read_b64_tr_b16 v[138:139], v20 offset:48128
 v_mfma_f32_16x16x32_bf16 v[116:119], a[68:71], v[144:147], v[116:119]
 buffer_load_dwordx4 v4, s[12:15], s40 offen offset:0 sc1 lds
 v_mfma_f32_16x16x32_bf16 v[124:127], a[68:71], v[148:151], v[124:127]
 ds_read_b64_tr_b16 v[140:141], v21 offset:47104
 ds_read_b64_tr_b16 v[142:143], v21 offset:48128
 v_mfma_f32_16x16x32_bf16 v[120:123], a[64:67], v[148:151], v[120:123]
 s_waitcnt vmcnt(26) lgkmcnt(9)
 v_mfma_f32_16x16x32_bf16 v[32:35], v[152:155], a[72:75], v[32:35]
 ds_read_b64_tr_b16 v[144:145], v22 offset:47104
 ds_read_b64_tr_b16 v[146:147], v22 offset:48128
 v_mfma_f32_16x16x32_bf16 v[36:39], v[152:155], a[76:79], v[36:39]
 buffer_load_dwordx4 v5, s[12:15], s40 offen offset:1024 sc1 lds
 v_mfma_f32_16x16x32_bf16 v[44:47], v[156:159], a[76:79], v[44:47]
 ds_read_b64_tr_b16 v[148:149], v23 offset:47104
 ds_read_b64_tr_b16 v[150:151], v23 offset:48128
 v_mfma_f32_16x16x32_bf16 v[40:43], v[156:159], a[72:75], v[40:43]
 s_waitcnt lgkmcnt(8)
 v_mfma_f32_16x16x32_bf16 v[48:51], v[160:163], a[72:75], v[48:51]
 ds_read_b64_tr_b16 v[152:153], v20 offset:49152
 ds_read_b64_tr_b16 v[154:155], v20 offset:50176
 v_mfma_f32_16x16x32_bf16 v[52:55], v[160:163], a[76:79], v[52:55]
 buffer_load_dwordx4 a[16:19], v6, s[16:19], s42 offen offset:2048 sc1
 v_mfma_f32_16x16x32_bf16 v[60:63], v[164:167], a[76:79], v[60:63]
 ds_read_b64_tr_b16 v[156:157], v21 offset:49152
 ds_read_b64_tr_b16 v[158:159], v21 offset:50176
 v_mfma_f32_16x16x32_bf16 v[56:59], v[164:167], a[72:75], v[56:59]
 s_waitcnt lgkmcnt(8)
 v_mfma_f32_16x16x32_bf16 v[64:67], v[136:139], a[72:75], v[64:67]
 ds_read_b64_tr_b16 v[160:161], v22 offset:49152
 ds_read_b64_tr_b16 v[162:163], v22 offset:50176
 v_mfma_f32_16x16x32_bf16 v[128:131], v[136:139], v[172:175], v[128:131]
 v_mfma_f32_16x16x32_bf16 v[68:71], v[136:139], a[76:79], v[68:71]
 buffer_load_dwordx4 a[20:23], v7, s[16:19], s42 offen offset:2048 sc1
 v_mfma_f32_16x16x32_bf16 v[76:79], v[140:143], a[76:79], v[76:79]
 ds_read_b64_tr_b16 v[164:165], v23 offset:49152
 ds_read_b64_tr_b16 v[166:167], v23 offset:50176
 v_mfma_f32_16x16x32_bf16 v[72:75], v[140:143], a[72:75], v[72:75]
 s_waitcnt lgkmcnt(8)
 v_mfma_f32_16x16x32_bf16 v[80:83], v[144:147], a[72:75], v[80:83]
 s_waitcnt vmcnt(23)
 s_barrier
 ds_read_b64_tr_b16 v[136:137], v16 offset:0
 v_mfma_f32_16x16x32_bf16 v[84:87], v[144:147], a[76:79], v[84:87]
 ds_read_b64_tr_b16 v[138:139], v16 offset:1024
 buffer_load_dwordx4 a[24:27], v6, s[16:19], s42 offen offset:3072 sc1
 v_mfma_f32_16x16x32_bf16 v[92:95], v[148:151], a[76:79], v[92:95]
 ds_read_b64_tr_b16 v[140:141], v17 offset:0
 ds_read_b64_tr_b16 v[142:143], v17 offset:1024
 v_mfma_f32_16x16x32_bf16 v[88:91], v[148:151], a[72:75], v[88:91]
 ds_read_b128 v[192:195], v188
 s_waitcnt lgkmcnt(9)
 v_mfma_f32_16x16x32_bf16 v[96:99], a[72:75], v[152:155], v[96:99]
 ds_read_b64_tr_b16 v[144:145], v18 offset:0
 ds_read_b64_tr_b16 v[146:147], v18 offset:1024
 v_mfma_f32_16x16x32_bf16 v[132:135], v[172:175], v[152:155], v[132:135]
 v_mfma_f32_16x16x32_bf16 v[100:103], a[76:79], v[152:155], v[100:103]
 ds_read_b128 v[168:171], v24 offset:10240
 buffer_load_dwordx4 a[28:31], v7, s[16:19], s42 offen offset:3072 sc1
 v_mfma_f32_16x16x32_bf16 v[108:111], a[76:79], v[156:159], v[108:111]
 ds_read_b64_tr_b16 v[148:149], v19 offset:0
 ds_read_b64_tr_b16 v[150:151], v19 offset:1024
 s_add_u32 m0, s47, 139264
 v_mfma_f32_16x16x32_bf16 v[104:107], a[72:75], v[156:159], v[104:107]
 s_mov_b32 s46, 16384
 s_waitcnt lgkmcnt(10)
 v_mfma_f32_16x16x32_bf16 v[112:115], a[72:75], v[160:163], v[112:115]
 ds_read_b64_tr_b16 v[152:153], v16 offset:2048
 ds_read_b64_tr_b16 v[154:155], v16 offset:3072
 v_mfma_f32_16x16x32_bf16 v[116:119], a[76:79], v[160:163], v[116:119]
 buffer_load_dwordx4 v8, s[24:27], s46 offen sc1 lds
 v_mfma_f32_16x16x32_bf16 v[124:127], a[76:79], v[164:167], v[124:127]
 ds_read_b64_tr_b16 v[156:157], v17 offset:2048
 ds_read_b64_tr_b16 v[158:159], v17 offset:3072
 v_mfma_f32_16x16x32_bf16 v[120:123], a[72:75], v[164:167], v[120:123]
 s_waitcnt vmcnt(24) lgkmcnt(10)
 v_mfma_f32_16x16x32_bf16 v[32:35], v[136:139], a[80:83], v[32:35]
 ds_read_b64_tr_b16 v[160:161], v18 offset:2048
 ds_read_b64_tr_b16 v[162:163], v18 offset:3072
 v_mfma_f32_16x16x32_bf16 v[36:39], v[136:139], a[84:87], v[36:39]
 s_add_u32 s40, s40, s41
 s_add_u32 m0, s38, 73728
 v_mfma_f32_16x16x32_bf16 v[44:47], v[140:143], a[84:87], v[44:47]
 ds_read_b64_tr_b16 v[164:165], v19 offset:2048
 ds_read_b64_tr_b16 v[166:167], v19 offset:3072
 v_mfma_f32_16x16x32_bf16 v[40:43], v[140:143], a[80:83], v[40:43]
 buffer_load_dwordx4 v2, s[12:15], s40 offen offset:0 sc1 lds
 s_waitcnt lgkmcnt(8)
 v_mfma_f32_16x16x32_bf16 v[48:51], v[144:147], a[80:83], v[48:51]
 ds_read_b64_tr_b16 v[136:137], v16 offset:4096
 ds_read_b64_tr_b16 v[138:139], v16 offset:5120
 v_mfma_f32_16x16x32_bf16 v[52:55], v[144:147], a[84:87], v[52:55]
 v_mfma_f32_16x16x32_bf16 v[60:63], v[148:151], a[84:87], v[60:63]
 ds_read_b64_tr_b16 v[140:141], v17 offset:4096
 ds_read_b64_tr_b16 v[142:143], v17 offset:5120
 v_mfma_f32_16x16x32_bf16 v[56:59], v[148:151], a[80:83], v[56:59]
 buffer_load_dwordx4 v3, s[12:15], s40 offen offset:1024 sc1 lds
 buffer_store_dwordx4 v[192:195], v189, s[88:91], s52 offen sc1
 s_waitcnt lgkmcnt(8)
 v_mfma_f32_16x16x32_bf16 v[64:67], v[152:155], a[80:83], v[64:67]
 ds_read_b64_tr_b16 v[144:145], v18 offset:4096
 ds_read_b64_tr_b16 v[146:147], v18 offset:5120
 v_mfma_f32_16x16x32_bf16 v[128:131], v[152:155], v[168:171], v[128:131]
 v_mfma_f32_16x16x32_bf16 v[68:71], v[152:155], a[84:87], v[68:71]
 v_mfma_f32_16x16x32_bf16 v[76:79], v[156:159], a[84:87], v[76:79]
 ds_read_b64_tr_b16 v[148:149], v19 offset:4096
 ds_read_b64_tr_b16 v[150:151], v19 offset:5120
 v_mfma_f32_16x16x32_bf16 v[72:75], v[156:159], a[80:83], v[72:75]
 buffer_load_dwordx4 v2, s[12:15], s40 offen offset:2048 sc1 lds
 s_waitcnt lgkmcnt(8)
 v_mfma_f32_16x16x32_bf16 v[80:83], v[160:163], a[80:83], v[80:83]
 ds_read_b64_tr_b16 v[152:153], v16 offset:12288
 ds_read_b64_tr_b16 v[154:155], v16 offset:13312
 v_mfma_f32_16x16x32_bf16 v[84:87], v[160:163], a[84:87], v[84:87]
 v_mfma_f32_16x16x32_bf16 v[92:95], v[164:167], a[84:87], v[92:95]
 ds_read_b64_tr_b16 v[156:157], v17 offset:12288
 ds_read_b64_tr_b16 v[158:159], v17 offset:13312
 v_mfma_f32_16x16x32_bf16 v[88:91], v[164:167], a[80:83], v[88:91]
 buffer_load_dwordx4 v3, s[12:15], s40 offen offset:3072 sc1 lds
 s_waitcnt lgkmcnt(8)
 v_mfma_f32_16x16x32_bf16 v[96:99], a[80:83], v[136:139], v[96:99]
 ds_read_b64_tr_b16 v[160:161], v18 offset:12288
 ds_read_b64_tr_b16 v[162:163], v18 offset:13312
 v_mfma_f32_16x16x32_bf16 v[132:135], v[168:171], v[136:139], v[132:135]
 v_mfma_f32_16x16x32_bf16 v[100:103], a[84:87], v[136:139], v[100:103]
 ds_read_b128 v[172:175], v24 offset:11264
 s_add_u32 m0, s38, 77824
 v_mfma_f32_16x16x32_bf16 v[108:111], a[84:87], v[140:143], v[108:111]
 ds_read_b64_tr_b16 v[164:165], v19 offset:12288
 ds_read_b64_tr_b16 v[166:167], v19 offset:13312
 v_mfma_f32_16x16x32_bf16 v[104:107], a[80:83], v[140:143], v[104:107]
 buffer_load_dwordx4 v4, s[12:15], s40 offen offset:0 sc1 lds
 s_waitcnt lgkmcnt(9)
 v_mfma_f32_16x16x32_bf16 v[112:115], a[80:83], v[144:147], v[112:115]
 ds_read_b64_tr_b16 v[136:137], v16 offset:14336
 ds_read_b64_tr_b16 v[138:139], v16 offset:15360
 v_mfma_f32_16x16x32_bf16 v[116:119], a[84:87], v[144:147], v[116:119]
 v_mfma_f32_16x16x32_bf16 v[124:127], a[84:87], v[148:151], v[124:127]
 ds_read_b64_tr_b16 v[140:141], v17 offset:14336
 ds_read_b64_tr_b16 v[142:143], v17 offset:15360
 v_mfma_f32_16x16x32_bf16 v[120:123], a[80:83], v[148:151], v[120:123]
 buffer_load_dwordx4 v5, s[12:15], s40 offen offset:1024 sc1 lds
 s_waitcnt vmcnt(29) lgkmcnt(9)
 v_mfma_f32_16x16x32_bf16 v[32:35], v[152:155], a[88:91], v[32:35]
 ds_read_b64_tr_b16 v[144:145], v18 offset:14336
 ds_read_b64_tr_b16 v[146:147], v18 offset:15360
 v_mfma_f32_16x16x32_bf16 v[36:39], v[152:155], a[92:95], v[36:39]
 s_mov_b32 s42, 16384
 v_mfma_f32_16x16x32_bf16 v[44:47], v[156:159], a[92:95], v[44:47]
 ds_read_b64_tr_b16 v[148:149], v19 offset:14336
 ds_read_b64_tr_b16 v[150:151], v19 offset:15360
 v_mfma_f32_16x16x32_bf16 v[40:43], v[156:159], a[88:91], v[40:43]
 buffer_load_dwordx4 a[32:35], v6, s[16:19], s42 offen offset:0 sc1
 s_waitcnt lgkmcnt(8)
 v_mfma_f32_16x16x32_bf16 v[48:51], v[160:163], a[88:91], v[48:51]
 ds_read_b64_tr_b16 v[152:153], v16 offset:16384
 ds_read_b64_tr_b16 v[154:155], v16 offset:17408
 v_mfma_f32_16x16x32_bf16 v[52:55], v[160:163], a[92:95], v[52:55]
 v_mfma_f32_16x16x32_bf16 v[60:63], v[164:167], a[92:95], v[60:63]
 ds_read_b64_tr_b16 v[156:157], v17 offset:16384
 ds_read_b64_tr_b16 v[158:159], v17 offset:17408
 v_mfma_f32_16x16x32_bf16 v[56:59], v[164:167], a[88:91], v[56:59]
 buffer_load_dwordx4 a[36:39], v7, s[16:19], s42 offen offset:0 sc1
 s_waitcnt lgkmcnt(8)
 v_mfma_f32_16x16x32_bf16 v[64:67], v[136:139], a[88:91], v[64:67]
 ds_read_b64_tr_b16 v[160:161], v18 offset:16384
 ds_read_b64_tr_b16 v[162:163], v18 offset:17408
 v_mfma_f32_16x16x32_bf16 v[128:131], v[136:139], v[172:175], v[128:131]
 v_mfma_f32_16x16x32_bf16 v[68:71], v[136:139], a[92:95], v[68:71]
 v_mfma_f32_16x16x32_bf16 v[76:79], v[140:143], a[92:95], v[76:79]
 ds_read_b64_tr_b16 v[164:165], v19 offset:16384
 ds_read_b64_tr_b16 v[166:167], v19 offset:17408
 v_mfma_f32_16x16x32_bf16 v[72:75], v[140:143], a[88:91], v[72:75]
 buffer_load_dwordx4 a[40:43], v6, s[16:19], s42 offen offset:1024 sc1
 s_waitcnt lgkmcnt(8)
 v_mfma_f32_16x16x32_bf16 v[80:83], v[144:147], a[88:91], v[80:83]
 s_waitcnt vmcnt(25)
 s_barrier
 ds_read_b64_tr_b16 v[136:137], v16 offset:24576
 v_mfma_f32_16x16x32_bf16 v[84:87], v[144:147], a[92:95], v[84:87]
 ds_read_b64_tr_b16 v[138:139], v16 offset:25600
 v_mfma_f32_16x16x32_bf16 v[92:95], v[148:151], a[92:95], v[92:95]
 ds_read_b64_tr_b16 v[140:141], v17 offset:24576
 ds_read_b64_tr_b16 v[142:143], v17 offset:25600
 v_mfma_f32_16x16x32_bf16 v[88:91], v[148:151], a[88:91], v[88:91]
 buffer_load_dwordx4 a[44:47], v7, s[16:19], s42 offen offset:1024 sc1
 s_waitcnt lgkmcnt(8)
 v_mfma_f32_16x16x32_bf16 v[96:99], a[88:91], v[152:155], v[96:99]
 ds_read_b64_tr_b16 v[144:145], v18 offset:24576
 ds_read_b64_tr_b16 v[146:147], v18 offset:25600
 v_mfma_f32_16x16x32_bf16 v[132:135], v[172:175], v[152:155], v[132:135]
 s_add_u32 s40, s40, s41
 s_add_u32 m0, s38, 98304
 v_mfma_f32_16x16x32_bf16 v[100:103], a[92:95], v[152:155], v[100:103]
 ds_read_b128 v[168:171], v24 offset:12288
 v_mfma_f32_16x16x32_bf16 v[108:111], a[92:95], v[156:159], v[108:111]
 ds_read_b64_tr_b16 v[148:149], v19 offset:24576
 ds_read_b64_tr_b16 v[150:151], v19 offset:25600
 v_mfma_f32_16x16x32_bf16 v[104:107], a[88:91], v[156:159], v[104:107]
 buffer_load_dwordx4 v2, s[12:15], s40 offen offset:0 sc1 lds
 s_waitcnt lgkmcnt(9)
 v_mfma_f32_16x16x32_bf16 v[112:115], a[88:91], v[160:163], v[112:115]
 ds_read_b64_tr_b16 v[152:153], v16 offset:26624
 ds_read_b64_tr_b16 v[154:155], v16 offset:27648
 v_mfma_f32_16x16x32_bf16 v[116:119], a[92:95], v[160:163], v[116:119]
 v_mfma_f32_16x16x32_bf16 v[124:127], a[92:95], v[164:167], v[124:127]
 ds_read_b64_tr_b16 v[156:157], v17 offset:26624
 ds_read_b64_tr_b16 v[158:159], v17 offset:27648
 v_mfma_f32_16x16x32_bf16 v[120:123], a[88:91], v[164:167], v[120:123]
 buffer_load_dwordx4 v3, s[12:15], s40 offen offset:1024 sc1 lds
 s_waitcnt vmcnt(26) lgkmcnt(9)
 v_mfma_f32_16x16x32_bf16 v[32:35], v[136:139], a[0:3], v[32:35]
 ds_read_b64_tr_b16 v[160:161], v18 offset:26624
 ds_read_b64_tr_b16 v[162:163], v18 offset:27648
 v_mfma_f32_16x16x32_bf16 v[36:39], v[136:139], a[4:7], v[36:39]
 v_mfma_f32_16x16x32_bf16 v[44:47], v[140:143], a[4:7], v[44:47]
 ds_read_b64_tr_b16 v[164:165], v19 offset:26624
 ds_read_b64_tr_b16 v[166:167], v19 offset:27648
 v_mfma_f32_16x16x32_bf16 v[40:43], v[140:143], a[0:3], v[40:43]
 s_waitcnt lgkmcnt(8)
 v_mfma_f32_16x16x32_bf16 v[48:51], v[144:147], a[0:3], v[48:51]
 ds_read_b64_tr_b16 v[136:137], v16 offset:28672
 ds_read_b64_tr_b16 v[138:139], v16 offset:29696
 v_mfma_f32_16x16x32_bf16 v[52:55], v[144:147], a[4:7], v[52:55]
 buffer_load_dwordx4 v2, s[12:15], s40 offen offset:2048 sc1 lds
 v_mfma_f32_16x16x32_bf16 v[60:63], v[148:151], a[4:7], v[60:63]
 ds_read_b64_tr_b16 v[140:141], v17 offset:28672
 ds_read_b64_tr_b16 v[142:143], v17 offset:29696
 v_mfma_f32_16x16x32_bf16 v[56:59], v[148:151], a[0:3], v[56:59]
 s_waitcnt lgkmcnt(8)
 v_mfma_f32_16x16x32_bf16 v[64:67], v[152:155], a[0:3], v[64:67]
 ds_read_b64_tr_b16 v[144:145], v18 offset:28672
 ds_read_b64_tr_b16 v[146:147], v18 offset:29696
 v_mfma_f32_16x16x32_bf16 v[128:131], v[152:155], v[168:171], v[128:131]
 buffer_load_dwordx4 v3, s[12:15], s40 offen offset:3072 sc1 lds
 v_mfma_f32_16x16x32_bf16 v[68:71], v[152:155], a[4:7], v[68:71]
 v_mfma_f32_16x16x32_bf16 v[76:79], v[156:159], a[4:7], v[76:79]
 ds_read_b64_tr_b16 v[148:149], v19 offset:28672
 ds_read_b64_tr_b16 v[150:151], v19 offset:29696
 v_mfma_f32_16x16x32_bf16 v[72:75], v[156:159], a[0:3], v[72:75]
 s_add_u32 m0, s38, 102400
 s_waitcnt lgkmcnt(8)
 v_mfma_f32_16x16x32_bf16 v[80:83], v[160:163], a[0:3], v[80:83]
 ds_read_b64_tr_b16 v[152:153], v16 offset:36864
 ds_read_b64_tr_b16 v[154:155], v16 offset:37888
 v_mfma_f32_16x16x32_bf16 v[84:87], v[160:163], a[4:7], v[84:87]
 buffer_load_dwordx4 v4, s[12:15], s40 offen offset:0 sc1 lds
 v_mfma_f32_16x16x32_bf16 v[92:95], v[164:167], a[4:7], v[92:95]
 ds_read_b64_tr_b16 v[156:157], v17 offset:36864
 ds_read_b64_tr_b16 v[158:159], v17 offset:37888
 v_mfma_f32_16x16x32_bf16 v[88:91], v[164:167], a[0:3], v[88:91]
 s_waitcnt lgkmcnt(8)
 v_mfma_f32_16x16x32_bf16 v[96:99], a[0:3], v[136:139], v[96:99]
 ds_read_b64_tr_b16 v[160:161], v18 offset:36864
 ds_read_b64_tr_b16 v[162:163], v18 offset:37888
 v_mfma_f32_16x16x32_bf16 v[132:135], v[168:171], v[136:139], v[132:135]
 buffer_load_dwordx4 v5, s[12:15], s40 offen offset:1024 sc1 lds
 v_mfma_f32_16x16x32_bf16 v[100:103], a[4:7], v[136:139], v[100:103]
 ds_read_b128 v[172:175], v24 offset:13312
 v_mfma_f32_16x16x32_bf16 v[108:111], a[4:7], v[140:143], v[108:111]
 ds_read_b64_tr_b16 v[164:165], v19 offset:36864
 ds_read_b64_tr_b16 v[166:167], v19 offset:37888
 v_mfma_f32_16x16x32_bf16 v[104:107], a[0:3], v[140:143], v[104:107]
 s_waitcnt lgkmcnt(9)
 v_mfma_f32_16x16x32_bf16 v[112:115], a[0:3], v[144:147], v[112:115]
 ds_read_b64_tr_b16 v[136:137], v16 offset:38912
 ds_read_b64_tr_b16 v[138:139], v16 offset:39936
 v_mfma_f32_16x16x32_bf16 v[116:119], a[4:7], v[144:147], v[116:119]
 buffer_load_dwordx4 a[48:51], v6, s[16:19], s42 offen offset:2048 sc1
 v_mfma_f32_16x16x32_bf16 v[124:127], a[4:7], v[148:151], v[124:127]
 ds_read_b64_tr_b16 v[140:141], v17 offset:38912
 ds_read_b64_tr_b16 v[142:143], v17 offset:39936
 v_mfma_f32_16x16x32_bf16 v[120:123], a[0:3], v[148:151], v[120:123]
 s_waitcnt vmcnt(29) lgkmcnt(9)
 v_mfma_f32_16x16x32_bf16 v[32:35], v[152:155], a[8:11], v[32:35]
 ds_read_b64_tr_b16 v[144:145], v18 offset:38912
 ds_read_b64_tr_b16 v[146:147], v18 offset:39936
 v_mfma_f32_16x16x32_bf16 v[36:39], v[152:155], a[12:15], v[36:39]
 buffer_load_dwordx4 a[52:55], v7, s[16:19], s42 offen offset:2048 sc1
 v_bfe_u32 v14, v0, 4, 1
 v_mfma_f32_16x16x32_bf16 v[44:47], v[156:159], a[12:15], v[44:47]
 ds_read_b64_tr_b16 v[148:149], v19 offset:38912
 ds_read_b64_tr_b16 v[150:151], v19 offset:39936
 v_mfma_f32_16x16x32_bf16 v[40:43], v[156:159], a[8:11], v[40:43]
 v_bfe_u32 v15, v0, 1, 1
 s_waitcnt lgkmcnt(8)
 v_mfma_f32_16x16x32_bf16 v[48:51], v[160:163], a[8:11], v[48:51]
 ds_read_b64_tr_b16 v[152:153], v16 offset:40960
 ds_read_b64_tr_b16 v[154:155], v16 offset:41984
 v_mfma_f32_16x16x32_bf16 v[52:55], v[160:163], a[12:15], v[52:55]
 buffer_load_dwordx4 a[56:59], v6, s[16:19], s42 offen offset:3072 sc1
 v_cmp_eq_u32 vcc, v14, v15
 v_mfma_f32_16x16x32_bf16 v[60:63], v[164:167], a[12:15], v[60:63]
 ds_read_b64_tr_b16 v[156:157], v17 offset:40960
 ds_read_b64_tr_b16 v[158:159], v17 offset:41984
 v_mfma_f32_16x16x32_bf16 v[56:59], v[164:167], a[8:11], v[56:59]
 v_lshrrev_b32 v14, 5, v0
 s_waitcnt lgkmcnt(8)
 v_mfma_f32_16x16x32_bf16 v[64:67], v[136:139], a[8:11], v[64:67]
 ds_read_b64_tr_b16 v[160:161], v18 offset:40960
 ds_read_b64_tr_b16 v[162:163], v18 offset:41984
 v_mfma_f32_16x16x32_bf16 v[128:131], v[136:139], v[172:175], v[128:131]
 buffer_load_dwordx4 a[60:63], v7, s[16:19], s42 offen offset:3072 sc1
 v_lshlrev_b32 v14, 5, v14
 v_mfma_f32_16x16x32_bf16 v[68:71], v[136:139], a[12:15], v[68:71]
 v_and_b32 v15, 1, v0
 v_lshl_add_u32 v14, v15, 3, v14
 v_mfma_f32_16x16x32_bf16 v[76:79], v[140:143], a[12:15], v[76:79]
 ds_read_b64_tr_b16 v[164:165], v19 offset:40960
 ds_read_b64_tr_b16 v[166:167], v19 offset:41984
 v_mfma_f32_16x16x32_bf16 v[72:75], v[140:143], a[8:11], v[72:75]
 s_mov_b32 s42, 20480
 s_waitcnt lgkmcnt(8)
 v_mfma_f32_16x16x32_bf16 v[80:83], v[144:147], a[8:11], v[80:83]
 s_waitcnt vmcnt(26)
 s_barrier
 ds_read_b64_tr_b16 v[136:137], v16 offset:49152
 v_mfma_f32_16x16x32_bf16 v[84:87], v[144:147], a[12:15], v[84:87]
 ds_read_b64_tr_b16 v[138:139], v16 offset:50176
 buffer_load_dwordx4 a[64:67], v6, s[16:19], s42 offen offset:0 sc1
 v_mfma_f32_16x16x32_bf16 v[92:95], v[148:151], a[12:15], v[92:95]
 ds_read_b64_tr_b16 v[140:141], v17 offset:49152
 ds_read_b64_tr_b16 v[142:143], v17 offset:50176
 s_add_u32 m0, s47, 143360
 v_mfma_f32_16x16x32_bf16 v[88:91], v[148:151], a[8:11], v[88:91]
 s_mov_b32 s46, 20480
 s_waitcnt lgkmcnt(8)
 v_mfma_f32_16x16x32_bf16 v[96:99], a[8:11], v[152:155], v[96:99]
 ds_read_b64_tr_b16 v[144:145], v18 offset:49152
 ds_read_b64_tr_b16 v[146:147], v18 offset:50176
 v_mfma_f32_16x16x32_bf16 v[132:135], v[172:175], v[152:155], v[132:135]
 buffer_load_dwordx4 v8, s[24:27], s46 offen sc1 lds
 v_mfma_f32_16x16x32_bf16 v[100:103], a[12:15], v[152:155], v[100:103]
 ds_read_b128 v[168:171], v24 offset:14336
 s_waitcnt vmcnt(20)
 buffer_store_dwordx2 v[190:191], v189, s[60:63], s53 offen sc1
 v_mfma_f32_16x16x32_bf16 v[108:111], a[12:15], v[156:159], v[108:111]
 ds_read_b64_tr_b16 v[148:149], v19 offset:49152
 ds_read_b64_tr_b16 v[150:151], v19 offset:50176
 s_add_u32 m0, s38, 0
 v_mfma_f32_16x16x32_bf16 v[104:107], a[8:11], v[156:159], v[104:107]
 s_add_u32 s40, s40, s41
 s_waitcnt lgkmcnt(9)
 v_mfma_f32_16x16x32_bf16 v[112:115], a[8:11], v[160:163], v[112:115]
 ds_read_b64_tr_b16 v[152:153], v16 offset:51200
 ds_read_b64_tr_b16 v[154:155], v16 offset:52224
 v_mfma_f32_16x16x32_bf16 v[116:119], a[12:15], v[160:163], v[116:119]
 buffer_load_dwordx4 v2, s[12:15], s40 offen offset:0 sc1 lds
 v_mfma_f32_16x16x32_bf16 v[124:127], a[12:15], v[164:167], v[124:127]
 ds_read_b64_tr_b16 v[156:157], v17 offset:51200
 ds_read_b64_tr_b16 v[158:159], v17 offset:52224
 v_mfma_f32_16x16x32_bf16 v[120:123], a[8:11], v[164:167], v[120:123]
 s_waitcnt lgkmcnt(9)
 v_mfma_f32_16x16x32_bf16 v[32:35], v[136:139], a[16:19], v[32:35]
 ds_read_b64_tr_b16 v[160:161], v18 offset:51200
 ds_read_b64_tr_b16 v[162:163], v18 offset:52224
 v_mfma_f32_16x16x32_bf16 v[36:39], v[136:139], a[20:23], v[36:39]
 global_load_dword v25, v[26:27], off
 v_mfma_f32_16x16x32_bf16 v[44:47], v[140:143], a[20:23], v[44:47]
 ds_read_b64_tr_b16 v[164:165], v19 offset:51200
 ds_read_b64_tr_b16 v[166:167], v19 offset:52224
 v_mfma_f32_16x16x32_bf16 v[40:43], v[140:143], a[16:19], v[40:43]
 s_lshl_b32 s49, s30, 8
 s_waitcnt lgkmcnt(8)
 v_mfma_f32_16x16x32_bf16 v[48:51], v[144:147], a[16:19], v[48:51]
 ds_read_b64_tr_b16 v[136:137], v16 offset:53248
 ds_read_b64_tr_b16 v[138:139], v16 offset:54272
 v_mfma_f32_16x16x32_bf16 v[52:55], v[144:147], a[20:23], v[52:55]
 s_add_u32 s49, s49, 0x2060000
 v_add_u32 v14, s49, v14
 v_mfma_f32_16x16x32_bf16 v[60:63], v[148:151], a[20:23], v[60:63]
 ds_read_b64_tr_b16 v[140:141], v17 offset:53248
 ds_read_b64_tr_b16 v[142:143], v17 offset:54272
 v_mfma_f32_16x16x32_bf16 v[56:59], v[148:151], a[16:19], v[56:59]
 buffer_load_dwordx4 v3, s[12:15], s40 offen offset:1024 sc1 lds
 s_waitcnt lgkmcnt(8)
 v_mfma_f32_16x16x32_bf16 v[64:67], v[152:155], a[16:19], v[64:67]
 ds_read_b64_tr_b16 v[144:145], v18 offset:53248
 ds_read_b64_tr_b16 v[146:147], v18 offset:54272
 v_mfma_f32_16x16x32_bf16 v[128:131], v[152:155], v[168:171], v[128:131]
 v_mov_b32 v15, 0x40000000
 v_cndmask_b32 v237, v15, v14, vcc
 v_mfma_f32_16x16x32_bf16 v[68:71], v[152:155], a[20:23], v[68:71]
 buffer_load_dwordx4 v2, s[12:15], s40 offen offset:2048 sc1 lds
 v_mfma_f32_16x16x32_bf16 v[76:79], v[156:159], a[20:23], v[76:79]
 ds_read_b64_tr_b16 v[148:149], v19 offset:53248
 ds_read_b64_tr_b16 v[150:151], v19 offset:54272
 v_mfma_f32_16x16x32_bf16 v[72:75], v[156:159], a[16:19], v[72:75]
 s_waitcnt lgkmcnt(8)
 v_mfma_f32_16x16x32_bf16 v[80:83], v[160:163], a[16:19], v[80:83]
 ds_read_b64_tr_b16 v[152:153], v16 offset:61440
 ds_read_b64_tr_b16 v[154:155], v16 offset:62464
 v_mfma_f32_16x16x32_bf16 v[84:87], v[160:163], a[20:23], v[84:87]
 v_mfma_f32_16x16x32_bf16 v[92:95], v[164:167], a[20:23], v[92:95]
 ds_read_b64_tr_b16 v[156:157], v17 offset:61440
 ds_read_b64_tr_b16 v[158:159], v17 offset:62464
 v_mfma_f32_16x16x32_bf16 v[88:91], v[164:167], a[16:19], v[88:91]
 buffer_load_dwordx4 v3, s[12:15], s40 offen offset:3072 sc1 lds
 s_waitcnt lgkmcnt(8)
 v_mfma_f32_16x16x32_bf16 v[96:99], a[16:19], v[136:139], v[96:99]
 ds_read_b64_tr_b16 v[160:161], v18 offset:61440
 ds_read_b64_tr_b16 v[162:163], v18 offset:62464
 v_mfma_f32_16x16x32_bf16 v[132:135], v[168:171], v[136:139], v[132:135]
 s_add_u32 m0, s38, 4096
 v_mfma_f32_16x16x32_bf16 v[100:103], a[20:23], v[136:139], v[100:103]
 ds_read_b128 v[172:175], v24 offset:15360
 buffer_load_dwordx4 v4, s[12:15], s40 offen offset:0 sc1 lds
 v_mfma_f32_16x16x32_bf16 v[108:111], a[20:23], v[140:143], v[108:111]
 ds_read_b64_tr_b16 v[164:165], v19 offset:61440
 ds_read_b64_tr_b16 v[166:167], v19 offset:62464
 v_mfma_f32_16x16x32_bf16 v[104:107], a[16:19], v[140:143], v[104:107]
 s_waitcnt lgkmcnt(9)
 v_mfma_f32_16x16x32_bf16 v[112:115], a[16:19], v[144:147], v[112:115]
 ds_read_b64_tr_b16 v[136:137], v16 offset:63488
 ds_read_b64_tr_b16 v[138:139], v16 offset:64512
 v_mfma_f32_16x16x32_bf16 v[116:119], a[20:23], v[144:147], v[116:119]
 v_mfma_f32_16x16x32_bf16 v[124:127], a[20:23], v[148:151], v[124:127]
 ds_read_b64_tr_b16 v[140:141], v17 offset:63488
 ds_read_b64_tr_b16 v[142:143], v17 offset:64512
 v_mfma_f32_16x16x32_bf16 v[120:123], a[16:19], v[148:151], v[120:123]
 buffer_load_dwordx4 v5, s[12:15], s40 offen offset:1024 sc1 lds
 s_waitcnt lgkmcnt(9)
 v_mfma_f32_16x16x32_bf16 v[32:35], v[152:155], a[24:27], v[32:35]
 ds_read_b64_tr_b16 v[144:145], v18 offset:63488
 ds_read_b64_tr_b16 v[146:147], v18 offset:64512
 v_mfma_f32_16x16x32_bf16 v[36:39], v[152:155], a[28:31], v[36:39]
 v_mfma_f32_16x16x32_bf16 v[44:47], v[156:159], a[28:31], v[44:47]
 ds_read_b64_tr_b16 v[148:149], v19 offset:63488
 ds_read_b64_tr_b16 v[150:151], v19 offset:64512
 v_mfma_f32_16x16x32_bf16 v[40:43], v[156:159], a[24:27], v[40:43]
 buffer_load_dwordx4 a[68:71], v7, s[16:19], s42 offen offset:0 sc1
 s_waitcnt lgkmcnt(8)
 v_mfma_f32_16x16x32_bf16 v[48:51], v[160:163], a[24:27], v[48:51]
 ds_read_b64_tr_b16 v[152:153], v20 offset:0
 ds_read_b64_tr_b16 v[154:155], v20 offset:1024
 v_mfma_f32_16x16x32_bf16 v[52:55], v[160:163], a[28:31], v[52:55]
 v_mfma_f32_16x16x32_bf16 v[60:63], v[164:167], a[28:31], v[60:63]
 ds_read_b64_tr_b16 v[156:157], v21 offset:0
 ds_read_b64_tr_b16 v[158:159], v21 offset:1024
 v_mfma_f32_16x16x32_bf16 v[56:59], v[164:167], a[24:27], v[56:59]
 buffer_load_dwordx4 a[72:75], v6, s[16:19], s42 offen offset:1024 sc1
 s_waitcnt lgkmcnt(8)
 v_mfma_f32_16x16x32_bf16 v[64:67], v[136:139], a[24:27], v[64:67]
 ds_read_b64_tr_b16 v[160:161], v22 offset:0
 ds_read_b64_tr_b16 v[162:163], v22 offset:1024
 v_mfma_f32_16x16x32_bf16 v[128:131], v[136:139], v[172:175], v[128:131]
 v_mfma_f32_16x16x32_bf16 v[68:71], v[136:139], a[28:31], v[68:71]
 v_mfma_f32_16x16x32_bf16 v[76:79], v[140:143], a[28:31], v[76:79]
 ds_read_b64_tr_b16 v[164:165], v23 offset:0
 ds_read_b64_tr_b16 v[166:167], v23 offset:1024
 v_mfma_f32_16x16x32_bf16 v[72:75], v[140:143], a[24:27], v[72:75]
 buffer_load_dwordx4 a[76:79], v7, s[16:19], s42 offen offset:1024 sc1
 s_waitcnt lgkmcnt(8)
 v_mfma_f32_16x16x32_bf16 v[80:83], v[144:147], a[24:27], v[80:83]
 s_waitcnt vmcnt(27)
 s_barrier
 ds_read_b64_tr_b16 v[136:137], v20 offset:8192
 v_mfma_f32_16x16x32_bf16 v[84:87], v[144:147], a[28:31], v[84:87]
 ds_read_b64_tr_b16 v[138:139], v20 offset:9216
 s_add_u32 s40, s40, s41
 s_add_u32 m0, s38, 24576
 v_mfma_f32_16x16x32_bf16 v[92:95], v[148:151], a[28:31], v[92:95]
 ds_read_b64_tr_b16 v[140:141], v21 offset:8192
 ds_read_b64_tr_b16 v[142:143], v21 offset:9216
 v_mfma_f32_16x16x32_bf16 v[88:91], v[148:151], a[24:27], v[88:91]
 buffer_load_dwordx4 v2, s[12:15], s40 offen offset:0 sc1 lds
 s_waitcnt lgkmcnt(8)
 v_mfma_f32_16x16x32_bf16 v[96:99], a[24:27], v[152:155], v[96:99]
 ds_read_b64_tr_b16 v[144:145], v22 offset:8192
 ds_read_b64_tr_b16 v[146:147], v22 offset:9216
 v_mfma_f32_16x16x32_bf16 v[132:135], v[172:175], v[152:155], v[132:135]
 v_mfma_f32_16x16x32_bf16 v[100:103], a[28:31], v[152:155], v[100:103]
 ds_read_b128 v[168:171], v24 offset:16384
 v_mfma_f32_16x16x32_bf16 v[108:111], a[28:31], v[156:159], v[108:111]
 ds_read_b64_tr_b16 v[148:149], v23 offset:8192
 ds_read_b64_tr_b16 v[150:151], v23 offset:9216
 v_mfma_f32_16x16x32_bf16 v[104:107], a[24:27], v[156:159], v[104:107]
 buffer_load_dwordx4 v3, s[12:15], s40 offen offset:1024 sc1 lds
 s_waitcnt lgkmcnt(9)
 v_mfma_f32_16x16x32_bf16 v[112:115], a[24:27], v[160:163], v[112:115]
 ds_read_b64_tr_b16 v[152:153], v20 offset:10240
 ds_read_b64_tr_b16 v[154:155], v20 offset:11264
 v_mfma_f32_16x16x32_bf16 v[116:119], a[28:31], v[160:163], v[116:119]
 v_mfma_f32_16x16x32_bf16 v[124:127], a[28:31], v[164:167], v[124:127]
 ds_read_b64_tr_b16 v[156:157], v21 offset:10240
 ds_read_b64_tr_b16 v[158:159], v21 offset:11264
 v_mfma_f32_16x16x32_bf16 v[120:123], a[24:27], v[164:167], v[120:123]
 buffer_load_dwordx4 v2, s[12:15], s40 offen offset:2048 sc1 lds
 s_waitcnt vmcnt(28) lgkmcnt(9)
 v_mfma_f32_16x16x32_bf16 v[32:35], v[136:139], a[32:35], v[32:35]
 ds_read_b64_tr_b16 v[160:161], v22 offset:10240
 ds_read_b64_tr_b16 v[162:163], v22 offset:11264
 v_mfma_f32_16x16x32_bf16 v[36:39], v[136:139], a[36:39], v[36:39]
 v_mfma_f32_16x16x32_bf16 v[44:47], v[140:143], a[36:39], v[44:47]
 ds_read_b64_tr_b16 v[164:165], v23 offset:10240
 ds_read_b64_tr_b16 v[166:167], v23 offset:11264
 v_mfma_f32_16x16x32_bf16 v[40:43], v[140:143], a[32:35], v[40:43]
 buffer_load_dwordx4 v3, s[12:15], s40 offen offset:3072 sc1 lds
 s_waitcnt lgkmcnt(8)
 v_mfma_f32_16x16x32_bf16 v[48:51], v[144:147], a[32:35], v[48:51]
 ds_read_b64_tr_b16 v[136:137], v20 offset:12288
 ds_read_b64_tr_b16 v[138:139], v20 offset:13312
 s_branch m_ps_p1_2
m_pad_p1_2:
 s_branch m_reta_p1
m_ps_p1_2:
 v_mfma_f32_16x16x32_bf16 v[52:55], v[144:147], a[36:39], v[52:55]
 v_mfma_f32_16x16x32_bf16 v[60:63], v[148:151], a[36:39], v[60:63]
 ds_read_b64_tr_b16 v[140:141], v21 offset:12288
 ds_read_b64_tr_b16 v[142:143], v21 offset:13312
 v_mfma_f32_16x16x32_bf16 v[56:59], v[148:151], a[32:35], v[56:59]
 s_add_u32 m0, s38, 28672
 s_waitcnt lgkmcnt(8)
 v_mfma_f32_16x16x32_bf16 v[64:67], v[152:155], a[32:35], v[64:67]
 ds_read_b64_tr_b16 v[144:145], v22 offset:12288
 ds_read_b64_tr_b16 v[146:147], v22 offset:13312
 v_mfma_f32_16x16x32_bf16 v[128:131], v[152:155], v[168:171], v[128:131]
 buffer_load_dwordx4 v4, s[12:15], s40 offen offset:0 sc1 lds
 v_mfma_f32_16x16x32_bf16 v[68:71], v[152:155], a[36:39], v[68:71]
 v_mfma_f32_16x16x32_bf16 v[76:79], v[156:159], a[36:39], v[76:79]
 ds_read_b64_tr_b16 v[148:149], v23 offset:12288
 ds_read_b64_tr_b16 v[150:151], v23 offset:13312
 v_mfma_f32_16x16x32_bf16 v[72:75], v[156:159], a[32:35], v[72:75]
 buffer_load_dwordx4 v5, s[12:15], s40 offen offset:1024 sc1 lds
 s_waitcnt lgkmcnt(8)
 v_mfma_f32_16x16x32_bf16 v[80:83], v[160:163], a[32:35], v[80:83]
 ds_read_b64_tr_b16 v[152:153], v20 offset:20480
 ds_read_b64_tr_b16 v[154:155], v20 offset:21504
 v_mfma_f32_16x16x32_bf16 v[84:87], v[160:163], a[36:39], v[84:87]
 v_mfma_f32_16x16x32_bf16 v[92:95], v[164:167], a[36:39], v[92:95]
 ds_read_b64_tr_b16 v[156:157], v21 offset:20480
 ds_read_b64_tr_b16 v[158:159], v21 offset:21504
 v_mfma_f32_16x16x32_bf16 v[88:91], v[164:167], a[32:35], v[88:91]
 s_waitcnt lgkmcnt(8)
 v_mfma_f32_16x16x32_bf16 v[96:99], a[32:35], v[136:139], v[96:99]
 ds_read_b64_tr_b16 v[160:161], v22 offset:20480
 ds_read_b64_tr_b16 v[162:163], v22 offset:21504
 v_mfma_f32_16x16x32_bf16 v[132:135], v[168:171], v[136:139], v[132:135]
 buffer_load_dwordx4 a[80:83], v6, s[16:19], s42 offen offset:2048 sc1
 v_mfma_f32_16x16x32_bf16 v[100:103], a[36:39], v[136:139], v[100:103]
 ds_read_b128 v[172:175], v24 offset:17408
 v_mfma_f32_16x16x32_bf16 v[108:111], a[36:39], v[140:143], v[108:111]
 ds_read_b64_tr_b16 v[164:165], v23 offset:20480
 ds_read_b64_tr_b16 v[166:167], v23 offset:21504
 v_mfma_f32_16x16x32_bf16 v[104:107], a[32:35], v[140:143], v[104:107]
 buffer_load_dwordx4 a[84:87], v7, s[16:19], s42 offen offset:2048 sc1
 s_waitcnt lgkmcnt(9)
 v_mfma_f32_16x16x32_bf16 v[112:115], a[32:35], v[144:147], v[112:115]
 ds_read_b64_tr_b16 v[136:137], v20 offset:22528
 ds_read_b64_tr_b16 v[138:139], v20 offset:23552
 v_mfma_f32_16x16x32_bf16 v[116:119], a[36:39], v[144:147], v[116:119]
 v_mfma_f32_16x16x32_bf16 v[124:127], a[36:39], v[148:151], v[124:127]
 ds_read_b64_tr_b16 v[140:141], v21 offset:22528
 ds_read_b64_tr_b16 v[142:143], v21 offset:23552
 v_mfma_f32_16x16x32_bf16 v[120:123], a[32:35], v[148:151], v[120:123]
 s_waitcnt vmcnt(31) lgkmcnt(9)
 v_mfma_f32_16x16x32_bf16 v[32:35], v[152:155], a[40:43], v[32:35]
 ds_read_b64_tr_b16 v[144:145], v22 offset:22528
 ds_read_b64_tr_b16 v[146:147], v22 offset:23552
 v_mfma_f32_16x16x32_bf16 v[36:39], v[152:155], a[44:47], v[36:39]
 buffer_load_dwordx4 a[88:91], v6, s[16:19], s42 offen offset:3072 sc1
 v_mfma_f32_16x16x32_bf16 v[44:47], v[156:159], a[44:47], v[44:47]
 ds_read_b64_tr_b16 v[148:149], v23 offset:22528
 ds_read_b64_tr_b16 v[150:151], v23 offset:23552
 v_mfma_f32_16x16x32_bf16 v[40:43], v[156:159], a[40:43], v[40:43]
 s_waitcnt lgkmcnt(8)
 v_mfma_f32_16x16x32_bf16 v[48:51], v[160:163], a[40:43], v[48:51]
 ds_read_b64_tr_b16 v[152:153], v20 offset:24576
 ds_read_b64_tr_b16 v[154:155], v20 offset:25600
 v_mfma_f32_16x16x32_bf16 v[52:55], v[160:163], a[44:47], v[52:55]
 buffer_load_dwordx4 a[92:95], v7, s[16:19], s42 offen offset:3072 sc1
 v_mfma_f32_16x16x32_bf16 v[60:63], v[164:167], a[44:47], v[60:63]
 ds_read_b64_tr_b16 v[156:157], v21 offset:24576
 ds_read_b64_tr_b16 v[158:159], v21 offset:25600
 v_mfma_f32_16x16x32_bf16 v[56:59], v[164:167], a[40:43], v[56:59]
 s_mov_b32 s42, 24576
 s_waitcnt lgkmcnt(8)
 v_mfma_f32_16x16x32_bf16 v[64:67], v[136:139], a[40:43], v[64:67]
 ds_read_b64_tr_b16 v[160:161], v22 offset:24576
 ds_read_b64_tr_b16 v[162:163], v22 offset:25600
 v_mfma_f32_16x16x32_bf16 v[128:131], v[136:139], v[172:175], v[128:131]
 buffer_load_dwordx4 a[0:3], v6, s[16:19], s42 offen offset:0 sc1
 v_mfma_f32_16x16x32_bf16 v[68:71], v[136:139], a[44:47], v[68:71]
 v_mfma_f32_16x16x32_bf16 v[76:79], v[140:143], a[44:47], v[76:79]
 ds_read_b64_tr_b16 v[164:165], v23 offset:24576
 ds_read_b64_tr_b16 v[166:167], v23 offset:25600
 v_mfma_f32_16x16x32_bf16 v[72:75], v[140:143], a[40:43], v[72:75]
 s_waitcnt lgkmcnt(8)
 v_mfma_f32_16x16x32_bf16 v[80:83], v[144:147], a[40:43], v[80:83]
 s_waitcnt vmcnt(28)
 s_barrier
 ds_read_b64_tr_b16 v[136:137], v20 offset:32768
 v_mfma_f32_16x16x32_bf16 v[84:87], v[144:147], a[44:47], v[84:87]
 ds_read_b64_tr_b16 v[138:139], v20 offset:33792
 buffer_load_dwordx4 a[4:7], v7, s[16:19], s42 offen offset:0 sc1
 v_mfma_f32_16x16x32_bf16 v[92:95], v[148:151], a[44:47], v[92:95]
 ds_read_b64_tr_b16 v[140:141], v21 offset:32768
 ds_read_b64_tr_b16 v[142:143], v21 offset:33792
 s_add_u32 m0, s47, 147456
 v_mfma_f32_16x16x32_bf16 v[88:91], v[148:151], a[40:43], v[88:91]
 s_mov_b32 s46, 24576
 s_waitcnt lgkmcnt(8)
 v_mfma_f32_16x16x32_bf16 v[96:99], a[40:43], v[152:155], v[96:99]
 ds_read_b64_tr_b16 v[144:145], v22 offset:32768
 ds_read_b64_tr_b16 v[146:147], v22 offset:33792
 v_mfma_f32_16x16x32_bf16 v[132:135], v[172:175], v[152:155], v[132:135]
 buffer_load_dwordx4 v8, s[24:27], s46 offen sc1 lds
 v_mfma_f32_16x16x32_bf16 v[100:103], a[44:47], v[152:155], v[100:103]
 ds_read_b128 v[168:171], v24 offset:18432
 v_mfma_f32_16x16x32_bf16 v[108:111], a[44:47], v[156:159], v[108:111]
 ds_read_b64_tr_b16 v[148:149], v23 offset:32768
 ds_read_b64_tr_b16 v[150:151], v23 offset:33792
 s_add_u32 m0, s38, 49152
 v_mfma_f32_16x16x32_bf16 v[104:107], a[40:43], v[156:159], v[104:107]
 s_add_u32 s40, s40, s41
 s_waitcnt lgkmcnt(9)
 v_mfma_f32_16x16x32_bf16 v[112:115], a[40:43], v[160:163], v[112:115]
 ds_read_b64_tr_b16 v[152:153], v20 offset:34816
 ds_read_b64_tr_b16 v[154:155], v20 offset:35840
 v_mfma_f32_16x16x32_bf16 v[116:119], a[44:47], v[160:163], v[116:119]
 buffer_load_dwordx4 v2, s[12:15], s40 offen offset:0 sc1 lds
 v_mfma_f32_16x16x32_bf16 v[124:127], a[44:47], v[164:167], v[124:127]
 ds_read_b64_tr_b16 v[156:157], v21 offset:34816
 ds_read_b64_tr_b16 v[158:159], v21 offset:35840
 v_mfma_f32_16x16x32_bf16 v[120:123], a[40:43], v[164:167], v[120:123]
 s_waitcnt vmcnt(29) lgkmcnt(9)
 v_mfma_f32_16x16x32_bf16 v[32:35], v[136:139], a[48:51], v[32:35]
 ds_read_b64_tr_b16 v[160:161], v22 offset:34816
 ds_read_b64_tr_b16 v[162:163], v22 offset:35840
 v_mfma_f32_16x16x32_bf16 v[36:39], v[136:139], a[52:55], v[36:39]
 buffer_load_dwordx4 v3, s[12:15], s40 offen offset:1024 sc1 lds
 v_mfma_f32_16x16x32_bf16 v[44:47], v[140:143], a[52:55], v[44:47]
 ds_read_b64_tr_b16 v[164:165], v23 offset:34816
 ds_read_b64_tr_b16 v[166:167], v23 offset:35840
 v_mfma_f32_16x16x32_bf16 v[40:43], v[140:143], a[48:51], v[40:43]
 s_waitcnt lgkmcnt(8)
 v_mfma_f32_16x16x32_bf16 v[48:51], v[144:147], a[48:51], v[48:51]
 ds_read_b64_tr_b16 v[136:137], v20 offset:36864
 ds_read_b64_tr_b16 v[138:139], v20 offset:37888
 v_mfma_f32_16x16x32_bf16 v[52:55], v[144:147], a[52:55], v[52:55]
 buffer_load_dwordx4 v2, s[12:15], s40 offen offset:2048 sc1 lds
 v_mfma_f32_16x16x32_bf16 v[60:63], v[148:151], a[52:55], v[60:63]
 ds_read_b64_tr_b16 v[140:141], v21 offset:36864
 ds_read_b64_tr_b16 v[142:143], v21 offset:37888
 v_mfma_f32_16x16x32_bf16 v[56:59], v[148:151], a[48:51], v[56:59]
 s_waitcnt lgkmcnt(8)
 v_mfma_f32_16x16x32_bf16 v[64:67], v[152:155], a[48:51], v[64:67]
 ds_read_b64_tr_b16 v[144:145], v22 offset:36864
 ds_read_b64_tr_b16 v[146:147], v22 offset:37888
 v_mfma_f32_16x16x32_bf16 v[128:131], v[152:155], v[168:171], v[128:131]
 v_mfma_f32_16x16x32_bf16 v[68:71], v[152:155], a[52:55], v[68:71]
 buffer_load_dwordx4 v3, s[12:15], s40 offen offset:3072 sc1 lds
 v_mfma_f32_16x16x32_bf16 v[76:79], v[156:159], a[52:55], v[76:79]
 ds_read_b64_tr_b16 v[148:149], v23 offset:36864
 ds_read_b64_tr_b16 v[150:151], v23 offset:37888
 v_mfma_f32_16x16x32_bf16 v[72:75], v[156:159], a[48:51], v[72:75]
 s_add_u32 m0, s38, 53248
 s_waitcnt lgkmcnt(8)
 v_mfma_f32_16x16x32_bf16 v[80:83], v[160:163], a[48:51], v[80:83]
 ds_read_b64_tr_b16 v[152:153], v20 offset:45056
 ds_read_b64_tr_b16 v[154:155], v20 offset:46080
 v_mfma_f32_16x16x32_bf16 v[84:87], v[160:163], a[52:55], v[84:87]
 buffer_load_dwordx4 v4, s[12:15], s40 offen offset:0 sc1 lds
 v_mfma_f32_16x16x32_bf16 v[92:95], v[164:167], a[52:55], v[92:95]
 ds_read_b64_tr_b16 v[156:157], v21 offset:45056
 ds_read_b64_tr_b16 v[158:159], v21 offset:46080
 v_mfma_f32_16x16x32_bf16 v[88:91], v[164:167], a[48:51], v[88:91]
 s_waitcnt lgkmcnt(8)
 v_mfma_f32_16x16x32_bf16 v[96:99], a[48:51], v[136:139], v[96:99]
 ds_read_b64_tr_b16 v[160:161], v22 offset:45056
 ds_read_b64_tr_b16 v[162:163], v22 offset:46080
 v_mfma_f32_16x16x32_bf16 v[132:135], v[168:171], v[136:139], v[132:135]
 v_mfma_f32_16x16x32_bf16 v[100:103], a[52:55], v[136:139], v[100:103]
 ds_read_b128 v[172:175], v24 offset:19456
 buffer_load_dwordx4 v5, s[12:15], s40 offen offset:1024 sc1 lds
 v_mfma_f32_16x16x32_bf16 v[108:111], a[52:55], v[140:143], v[108:111]
 ds_read_b64_tr_b16 v[164:165], v23 offset:45056
 ds_read_b64_tr_b16 v[166:167], v23 offset:46080
 v_mfma_f32_16x16x32_bf16 v[104:107], a[48:51], v[140:143], v[104:107]
 s_waitcnt lgkmcnt(9)
 v_mfma_f32_16x16x32_bf16 v[112:115], a[48:51], v[144:147], v[112:115]
 ds_read_b64_tr_b16 v[136:137], v20 offset:47104
 ds_read_b64_tr_b16 v[138:139], v20 offset:48128
 v_mfma_f32_16x16x32_bf16 v[116:119], a[52:55], v[144:147], v[116:119]
 buffer_load_dwordx4 a[8:11], v6, s[16:19], s42 offen offset:1024 sc1
 v_mfma_f32_16x16x32_bf16 v[124:127], a[52:55], v[148:151], v[124:127]
 ds_read_b64_tr_b16 v[140:141], v21 offset:47104
 ds_read_b64_tr_b16 v[142:143], v21 offset:48128
 v_mfma_f32_16x16x32_bf16 v[120:123], a[48:51], v[148:151], v[120:123]
 s_waitcnt vmcnt(33) lgkmcnt(9)
 v_mfma_f32_16x16x32_bf16 v[32:35], v[152:155], a[56:59], v[32:35]
 ds_read_b64_tr_b16 v[144:145], v22 offset:47104
 ds_read_b64_tr_b16 v[146:147], v22 offset:48128
 v_mfma_f32_16x16x32_bf16 v[36:39], v[152:155], a[60:63], v[36:39]
 s_and_b32 s33, s11, 1
 s_lshl_b32 s33, s33, 3
 v_mfma_f32_16x16x32_bf16 v[44:47], v[156:159], a[60:63], v[44:47]
 ds_read_b64_tr_b16 v[148:149], v23 offset:47104
 ds_read_b64_tr_b16 v[150:151], v23 offset:48128
 v_mfma_f32_16x16x32_bf16 v[40:43], v[156:159], a[56:59], v[40:43]
 buffer_load_dwordx4 a[12:15], v7, s[16:19], s42 offen offset:1024 sc1
 s_waitcnt lgkmcnt(8)
 v_mfma_f32_16x16x32_bf16 v[48:51], v[160:163], a[56:59], v[48:51]
 ds_read_b64_tr_b16 v[152:153], v20 offset:49152
 ds_read_b64_tr_b16 v[154:155], v20 offset:50176
 v_mfma_f32_16x16x32_bf16 v[52:55], v[160:163], a[60:63], v[52:55]
 s_and_b32 s34, s11, 2
 s_lshl_b32 s34, s34, 1
 v_mfma_f32_16x16x32_bf16 v[60:63], v[164:167], a[60:63], v[60:63]
 ds_read_b64_tr_b16 v[156:157], v21 offset:49152
 ds_read_b64_tr_b16 v[158:159], v21 offset:50176
 v_mfma_f32_16x16x32_bf16 v[56:59], v[164:167], a[56:59], v[56:59]
 buffer_load_dwordx4 a[16:19], v6, s[16:19], s42 offen offset:2048 sc1
 s_waitcnt lgkmcnt(8)
 v_mfma_f32_16x16x32_bf16 v[64:67], v[136:139], a[56:59], v[64:67]
 ds_read_b64_tr_b16 v[160:161], v22 offset:49152
 ds_read_b64_tr_b16 v[162:163], v22 offset:50176
 v_mfma_f32_16x16x32_bf16 v[128:131], v[136:139], v[172:175], v[128:131]
 s_add_u32 s33, s33, s34
 s_and_b32 s34, s28, 3
 v_mfma_f32_16x16x32_bf16 v[68:71], v[136:139], a[60:63], v[68:71]
 s_add_u32 s33, s33, s34
 s_lshr_b32 s34, s11, 2
 v_mfma_f32_16x16x32_bf16 v[76:79], v[140:143], a[60:63], v[76:79]
 ds_read_b64_tr_b16 v[164:165], v23 offset:49152
 ds_read_b64_tr_b16 v[166:167], v23 offset:50176
 v_mfma_f32_16x16x32_bf16 v[72:75], v[140:143], a[56:59], v[72:75]
 buffer_load_dwordx4 a[20:23], v7, s[16:19], s42 offen offset:2048 sc1
 s_waitcnt lgkmcnt(8)
 v_mfma_f32_16x16x32_bf16 v[80:83], v[144:147], a[56:59], v[80:83]
 s_waitcnt vmcnt(26)
 s_barrier
 ds_read_b64_tr_b16 v[136:137], v16 offset:0
 v_mfma_f32_16x16x32_bf16 v[84:87], v[144:147], a[60:63], v[84:87]
 ds_read_b64_tr_b16 v[138:139], v16 offset:1024
 s_add_u32 s40, s40, s41
 s_add_u32 m0, s38, 73728
 v_mfma_f32_16x16x32_bf16 v[92:95], v[148:151], a[60:63], v[92:95]
 ds_read_b64_tr_b16 v[140:141], v17 offset:0
 ds_read_b64_tr_b16 v[142:143], v17 offset:1024
 v_mfma_f32_16x16x32_bf16 v[88:91], v[148:151], a[56:59], v[88:91]
 buffer_load_dwordx4 v2, s[12:15], s40 offen offset:0 sc1 lds
 s_waitcnt lgkmcnt(8)
 v_mfma_f32_16x16x32_bf16 v[96:99], a[56:59], v[152:155], v[96:99]
 ds_read_b64_tr_b16 v[144:145], v18 offset:0
 ds_read_b64_tr_b16 v[146:147], v18 offset:1024
 v_mfma_f32_16x16x32_bf16 v[132:135], v[172:175], v[152:155], v[132:135]
 v_mfma_f32_16x16x32_bf16 v[100:103], a[60:63], v[152:155], v[100:103]
 ds_read_b128 v[168:171], v24 offset:20480
 s_lshr_b32 s31, s28, 2
 v_mfma_f32_16x16x32_bf16 v[108:111], a[60:63], v[156:159], v[108:111]
 ds_read_b64_tr_b16 v[148:149], v19 offset:0
 ds_read_b64_tr_b16 v[150:151], v19 offset:1024
 v_mfma_f32_16x16x32_bf16 v[104:107], a[56:59], v[156:159], v[104:107]
 buffer_load_dwordx4 v3, s[12:15], s40 offen offset:1024 sc1 lds
 s_waitcnt lgkmcnt(9)
 v_mfma_f32_16x16x32_bf16 v[112:115], a[56:59], v[160:163], v[112:115]
 ds_read_b64_tr_b16 v[152:153], v16 offset:2048
 ds_read_b64_tr_b16 v[154:155], v16 offset:3072
 v_mfma_f32_16x16x32_bf16 v[116:119], a[60:63], v[160:163], v[116:119]
 s_lshl_b32 s34, s34, 3
 s_add_u32 s34, s34, s31
 v_mfma_f32_16x16x32_bf16 v[124:127], a[60:63], v[164:167], v[124:127]
 ds_read_b64_tr_b16 v[156:157], v17 offset:2048
 ds_read_b64_tr_b16 v[158:159], v17 offset:3072
 v_mfma_f32_16x16x32_bf16 v[120:123], a[56:59], v[164:167], v[120:123]
 buffer_load_dwordx4 v2, s[12:15], s40 offen offset:2048 sc1 lds
 s_waitcnt vmcnt(28) lgkmcnt(9)
 v_mfma_f32_16x16x32_bf16 v[32:35], v[136:139], a[64:67], v[32:35]
 ds_read_b64_tr_b16 v[160:161], v18 offset:2048
 ds_read_b64_tr_b16 v[162:163], v18 offset:3072
 v_mfma_f32_16x16x32_bf16 v[36:39], v[136:139], a[68:71], v[36:39]
 s_lshl_b32 s35, s34, 7
 v_mfma_f32_16x16x32_bf16 v[44:47], v[140:143], a[68:71], v[44:47]
 ds_read_b64_tr_b16 v[164:165], v19 offset:2048
 ds_read_b64_tr_b16 v[166:167], v19 offset:3072
 v_mfma_f32_16x16x32_bf16 v[40:43], v[140:143], a[64:67], v[40:43]
 buffer_load_dwordx4 v3, s[12:15], s40 offen offset:3072 sc1 lds
 s_waitcnt lgkmcnt(8)
 v_mfma_f32_16x16x32_bf16 v[48:51], v[144:147], a[64:67], v[48:51]
 ds_read_b64_tr_b16 v[136:137], v16 offset:4096
 ds_read_b64_tr_b16 v[138:139], v16 offset:5120
 v_mfma_f32_16x16x32_bf16 v[52:55], v[144:147], a[68:71], v[52:55]
 s_add_u32 m0, s38, 77824
 s_sub_u32 s39, s35, 1024
 s_subb_u32 s43, 0, 0
 v_mfma_f32_16x16x32_bf16 v[60:63], v[148:151], a[68:71], v[60:63]
 ds_read_b64_tr_b16 v[140:141], v17 offset:4096
 ds_read_b64_tr_b16 v[142:143], v17 offset:5120
 v_mfma_f32_16x16x32_bf16 v[56:59], v[148:151], a[64:67], v[56:59]
 buffer_load_dwordx4 v4, s[12:15], s40 offen offset:0 sc1 lds
 s_waitcnt lgkmcnt(8)
 v_mfma_f32_16x16x32_bf16 v[64:67], v[152:155], a[64:67], v[64:67]
 ds_read_b64_tr_b16 v[144:145], v18 offset:4096
 ds_read_b64_tr_b16 v[146:147], v18 offset:5120
 v_mfma_f32_16x16x32_bf16 v[128:131], v[152:155], v[168:171], v[128:131]
 s_add_u32 s20, s68, s39
 s_addc_u32 s21, s69, s43
 v_mfma_f32_16x16x32_bf16 v[68:71], v[152:155], a[68:71], v[68:71]
 s_sub_u32 s22, 2098176, s35
 s_mov_b32 s23, 0x20000
 v_mfma_f32_16x16x32_bf16 v[76:79], v[156:159], a[68:71], v[76:79]
 ds_read_b64_tr_b16 v[148:149], v19 offset:4096
 ds_read_b64_tr_b16 v[150:151], v19 offset:5120
 v_mfma_f32_16x16x32_bf16 v[72:75], v[156:159], a[64:67], v[72:75]
 buffer_load_dwordx4 v5, s[12:15], s40 offen offset:1024 sc1 lds
 s_waitcnt lgkmcnt(8)
 v_mfma_f32_16x16x32_bf16 v[80:83], v[160:163], a[64:67], v[80:83]
 ds_read_b64_tr_b16 v[152:153], v16 offset:12288
 ds_read_b64_tr_b16 v[154:155], v16 offset:13312
 v_mfma_f32_16x16x32_bf16 v[84:87], v[160:163], a[68:71], v[84:87]
 v_lshrrev_b32 v11, 5, v0
 v_lshlrev_b32 v11, 3, v11
 v_mfma_f32_16x16x32_bf16 v[92:95], v[164:167], a[68:71], v[92:95]
 ds_read_b64_tr_b16 v[156:157], v17 offset:12288
 ds_read_b64_tr_b16 v[158:159], v17 offset:13312
 v_mfma_f32_16x16x32_bf16 v[88:91], v[164:167], a[64:67], v[88:91]
 buffer_load_dwordx4 a[24:27], v6, s[16:19], s42 offen offset:3072 sc1
 s_waitcnt lgkmcnt(8)
 v_mfma_f32_16x16x32_bf16 v[96:99], a[64:67], v[136:139], v[96:99]
 ds_read_b64_tr_b16 v[160:161], v18 offset:12288
 ds_read_b64_tr_b16 v[162:163], v18 offset:13312
 v_mfma_f32_16x16x32_bf16 v[132:135], v[168:171], v[136:139], v[132:135]
 v_bfe_u32 v12, v0, 3, 2
 v_add_u32 v11, v11, v12
 v_mfma_f32_16x16x32_bf16 v[100:103], a[68:71], v[136:139], v[100:103]
 ds_read_b128 v[172:175], v24 offset:21504
 s_lshl_b32 s32, s10, 4
 v_mfma_f32_16x16x32_bf16 v[108:111], a[68:71], v[140:143], v[108:111]
 ds_read_b64_tr_b16 v[164:165], v19 offset:12288
 ds_read_b64_tr_b16 v[166:167], v19 offset:13312
 v_mfma_f32_16x16x32_bf16 v[104:107], a[64:67], v[140:143], v[104:107]
 buffer_load_dwordx4 a[28:31], v7, s[16:19], s42 offen offset:3072 sc1
 s_waitcnt lgkmcnt(9)
 v_mfma_f32_16x16x32_bf16 v[112:115], a[64:67], v[144:147], v[112:115]
 ds_read_b64_tr_b16 v[136:137], v16 offset:14336
 ds_read_b64_tr_b16 v[138:139], v16 offset:15360
 v_mfma_f32_16x16x32_bf16 v[116:119], a[68:71], v[144:147], v[116:119]
 s_mov_b32 s42, 28672
 v_add_u32 v11, s32, v11
 v_mfma_f32_16x16x32_bf16 v[124:127], a[68:71], v[148:151], v[124:127]
 ds_read_b64_tr_b16 v[140:141], v17 offset:14336
 ds_read_b64_tr_b16 v[142:143], v17 offset:15360
 v_mfma_f32_16x16x32_bf16 v[120:123], a[64:67], v[148:151], v[120:123]
 buffer_load_dwordx4 a[32:35], v6, s[16:19], s42 offen offset:0 sc1
 s_waitcnt vmcnt(32) lgkmcnt(9)
 v_mfma_f32_16x16x32_bf16 v[32:35], v[152:155], a[72:75], v[32:35]
 ds_read_b64_tr_b16 v[144:145], v18 offset:14336
 ds_read_b64_tr_b16 v[146:147], v18 offset:15360
 v_mfma_f32_16x16x32_bf16 v[36:39], v[152:155], a[76:79], v[36:39]
 v_lshlrev_b32 v11, 11, v11
 v_bfe_u32 v12, v0, 4, 2
 v_mfma_f32_16x16x32_bf16 v[44:47], v[156:159], a[76:79], v[44:47]
 ds_read_b64_tr_b16 v[148:149], v19 offset:14336
 ds_read_b64_tr_b16 v[150:151], v19 offset:15360
 v_mfma_f32_16x16x32_bf16 v[40:43], v[156:159], a[72:75], v[40:43]
 v_lshlrev_b32 v12, 1, v12
 s_waitcnt lgkmcnt(8)
 v_mfma_f32_16x16x32_bf16 v[48:51], v[160:163], a[72:75], v[48:51]
 ds_read_b64_tr_b16 v[152:153], v16 offset:16384
 ds_read_b64_tr_b16 v[154:155], v16 offset:17408
 v_mfma_f32_16x16x32_bf16 v[52:55], v[160:163], a[76:79], v[52:55]
 buffer_load_dwordx4 a[36:39], v7, s[16:19], s42 offen offset:0 sc1
 v_and_b32 v14, 7, v0
 v_mfma_f32_16x16x32_bf16 v[60:63], v[164:167], a[76:79], v[60:63]
 ds_read_b64_tr_b16 v[156:157], v17 offset:16384
 ds_read_b64_tr_b16 v[158:159], v17 offset:17408
 v_mfma_f32_16x16x32_bf16 v[56:59], v[164:167], a[72:75], v[56:59]
 v_xor_b32 v12, v12, v14
 s_waitcnt lgkmcnt(8)
 v_mfma_f32_16x16x32_bf16 v[64:67], v[136:139], a[72:75], v[64:67]
 ds_read_b64_tr_b16 v[160:161], v18 offset:16384
 ds_read_b64_tr_b16 v[162:163], v18 offset:17408
 v_mfma_f32_16x16x32_bf16 v[128:131], v[136:139], v[172:175], v[128:131]
 buffer_load_dwordx4 a[40:43], v6, s[16:19], s42 offen offset:1024 sc1
 v_lshl_add_u32 v27, v12, 4, v11
 v_mfma_f32_16x16x32_bf16 v[68:71], v[136:139], a[76:79], v[68:71]
 v_add_u32 v26, 1024, v27
 v_add_u32 v27, 8192, v27
 v_mfma_f32_16x16x32_bf16 v[76:79], v[140:143], a[76:79], v[76:79]
 ds_read_b64_tr_b16 v[164:165], v19 offset:16384
 ds_read_b64_tr_b16 v[166:167], v19 offset:17408
 v_mfma_f32_16x16x32_bf16 v[72:75], v[140:143], a[72:75], v[72:75]
 s_lshl_b32 s45, s10, 11
 s_waitcnt lgkmcnt(8)
 v_mfma_f32_16x16x32_bf16 v[80:83], v[144:147], a[72:75], v[80:83]
 s_waitcnt vmcnt(28)
 s_barrier
 ds_read_b64_tr_b16 v[136:137], v16 offset:24576
 v_mfma_f32_16x16x32_bf16 v[84:87], v[144:147], a[76:79], v[84:87]
 ds_read_b64_tr_b16 v[138:139], v16 offset:25600
 buffer_load_dwordx4 a[44:47], v7, s[16:19], s42 offen offset:1024 sc1
 v_mfma_f32_16x16x32_bf16 v[92:95], v[148:151], a[76:79], v[92:95]
 ds_read_b64_tr_b16 v[140:141], v17 offset:24576
 ds_read_b64_tr_b16 v[142:143], v17 offset:25600
 s_add_u32 m0, s47, 151552
 v_mfma_f32_16x16x32_bf16 v[88:91], v[148:151], a[72:75], v[88:91]
 s_mov_b32 s46, 28672
 s_waitcnt lgkmcnt(8)
 v_mfma_f32_16x16x32_bf16 v[96:99], a[72:75], v[152:155], v[96:99]
 ds_read_b64_tr_b16 v[144:145], v18 offset:24576
 ds_read_b64_tr_b16 v[146:147], v18 offset:25600
 v_mfma_f32_16x16x32_bf16 v[132:135], v[172:175], v[152:155], v[132:135]
 buffer_load_dwordx4 v8, s[24:27], s46 offen sc1 lds
 s_mov_b32 s44, 0x20000
 v_mfma_f32_16x16x32_bf16 v[100:103], a[76:79], v[152:155], v[100:103]
 ds_read_b128 v[168:171], v24 offset:22528
 v_mfma_f32_16x16x32_bf16 v[108:111], a[76:79], v[156:159], v[108:111]
 ds_read_b64_tr_b16 v[148:149], v19 offset:24576
 ds_read_b64_tr_b16 v[150:151], v19 offset:25600
 s_add_u32 m0, s38, 98304
 buffer_load_dwordx2 v[196:197], v198, s[60:63], s44 offen sc1
 v_mfma_f32_16x16x32_bf16 v[104:107], a[72:75], v[156:159], v[104:107]
 s_add_u32 s40, s40, s41
 s_waitcnt lgkmcnt(9)
 v_mfma_f32_16x16x32_bf16 v[112:115], a[72:75], v[160:163], v[112:115]
 ds_read_b64_tr_b16 v[152:153], v16 offset:26624
 ds_read_b64_tr_b16 v[154:155], v16 offset:27648
 v_mfma_f32_16x16x32_bf16 v[116:119], a[76:79], v[160:163], v[116:119]
 buffer_load_dwordx4 v2, s[12:15], s40 offen offset:0 sc1 lds
 v_mfma_f32_16x16x32_bf16 v[124:127], a[76:79], v[164:167], v[124:127]
 ds_read_b64_tr_b16 v[156:157], v17 offset:26624
 ds_read_b64_tr_b16 v[158:159], v17 offset:27648
 v_mfma_f32_16x16x32_bf16 v[120:123], a[72:75], v[164:167], v[120:123]
 s_lshl_b32 s31, s33, 3
 s_waitcnt vmcnt(30) lgkmcnt(9)
 v_mfma_f32_16x16x32_bf16 v[32:35], v[136:139], a[80:83], v[32:35]
 ds_read_b64_tr_b16 v[160:161], v18 offset:26624
 ds_read_b64_tr_b16 v[162:163], v18 offset:27648
 v_mfma_f32_16x16x32_bf16 v[36:39], v[136:139], a[84:87], v[36:39]
 buffer_load_dwordx4 v3, s[12:15], s40 offen offset:1024 sc1 lds
 s_lshl_b32 s32, s10, 1
 v_mfma_f32_16x16x32_bf16 v[44:47], v[140:143], a[84:87], v[44:47]
 ds_read_b64_tr_b16 v[164:165], v19 offset:26624
 ds_read_b64_tr_b16 v[166:167], v19 offset:27648
 v_mfma_f32_16x16x32_bf16 v[40:43], v[140:143], a[80:83], v[40:43]
 s_add_u32 s31, s31, s32
 s_waitcnt lgkmcnt(8)
 v_mfma_f32_16x16x32_bf16 v[48:51], v[144:147], a[80:83], v[48:51]
 ds_read_b64_tr_b16 v[136:137], v16 offset:28672
 ds_read_b64_tr_b16 v[138:139], v16 offset:29696
 v_mfma_f32_16x16x32_bf16 v[52:55], v[144:147], a[84:87], v[52:55]
 buffer_load_dwordx4 v2, s[12:15], s40 offen offset:2048 sc1 lds
 v_bfe_u32 v11, v0, 4, 1
 v_mfma_f32_16x16x32_bf16 v[60:63], v[148:151], a[84:87], v[60:63]
 ds_read_b64_tr_b16 v[140:141], v17 offset:28672
 ds_read_b64_tr_b16 v[142:143], v17 offset:29696
 v_mfma_f32_16x16x32_bf16 v[56:59], v[148:151], a[80:83], v[56:59]
 v_add_u32 v11, s31, v11
 s_waitcnt lgkmcnt(8)
 v_mfma_f32_16x16x32_bf16 v[64:67], v[152:155], a[80:83], v[64:67]
 ds_read_b64_tr_b16 v[144:145], v18 offset:28672
 ds_read_b64_tr_b16 v[146:147], v18 offset:29696
 v_mfma_f32_16x16x32_bf16 v[128:131], v[152:155], v[168:171], v[128:131]
 buffer_load_dwordx4 v3, s[12:15], s40 offen offset:3072 sc1 lds
 v_and_b32 v12, 15, v0
 v_mfma_f32_16x16x32_bf16 v[68:71], v[152:155], a[84:87], v[68:71]
 v_lshl_add_u32 v11, v11, 4, v12
 v_lshrrev_b32 v12, 5, v0
 v_mfma_f32_16x16x32_bf16 v[76:79], v[156:159], a[84:87], v[76:79]
 ds_read_b64_tr_b16 v[148:149], v19 offset:28672
 ds_read_b64_tr_b16 v[150:151], v19 offset:29696
 v_mfma_f32_16x16x32_bf16 v[72:75], v[156:159], a[80:83], v[72:75]
 s_add_u32 m0, s38, 102400
 s_waitcnt lgkmcnt(8)
 v_mfma_f32_16x16x32_bf16 v[80:83], v[160:163], a[80:83], v[80:83]
 ds_read_b64_tr_b16 v[152:153], v16 offset:36864
 ds_read_b64_tr_b16 v[154:155], v16 offset:37888
 v_mfma_f32_16x16x32_bf16 v[84:87], v[160:163], a[84:87], v[84:87]
 buffer_load_dwordx4 v4, s[12:15], s40 offen offset:0 sc1 lds
 v_lshlrev_b32 v11, 11, v11
 v_mfma_f32_16x16x32_bf16 v[92:95], v[164:167], a[84:87], v[92:95]
 ds_read_b64_tr_b16 v[156:157], v17 offset:36864
 ds_read_b64_tr_b16 v[158:159], v17 offset:37888
 v_mfma_f32_16x16x32_bf16 v[88:91], v[164:167], a[80:83], v[88:91]
 v_lshl_add_u32 v11, v12, 4, v11
 s_waitcnt lgkmcnt(8)
 v_mfma_f32_16x16x32_bf16 v[96:99], a[80:83], v[136:139], v[96:99]
 ds_read_b64_tr_b16 v[160:161], v18 offset:36864
 ds_read_b64_tr_b16 v[162:163], v18 offset:37888
 v_mfma_f32_16x16x32_bf16 v[132:135], v[168:171], v[136:139], v[132:135]
 buffer_load_dwordx4 v5, s[12:15], s40 offen offset:1024 sc1 lds
 v_add_u32 v28, s35, v11
 v_mfma_f32_16x16x32_bf16 v[100:103], a[84:87], v[136:139], v[100:103]
 ds_read_b128 v[172:175], v24 offset:23552
 v_mfma_f32_16x16x32_bf16 v[108:111], a[84:87], v[140:143], v[108:111]
 ds_read_b64_tr_b16 v[164:165], v19 offset:36864
 ds_read_b64_tr_b16 v[166:167], v19 offset:37888
 v_mfma_f32_16x16x32_bf16 v[104:107], a[80:83], v[140:143], v[104:107]
 s_waitcnt lgkmcnt(9)
 v_mfma_f32_16x16x32_bf16 v[112:115], a[80:83], v[144:147], v[112:115]
 ds_read_b64_tr_b16 v[136:137], v16 offset:38912
 ds_read_b64_tr_b16 v[138:139], v16 offset:39936
 v_mfma_f32_16x16x32_bf16 v[116:119], a[84:87], v[144:147], v[116:119]
 buffer_load_dwordx4 a[48:51], v6, s[16:19], s42 offen offset:2048 sc1
 v_mfma_f32_16x16x32_bf16 v[124:127], a[84:87], v[148:151], v[124:127]
 ds_read_b64_tr_b16 v[140:141], v17 offset:38912
 ds_read_b64_tr_b16 v[142:143], v17 offset:39936
 v_mfma_f32_16x16x32_bf16 v[120:123], a[80:83], v[148:151], v[120:123]
 s_waitcnt vmcnt(34) lgkmcnt(9)
 v_mfma_f32_16x16x32_bf16 v[32:35], v[152:155], a[88:91], v[32:35]
 ds_read_b64_tr_b16 v[144:145], v18 offset:38912
 ds_read_b64_tr_b16 v[146:147], v18 offset:39936
 v_mfma_f32_16x16x32_bf16 v[36:39], v[152:155], a[92:95], v[36:39]
 buffer_load_dwordx4 a[52:55], v7, s[16:19], s42 offen offset:2048 sc1
 v_mfma_f32_16x16x32_bf16 v[44:47], v[156:159], a[92:95], v[44:47]
 ds_read_b64_tr_b16 v[148:149], v19 offset:38912
 ds_read_b64_tr_b16 v[150:151], v19 offset:39936
 v_mfma_f32_16x16x32_bf16 v[40:43], v[156:159], a[88:91], v[40:43]
 s_waitcnt lgkmcnt(8)
 v_mfma_f32_16x16x32_bf16 v[48:51], v[160:163], a[88:91], v[48:51]
 ds_read_b64_tr_b16 v[152:153], v16 offset:40960
 ds_read_b64_tr_b16 v[154:155], v16 offset:41984
 v_mfma_f32_16x16x32_bf16 v[52:55], v[160:163], a[92:95], v[52:55]
 v_mfma_f32_16x16x32_bf16 v[60:63], v[164:167], a[92:95], v[60:63]
 ds_read_b64_tr_b16 v[156:157], v17 offset:40960
 ds_read_b64_tr_b16 v[158:159], v17 offset:41984
 v_mfma_f32_16x16x32_bf16 v[56:59], v[164:167], a[88:91], v[56:59]
 buffer_load_dwordx4 a[56:59], v6, s[16:19], s42 offen offset:3072 sc1
 s_waitcnt lgkmcnt(8)
 v_mfma_f32_16x16x32_bf16 v[64:67], v[136:139], a[88:91], v[64:67]
 ds_read_b64_tr_b16 v[160:161], v18 offset:40960
 ds_read_b64_tr_b16 v[162:163], v18 offset:41984
 v_mfma_f32_16x16x32_bf16 v[128:131], v[136:139], v[172:175], v[128:131]
 v_mfma_f32_16x16x32_bf16 v[68:71], v[136:139], a[92:95], v[68:71]
 buffer_load_dwordx4 a[60:63], v7, s[16:19], s42 offen offset:3072 sc1
 v_mfma_f32_16x16x32_bf16 v[76:79], v[140:143], a[92:95], v[76:79]
 ds_read_b64_tr_b16 v[164:165], v19 offset:40960
 ds_read_b64_tr_b16 v[166:167], v19 offset:41984
 v_mfma_f32_16x16x32_bf16 v[72:75], v[140:143], a[88:91], v[72:75]
 s_waitcnt vmcnt(10)
 v_cmp_ne_u64 vcc, s[8:9], v[196:197]
 s_mov_b32 s57, 0
 s_cbranch_vccz L_ok_fw
L_re_fw:
 buffer_load_dwordx2 v[196:197], v198, s[60:63], s44 offen sc1
 s_add_u32 s57, s57, 1
 s_waitcnt vmcnt(0)
 v_cmp_ne_u64 vcc, s[8:9], v[196:197]
 s_cmp_gt_u32 s57, 0x40000
 s_cbranch_vccz L_ok_fw
 s_cbranch_scc0 L_re_fw
L_ok_fw:
 s_waitcnt lgkmcnt(8)
 v_mfma_f32_16x16x32_bf16 v[80:83], v[144:147], a[88:91], v[80:83]
 s_barrier
 ds_read_b64_tr_b16 v[136:137], v16 offset:49152
 v_mfma_f32_16x16x32_bf16 v[84:87], v[144:147], a[92:95], v[84:87]
 ds_read_b64_tr_b16 v[138:139], v16 offset:50176
 s_add_u32 s40, s40, s41
 s_add_u32 m0, s38, 0
 v_mfma_f32_16x16x32_bf16 v[92:95], v[148:151], a[92:95], v[92:95]
 ds_read_b64_tr_b16 v[140:141], v17 offset:49152
 ds_read_b64_tr_b16 v[142:143], v17 offset:50176
 s_xor_b32 s49, s10, 0
 s_lshl_b32 s49, s49, 6
 v_mfma_f32_16x16x32_bf16 v[88:91], v[148:151], a[88:91], v[88:91]
 buffer_load_dwordx4 v2, s[12:15], s40 offen offset:0 sc1 lds
 s_waitcnt lgkmcnt(8)
 v_mfma_f32_16x16x32_bf16 v[96:99], a[88:91], v[152:155], v[96:99]
 ds_read_b64_tr_b16 v[144:145], v18 offset:49152
 ds_read_b64_tr_b16 v[146:147], v18 offset:50176
 buffer_load_dwordx2 a[128:129], v237, s[88:91], s49 offen offset:0 sc1
 v_mfma_f32_16x16x32_bf16 v[132:135], v[172:175], v[152:155], v[132:135]
 v_mfma_f32_16x16x32_bf16 v[100:103], a[92:95], v[152:155], v[100:103]
 ds_read_b128 v[168:171], v24 offset:24576
 buffer_load_dwordx4 v3, s[12:15], s40 offen offset:1024 sc1 lds
 v_mfma_f32_16x16x32_bf16 v[108:111], a[92:95], v[156:159], v[108:111]
 ds_read_b64_tr_b16 v[148:149], v19 offset:49152
 ds_read_b64_tr_b16 v[150:151], v19 offset:50176
 s_branch m_ps_p1_3
m_pad_p1_3:
 s_branch m_reta_p1
m_ps_p1_3:
 v_mfma_f32_16x16x32_bf16 v[104:107], a[88:91], v[156:159], v[104:107]
 s_waitcnt lgkmcnt(9)
 v_mfma_f32_16x16x32_bf16 v[112:115], a[88:91], v[160:163], v[112:115]
 ds_read_b64_tr_b16 v[152:153], v16 offset:51200
 ds_read_b64_tr_b16 v[154:155], v16 offset:52224
 buffer_load_dwordx2 a[130:131], v237, s[88:91], s49 offen offset:16 sc1
 v_mfma_f32_16x16x32_bf16 v[116:119], a[92:95], v[160:163], v[116:119]
 v_mfma_f32_16x16x32_bf16 v[124:127], a[92:95], v[164:167], v[124:127]
 ds_read_b64_tr_b16 v[156:157], v17 offset:51200
 ds_read_b64_tr_b16 v[158:159], v17 offset:52224
 s_mov_b32 s96, s64
 s_mov_b32 s97, s65
 s_mov_b32 s98, 4194304
 s_mov_b32 s99, 0x20000
 v_mfma_f32_16x16x32_bf16 v[120:123], a[88:91], v[164:167], v[120:123]
 buffer_load_dwordx4 v2, s[12:15], s40 offen offset:2048 sc1 lds
 s_xor_b32 s49, s10, 1
 s_lshl_b32 s49, s49, 6
 s_waitcnt lgkmcnt(9)
 v_mfma_f32_16x16x32_bf16 v[32:35], v[136:139], a[0:3], v[32:35]
 ds_read_b64_tr_b16 v[160:161], v18 offset:51200
 ds_read_b64_tr_b16 v[162:163], v18 offset:52224
 v_mfma_f32_16x16x32_bf16 v[36:39], v[136:139], a[4:7], v[36:39]
 buffer_load_dwordx2 a[132:133], v237, s[88:91], s49 offen offset:0 sc1
 v_mfma_f32_16x16x32_bf16 v[44:47], v[140:143], a[4:7], v[44:47]
 ds_read_b64_tr_b16 v[164:165], v19 offset:51200
 ds_read_b64_tr_b16 v[166:167], v19 offset:52224
 v_mfma_f32_16x16x32_bf16 v[40:43], v[140:143], a[0:3], v[40:43]
 buffer_load_dwordx4 v3, s[12:15], s40 offen offset:3072 sc1 lds
 s_waitcnt lgkmcnt(8)
 v_mfma_f32_16x16x32_bf16 v[48:51], v[144:147], a[0:3], v[48:51]
 ds_read_b64_tr_b16 v[136:137], v16 offset:53248
 ds_read_b64_tr_b16 v[138:139], v16 offset:54272
 v_mfma_f32_16x16x32_bf16 v[52:55], v[144:147], a[4:7], v[52:55]
 s_add_u32 m0, s38, 4096
 v_mfma_f32_16x16x32_bf16 v[60:63], v[148:151], a[4:7], v[60:63]
 ds_read_b64_tr_b16 v[140:141], v17 offset:53248
 ds_read_b64_tr_b16 v[142:143], v17 offset:54272
 buffer_load_dwordx2 a[134:135], v237, s[88:91], s49 offen offset:16 sc1
 v_mfma_f32_16x16x32_bf16 v[56:59], v[148:151], a[0:3], v[56:59]
 buffer_load_dwordx4 v4, s[12:15], s40 offen offset:0 sc1 lds
 s_waitcnt lgkmcnt(8)
 v_mfma_f32_16x16x32_bf16 v[64:67], v[152:155], a[0:3], v[64:67]
 ds_read_b64_tr_b16 v[144:145], v18 offset:53248
 ds_read_b64_tr_b16 v[146:147], v18 offset:54272
 v_mfma_f32_16x16x32_bf16 v[128:131], v[152:155], v[168:171], v[128:131]
 s_xor_b32 s49, s10, 2
 s_lshl_b32 s49, s49, 6
 v_mfma_f32_16x16x32_bf16 v[68:71], v[152:155], a[4:7], v[68:71]
 v_mfma_f32_16x16x32_bf16 v[76:79], v[156:159], a[4:7], v[76:79]
 ds_read_b64_tr_b16 v[148:149], v19 offset:53248
 ds_read_b64_tr_b16 v[150:151], v19 offset:54272
 buffer_load_dwordx2 a[136:137], v237, s[88:91], s49 offen offset:0 sc1
 v_mfma_f32_16x16x32_bf16 v[72:75], v[156:159], a[0:3], v[72:75]
 buffer_load_dwordx4 v5, s[12:15], s40 offen offset:1024 sc1 lds
 s_waitcnt lgkmcnt(8)
 v_mfma_f32_16x16x32_bf16 v[80:83], v[160:163], a[0:3], v[80:83]
 ds_read_b64_tr_b16 v[152:153], v16 offset:61440
 ds_read_b64_tr_b16 v[154:155], v16 offset:62464
 v_mfma_f32_16x16x32_bf16 v[84:87], v[160:163], a[4:7], v[84:87]
 v_mfma_f32_16x16x32_bf16 v[92:95], v[164:167], a[4:7], v[92:95]
 ds_read_b64_tr_b16 v[156:157], v17 offset:61440
 ds_read_b64_tr_b16 v[158:159], v17 offset:62464
 v_mfma_f32_16x16x32_bf16 v[88:91], v[164:167], a[0:3], v[88:91]
 buffer_load_dwordx4 a[112:115], v28, s[96:99], 0 offen offset:0
 buffer_load_dwordx2 a[138:139], v237, s[88:91], s49 offen offset:16 sc1
 s_waitcnt lgkmcnt(8)
 v_mfma_f32_16x16x32_bf16 v[96:99], a[0:3], v[136:139], v[96:99]
 ds_read_b64_tr_b16 v[160:161], v18 offset:61440
 ds_read_b64_tr_b16 v[162:163], v18 offset:62464
 v_mfma_f32_16x16x32_bf16 v[132:135], v[168:171], v[136:139], v[132:135]
 v_mfma_f32_16x16x32_bf16 v[100:103], a[4:7], v[136:139], v[100:103]
 ds_read_b128 v[172:175], v24 offset:25600
 s_xor_b32 s49, s10, 3
 s_lshl_b32 s49, s49, 6
 v_mfma_f32_16x16x32_bf16 v[108:111], a[4:7], v[140:143], v[108:111]
 ds_read_b64_tr_b16 v[164:165], v19 offset:61440
 ds_read_b64_tr_b16 v[166:167], v19 offset:62464
 v_mfma_f32_16x16x32_bf16 v[104:107], a[0:3], v[140:143], v[104:107]
 buffer_load_dwordx4 a[116:119], v28, s[96:99], 0 offen offset:32
 buffer_load_dwordx2 a[140:141], v237, s[88:91], s49 offen offset:0 sc1
 s_waitcnt lgkmcnt(9)
 v_mfma_f32_16x16x32_bf16 v[112:115], a[0:3], v[144:147], v[112:115]
 ds_read_b64_tr_b16 v[136:137], v16 offset:63488
 ds_read_b64_tr_b16 v[138:139], v16 offset:64512
 v_mfma_f32_16x16x32_bf16 v[116:119], a[4:7], v[144:147], v[116:119]
 v_mfma_f32_16x16x32_bf16 v[124:127], a[4:7], v[148:151], v[124:127]
 ds_read_b64_tr_b16 v[140:141], v17 offset:63488
 ds_read_b64_tr_b16 v[142:143], v17 offset:64512
 v_mfma_f32_16x16x32_bf16 v[120:123], a[0:3], v[148:151], v[120:123]
 buffer_load_dwordx4 a[120:123], v28, s[96:99], 0 offen offset:64
 s_waitcnt lgkmcnt(9)
 v_mfma_f32_16x16x32_bf16 v[32:35], v[152:155], a[8:11], v[32:35]
 ds_read_b64_tr_b16 v[144:145], v18 offset:63488
 ds_read_b64_tr_b16 v[146:147], v18 offset:64512
 buffer_load_dwordx2 a[142:143], v237, s[88:91], s49 offen offset:16 sc1
 v_mfma_f32_16x16x32_bf16 v[36:39], v[152:155], a[12:15], v[36:39]
 v_mfma_f32_16x16x32_bf16 v[44:47], v[156:159], a[12:15], v[44:47]
 ds_read_b64_tr_b16 v[148:149], v19 offset:63488
 ds_read_b64_tr_b16 v[150:151], v19 offset:64512
 v_mfma_f32_16x16x32_bf16 v[40:43], v[156:159], a[8:11], v[40:43]
 s_waitcnt lgkmcnt(8)
 v_mfma_f32_16x16x32_bf16 v[48:51], v[160:163], a[8:11], v[48:51]
 ds_read_b64_tr_b16 v[152:153], v20 offset:0
 ds_read_b64_tr_b16 v[154:155], v20 offset:1024
 v_mfma_f32_16x16x32_bf16 v[52:55], v[160:163], a[12:15], v[52:55]
 v_mfma_f32_16x16x32_bf16 v[60:63], v[164:167], a[12:15], v[60:63]
 ds_read_b64_tr_b16 v[156:157], v21 offset:0
 ds_read_b64_tr_b16 v[158:159], v21 offset:1024
 v_mfma_f32_16x16x32_bf16 v[56:59], v[164:167], a[8:11], v[56:59]
 s_waitcnt lgkmcnt(8)
 v_mfma_f32_16x16x32_bf16 v[64:67], v[136:139], a[8:11], v[64:67]
 ds_read_b64_tr_b16 v[160:161], v22 offset:0
 ds_read_b64_tr_b16 v[162:163], v22 offset:1024
 v_mfma_f32_16x16x32_bf16 v[128:131], v[136:139], v[172:175], v[128:131]
 v_mfma_f32_16x16x32_bf16 v[68:71], v[136:139], a[12:15], v[68:71]
 v_mfma_f32_16x16x32_bf16 v[76:79], v[140:143], a[12:15], v[76:79]
 ds_read_b64_tr_b16 v[164:165], v23 offset:0
 ds_read_b64_tr_b16 v[166:167], v23 offset:1024
 v_mfma_f32_16x16x32_bf16 v[72:75], v[140:143], a[8:11], v[72:75]
 buffer_load_dwordx4 a[124:127], v28, s[96:99], 0 offen offset:96
 s_waitcnt lgkmcnt(8)
 v_mfma_f32_16x16x32_bf16 v[80:83], v[144:147], a[8:11], v[80:83]
 s_barrier
 ds_read_b64_tr_b16 v[136:137], v20 offset:8192
 v_mfma_f32_16x16x32_bf16 v[84:87], v[144:147], a[12:15], v[84:87]
 ds_read_b64_tr_b16 v[138:139], v20 offset:9216
 v_mfma_f32_16x16x32_bf16 v[92:95], v[148:151], a[12:15], v[92:95]
 ds_read_b64_tr_b16 v[140:141], v21 offset:8192
 ds_read_b64_tr_b16 v[142:143], v21 offset:9216
 v_mfma_f32_16x16x32_bf16 v[88:91], v[148:151], a[8:11], v[88:91]
 s_waitcnt lgkmcnt(8)
 v_mfma_f32_16x16x32_bf16 v[96:99], a[8:11], v[152:155], v[96:99]
 ds_read_b64_tr_b16 v[144:145], v22 offset:8192
 ds_read_b64_tr_b16 v[146:147], v22 offset:9216
 v_mfma_f32_16x16x32_bf16 v[132:135], v[172:175], v[152:155], v[132:135]
 v_mfma_f32_16x16x32_bf16 v[100:103], a[12:15], v[152:155], v[100:103]
 ds_read_b128 v[168:171], v24 offset:26624
 v_mfma_f32_16x16x32_bf16 v[108:111], a[12:15], v[156:159], v[108:111]
 ds_read_b64_tr_b16 v[148:149], v23 offset:8192
 ds_read_b64_tr_b16 v[150:151], v23 offset:9216
 v_mfma_f32_16x16x32_bf16 v[104:107], a[8:11], v[156:159], v[104:107]
 s_waitcnt lgkmcnt(9)
 v_mfma_f32_16x16x32_bf16 v[112:115], a[8:11], v[160:163], v[112:115]
 ds_read_b64_tr_b16 v[152:153], v20 offset:10240
 ds_read_b64_tr_b16 v[154:155], v20 offset:11264
 v_mfma_f32_16x16x32_bf16 v[116:119], a[12:15], v[160:163], v[116:119]
 buffer_load_dword v9, v9, s[92:95], 0 offen
 v_and_b32 v11, 15, v0
 v_mfma_f32_16x16x32_bf16 v[124:127], a[12:15], v[164:167], v[124:127]
 ds_read_b64_tr_b16 v[156:157], v21 offset:10240
 ds_read_b64_tr_b16 v[158:159], v21 offset:11264
 v_mfma_f32_16x16x32_bf16 v[120:123], a[8:11], v[164:167], v[120:123]
 v_lshrrev_b32 v12, 4, v0
 s_waitcnt lgkmcnt(9)
 v_mfma_f32_16x16x32_bf16 v[32:35], v[136:139], a[16:19], v[32:35]
 ds_read_b64_tr_b16 v[160:161], v22 offset:10240
 ds_read_b64_tr_b16 v[162:163], v22 offset:11264
 v_mfma_f32_16x16x32_bf16 v[36:39], v[136:139], a[20:23], v[36:39]
 v_and_b32 v13, 1, v0
 v_cmp_eq_u32 s[50:51], 1, v13
 v_mfma_f32_16x16x32_bf16 v[44:47], v[140:143], a[20:23], v[44:47]
 ds_read_b64_tr_b16 v[164:165], v23 offset:10240
 ds_read_b64_tr_b16 v[166:167], v23 offset:11264
 v_mfma_f32_16x16x32_bf16 v[40:43], v[140:143], a[16:19], v[40:43]
 v_and_b32 v14, 14, v11
 s_waitcnt lgkmcnt(8)
 v_mfma_f32_16x16x32_bf16 v[48:51], v[144:147], a[16:19], v[48:51]
 ds_read_b64_tr_b16 v[136:137], v20 offset:12288
 ds_read_b64_tr_b16 v[138:139], v20 offset:13312
 v_mfma_f32_16x16x32_bf16 v[52:55], v[144:147], a[20:23], v[52:55]
 v_lshlrev_b32 v15, 2, v12
 v_sub_u32 v14, v14, v15
 v_mfma_f32_16x16x32_bf16 v[60:63], v[148:151], a[20:23], v[60:63]
 ds_read_b64_tr_b16 v[140:141], v21 offset:12288
 ds_read_b64_tr_b16 v[142:143], v21 offset:13312
 v_mfma_f32_16x16x32_bf16 v[56:59], v[148:151], a[16:19], v[56:59]
 v_cmp_le_i32 s[52:53], 0, v14
 s_waitcnt lgkmcnt(8)
 v_mfma_f32_16x16x32_bf16 v[64:67], v[152:155], a[16:19], v[64:67]
 ds_read_b64_tr_b16 v[144:145], v22 offset:12288
 ds_read_b64_tr_b16 v[146:147], v22 offset:13312
 v_mfma_f32_16x16x32_bf16 v[128:131], v[152:155], v[168:171], v[128:131]
 v_cmp_le_i32 s[54:55], 2, v14
 v_mov_b32 v15, 0xffff
 v_mfma_f32_16x16x32_bf16 v[68:71], v[152:155], a[20:23], v[68:71]
 v_mov_b32 v14, 0xffff0000
 v_cndmask_b32 v15, v15, v14, s[50:51]
 v_mfma_f32_16x16x32_bf16 v[76:79], v[156:159], a[20:23], v[76:79]
 ds_read_b64_tr_b16 v[148:149], v23 offset:12288
 ds_read_b64_tr_b16 v[150:151], v23 offset:13312
 v_mfma_f32_16x16x32_bf16 v[72:75], v[156:159], a[16:19], v[72:75]
 v_cndmask_b32 v244, v15, 0, s[52:53]
 s_waitcnt lgkmcnt(8)
 v_mfma_f32_16x16x32_bf16 v[80:83], v[160:163], a[16:19], v[80:83]
 ds_read_b64_tr_b16 v[152:153], v20 offset:20480
 ds_read_b64_tr_b16 v[154:155], v20 offset:21504
 v_mfma_f32_16x16x32_bf16 v[84:87], v[160:163], a[20:23], v[84:87]
 v_cndmask_b32 v245, v15, 0, s[54:55]
 v_cndmask_b32 v246, 0, v15, s[52:53]
 v_mfma_f32_16x16x32_bf16 v[92:95], v[164:167], a[20:23], v[92:95]
 ds_read_b64_tr_b16 v[156:157], v21 offset:20480
 ds_read_b64_tr_b16 v[158:159], v21 offset:21504
 v_mfma_f32_16x16x32_bf16 v[88:91], v[164:167], a[16:19], v[88:91]
 v_cndmask_b32 v247, 0, v15, s[54:55]
 s_waitcnt lgkmcnt(8)
 v_mfma_f32_16x16x32_bf16 v[96:99], a[16:19], v[136:139], v[96:99]
 ds_read_b64_tr_b16 v[160:161], v22 offset:20480
 ds_read_b64_tr_b16 v[162:163], v22 offset:21504
 v_mfma_f32_16x16x32_bf16 v[132:135], v[168:171], v[136:139], v[132:135]
 s_min_u32 s56, s36, 1
 s_sub_u32 s56, s56, 1
 v_mfma_f32_16x16x32_bf16 v[100:103], a[20:23], v[136:139], v[100:103]
 ds_read_b128 v[172:175], v24 offset:27648
 s_and_b32 s56, s56, 0xf149f2ca
 v_mfma_f32_16x16x32_bf16 v[108:111], a[20:23], v[140:143], v[108:111]
 ds_read_b64_tr_b16 v[164:165], v23 offset:20480
 ds_read_b64_tr_b16 v[166:167], v23 offset:21504
 v_mfma_f32_16x16x32_bf16 v[104:107], a[16:19], v[140:143], v[104:107]
 v_mov_b32 v14, s56
 s_waitcnt lgkmcnt(9)
 v_mfma_f32_16x16x32_bf16 v[112:115], a[16:19], v[144:147], v[112:115]
 ds_read_b64_tr_b16 v[136:137], v20 offset:22528
 ds_read_b64_tr_b16 v[138:139], v20 offset:23552
 v_mfma_f32_16x16x32_bf16 v[116:119], a[20:23], v[144:147], v[116:119]
 v_cndmask_b32 v248, v14, 0, s[52:53]
 v_cndmask_b32 v249, v14, 0, s[54:55]
 v_mfma_f32_16x16x32_bf16 v[124:127], a[20:23], v[148:151], v[124:127]
 ds_read_b64_tr_b16 v[140:141], v21 offset:22528
 ds_read_b64_tr_b16 v[142:143], v21 offset:23552
 v_mfma_f32_16x16x32_bf16 v[120:123], a[16:19], v[148:151], v[120:123]
 v_mov_b32 v224, 0x3f803f80
 s_waitcnt lgkmcnt(9)
 v_mfma_f32_16x16x32_bf16 v[32:35], v[152:155], a[24:27], v[32:35]
 ds_read_b64_tr_b16 v[144:145], v22 offset:22528
 ds_read_b64_tr_b16 v[146:147], v22 offset:23552
 v_mfma_f32_16x16x32_bf16 v[36:39], v[152:155], a[28:31], v[36:39]
 v_mov_b32 v225, 0x3f803f80
 v_mov_b32 v226, 0x3f803f80
 v_mfma_f32_16x16x32_bf16 v[44:47], v[156:159], a[28:31], v[44:47]
 ds_read_b64_tr_b16 v[148:149], v23 offset:22528
 ds_read_b64_tr_b16 v[150:151], v23 offset:23552
 v_mfma_f32_16x16x32_bf16 v[40:43], v[156:159], a[24:27], v[40:43]
 v_mov_b32 v227, 0x3f803f80
 s_waitcnt lgkmcnt(8)
 v_mfma_f32_16x16x32_bf16 v[48:51], v[160:163], a[24:27], v[48:51]
 ds_read_b64_tr_b16 v[152:153], v20 offset:24576
 ds_read_b64_tr_b16 v[154:155], v20 offset:25600
 v_mfma_f32_16x16x32_bf16 v[52:55], v[160:163], a[28:31], v[52:55]
 v_lshlrev_b32 v13, 3, v0
 v_add_u32 v13, 122880, v13
 v_mfma_f32_16x16x32_bf16 v[60:63], v[164:167], a[28:31], v[60:63]
 ds_read_b64_tr_b16 v[156:157], v21 offset:24576
 ds_read_b64_tr_b16 v[158:159], v21 offset:25600
 v_mfma_f32_16x16x32_bf16 v[56:59], v[164:167], a[24:27], v[56:59]
 s_lshl_b32 s57, s10, 9
 s_waitcnt lgkmcnt(8)
 v_mfma_f32_16x16x32_bf16 v[64:67], v[136:139], a[24:27], v[64:67]
 ds_read_b64_tr_b16 v[160:161], v22 offset:24576
 ds_read_b64_tr_b16 v[162:163], v22 offset:25600
 v_mfma_f32_16x16x32_bf16 v[128:131], v[136:139], v[172:175], v[128:131]
 v_add_u32 v233, s57, v13
 s_lshl_b32 s57, s10, 12
 v_mfma_f32_16x16x32_bf16 v[68:71], v[136:139], a[28:31], v[68:71]
 v_add_u32 v13, s57, v13
 s_xor_b32 s84, s10, 0
 v_mfma_f32_16x16x32_bf16 v[76:79], v[140:143], a[28:31], v[76:79]
 ds_read_b64_tr_b16 v[164:165], v23 offset:24576
 ds_read_b64_tr_b16 v[166:167], v23 offset:25600
 v_mfma_f32_16x16x32_bf16 v[72:75], v[140:143], a[24:27], v[72:75]
 s_lshl_b32 s84, s84, 9
 s_waitcnt lgkmcnt(8)
 v_mfma_f32_16x16x32_bf16 v[80:83], v[144:147], a[24:27], v[80:83]
 s_waitcnt vmcnt(23)
 s_barrier
 ds_read_b64_tr_b16 v[136:137], v20 offset:34816
 v_mfma_f32_16x16x32_bf16 v[84:87], v[144:147], a[28:31], v[84:87]
 ds_read_b64_tr_b16 v[138:139], v20 offset:35840
 v_mfma_f32_16x16x32_bf16 v[92:95], v[148:151], a[28:31], v[92:95]
 ds_read_b64_tr_b16 v[140:141], v21 offset:34816
 ds_read_b64_tr_b16 v[142:143], v21 offset:35840
 v_mfma_f32_16x16x32_bf16 v[88:91], v[148:151], a[24:27], v[88:91]
 v_add_u32 v228, s84, v13
 s_waitcnt lgkmcnt(8)
 v_mfma_f32_16x16x32_bf16 v[96:99], a[24:27], v[152:155], v[96:99]
 ds_read_b64_tr_b16 v[144:145], v22 offset:34816
 ds_read_b64_tr_b16 v[146:147], v22 offset:35840
 v_mfma_f32_16x16x32_bf16 v[132:135], v[172:175], v[152:155], v[132:135]
 s_xor_b32 s85, s10, 1
 s_lshl_b32 s85, s85, 9
 v_mfma_f32_16x16x32_bf16 v[100:103], a[28:31], v[152:155], v[100:103]
 ds_read_b128 v[168:171], v24 offset:28672
 v_add_u32 v229, s85, v13
 v_mfma_f32_16x16x32_bf16 v[108:111], a[28:31], v[156:159], v[108:111]
 ds_read_b64_tr_b16 v[148:149], v23 offset:34816
 ds_read_b64_tr_b16 v[150:151], v23 offset:35840
 v_mfma_f32_16x16x32_bf16 v[104:107], a[24:27], v[156:159], v[104:107]
 ds_read_b128 v[172:175], v24 offset:29696
 s_waitcnt lgkmcnt(10)
 v_mfma_f32_16x16x32_bf16 v[112:115], a[24:27], v[160:163], v[112:115]
 ds_read_b64_tr_b16 v[152:153], v20 offset:36864
 ds_read_b64_tr_b16 v[154:155], v20 offset:37888
 v_mfma_f32_16x16x32_bf16 v[116:119], a[28:31], v[160:163], v[116:119]
 s_xor_b32 s86, s10, 2
 s_lshl_b32 s86, s86, 9
 v_mfma_f32_16x16x32_bf16 v[124:127], a[28:31], v[164:167], v[124:127]
 ds_read_b64_tr_b16 v[156:157], v21 offset:36864
 ds_read_b64_tr_b16 v[158:159], v21 offset:37888
 v_mfma_f32_16x16x32_bf16 v[120:123], a[24:27], v[164:167], v[120:123]
 v_add_u32 v230, s86, v13
 s_waitcnt lgkmcnt(7)
 v_mfma_f32_16x16x32_bf16 v[64:67], v[136:139], a[32:35], v[64:67]
 ds_read_b64_tr_b16 v[160:161], v22 offset:36864
 ds_read_b64_tr_b16 v[162:163], v22 offset:37888
 v_mfma_f32_16x16x32_bf16 v[128:131], v[136:139], v[168:171], v[128:131]
 s_xor_b32 s87, s10, 3
 s_lshl_b32 s87, s87, 9
 v_mfma_f32_16x16x32_bf16 v[68:71], v[136:139], a[36:39], v[68:71]
 v_add_u32 v231, s87, v13
 v_and_b32 v14, 1, v12
 v_mfma_f32_16x16x32_bf16 v[76:79], v[140:143], a[36:39], v[76:79]
 ds_read_b64_tr_b16 v[164:165], v23 offset:36864
 ds_read_b64_tr_b16 v[166:167], v23 offset:37888
 v_mfma_f32_16x16x32_bf16 v[72:75], v[140:143], a[32:35], v[72:75]
 v_add_u32 v14, s36, v14
 s_waitcnt lgkmcnt(9)
 v_mfma_f32_16x16x32_bf16 v[80:83], v[144:147], a[32:35], v[80:83]
 ds_read_b64_tr_b16 v[136:137], v20 offset:47104
 ds_read_b64_tr_b16 v[138:139], v20 offset:48128
 v_mfma_f32_16x16x32_bf16 v[84:87], v[144:147], a[36:39], v[84:87]
 v_lshlrev_b32 v232, 15, v14
 v_lshrrev_b32 v14, 1, v12
 v_mfma_f32_16x16x32_bf16 v[92:95], v[148:151], a[36:39], v[92:95]
 ds_read_b64_tr_b16 v[140:141], v21 offset:47104
 ds_read_b64_tr_b16 v[142:143], v21 offset:48128
 v_mfma_f32_16x16x32_bf16 v[88:91], v[148:151], a[32:35], v[88:91]
 v_lshl_add_u32 v232, v14, 8, v232
 s_waitcnt lgkmcnt(8)
 v_mfma_f32_16x16x32_bf16 v[96:99], a[32:35], v[152:155], v[96:99]
 ds_read_b64_tr_b16 v[144:145], v22 offset:47104
 ds_read_b64_tr_b16 v[146:147], v22 offset:48128
 v_mfma_f32_16x16x32_bf16 v[132:135], v[168:171], v[152:155], v[132:135]
 v_lshl_add_u32 v232, v11, 4, v232
 s_lshl_b32 s57, s30, 11
 v_mfma_f32_16x16x32_bf16 v[100:103], a[36:39], v[152:155], v[100:103]
 s_add_u32 s57, s57, 0x400000
 v_add_u32 v232, s57, v232
 v_mfma_f32_16x16x32_bf16 v[108:111], a[36:39], v[156:159], v[108:111]
 ds_read_b64_tr_b16 v[148:149], v23 offset:47104
 ds_read_b64_tr_b16 v[150:151], v23 offset:48128
 v_mfma_f32_16x16x32_bf16 v[104:107], a[32:35], v[156:159], v[104:107]
 ds_read_b128 v[168:171], v24 offset:30720
 s_waitcnt lgkmcnt(9)
 v_mfma_f32_16x16x32_bf16 v[112:115], a[32:35], v[160:163], v[112:115]
 ds_read_b64_tr_b16 v[152:153], v20 offset:49152
 ds_read_b64_tr_b16 v[154:155], v20 offset:50176
 v_mfma_f32_16x16x32_bf16 v[116:119], a[36:39], v[160:163], v[116:119]
 s_mov_b32 s48, 0x3e8293ee
 v_and_b32 v14, 1, v12
 v_mfma_f32_16x16x32_bf16 v[124:127], a[36:39], v[164:167], v[124:127]
 ds_read_b64_tr_b16 v[156:157], v21 offset:49152
 ds_read_b64_tr_b16 v[158:159], v21 offset:50176
 v_mfma_f32_16x16x32_bf16 v[120:123], a[32:35], v[164:167], v[120:123]
 v_cmp_eq_u32 s[42:43], 1, v14
 s_waitcnt lgkmcnt(9)
 v_mfma_f32_16x16x32_bf16 v[64:67], v[136:139], a[40:43], v[64:67]
 ds_read_b64_tr_b16 v[160:161], v22 offset:49152
 ds_read_b64_tr_b16 v[162:163], v22 offset:50176
 v_mfma_f32_16x16x32_bf16 v[128:131], v[136:139], v[172:175], v[128:131]
 v_add_u32 v15, s36, v14
 v_lshlrev_b32 v236, 10, v15
 v_mfma_f32_16x16x32_bf16 v[68:71], v[136:139], a[44:47], v[68:71]
 v_lshl_add_u32 v236, v11, 2, v236
 s_lshl_b32 s57, s30, 6
 v_mfma_f32_16x16x32_bf16 v[76:79], v[140:143], a[44:47], v[76:79]
 ds_read_b64_tr_b16 v[164:165], v23 offset:49152
 ds_read_b64_tr_b16 v[166:167], v23 offset:50176
 v_mfma_f32_16x16x32_bf16 v[72:75], v[140:143], a[40:43], v[72:75]
 s_add_u32 s57, s57, 0x2020000
 s_waitcnt lgkmcnt(9)
 v_mfma_f32_16x16x32_bf16 v[80:83], v[144:147], a[40:43], v[80:83]
 s_waitcnt vmcnt(8)
 s_barrier
 ds_read_b64_tr_b16 v[136:137], v16 offset:2048
 v_mfma_f32_16x16x32_bf16 v[84:87], v[144:147], a[44:47], v[84:87]
 ds_read_b64_tr_b16 v[138:139], v16 offset:3072
 v_mfma_f32_16x16x32_bf16 v[92:95], v[148:151], a[44:47], v[92:95]
 ds_read_b64_tr_b16 v[140:141], v17 offset:2048
 ds_read_b64_tr_b16 v[142:143], v17 offset:3072
 v_mfma_f32_16x16x32_bf16 v[88:91], v[148:151], a[40:43], v[88:91]
 v_add_u32 v236, s57, v236
 s_waitcnt lgkmcnt(8)
 v_mfma_f32_16x16x32_bf16 v[96:99], a[40:43], v[152:155], v[96:99]
 ds_read_b64_tr_b16 v[144:145], v18 offset:2048
 ds_read_b64_tr_b16 v[146:147], v18 offset:3072
 v_mfma_f32_16x16x32_bf16 v[132:135], v[172:175], v[152:155], v[132:135]
 s_lshl_b32 s58, s29, 4
 s_add_u32 s58, s58, s30
 v_mfma_f32_16x16x32_bf16 v[100:103], a[44:47], v[152:155], v[100:103]
 s_lshl_b32 s58, s58, 7
 s_add_u32 s58, s58, 0x8000
 v_mfma_f32_16x16x32_bf16 v[108:111], a[44:47], v[156:159], v[108:111]
 ds_read_b64_tr_b16 v[148:149], v19 offset:2048
 ds_read_b64_tr_b16 v[150:151], v19 offset:3072
 v_mfma_f32_16x16x32_bf16 v[104:107], a[40:43], v[156:159], v[104:107]
 ds_read_b128 v[172:175], v24 offset:31744
 s_waitcnt lgkmcnt(9)
 v_mfma_f32_16x16x32_bf16 v[112:115], a[40:43], v[160:163], v[112:115]
 ds_read_b64_tr_b16 v[152:153], v16 offset:4096
 ds_read_b64_tr_b16 v[154:155], v16 offset:5120
 v_mfma_f32_16x16x32_bf16 v[116:119], a[44:47], v[160:163], v[116:119]
 v_mfma_f32_16x16x32_bf16 v[124:127], a[44:47], v[164:167], v[124:127]
 ds_read_b64_tr_b16 v[156:157], v17 offset:4096
 ds_read_b64_tr_b16 v[158:159], v17 offset:5120
 v_mfma_f32_16x16x32_bf16 v[120:123], a[40:43], v[164:167], v[120:123]
 s_waitcnt lgkmcnt(9)
 v_mfma_f32_16x16x32_bf16 v[64:67], v[136:139], a[48:51], v[64:67]
 ds_read_b64_tr_b16 v[160:161], v18 offset:4096
 ds_read_b64_tr_b16 v[162:163], v18 offset:5120
 v_mfma_f32_16x16x32_bf16 v[128:131], v[136:139], v[168:171], v[128:131]
 v_mfma_f32_16x16x32_bf16 v[68:71], v[136:139], a[52:55], v[68:71]
 v_mfma_f32_16x16x32_bf16 v[76:79], v[140:143], a[52:55], v[76:79]
 ds_read_b64_tr_b16 v[164:165], v19 offset:4096
 ds_read_b64_tr_b16 v[166:167], v19 offset:5120
 v_mfma_f32_16x16x32_bf16 v[72:75], v[140:143], a[48:51], v[72:75]
 s_waitcnt lgkmcnt(9)
 v_mfma_f32_16x16x32_bf16 v[80:83], v[144:147], a[48:51], v[80:83]
 ds_read_b64_tr_b16 v[136:137], v16 offset:14336
 ds_read_b64_tr_b16 v[138:139], v16 offset:15360
 v_mfma_f32_16x16x32_bf16 v[84:87], v[144:147], a[52:55], v[84:87]
 v_mfma_f32_16x16x32_bf16 v[92:95], v[148:151], a[52:55], v[92:95]
 ds_read_b64_tr_b16 v[140:141], v17 offset:14336
 ds_read_b64_tr_b16 v[142:143], v17 offset:15360
 v_mfma_f32_16x16x32_bf16 v[88:91], v[148:151], a[48:51], v[88:91]
 s_waitcnt lgkmcnt(8)
 v_mfma_f32_16x16x32_bf16 v[96:99], a[48:51], v[152:155], v[96:99]
 ds_read_b64_tr_b16 v[144:145], v18 offset:14336
 ds_read_b64_tr_b16 v[146:147], v18 offset:15360
 v_mfma_f32_16x16x32_bf16 v[132:135], v[168:171], v[152:155], v[132:135]
 v_mfma_f32_16x16x32_bf16 v[100:103], a[52:55], v[152:155], v[100:103]
 v_mfma_f32_16x16x32_bf16 v[108:111], a[52:55], v[156:159], v[108:111]
 ds_read_b64_tr_b16 v[148:149], v19 offset:14336
 ds_read_b64_tr_b16 v[150:151], v19 offset:15360
 v_mfma_f32_16x16x32_bf16 v[104:107], a[48:51], v[156:159], v[104:107]
 s_waitcnt lgkmcnt(8)
 v_mfma_f32_16x16x32_bf16 v[112:115], a[48:51], v[160:163], v[112:115]
 ds_read_b64_tr_b16 v[152:153], v16 offset:16384
 ds_read_b64_tr_b16 v[154:155], v16 offset:17408
 v_mfma_f32_16x16x32_bf16 v[116:119], a[52:55], v[160:163], v[116:119]
 v_mfma_f32_16x16x32_bf16 v[124:127], a[52:55], v[164:167], v[124:127]
 ds_read_b64_tr_b16 v[156:157], v17 offset:16384
 ds_read_b64_tr_b16 v[158:159], v17 offset:17408
 v_mfma_f32_16x16x32_bf16 v[120:123], a[48:51], v[164:167], v[120:123]
 s_waitcnt lgkmcnt(8)
 v_mfma_f32_16x16x32_bf16 v[64:67], v[136:139], a[56:59], v[64:67]
 ds_read_b64_tr_b16 v[160:161], v18 offset:16384
 ds_read_b64_tr_b16 v[162:163], v18 offset:17408
 v_mfma_f32_16x16x32_bf16 v[128:131], v[136:139], v[172:175], v[128:131]
 v_mfma_f32_16x16x32_bf16 v[68:71], v[136:139], a[60:63], v[68:71]
 v_mfma_f32_16x16x32_bf16 v[76:79], v[140:143], a[60:63], v[76:79]
 ds_read_b64_tr_b16 v[164:165], v19 offset:16384
 ds_read_b64_tr_b16 v[166:167], v19 offset:17408
 v_mfma_f32_16x16x32_bf16 v[72:75], v[140:143], a[56:59], v[72:75]
 s_waitcnt lgkmcnt(8)
 v_mfma_f32_16x16x32_bf16 v[80:83], v[144:147], a[56:59], v[80:83]
 ds_read_b64_tr_b16 v[136:137], v20 offset:32768
 ds_read_b64_tr_b16 v[138:139], v20 offset:33792
 v_mfma_f32_16x16x32_bf16 v[84:87], v[144:147], a[60:63], v[84:87]
 v_mfma_f32_16x16x32_bf16 v[92:95], v[148:151], a[60:63], v[92:95]
 ds_read_b64_tr_b16 v[140:141], v21 offset:32768
 ds_read_b64_tr_b16 v[142:143], v21 offset:33792
 v_mfma_f32_16x16x32_bf16 v[88:91], v[148:151], a[56:59], v[88:91]
 s_waitcnt lgkmcnt(8)
 v_mfma_f32_16x16x32_bf16 v[96:99], a[56:59], v[152:155], v[96:99]
 ds_read_b64_tr_b16 v[144:145], v22 offset:32768
 ds_read_b64_tr_b16 v[146:147], v22 offset:33792
 v_mfma_f32_16x16x32_bf16 v[132:135], v[172:175], v[152:155], v[132:135]
 v_mfma_f32_16x16x32_bf16 v[100:103], a[60:63], v[152:155], v[100:103]
 v_mfma_f32_16x16x32_bf16 v[108:111], a[60:63], v[156:159], v[108:111]
 ds_read_b64_tr_b16 v[148:149], v23 offset:32768
 ds_read_b64_tr_b16 v[150:151], v23 offset:33792
 v_mfma_f32_16x16x32_bf16 v[104:107], a[56:59], v[156:159], v[104:107]
 s_waitcnt lgkmcnt(8)
 v_mfma_f32_16x16x32_bf16 v[112:115], a[56:59], v[160:163], v[112:115]
 ds_read_b64_tr_b16 v[152:153], v20 offset:45056
 ds_read_b64_tr_b16 v[154:155], v20 offset:46080
 v_mfma_f32_16x16x32_bf16 v[116:119], a[60:63], v[160:163], v[116:119]
 v_mfma_f32_16x16x32_bf16 v[124:127], a[60:63], v[164:167], v[124:127]
 ds_read_b64_tr_b16 v[156:157], v21 offset:45056
 ds_read_b64_tr_b16 v[158:159], v21 offset:46080
 v_mfma_f32_16x16x32_bf16 v[120:123], a[56:59], v[164:167], v[120:123]
 s_waitcnt lgkmcnt(8)
 v_mfma_f32_16x16x32_bf16 v[32:35], v[136:139], a[32:35], v[32:35]
 ds_read_b64_tr_b16 v[160:161], v22 offset:45056
 ds_read_b64_tr_b16 v[162:163], v22 offset:46080
 v_cvt_pk_bf16_f32 v208, v68, v69
 v_mfma_f32_16x16x32_bf16 v[36:39], v[136:139], a[36:39], v[36:39]
 v_cvt_pk_bf16_f32 v209, v70, v71
 ds_write_b64 v228, v[208:209] offset:4096
 v_mfma_f32_16x16x32_bf16 v[44:47], v[140:143], a[36:39], v[44:47]
 ds_read_b64_tr_b16 v[164:165], v23 offset:45056
 ds_read_b64_tr_b16 v[166:167], v23 offset:46080
 v_cvt_pk_bf16_f32 v210, v76, v77
 v_mfma_f32_16x16x32_bf16 v[40:43], v[140:143], a[32:35], v[40:43]
 v_cvt_pk_bf16_f32 v211, v78, v79
 s_waitcnt lgkmcnt(9)
 v_mfma_f32_16x16x32_bf16 v[48:51], v[144:147], a[32:35], v[48:51]
 ds_read_b64_tr_b16 v[136:137], v16 offset:0
 ds_read_b64_tr_b16 v[138:139], v16 offset:1024
 ds_write_b64 v229, v[210:211] offset:4096
 v_mfma_f32_16x16x32_bf16 v[52:55], v[144:147], a[36:39], v[52:55]
 v_cvt_pk_bf16_f32 v220, v84, v85
 v_cvt_pk_bf16_f32 v221, v86, v87
 v_mfma_f32_16x16x32_bf16 v[60:63], v[148:151], a[36:39], v[60:63]
 ds_read_b64_tr_b16 v[140:141], v17 offset:0
 ds_read_b64_tr_b16 v[142:143], v17 offset:1024
 ds_write_b64 v230, v[220:221] offset:4096
 v_mfma_f32_16x16x32_bf16 v[56:59], v[148:151], a[32:35], v[56:59]
 v_cvt_pk_bf16_f32 v222, v92, v93
 s_waitcnt lgkmcnt(11)
 v_mfma_f32_16x16x32_bf16 v[32:35], v[152:155], a[40:43], v[32:35]
 ds_read_b64_tr_b16 v[144:145], v18 offset:0
 ds_read_b64_tr_b16 v[146:147], v18 offset:1024
 v_cvt_pk_bf16_f32 v223, v94, v95
 v_mfma_f32_16x16x32_bf16 v[36:39], v[152:155], a[44:47], v[36:39]
 ds_write_b64 v231, v[222:223] offset:4096
 v_cvt_pk_bf16_f32 v128, v128, v129
 v_mfma_f32_16x16x32_bf16 v[44:47], v[156:159], a[44:47], v[44:47]
 ds_read_b64_tr_b16 v[148:149], v19 offset:0
 ds_read_b64_tr_b16 v[150:151], v19 offset:1024
 v_cvt_pk_bf16_f32 v129, v130, v131
 v_mfma_f32_16x16x32_bf16 v[40:43], v[156:159], a[40:43], v[40:43]
 ds_write_b64 v233, v[128:129]
 s_waitcnt lgkmcnt(12)
 v_mfma_f32_16x16x32_bf16 v[48:51], v[160:163], a[40:43], v[48:51]
 ds_read_b64_tr_b16 v[152:153], v16 offset:12288
 ds_read_b64_tr_b16 v[154:155], v16 offset:13312
 v_cvt_pk_bf16_f32 v132, v132, v133
 v_mfma_f32_16x16x32_bf16 v[52:55], v[160:163], a[44:47], v[52:55]
 v_cvt_pk_bf16_f32 v133, v134, v135
 ds_write_b64 v233, v[132:133] offset:2048
 v_mfma_f32_16x16x32_bf16 v[60:63], v[164:167], a[44:47], v[60:63]
 ds_read_b64_tr_b16 v[156:157], v17 offset:12288
 ds_read_b64_tr_b16 v[158:159], v17 offset:13312
 v_cvt_pk_bf16_f32 v180, v100, v101
 v_mfma_f32_16x16x32_bf16 v[56:59], v[164:167], a[40:43], v[56:59]
 v_cvt_pk_bf16_f32 v181, v102, v103
 s_waitcnt lgkmcnt(12)
 v_mfma_f32_16x16x32_bf16 v[32:35], v[136:139], a[48:51], v[32:35]
 ds_read_b64_tr_b16 v[160:161], v18 offset:12288
 ds_read_b64_tr_b16 v[162:163], v18 offset:13312
 ds_write_b64 v228, v[180:181] offset:6144
 v_mfma_f32_16x16x32_bf16 v[36:39], v[136:139], a[52:55], v[36:39]
 v_cvt_pk_bf16_f32 v186, v108, v109
 v_cvt_pk_bf16_f32 v187, v110, v111
 v_mfma_f32_16x16x32_bf16 v[44:47], v[140:143], a[52:55], v[44:47]
 ds_read_b64_tr_b16 v[164:165], v19 offset:12288
 ds_read_b64_tr_b16 v[166:167], v19 offset:13312
 ds_write_b64 v229, v[186:187] offset:6144
 s_branch m_ps_p1_4
m_pad_p1_4:
 s_branch m_ret_p1
m_ps_p1_4:
 v_mfma_f32_16x16x32_bf16 v[40:43], v[140:143], a[48:51], v[40:43]
 v_cvt_pk_bf16_f32 v192, v116, v117
 s_waitcnt lgkmcnt(12)
 v_mfma_f32_16x16x32_bf16 v[48:51], v[144:147], a[48:51], v[48:51]
 v_cvt_pk_bf16_f32 v193, v118, v119
 ds_write_b64 v230, v[192:193] offset:6144
 v_cvt_pk_bf16_f32 v198, v124, v125
 v_mfma_f32_16x16x32_bf16 v[52:55], v[144:147], a[52:55], v[52:55]
 v_cvt_pk_bf16_f32 v199, v126, v127
 ds_write_b64 v231, v[198:199] offset:6144
 v_mfma_f32_16x16x32_bf16 v[60:63], v[148:151], a[52:55], v[60:63]
 v_cvt_pk_bf16_f32 v204, v64, v65
 v_cvt_pk_bf16_f32 v205, v66, v67
 v_cvt_pk_bf16_f32 v178, v96, v97
 v_mfma_f32_16x16x32_bf16 v[56:59], v[148:151], a[48:51], v[56:59]
 v_cvt_pk_bf16_f32 v179, v98, v99
 s_waitcnt lgkmcnt(8)
 v_mfma_f32_16x16x32_bf16 v[32:35], v[152:155], a[56:59], v[32:35]
 v_cvt_pk_bf16_f32 v206, v72, v73
 v_cvt_pk_bf16_f32 v207, v74, v75
 v_cvt_pk_bf16_f32 v184, v104, v105
 v_mfma_f32_16x16x32_bf16 v[36:39], v[152:155], a[60:63], v[36:39]
 v_cvt_pk_bf16_f32 v185, v106, v107
 v_cvt_pk_bf16_f32 v216, v80, v81
 v_mfma_f32_16x16x32_bf16 v[44:47], v[156:159], a[60:63], v[44:47]
 v_cvt_pk_bf16_f32 v217, v82, v83
 v_cvt_pk_bf16_f32 v190, v112, v113
 v_cvt_pk_bf16_f32 v191, v114, v115
 v_mfma_f32_16x16x32_bf16 v[40:43], v[156:159], a[56:59], v[40:43]
 v_cvt_pk_bf16_f32 v218, v88, v89
 s_waitcnt lgkmcnt(3)
 v_mfma_f32_16x16x32_bf16 v[48:51], v[160:163], a[56:59], v[48:51]
 v_cvt_pk_bf16_f32 v219, v90, v91
 v_cvt_pk_bf16_f32 v196, v120, v121
 v_cvt_pk_bf16_f32 v197, v122, v123
 v_mfma_f32_16x16x32_bf16 v[52:55], v[160:163], a[60:63], v[52:55]
 s_waitcnt lgkmcnt(0)
 s_barrier
 v_mfma_f32_16x16x32_bf16 v[60:63], v[164:167], a[60:63], v[60:63]
 v_mfma_f32_16x16x32_bf16 v[56:59], v[164:167], a[56:59], v[56:59]
 s_waitcnt vmcnt(2)
 ds_read_b64 v[200:201], v228
 ds_read_b64 v[202:203], v229
 ds_read_b64 v[212:213], v230
 ds_read_b64 v[214:215], v231
 ds_read_b64 v[176:177], v228 offset:2048
 ds_read_b64 v[182:183], v229 offset:2048
 ds_read_b64 v[188:189], v230 offset:2048
 ds_read_b64 v[194:195], v231 offset:2048
 v_cvt_pk_bf16_f32 v140, v36, v37
 v_cvt_pk_bf16_f32 v141, v38, v39
 v_cvt_pk_bf16_f32 v142, v44, v45
 v_cvt_pk_bf16_f32 v143, v46, v47
 v_cvt_pk_bf16_f32 v148, v52, v53
 v_cvt_pk_bf16_f32 v149, v54, v55
 v_cvt_pk_bf16_f32 v150, v60, v61
 v_cvt_pk_bf16_f32 v151, v62, v63
 v_cvt_pk_bf16_f32 v136, v32, v33
 v_cvt_pk_bf16_f32 v137, v34, v35
 v_cvt_pk_bf16_f32 v138, v40, v41
 v_cvt_pk_bf16_f32 v139, v42, v43
 v_cvt_pk_bf16_f32 v144, v48, v49
 v_cvt_pk_bf16_f32 v145, v50, v51
 v_cvt_pk_bf16_f32 v146, v56, v57
 v_cvt_pk_bf16_f32 v147, v58, v59
 s_mov_b32 s40, 0
 s_add_u32 m0, s45, 0
 s_nop 0
 buffer_load_dwordx4 v26, s[20:23], s40 offen offset:0 lds
 v_mfma_f32_16x16x32_bf16 v[36:39], v[208:211], v[140:143], 0
 v_mfma_f32_16x16x32_bf16 v[32:35], v[204:207], v[140:143], 0
 v_mfma_f32_16x16x32_bf16 v[52:55], v[220:223], v[148:151], 0
 v_mfma_f32_16x16x32_bf16 v[48:51], v[216:219], v[148:151], 0
 s_waitcnt lgkmcnt(4)
 v_mfma_f32_16x16x32_bf16 v[68:71], v[204:207], v[136:139], 0
 v_mfma_f32_16x16x32_bf16 v[64:67], v[200:203], v[136:139], 0
 v_mfma_f32_16x16x32_bf16 v[84:87], v[216:219], v[144:147], 0
 v_mfma_f32_16x16x32_bf16 v[80:83], v[212:215], v[144:147], 0
 s_nop 2
 v_cndmask_b32 v36, v36, v37, s[50:51]
 v_cndmask_b32 v38, v38, v39, s[50:51]
 v_cndmask_b32 v32, v32, v33, s[50:51]
 v_cndmask_b32 v34, v34, v35, s[50:51]
 v_cndmask_b32 v32, v32, v36, s[52:53]
 v_cndmask_b32 v34, v34, v38, s[54:55]
 buffer_load_dwordx4 v27, s[20:23], s40 offen offset:1024 lds
 v_max_f32 v44, v32, v34
 v_max_f32 v45, v32, v34
 v_cndmask_b32 v52, v52, v53, s[50:51]
 v_cndmask_b32 v54, v54, v55, s[50:51]
 v_cndmask_b32 v48, v48, v49, s[50:51]
 v_cndmask_b32 v50, v50, v51, s[50:51]
 v_cndmask_b32 v48, v48, v52, s[52:53]
 v_cndmask_b32 v50, v50, v54, s[54:55]
 v_max_f32 v60, v48, v50
 v_max_f32 v61, v48, v50
 v_cndmask_b32 v68, v68, v69, s[50:51]
 v_cndmask_b32 v70, v70, v71, s[50:51]
 v_cndmask_b32 v64, v64, v65, s[50:51]
 v_cndmask_b32 v66, v66, v67, s[50:51]
 v_cndmask_b32 v64, v64, v68, s[52:53]
 v_cndmask_b32 v66, v66, v70, s[54:55]
 s_mov_b32 s40, 131072
 s_add_u32 m0, s45, 8192
 s_nop 0
 buffer_load_dwordx4 v26, s[20:23], s40 offen offset:0 lds
 v_add_f32 v64, v64, v248
 v_add_f32 v66, v66, v249
 v_max_f32 v76, v64, v66
 v_max_f32 v77, v64, v66
 v_cndmask_b32 v84, v84, v85, s[50:51]
 v_cndmask_b32 v86, v86, v87, s[50:51]
 v_cndmask_b32 v80, v80, v81, s[50:51]
 v_cndmask_b32 v82, v82, v83, s[50:51]
 v_cndmask_b32 v80, v80, v84, s[52:53]
 v_cndmask_b32 v82, v82, v86, s[54:55]
 v_add_f32 v80, v80, v248
 v_add_f32 v82, v82, v249
 v_max_f32 v92, v80, v82
 v_max_f32 v93, v80, v82
 v_permlane16_swap_b32 v44, v45
 v_permlane16_swap_b32 v60, v61
 buffer_load_dwordx4 v27, s[20:23], s40 offen offset:1024 lds
 v_permlane16_swap_b32 v76, v77
 v_permlane16_swap_b32 v92, v93
 v_max_f32 v46, v44, v45
 v_max_f32 v47, v44, v45
 v_max_f32 v62, v60, v61
 v_max_f32 v63, v60, v61
 v_max_f32 v78, v76, v77
 v_max_f32 v79, v76, v77
 v_max_f32 v94, v92, v93
 v_max_f32 v95, v92, v93
 v_permlane32_swap_b32 v46, v47
 v_permlane32_swap_b32 v62, v63
 v_permlane32_swap_b32 v78, v79
 v_permlane32_swap_b32 v94, v95
 v_max_f32 v44, v46, v47
 v_sub_f32 v32, v32, v44
 s_mov_b32 s40, 262144
 s_add_u32 m0, s45, 16384
 s_nop 0
 buffer_load_dwordx4 v26, s[20:23], s40 offen offset:0 lds
 v_sub_f32 v34, v34, v44
 v_mul_f32 v32, s48, v32
 v_mul_f32 v34, s48, v34
 v_exp_f32 v32, v32
 v_exp_f32 v34, v34
 v_max_f32 v60, v62, v63
 v_sub_f32 v48, v48, v60
 v_sub_f32 v50, v50, v60
 v_mul_f32 v48, s48, v48
 v_mul_f32 v50, s48, v50
 v_exp_f32 v48, v48
 v_exp_f32 v50, v50
 v_max_f32 v76, v78, v79
 v_sub_f32 v64, v64, v76
 v_sub_f32 v66, v66, v76
 v_mul_f32 v64, s48, v64
 buffer_load_dwordx4 v27, s[20:23], s40 offen offset:1024 lds
 v_mul_f32 v66, s48, v66
 v_exp_f32 v64, v64
 v_exp_f32 v66, v66
 v_max_f32 v92, v94, v95
 v_sub_f32 v80, v80, v92
 v_sub_f32 v82, v82, v92
 v_mul_f32 v80, s48, v80
 v_mul_f32 v82, s48, v82
 v_exp_f32 v80, v80
 v_exp_f32 v82, v82
 s_waitcnt lgkmcnt(0)
 v_cvt_pk_bf16_f32 v32, v32, v32
 v_cvt_pk_bf16_f32 v34, v34, v34
 v_and_b32 v40, v32, v244
 v_and_b32 v41, v34, v245
 v_and_b32 v42, v32, v246
 s_mov_b32 s40, 393216
 s_add_u32 m0, s45, 24576
 s_nop 0
 buffer_load_dwordx4 v26, s[20:23], s40 offen offset:0 lds
 v_and_b32 v43, v34, v247
 v_cvt_pk_bf16_f32 v48, v48, v48
 v_cvt_pk_bf16_f32 v50, v50, v50
 v_and_b32 v56, v48, v244
 v_and_b32 v57, v50, v245
 v_and_b32 v58, v48, v246
 v_and_b32 v59, v50, v247
 v_cvt_pk_bf16_f32 v64, v64, v64
 v_cvt_pk_bf16_f32 v66, v66, v66
 v_and_b32 v72, v64, v244
 v_and_b32 v73, v66, v245
 v_and_b32 v74, v64, v246
 v_and_b32 v75, v66, v247
 v_cvt_pk_bf16_f32 v80, v80, v80
 v_cvt_pk_bf16_f32 v82, v82, v82
 v_and_b32 v88, v80, v244
 buffer_load_dwordx4 v27, s[20:23], s40 offen offset:1024 lds
 v_and_b32 v89, v82, v245
 v_and_b32 v90, v80, v246
 v_and_b32 v91, v82, v247
 v_mfma_f32_16x16x32_bf16 v[36:39], v[224:227], v[40:43], 0
 v_mfma_f32_16x16x32_bf16 v[52:55], v[224:227], v[56:59], 0
 v_mfma_f32_16x16x32_bf16 v[68:71], v[224:227], v[72:75], 0
 v_mfma_f32_16x16x32_bf16 v[84:87], v[224:227], v[88:91], 0
 v_mfma_f32_16x16x32_bf16 v[100:103], v[178:181], v[40:43], 0
 v_mfma_f32_16x16x32_bf16 v[108:111], v[184:187], v[40:43], 0
 v_mfma_f32_16x16x32_bf16 v[96:99], v[176:179], v[72:75], 0
 v_mfma_f32_16x16x32_bf16 v[104:107], v[182:185], v[72:75], 0
 v_mfma_f32_16x16x32_bf16 v[116:119], v[190:193], v[56:59], 0
 v_mfma_f32_16x16x32_bf16 v[124:127], v[196:199], v[56:59], 0
 v_mfma_f32_16x16x32_bf16 v[112:115], v[188:191], v[88:91], 0
 v_mfma_f32_16x16x32_bf16 v[120:123], v[194:197], v[88:91], 0
 v_rcp_f32 v36, v36
 s_mov_b32 s40, 524288
 s_add_u32 m0, s45, 32768
 s_nop 0
 buffer_load_dwordx4 v26, s[20:23], s40 offen offset:0 lds
 v_rcp_f32 v52, v52
 v_rcp_f32 v68, v68
 v_rcp_f32 v84, v84
 s_nop 0
 v_mul_f32 v96, v96, v68
 v_mul_f32 v97, v97, v68
 v_mul_f32 v98, v98, v68
 v_mul_f32 v99, v99, v68
 v_mul_f32 v100, v100, v36
 v_mul_f32 v101, v101, v36
 v_mul_f32 v102, v102, v36
 v_mul_f32 v103, v103, v36
 v_cvt_pk_bf16_f32 v136, v96, v97
 v_cvt_pk_bf16_f32 v137, v98, v99
 v_cvt_pk_bf16_f32 v138, v100, v101
 v_cvt_pk_bf16_f32 v139, v102, v103
 buffer_load_dwordx4 v27, s[20:23], s40 offen offset:1024 lds
 s_nop 1
 v_permlane16_swap_b32 v136, v138
 v_permlane16_swap_b32 v137, v139
 buffer_store_dwordx4 v[136:139], v232, s[88:91], s84 offen sc1
 s_nop 0
 v_mfma_f32_16x16x32_bf16 v[216:219], a[128:131], v[136:139], 0
 v_mul_f32 v104, v104, v68
 v_mul_f32 v105, v105, v68
 v_mul_f32 v106, v106, v68
 v_mul_f32 v107, v107, v68
 v_mul_f32 v108, v108, v36
 v_mul_f32 v109, v109, v36
 v_mul_f32 v110, v110, v36
 v_mul_f32 v111, v111, v36
 v_cvt_pk_bf16_f32 v140, v104, v105
 v_cvt_pk_bf16_f32 v141, v106, v107
 v_cvt_pk_bf16_f32 v142, v108, v109
 v_cvt_pk_bf16_f32 v143, v110, v111
 s_nop 1
 v_permlane16_swap_b32 v140, v142
 v_permlane16_swap_b32 v141, v143
 buffer_store_dwordx4 v[140:143], v232, s[88:91], s85 offen sc1
 s_nop 0
 v_mfma_f32_16x16x32_bf16 v[216:219], a[132:135], v[140:143], v[216:219]
 v_mul_f32 v112, v112, v84
 v_mul_f32 v113, v113, v84
 v_mul_f32 v114, v114, v84
 v_mul_f32 v115, v115, v84
 v_mul_f32 v116, v116, v52
 v_mul_f32 v117, v117, v52
 v_mul_f32 v118, v118, v52
 v_mul_f32 v119, v119, v52
 v_cvt_pk_bf16_f32 v144, v112, v113
 v_cvt_pk_bf16_f32 v145, v114, v115
 v_cvt_pk_bf16_f32 v146, v116, v117
 v_cvt_pk_bf16_f32 v147, v118, v119
 s_nop 1
 v_permlane16_swap_b32 v144, v146
 v_permlane16_swap_b32 v145, v147
 buffer_store_dwordx4 v[144:147], v232, s[88:91], s86 offen sc1
 s_nop 0
 v_mfma_f32_16x16x32_bf16 v[216:219], a[136:139], v[144:147], v[216:219]
 v_mul_f32 v120, v120, v84
 v_mul_f32 v121, v121, v84
 v_mul_f32 v122, v122, v84
 v_mul_f32 v123, v123, v84
 v_mul_f32 v124, v124, v52
 v_mul_f32 v125, v125, v52
 v_mul_f32 v126, v126, v52
 v_mul_f32 v127, v127, v52
 v_cvt_pk_bf16_f32 v148, v120, v121
 v_cvt_pk_bf16_f32 v149, v122, v123
 v_cvt_pk_bf16_f32 v150, v124, v125
 v_cvt_pk_bf16_f32 v151, v126, v127
 s_nop 1
 v_permlane16_swap_b32 v148, v150
 v_permlane16_swap_b32 v149, v151
 buffer_store_dwordx4 v[148:151], v232, s[88:91], s87 offen sc1
 s_nop 0
 v_mfma_f32_16x16x32_bf16 v[216:219], a[140:143], v[148:151], v[216:219]
 s_nop 7
 v_add_f32 v216, v216, v217
 v_add_f32 v218, v218, v219
 s_mov_b32 exec_hi, 0
 v_cndmask_b32 v216, v216, v218, s[42:43]
 buffer_store_dword v216, v236, s[88:91], 0 offen sc1
 s_mov_b32 exec_hi, -1
 s_mov_b32 s29, s33
 s_mov_b32 s30, s34
 s_lshl_b32 s36, s29, 3
 s_lshl_b32 s37, s10, 1
 s_add_u32 s36, s36, s37
 v_bfe_u32 v13, v0, 4, 1
 v_add_u32 v13, s36, v13
 v_and_b32 v14, 15, v0
 v_lshrrev_b32 v15, 5, v0
 v_lshl_add_u32 v4, v13, 4, v14
 s_add_u32 s60, s82, 0x2080000
 s_addc_u32 s61, s83, 0
 s_mov_b32 s62, 262144
 s_mov_b32 s63, 0x20000
 v_cmp_eq_u32 vcc, 0, v0
 v_mov_b32 v29, 0x40000000
 s_nop 0
 v_cndmask_b32 v29, v29, 0, vcc
 s_cmp_eq_u32 s10, 1
 s_cbranch_scc1 m_pad_p2_0
 s_cmp_eq_u32 s10, 2
 s_cbranch_scc1 m_pad_p2_1
 s_cmp_eq_u32 s10, 3
 s_cbranch_scc1 m_reta_p2
 s_branch m_reta_p2
m_reta_p2:
 s_waitcnt vmcnt(0)
 s_barrier
 s_cmp_lg_u32 s10, 0
 s_cbranch_scc1 L_pub_p2
 v_mov_b32 v30, s8
 v_mov_b32 v31, s9
 buffer_store_dwordx2 v[30:31], v29, s[60:63], s58 offen sc1
L_pub_p2:
 s_mov_b32 s40, 655360
 s_add_u32 m0, s45, 40960
 s_nop 0
 buffer_load_dwordx4 v26, s[20:23], s40 offen offset:0 lds
 buffer_load_dwordx4 v27, s[20:23], s40 offen offset:1024 lds
 s_mov_b32 s40, 786432
 s_add_u32 m0, s45, 49152
 s_nop 0
 buffer_load_dwordx4 v26, s[20:23], s40 offen offset:0 lds
 buffer_load_dwordx4 v27, s[20:23], s40 offen offset:1024 lds
 s_mov_b32 s40, 917504
 s_add_u32 m0, s45, 57344
 s_nop 0
 buffer_load_dwordx4 v26, s[20:23], s40 offen offset:0 lds
 buffer_load_dwordx4 v27, s[20:23], s40 offen offset:1024 lds
 s_mov_b32 s40, 1048576
 s_add_u32 m0, s45, 65536
 s_nop 0
 buffer_load_dwordx4 v26, s[20:23], s40 offen offset:0 lds
 buffer_load_dwordx4 v27, s[20:23], s40 offen offset:1024 lds
 s_mov_b32 s40, 1179648
 s_add_u32 m0, s45, 73728
 s_nop 0
 buffer_load_dwordx4 v26, s[20:23], s40 offen offset:0 lds
 buffer_load_dwordx4 v27, s[20:23], s40 offen offset:1024 lds
 s_mov_b32 s40, 1310720
 s_add_u32 m0, s45, 81920
 s_nop 0
 buffer_load_dwordx4 v26, s[20:23], s40 offen offset:0 lds
 buffer_load_dwordx4 v27, s[20:23], s40 offen offset:1024 lds
 s_mov_b32 s40, 1441792
 s_add_u32 m0, s45, 90112
 s_nop 0
 buffer_load_dwordx4 v26, s[20:23], s40 offen offset:0 lds
 buffer_load_dwordx4 v27, s[20:23], s40 offen offset:1024 lds
 s_mov_b32 s40, 1572864
 s_add_u32 m0, s45, 98304
 s_nop 0
 buffer_load_dwordx4 v26, s[20:23], s40 offen offset:0 lds
 buffer_load_dwordx4 v27, s[20:23], s40 offen offset:1024 lds
 s_lshl_b32 s37, s36, 15
 s_add_u32 s37, s37, 0x400000
 s_add_u32 s16, s82, s37
 s_addc_u32 s17, s83, 0
 s_mov_b32 s18, 65536
 s_mov_b32 s19, 0x20000
 v_lshrrev_b32 v11, 5, v0
 v_lshlrev_b32 v11, 4, v11
 v_bfe_u32 v12, v0, 2, 3
 v_add_u32 v11, v11, v12
 v_lshlrev_b32 v11, 7, v11
 v_and_b32 v12, 3, v0
 v_lshl_add_u32 v11, v12, 3, v11
 v_bfe_u32 v12, v0, 3, 2
 v_xor_b32 v14, 0, v12
 v_lshl_add_u32 v16, v14, 5, v11
 v_add_u32 v20, 0x10000, v16
 v_xor_b32 v14, 1, v12
 v_lshl_add_u32 v17, v14, 5, v11
 v_add_u32 v21, 0x10000, v17
 v_xor_b32 v14, 2, v12
 v_lshl_add_u32 v18, v14, 5, v11
 v_add_u32 v22, 0x10000, v18
 v_xor_b32 v14, 3, v12
 v_lshl_add_u32 v19, v14, 5, v11
 v_add_u32 v23, 0x10000, v19
 v_bfe_u32 v13, v0, 4, 1
 v_add_u32 v13, s36, v13
 v_and_b32 v14, 15, v0
 v_lshrrev_b32 v15, 5, v0
 v_lshlrev_b32 v12, 15, v13
 v_lshl_add_u32 v12, v15, 8, v12
 v_lshl_add_u32 v12, v14, 4, v12
 s_lshl_b32 s39, s30, 11
 v_add_u32 v12, s39, v12
 v_lshlrev_b32 v5, 10, v13
 v_lshl_add_u32 v5, v14, 2, v5
 v_lshl_add_u32 v8, v15, 9, v5
 s_mov_b32 s47, 0x20000
 v_lshlrev_b32 v13, 2, v4
 s_add_u32 s84, s82, 0x800000
 s_addc_u32 s85, s83, 0
 s_mov_b32 s86, 4194304
 s_mov_b32 s87, 0x20000
 s_add_u32 s88, s82, 0x2000000
 s_addc_u32 s89, s83, 0
 s_mov_b32 s90, 393216
 s_mov_b32 s91, 0x20000
 s_mov_b32 s44, 0x40000
 s_mov_b32 s46, 0x50000
 s_getpc_b64 s[60:61]
pc_p2:
 s_lshr_b32 s62, s2, 3
 s_lshl_b32 s62, s62, 2
 s_add_u32 s62, s62, s10
 s_lshl_b32 s62, s62, 9
 s_add_u32 s62, s62, 4096
 s_min_u32 s62, s62, L_done-pc_p2-512
 v_and_b32 v146, 3, v0
 v_lshl_add_u32 v146, v146, 7, s62
 v_add_co_u32 v146, vcc, s60, v146
 v_mov_b32 v147, s61
 s_nop 0
 v_addc_co_u32 v147, vcc, 0, v147, vcc
 s_and_b32 s56, s10, 1
 s_lshl_b32 s56, s56, 8
 s_add_u32 s56, s56, s2
 s_mul_i32 s56, s56, 48
 s_add_u32 s56, s56, 32768
 v_min_u32 v10, 47, v0
 v_add_u32 v10, s56, v10
 v_lshlrev_b32 v10, 7, v10
 s_lshl_b32 s59, s29, 11
 s_add_u32 s59, s59, 0x8000
 s_add_u32 s60, s82, 0x2080000
 s_addc_u32 s61, s83, 0
 s_mov_b32 s62, 262144
 s_mov_b32 s63, 0x20000
 s_cmp_lg_u32 s10, 0
 s_cbranch_scc1 L_warm_p2
 v_min_u32 v136, 15, v0
 v_lshlrev_b32 v136, 7, v136
 v_add_u32 v136, s59, v136
 v_max_i32 v136, 0, v136
 s_mov_b32 s57, 0
L_poll_p2:
 buffer_load_dwordx2 v[138:139], v136, s[60:63], 0 offen sc1
 s_waitcnt vmcnt(0)
 v_cmp_ne_u64 vcc, s[8:9], v[138:139]
 s_add_u32 s57, s57, 1
 s_cbranch_vccz L_go_p2
 s_sleep 1
 s_cmp_gt_u32 s57, 0x40000
 s_cbranch_scc0 L_poll_p2
 s_branch L_go_p2
L_warm_p2:
 s_cmp_eq_u32 s10, 1
 s_cbranch_scc1 m_ret_p2
 s_cmp_eq_u32 s10, 2
 s_cbranch_scc1 m_ret_p2
 s_branch m_ret_p2
m_ret_p2:
 s_waitcnt vmcnt(0)
L_go_p2:
 s_barrier
 s_mov_b32 s42, 0
 buffer_load_dwordx4 v[152:155], v6, s[16:19], s42 offen offset:0 sc1
 buffer_load_dwordx4 v[156:159], v7, s[16:19], s42 offen offset:0 sc1
 buffer_load_dwordx4 v[160:163], v6, s[16:19], s42 offen offset:1024 sc1
 buffer_load_dwordx4 v[164:167], v7, s[16:19], s42 offen offset:1024 sc1
 buffer_load_dwordx4 v[168:171], v6, s[16:19], s42 offen offset:2048 sc1
 buffer_load_dwordx4 v[172:175], v7, s[16:19], s42 offen offset:2048 sc1
 buffer_load_dwordx4 v[176:179], v6, s[16:19], s42 offen offset:3072 sc1
 buffer_load_dwordx4 v[180:183], v7, s[16:19], s42 offen offset:3072 sc1
 s_mov_b32 s42, 4096
 buffer_load_dwordx4 v[184:187], v6, s[16:19], s42 offen offset:0 sc1
 buffer_load_dwordx4 v[188:191], v7, s[16:19], s42 offen offset:0 sc1
 buffer_load_dwordx4 v[192:195], v6, s[16:19], s42 offen offset:1024 sc1
 buffer_load_dwordx4 v[196:199], v7, s[16:19], s42 offen offset:1024 sc1
 ds_read_b64_tr_b16 v[72:73], v16 offset:0
 ds_read_b64_tr_b16 v[74:75], v16 offset:1024
 ds_read_b64_tr_b16 v[76:77], v17 offset:0
 ds_read_b64_tr_b16 v[78:79], v17 offset:1024
 ds_read_b64_tr_b16 v[80:81], v18 offset:0
 ds_read_b64_tr_b16 v[82:83], v18 offset:1024
 ds_read_b64_tr_b16 v[84:85], v19 offset:0
 ds_read_b64_tr_b16 v[86:87], v19 offset:1024
 ds_read_b64_tr_b16 v[88:89], v16 offset:4096
 ds_read_b64_tr_b16 v[90:91], v16 offset:5120
 ds_read_b64_tr_b16 v[92:93], v17 offset:4096
 ds_read_b64_tr_b16 v[94:95], v17 offset:5120
 v_accvgpr_read_b32 v113, a112
 v_lshlrev_b32 v112, 16, v113
 v_and_b32 v113, 0xffff0000, v113
 v_accvgpr_read_b32 v115, a113
 v_lshlrev_b32 v114, 16, v115
 v_and_b32 v115, 0xffff0000, v115
 v_accvgpr_read_b32 v117, a114
 v_lshlrev_b32 v116, 16, v117
 v_and_b32 v117, 0xffff0000, v117
 v_accvgpr_read_b32 v119, a115
 v_lshlrev_b32 v118, 16, v119
 v_and_b32 v119, 0xffff0000, v119
 v_accvgpr_read_b32 v121, a116
 v_lshlrev_b32 v120, 16, v121
 v_and_b32 v121, 0xffff0000, v121
 v_accvgpr_read_b32 v123, a117
 v_lshlrev_b32 v122, 16, v123
 v_and_b32 v123, 0xffff0000, v123
 v_accvgpr_read_b32 v125, a118
 v_lshlrev_b32 v124, 16, v125
 v_and_b32 v125, 0xffff0000, v125
 v_accvgpr_read_b32 v127, a119
 v_lshlrev_b32 v126, 16, v127
 v_and_b32 v127, 0xffff0000, v127
 v_accvgpr_read_b32 v129, a120
 v_lshlrev_b32 v128, 16, v129
 v_and_b32 v129, 0xffff0000, v129
 v_accvgpr_read_b32 v131, a121
 v_lshlrev_b32 v130, 16, v131
 v_and_b32 v131, 0xffff0000, v131
 v_accvgpr_read_b32 v133, a122
 v_lshlrev_b32 v132, 16, v133
 v_and_b32 v133, 0xffff0000, v133
 v_accvgpr_read_b32 v135, a123
 v_lshlrev_b32 v134, 16, v135
 v_and_b32 v135, 0xffff0000, v135
 v_accvgpr_read_b32 v137, a124
 v_lshlrev_b32 v136, 16, v137
 v_and_b32 v137, 0xffff0000, v137
 v_accvgpr_read_b32 v139, a125
 v_lshlrev_b32 v138, 16, v139
 v_and_b32 v139, 0xffff0000, v139
 v_accvgpr_read_b32 v141, a126
 v_lshlrev_b32 v140, 16, v141
 v_and_b32 v141, 0xffff0000, v141
 v_accvgpr_read_b32 v143, a127
 v_lshlrev_b32 v142, 16, v143
 v_and_b32 v143, 0xffff0000, v143
 s_waitcnt vmcnt(10) lgkmcnt(8)
 v_mfma_f32_16x16x32_bf16 v[32:35], v[72:75], v[152:155], 0
 ds_read_b64_tr_b16 v[96:97], v18 offset:4096
 ds_read_b64_tr_b16 v[98:99], v18 offset:5120
 v_mfma_f32_16x16x32_bf16 v[36:39], v[72:75], v[156:159], 0
 buffer_load_dwordx4 v[200:203], v6, s[16:19], s42 offen offset:2048 sc1
 v_mfma_f32_16x16x32_bf16 v[44:47], v[76:79], v[156:159], 0
 ds_read_b64_tr_b16 v[100:101], v19 offset:4096
 ds_read_b64_tr_b16 v[102:103], v19 offset:5120
 v_mfma_f32_16x16x32_bf16 v[40:43], v[76:79], v[152:155], 0
 s_waitcnt lgkmcnt(8)
 v_mfma_f32_16x16x32_bf16 v[48:51], v[80:83], v[152:155], 0
 ds_read_b64_tr_b16 v[72:73], v16 offset:8192
 ds_read_b64_tr_b16 v[74:75], v16 offset:9216
 v_mfma_f32_16x16x32_bf16 v[52:55], v[80:83], v[156:159], 0
 buffer_load_dwordx4 v[204:207], v7, s[16:19], s42 offen offset:2048 sc1
 v_mfma_f32_16x16x32_bf16 v[60:63], v[84:87], v[156:159], 0
 ds_read_b64_tr_b16 v[76:77], v17 offset:8192
 ds_read_b64_tr_b16 v[78:79], v17 offset:9216
 v_mfma_f32_16x16x32_bf16 v[56:59], v[84:87], v[152:155], 0
 buffer_load_dwordx4 v[208:211], v6, s[16:19], s42 offen offset:3072 sc1
 s_waitcnt vmcnt(11) lgkmcnt(8)
 v_mfma_f32_16x16x32_bf16 v[32:35], v[88:91], v[160:163], v[32:35]
 ds_read_b64_tr_b16 v[80:81], v18 offset:8192
 ds_read_b64_tr_b16 v[82:83], v18 offset:9216
 v_mfma_f32_16x16x32_bf16 v[36:39], v[88:91], v[164:167], v[36:39]
 v_mfma_f32_16x16x32_bf16 v[44:47], v[92:95], v[164:167], v[44:47]
 ds_read_b64_tr_b16 v[84:85], v19 offset:8192
 ds_read_b64_tr_b16 v[86:87], v19 offset:9216
 v_mfma_f32_16x16x32_bf16 v[40:43], v[92:95], v[160:163], v[40:43]
 buffer_load_dwordx4 v[212:215], v7, s[16:19], s42 offen offset:3072 sc1
 s_waitcnt lgkmcnt(8)
 v_mfma_f32_16x16x32_bf16 v[48:51], v[96:99], v[160:163], v[48:51]
 ds_read_b64_tr_b16 v[88:89], v16 offset:12288
 ds_read_b64_tr_b16 v[90:91], v16 offset:13312
 v_mfma_f32_16x16x32_bf16 v[52:55], v[96:99], v[164:167], v[52:55]
 s_mov_b32 s42, 8192
 v_mfma_f32_16x16x32_bf16 v[60:63], v[100:103], v[164:167], v[60:63]
 ds_read_b64_tr_b16 v[92:93], v17 offset:12288
 ds_read_b64_tr_b16 v[94:95], v17 offset:13312
 v_mfma_f32_16x16x32_bf16 v[56:59], v[100:103], v[160:163], v[56:59]
 buffer_load_dwordx4 v[216:219], v6, s[16:19], s42 offen offset:0 sc1
 s_waitcnt vmcnt(11) lgkmcnt(8)
 v_mfma_f32_16x16x32_bf16 v[32:35], v[72:75], v[168:171], v[32:35]
 ds_read_b64_tr_b16 v[96:97], v18 offset:12288
 ds_read_b64_tr_b16 v[98:99], v18 offset:13312
 v_mfma_f32_16x16x32_bf16 v[36:39], v[72:75], v[172:175], v[36:39]
 v_mfma_f32_16x16x32_bf16 v[44:47], v[76:79], v[172:175], v[44:47]
 ds_read_b64_tr_b16 v[100:101], v19 offset:12288
 ds_read_b64_tr_b16 v[102:103], v19 offset:13312
 buffer_load_dwordx4 v[220:223], v7, s[16:19], s42 offen offset:0 sc1
 v_mfma_f32_16x16x32_bf16 v[40:43], v[76:79], v[168:171], v[40:43]
 s_barrier
 s_waitcnt lgkmcnt(8)
 v_mfma_f32_16x16x32_bf16 v[48:51], v[80:83], v[168:171], v[48:51]
 ds_read_b64_tr_b16 v[72:73], v16 offset:16384
 ds_read_b64_tr_b16 v[74:75], v16 offset:17408
 v_mfma_f32_16x16x32_bf16 v[52:55], v[80:83], v[172:175], v[52:55]
 buffer_load_dword v144, v13, s[88:91], s44 offen sc1
 buffer_load_dwordx4 v[224:227], v6, s[16:19], s42 offen offset:1024 sc1
 v_mfma_f32_16x16x32_bf16 v[60:63], v[84:87], v[172:175], v[60:63]
 ds_read_b64_tr_b16 v[76:77], v17 offset:16384
 ds_read_b64_tr_b16 v[78:79], v17 offset:17408
 v_mfma_f32_16x16x32_bf16 v[56:59], v[84:87], v[168:171], v[56:59]
 s_waitcnt vmcnt(12) lgkmcnt(8)
 v_mfma_f32_16x16x32_bf16 v[32:35], v[88:91], v[176:179], v[32:35]
 ds_read_b64_tr_b16 v[80:81], v18 offset:16384
 ds_read_b64_tr_b16 v[82:83], v18 offset:17408
 v_mfma_f32_16x16x32_bf16 v[36:39], v[88:91], v[180:183], v[36:39]
 buffer_load_dwordx4 v[228:231], v7, s[16:19], s42 offen offset:1024 sc1
 v_mfma_f32_16x16x32_bf16 v[44:47], v[92:95], v[180:183], v[44:47]
 ds_read_b64_tr_b16 v[84:85], v19 offset:16384
 ds_read_b64_tr_b16 v[86:87], v19 offset:17408
 v_mfma_f32_16x16x32_bf16 v[40:43], v[92:95], v[176:179], v[40:43]
 s_waitcnt lgkmcnt(8)
 v_mfma_f32_16x16x32_bf16 v[48:51], v[96:99], v[176:179], v[48:51]
 ds_read_b64_tr_b16 v[88:89], v16 offset:20480
 ds_read_b64_tr_b16 v[90:91], v16 offset:21504
 v_mfma_f32_16x16x32_bf16 v[52:55], v[96:99], v[180:183], v[52:55]
 buffer_load_dword v64, v8, s[88:91], s47 offen offset:0 sc1
 buffer_load_dwordx4 v[232:235], v6, s[16:19], s42 offen offset:2048 sc1
 v_mfma_f32_16x16x32_bf16 v[60:63], v[100:103], v[180:183], v[60:63]
 ds_read_b64_tr_b16 v[92:93], v17 offset:20480
 ds_read_b64_tr_b16 v[94:95], v17 offset:21504
 v_mfma_f32_16x16x32_bf16 v[56:59], v[100:103], v[176:179], v[56:59]
 buffer_load_dwordx4 v[236:239], v7, s[16:19], s42 offen offset:2048 sc1
 s_waitcnt vmcnt(14) lgkmcnt(8)
 v_mfma_f32_16x16x32_bf16 v[32:35], v[72:75], v[184:187], v[32:35]
 ds_read_b64_tr_b16 v[96:97], v18 offset:20480
 ds_read_b64_tr_b16 v[98:99], v18 offset:21504
 v_mfma_f32_16x16x32_bf16 v[36:39], v[72:75], v[188:191], v[36:39]
 v_mfma_f32_16x16x32_bf16 v[44:47], v[76:79], v[188:191], v[44:47]
 ds_read_b64_tr_b16 v[100:101], v19 offset:20480
 ds_read_b64_tr_b16 v[102:103], v19 offset:21504
 v_mfma_f32_16x16x32_bf16 v[40:43], v[76:79], v[184:187], v[40:43]
 buffer_load_dwordx4 v[240:243], v6, s[16:19], s42 offen offset:3072 sc1
 s_waitcnt lgkmcnt(8)
 v_mfma_f32_16x16x32_bf16 v[48:51], v[80:83], v[184:187], v[48:51]
 ds_read_b64_tr_b16 v[72:73], v16 offset:24576
 ds_read_b64_tr_b16 v[74:75], v16 offset:25600
 s_branch m_ps_p2_0
m_pad_p2_0:
 s_branch m_reta_p2
m_ps_p2_0:
 v_mfma_f32_16x16x32_bf16 v[52:55], v[80:83], v[188:191], v[52:55]
 buffer_load_dword v65, v8, s[88:91], s47 offen offset:64 sc1
 v_mfma_f32_16x16x32_bf16 v[60:63], v[84:87], v[188:191], v[60:63]
 ds_read_b64_tr_b16 v[76:77], v17 offset:24576
 ds_read_b64_tr_b16 v[78:79], v17 offset:25600
 v_mfma_f32_16x16x32_bf16 v[56:59], v[84:87], v[184:187], v[56:59]
 buffer_load_dwordx4 v[244:247], v7, s[16:19], s42 offen offset:3072 sc1
 s_mov_b32 s42, 12288
 s_waitcnt vmcnt(15) lgkmcnt(8)
 v_mfma_f32_16x16x32_bf16 v[32:35], v[88:91], v[192:195], v[32:35]
 ds_read_b64_tr_b16 v[80:81], v18 offset:24576
 ds_read_b64_tr_b16 v[82:83], v18 offset:25600
 v_mfma_f32_16x16x32_bf16 v[36:39], v[88:91], v[196:199], v[36:39]
 buffer_load_dwordx4 v[152:155], v6, s[16:19], s42 offen offset:0 sc1
 v_mfma_f32_16x16x32_bf16 v[44:47], v[92:95], v[196:199], v[44:47]
 ds_read_b64_tr_b16 v[84:85], v19 offset:24576
 ds_read_b64_tr_b16 v[86:87], v19 offset:25600
 v_mfma_f32_16x16x32_bf16 v[40:43], v[92:95], v[192:195], v[40:43]
 s_waitcnt lgkmcnt(8)
 v_mfma_f32_16x16x32_bf16 v[48:51], v[96:99], v[192:195], v[48:51]
 ds_read_b64_tr_b16 v[88:89], v16 offset:28672
 ds_read_b64_tr_b16 v[90:91], v16 offset:29696
 v_mfma_f32_16x16x32_bf16 v[52:55], v[96:99], v[196:199], v[52:55]
 buffer_load_dword v66, v8, s[88:91], s47 offen offset:128 sc1
 buffer_load_dwordx4 v[156:159], v7, s[16:19], s42 offen offset:0 sc1
 v_mfma_f32_16x16x32_bf16 v[60:63], v[100:103], v[196:199], v[60:63]
 ds_read_b64_tr_b16 v[92:93], v17 offset:28672
 ds_read_b64_tr_b16 v[94:95], v17 offset:29696
 v_mfma_f32_16x16x32_bf16 v[56:59], v[100:103], v[192:195], v[56:59]
 s_waitcnt vmcnt(16) lgkmcnt(8)
 v_mfma_f32_16x16x32_bf16 v[32:35], v[72:75], v[200:203], v[32:35]
 ds_read_b64_tr_b16 v[96:97], v18 offset:28672
 ds_read_b64_tr_b16 v[98:99], v18 offset:29696
 v_mfma_f32_16x16x32_bf16 v[36:39], v[72:75], v[204:207], v[36:39]
 buffer_load_dwordx4 v[160:163], v6, s[16:19], s42 offen offset:1024 sc1
 v_mfma_f32_16x16x32_bf16 v[44:47], v[76:79], v[204:207], v[44:47]
 ds_read_b64_tr_b16 v[100:101], v19 offset:28672
 ds_read_b64_tr_b16 v[102:103], v19 offset:29696
 v_mfma_f32_16x16x32_bf16 v[40:43], v[76:79], v[200:203], v[40:43]
 buffer_load_dwordx4 v[164:167], v7, s[16:19], s42 offen offset:1024 sc1
 s_waitcnt lgkmcnt(8)
 v_mfma_f32_16x16x32_bf16 v[48:51], v[80:83], v[200:203], v[48:51]
 ds_read_b64_tr_b16 v[72:73], v16 offset:32768
 ds_read_b64_tr_b16 v[74:75], v16 offset:33792
 v_mfma_f32_16x16x32_bf16 v[52:55], v[80:83], v[204:207], v[52:55]
 buffer_load_dword v67, v8, s[88:91], s47 offen offset:192 sc1
 v_mfma_f32_16x16x32_bf16 v[60:63], v[84:87], v[204:207], v[60:63]
 ds_read_b64_tr_b16 v[76:77], v17 offset:32768
 ds_read_b64_tr_b16 v[78:79], v17 offset:33792
 v_mfma_f32_16x16x32_bf16 v[56:59], v[84:87], v[200:203], v[56:59]
 buffer_load_dwordx4 v[168:171], v6, s[16:19], s42 offen offset:2048 sc1
 s_waitcnt vmcnt(18) lgkmcnt(8)
 v_mfma_f32_16x16x32_bf16 v[32:35], v[88:91], v[208:211], v[32:35]
 ds_read_b64_tr_b16 v[80:81], v18 offset:32768
 ds_read_b64_tr_b16 v[82:83], v18 offset:33792
 v_mfma_f32_16x16x32_bf16 v[36:39], v[88:91], v[212:215], v[36:39]
 v_mfma_f32_16x16x32_bf16 v[44:47], v[92:95], v[212:215], v[44:47]
 ds_read_b64_tr_b16 v[84:85], v19 offset:32768
 ds_read_b64_tr_b16 v[86:87], v19 offset:33792
 v_mfma_f32_16x16x32_bf16 v[40:43], v[92:95], v[208:211], v[40:43]
 buffer_load_dwordx4 v[172:175], v7, s[16:19], s42 offen offset:2048 sc1
 s_waitcnt lgkmcnt(8)
 v_mfma_f32_16x16x32_bf16 v[48:51], v[96:99], v[208:211], v[48:51]
 ds_read_b64_tr_b16 v[88:89], v16 offset:36864
 ds_read_b64_tr_b16 v[90:91], v16 offset:37888
 v_mfma_f32_16x16x32_bf16 v[52:55], v[96:99], v[212:215], v[52:55]
 buffer_load_dword v68, v8, s[88:91], s47 offen offset:256 sc1
 v_mfma_f32_16x16x32_bf16 v[60:63], v[100:103], v[212:215], v[60:63]
 ds_read_b64_tr_b16 v[92:93], v17 offset:36864
 ds_read_b64_tr_b16 v[94:95], v17 offset:37888
 v_mfma_f32_16x16x32_bf16 v[56:59], v[100:103], v[208:211], v[56:59]
 buffer_load_dwordx4 v[176:179], v6, s[16:19], s42 offen offset:3072 sc1
 s_waitcnt vmcnt(19) lgkmcnt(8)
 v_mfma_f32_16x16x32_bf16 v[32:35], v[72:75], v[216:219], v[32:35]
 ds_read_b64_tr_b16 v[96:97], v18 offset:36864
 ds_read_b64_tr_b16 v[98:99], v18 offset:37888
 v_mfma_f32_16x16x32_bf16 v[36:39], v[72:75], v[220:223], v[36:39]
 buffer_load_dwordx4 v[180:183], v7, s[16:19], s42 offen offset:3072 sc1
 v_mfma_f32_16x16x32_bf16 v[44:47], v[76:79], v[220:223], v[44:47]
 ds_read_b64_tr_b16 v[100:101], v19 offset:36864
 ds_read_b64_tr_b16 v[102:103], v19 offset:37888
 v_mfma_f32_16x16x32_bf16 v[40:43], v[76:79], v[216:219], v[40:43]
 s_waitcnt lgkmcnt(8)
 v_mfma_f32_16x16x32_bf16 v[48:51], v[80:83], v[216:219], v[48:51]
 ds_read_b64_tr_b16 v[72:73], v16 offset:40960
 ds_read_b64_tr_b16 v[74:75], v16 offset:41984
 v_mfma_f32_16x16x32_bf16 v[52:55], v[80:83], v[220:223], v[52:55]
 buffer_load_dword v69, v8, s[88:91], s47 offen offset:320 sc1
 global_load_dword v148, v[146:147], off
 v_mfma_f32_16x16x32_bf16 v[60:63], v[84:87], v[220:223], v[60:63]
 ds_read_b64_tr_b16 v[76:77], v17 offset:40960
 ds_read_b64_tr_b16 v[78:79], v17 offset:41984
 v_mfma_f32_16x16x32_bf16 v[56:59], v[84:87], v[216:219], v[56:59]
 s_mov_b32 s42, 16384
 s_waitcnt vmcnt(19) lgkmcnt(8)
 v_mfma_f32_16x16x32_bf16 v[32:35], v[88:91], v[224:227], v[32:35]
 ds_read_b64_tr_b16 v[80:81], v18 offset:40960
 ds_read_b64_tr_b16 v[82:83], v18 offset:41984
 v_mfma_f32_16x16x32_bf16 v[36:39], v[88:91], v[228:231], v[36:39]
 buffer_load_dwordx4 v[184:187], v6, s[16:19], s42 offen offset:0 sc1
 v_mfma_f32_16x16x32_bf16 v[44:47], v[92:95], v[228:231], v[44:47]
 ds_read_b64_tr_b16 v[84:85], v19 offset:40960
 ds_read_b64_tr_b16 v[86:87], v19 offset:41984
 v_mfma_f32_16x16x32_bf16 v[40:43], v[92:95], v[224:227], v[40:43]
 buffer_load_dwordx4 v[188:191], v7, s[16:19], s42 offen offset:0 sc1
 s_waitcnt lgkmcnt(8)
 v_mfma_f32_16x16x32_bf16 v[48:51], v[96:99], v[224:227], v[48:51]
 ds_read_b64_tr_b16 v[88:89], v16 offset:45056
 ds_read_b64_tr_b16 v[90:91], v16 offset:46080
 v_mfma_f32_16x16x32_bf16 v[52:55], v[96:99], v[228:231], v[52:55]
 buffer_load_dword v70, v8, s[88:91], s47 offen offset:384 sc1
 v_mfma_f32_16x16x32_bf16 v[60:63], v[100:103], v[228:231], v[60:63]
 ds_read_b64_tr_b16 v[92:93], v17 offset:45056
 ds_read_b64_tr_b16 v[94:95], v17 offset:46080
 v_mfma_f32_16x16x32_bf16 v[56:59], v[100:103], v[224:227], v[56:59]
 buffer_load_dwordx4 v[192:195], v6, s[16:19], s42 offen offset:1024 sc1
 s_waitcnt vmcnt(20) lgkmcnt(8)
 v_mfma_f32_16x16x32_bf16 v[32:35], v[72:75], v[232:235], v[32:35]
 ds_read_b64_tr_b16 v[96:97], v18 offset:45056
 ds_read_b64_tr_b16 v[98:99], v18 offset:46080
 v_mfma_f32_16x16x32_bf16 v[36:39], v[72:75], v[236:239], v[36:39]
 v_mfma_f32_16x16x32_bf16 v[44:47], v[76:79], v[236:239], v[44:47]
 ds_read_b64_tr_b16 v[100:101], v19 offset:45056
 ds_read_b64_tr_b16 v[102:103], v19 offset:46080
 v_mfma_f32_16x16x32_bf16 v[40:43], v[76:79], v[232:235], v[40:43]
 buffer_load_dwordx4 v[196:199], v7, s[16:19], s42 offen offset:1024 sc1
 s_waitcnt lgkmcnt(8)
 v_mfma_f32_16x16x32_bf16 v[48:51], v[80:83], v[232:235], v[48:51]
 ds_read_b64_tr_b16 v[72:73], v16 offset:49152
 ds_read_b64_tr_b16 v[74:75], v16 offset:50176
 v_mfma_f32_16x16x32_bf16 v[52:55], v[80:83], v[236:239], v[52:55]
 buffer_load_dword v71, v8, s[88:91], s47 offen offset:448 sc1
 v_mfma_f32_16x16x32_bf16 v[60:63], v[84:87], v[236:239], v[60:63]
 ds_read_b64_tr_b16 v[76:77], v17 offset:49152
 ds_read_b64_tr_b16 v[78:79], v17 offset:50176
 v_mfma_f32_16x16x32_bf16 v[56:59], v[84:87], v[232:235], v[56:59]
 buffer_load_dwordx4 v[200:203], v6, s[16:19], s42 offen offset:2048 sc1
 s_waitcnt vmcnt(20) lgkmcnt(8)
 v_mfma_f32_16x16x32_bf16 v[32:35], v[88:91], v[240:243], v[32:35]
 ds_read_b64_tr_b16 v[80:81], v18 offset:49152
 ds_read_b64_tr_b16 v[82:83], v18 offset:50176
 v_mfma_f32_16x16x32_bf16 v[36:39], v[88:91], v[244:247], v[36:39]
 buffer_load_dwordx4 v[204:207], v7, s[16:19], s42 offen offset:2048 sc1
 v_mfma_f32_16x16x32_bf16 v[44:47], v[92:95], v[244:247], v[44:47]
 ds_read_b64_tr_b16 v[84:85], v19 offset:49152
 ds_read_b64_tr_b16 v[86:87], v19 offset:50176
 v_mfma_f32_16x16x32_bf16 v[40:43], v[92:95], v[240:243], v[40:43]
 s_waitcnt lgkmcnt(8)
 v_mfma_f32_16x16x32_bf16 v[48:51], v[96:99], v[240:243], v[48:51]
 ds_read_b64_tr_b16 v[88:89], v16 offset:53248
 ds_read_b64_tr_b16 v[90:91], v16 offset:54272
 v_mfma_f32_16x16x32_bf16 v[52:55], v[96:99], v[244:247], v[52:55]
 buffer_load_dwordx4 v[208:211], v6, s[16:19], s42 offen offset:3072 sc1
 v_mfma_f32_16x16x32_bf16 v[60:63], v[100:103], v[244:247], v[60:63]
 ds_read_b64_tr_b16 v[92:93], v17 offset:53248
 ds_read_b64_tr_b16 v[94:95], v17 offset:54272
 v_mfma_f32_16x16x32_bf16 v[56:59], v[100:103], v[240:243], v[56:59]
 s_waitcnt vmcnt(19) lgkmcnt(8)
 v_mfma_f32_16x16x32_bf16 v[32:35], v[72:75], v[152:155], v[32:35]
 ds_read_b64_tr_b16 v[96:97], v18 offset:53248
 ds_read_b64_tr_b16 v[98:99], v18 offset:54272
 v_mfma_f32_16x16x32_bf16 v[36:39], v[72:75], v[156:159], v[36:39]
 buffer_load_dwordx4 v[212:215], v7, s[16:19], s42 offen offset:3072 sc1
 s_mov_b32 s42, 20480
 v_mfma_f32_16x16x32_bf16 v[44:47], v[76:79], v[156:159], v[44:47]
 ds_read_b64_tr_b16 v[100:101], v19 offset:53248
 ds_read_b64_tr_b16 v[102:103], v19 offset:54272
 v_mfma_f32_16x16x32_bf16 v[40:43], v[76:79], v[152:155], v[40:43]
 buffer_load_dwordx4 v[216:219], v6, s[16:19], s42 offen offset:0 sc1
 s_waitcnt lgkmcnt(8)
 v_mfma_f32_16x16x32_bf16 v[48:51], v[80:83], v[152:155], v[48:51]
 ds_read_b64_tr_b16 v[72:73], v16 offset:57344
 ds_read_b64_tr_b16 v[74:75], v16 offset:58368
 v_mfma_f32_16x16x32_bf16 v[52:55], v[80:83], v[156:159], v[52:55]
 v_mfma_f32_16x16x32_bf16 v[60:63], v[84:87], v[156:159], v[60:63]
 ds_read_b64_tr_b16 v[76:77], v17 offset:57344
 ds_read_b64_tr_b16 v[78:79], v17 offset:58368
 v_mfma_f32_16x16x32_bf16 v[56:59], v[84:87], v[152:155], v[56:59]
 buffer_load_dwordx4 v[220:223], v7, s[16:19], s42 offen offset:0 sc1
 s_waitcnt vmcnt(20) lgkmcnt(8)
 v_mfma_f32_16x16x32_bf16 v[32:35], v[88:91], v[160:163], v[32:35]
 ds_read_b64_tr_b16 v[80:81], v18 offset:57344
 ds_read_b64_tr_b16 v[82:83], v18 offset:58368
 v_mfma_f32_16x16x32_bf16 v[36:39], v[88:91], v[164:167], v[36:39]
 v_mfma_f32_16x16x32_bf16 v[44:47], v[92:95], v[164:167], v[44:47]
 ds_read_b64_tr_b16 v[84:85], v19 offset:57344
 ds_read_b64_tr_b16 v[86:87], v19 offset:58368
 v_mfma_f32_16x16x32_bf16 v[40:43], v[92:95], v[160:163], v[40:43]
 buffer_load_dwordx4 v[224:227], v6, s[16:19], s42 offen offset:1024 sc1
 s_waitcnt lgkmcnt(8)
 v_mfma_f32_16x16x32_bf16 v[48:51], v[96:99], v[160:163], v[48:51]
 ds_read_b64_tr_b16 v[88:89], v16 offset:61440
 ds_read_b64_tr_b16 v[90:91], v16 offset:62464
 v_mfma_f32_16x16x32_bf16 v[52:55], v[96:99], v[164:167], v[52:55]
 buffer_load_dwordx4 v[228:231], v7, s[16:19], s42 offen offset:1024 sc1
 v_mfma_f32_16x16x32_bf16 v[60:63], v[100:103], v[164:167], v[60:63]
 ds_read_b64_tr_b16 v[92:93], v17 offset:61440
 ds_read_b64_tr_b16 v[94:95], v17 offset:62464
 v_mfma_f32_16x16x32_bf16 v[56:59], v[100:103], v[160:163], v[56:59]
 s_waitcnt vmcnt(19) lgkmcnt(8)
 v_mfma_f32_16x16x32_bf16 v[32:35], v[72:75], v[168:171], v[32:35]
 ds_read_b64_tr_b16 v[96:97], v18 offset:61440
 ds_read_b64_tr_b16 v[98:99], v18 offset:62464
 v_mfma_f32_16x16x32_bf16 v[36:39], v[72:75], v[172:175], v[36:39]
 buffer_load_dwordx4 v[232:235], v6, s[16:19], s42 offen offset:2048 sc1
 v_mfma_f32_16x16x32_bf16 v[44:47], v[76:79], v[172:175], v[44:47]
 ds_read_b64_tr_b16 v[100:101], v19 offset:61440
 ds_read_b64_tr_b16 v[102:103], v19 offset:62464
 v_mfma_f32_16x16x32_bf16 v[40:43], v[76:79], v[168:171], v[40:43]
 s_waitcnt lgkmcnt(8)
 v_mfma_f32_16x16x32_bf16 v[48:51], v[80:83], v[168:171], v[48:51]
 ds_read_b64_tr_b16 v[72:73], v20 offset:0
 ds_read_b64_tr_b16 v[74:75], v20 offset:1024
 v_mfma_f32_16x16x32_bf16 v[52:55], v[80:83], v[172:175], v[52:55]
 buffer_load_dwordx4 v[236:239], v7, s[16:19], s42 offen offset:2048 sc1
 v_mfma_f32_16x16x32_bf16 v[60:63], v[84:87], v[172:175], v[60:63]
 ds_read_b64_tr_b16 v[76:77], v21 offset:0
 ds_read_b64_tr_b16 v[78:79], v21 offset:1024
 v_mfma_f32_16x16x32_bf16 v[56:59], v[84:87], v[168:171], v[56:59]
 s_waitcnt vmcnt(18) lgkmcnt(8)
 v_mfma_f32_16x16x32_bf16 v[32:35], v[88:91], v[176:179], v[32:35]
 ds_read_b64_tr_b16 v[80:81], v22 offset:0
 ds_read_b64_tr_b16 v[82:83], v22 offset:1024
 v_mfma_f32_16x16x32_bf16 v[36:39], v[88:91], v[180:183], v[36:39]
 buffer_load_dwordx4 v[240:243], v6, s[16:19], s42 offen offset:3072 sc1
 v_mfma_f32_16x16x32_bf16 v[44:47], v[92:95], v[180:183], v[44:47]
 ds_read_b64_tr_b16 v[84:85], v23 offset:0
 ds_read_b64_tr_b16 v[86:87], v23 offset:1024
 v_mfma_f32_16x16x32_bf16 v[40:43], v[92:95], v[176:179], v[40:43]
 buffer_load_dwordx4 v[244:247], v7, s[16:19], s42 offen offset:3072 sc1
 s_waitcnt lgkmcnt(8)
 v_mfma_f32_16x16x32_bf16 v[48:51], v[96:99], v[176:179], v[48:51]
 ds_read_b64_tr_b16 v[88:89], v20 offset:4096
 ds_read_b64_tr_b16 v[90:91], v20 offset:5120
 v_mfma_f32_16x16x32_bf16 v[52:55], v[96:99], v[180:183], v[52:55]
 s_mov_b32 s42, 24576
 v_mfma_f32_16x16x32_bf16 v[60:63], v[100:103], v[180:183], v[60:63]
 ds_read_b64_tr_b16 v[92:93], v21 offset:4096
 ds_read_b64_tr_b16 v[94:95], v21 offset:5120
 v_mfma_f32_16x16x32_bf16 v[56:59], v[100:103], v[176:179], v[56:59]
 buffer_load_dwordx4 v[152:155], v6, s[16:19], s42 offen offset:0 sc1
 s_waitcnt vmcnt(17) lgkmcnt(8)
 v_mfma_f32_16x16x32_bf16 v[32:35], v[72:75], v[184:187], v[32:35]
 ds_read_b64_tr_b16 v[96:97], v22 offset:4096
 ds_read_b64_tr_b16 v[98:99], v22 offset:5120
 v_mfma_f32_16x16x32_bf16 v[36:39], v[72:75], v[188:191], v[36:39]
 v_mfma_f32_16x16x32_bf16 v[44:47], v[76:79], v[188:191], v[44:47]
 ds_read_b64_tr_b16 v[100:101], v23 offset:4096
 ds_read_b64_tr_b16 v[102:103], v23 offset:5120
 v_mfma_f32_16x16x32_bf16 v[40:43], v[76:79], v[184:187], v[40:43]
 buffer_load_dwordx4 v[156:159], v7, s[16:19], s42 offen offset:0 sc1
 s_mov_b32 s40, 1703936
 s_waitcnt lgkmcnt(8)
 v_mfma_f32_16x16x32_bf16 v[48:51], v[80:83], v[184:187], v[48:51]
 ds_read_b64_tr_b16 v[72:73], v20 offset:8192
 ds_read_b64_tr_b16 v[74:75], v20 offset:9216
 s_add_u32 m0, s45, 106496
 v_mfma_f32_16x16x32_bf16 v[52:55], v[80:83], v[188:191], v[52:55]
 buffer_load_dwordx4 v26, s[20:23], s40 offen offset:0 lds
 v_mfma_f32_16x16x32_bf16 v[60:63], v[84:87], v[188:191], v[60:63]
 ds_read_b64_tr_b16 v[76:77], v21 offset:8192
 ds_read_b64_tr_b16 v[78:79], v21 offset:9216
 v_mfma_f32_16x16x32_bf16 v[56:59], v[84:87], v[184:187], v[56:59]
 s_waitcnt vmcnt(16) lgkmcnt(8)
 v_mfma_f32_16x16x32_bf16 v[32:35], v[88:91], v[192:195], v[32:35]
 ds_read_b64_tr_b16 v[80:81], v22 offset:8192
 ds_read_b64_tr_b16 v[82:83], v22 offset:9216
 v_mfma_f32_16x16x32_bf16 v[36:39], v[88:91], v[196:199], v[36:39]
 buffer_load_dwordx4 v27, s[20:23], s40 offen offset:1024 lds
 v_mfma_f32_16x16x32_bf16 v[44:47], v[92:95], v[196:199], v[44:47]
 ds_read_b64_tr_b16 v[84:85], v23 offset:8192
 ds_read_b64_tr_b16 v[86:87], v23 offset:9216
 v_mfma_f32_16x16x32_bf16 v[40:43], v[92:95], v[192:195], v[40:43]
 s_waitcnt lgkmcnt(8)
 v_mfma_f32_16x16x32_bf16 v[48:51], v[96:99], v[192:195], v[48:51]
 ds_read_b64_tr_b16 v[88:89], v20 offset:12288
 ds_read_b64_tr_b16 v[90:91], v20 offset:13312
 v_mfma_f32_16x16x32_bf16 v[52:55], v[96:99], v[196:199], v[52:55]
 buffer_load_dwordx4 v[160:163], v6, s[16:19], s42 offen offset:1024 sc1
 v_mfma_f32_16x16x32_bf16 v[60:63], v[100:103], v[196:199], v[60:63]
 ds_read_b64_tr_b16 v[92:93], v21 offset:12288
 ds_read_b64_tr_b16 v[94:95], v21 offset:13312
 v_mfma_f32_16x16x32_bf16 v[56:59], v[100:103], v[192:195], v[56:59]
 buffer_load_dwordx4 v[164:167], v7, s[16:19], s42 offen offset:1024 sc1
 s_waitcnt vmcnt(16) lgkmcnt(8)
 v_mfma_f32_16x16x32_bf16 v[32:35], v[72:75], v[200:203], v[32:35]
 ds_read_b64_tr_b16 v[96:97], v22 offset:12288
 ds_read_b64_tr_b16 v[98:99], v22 offset:13312
 v_mfma_f32_16x16x32_bf16 v[36:39], v[72:75], v[204:207], v[36:39]
 v_mfma_f32_16x16x32_bf16 v[44:47], v[76:79], v[204:207], v[44:47]
 ds_read_b64_tr_b16 v[100:101], v23 offset:12288
 ds_read_b64_tr_b16 v[102:103], v23 offset:13312
 v_mfma_f32_16x16x32_bf16 v[40:43], v[76:79], v[200:203], v[40:43]
 buffer_load_dwordx4 v[168:171], v6, s[16:19], s42 offen offset:2048 sc1
 s_waitcnt lgkmcnt(8)
 v_mfma_f32_16x16x32_bf16 v[48:51], v[80:83], v[200:203], v[48:51]
 ds_read_b64_tr_b16 v[72:73], v20 offset:16384
 ds_read_b64_tr_b16 v[74:75], v20 offset:17408
 v_mfma_f32_16x16x32_bf16 v[52:55], v[80:83], v[204:207], v[52:55]
 v_mfma_f32_16x16x32_bf16 v[60:63], v[84:87], v[204:207], v[60:63]
 ds_read_b64_tr_b16 v[76:77], v21 offset:16384
 ds_read_b64_tr_b16 v[78:79], v21 offset:17408
 v_mfma_f32_16x16x32_bf16 v[56:59], v[84:87], v[200:203], v[56:59]
 buffer_load_dwordx4 v[172:175], v7, s[16:19], s42 offen offset:2048 sc1
 s_waitcnt vmcnt(16) lgkmcnt(8)
 v_mfma_f32_16x16x32_bf16 v[32:35], v[88:91], v[208:211], v[32:35]
 ds_read_b64_tr_b16 v[80:81], v22 offset:16384
 ds_read_b64_tr_b16 v[82:83], v22 offset:17408
 v_mfma_f32_16x16x32_bf16 v[36:39], v[88:91], v[212:215], v[36:39]
 s_mov_b32 s40, 1835008
 s_add_u32 m0, s45, 114688
 v_mfma_f32_16x16x32_bf16 v[44:47], v[92:95], v[212:215], v[44:47]
 ds_read_b64_tr_b16 v[84:85], v23 offset:16384
 ds_read_b64_tr_b16 v[86:87], v23 offset:17408
 v_mfma_f32_16x16x32_bf16 v[40:43], v[92:95], v[208:211], v[40:43]
 buffer_load_dwordx4 v26, s[20:23], s40 offen offset:0 lds
 s_waitcnt lgkmcnt(8)
 v_mfma_f32_16x16x32_bf16 v[48:51], v[96:99], v[208:211], v[48:51]
 ds_read_b64_tr_b16 v[88:89], v20 offset:20480
 ds_read_b64_tr_b16 v[90:91], v20 offset:21504
 v_mfma_f32_16x16x32_bf16 v[52:55], v[96:99], v[212:215], v[52:55]
 buffer_load_dwordx4 v27, s[20:23], s40 offen offset:1024 lds
 v_add_f32 v64, v64, v68
 v_mfma_f32_16x16x32_bf16 v[60:63], v[100:103], v[212:215], v[60:63]
 ds_read_b64_tr_b16 v[92:93], v21 offset:20480
 ds_read_b64_tr_b16 v[94:95], v21 offset:21504
 v_mfma_f32_16x16x32_bf16 v[56:59], v[100:103], v[208:211], v[56:59]
 v_add_f32 v65, v65, v69
 s_waitcnt vmcnt(16) lgkmcnt(8)
 v_mfma_f32_16x16x32_bf16 v[32:35], v[72:75], v[216:219], v[32:35]
 ds_read_b64_tr_b16 v[96:97], v22 offset:20480
 ds_read_b64_tr_b16 v[98:99], v22 offset:21504
 v_mfma_f32_16x16x32_bf16 v[36:39], v[72:75], v[220:223], v[36:39]
 buffer_load_dwordx4 v[176:179], v6, s[16:19], s42 offen offset:3072 sc1
 v_add_f32 v66, v66, v70
 v_mfma_f32_16x16x32_bf16 v[44:47], v[76:79], v[220:223], v[44:47]
 ds_read_b64_tr_b16 v[100:101], v23 offset:20480
 ds_read_b64_tr_b16 v[102:103], v23 offset:21504
 v_mfma_f32_16x16x32_bf16 v[40:43], v[76:79], v[216:219], v[40:43]
 v_add_f32 v67, v67, v71
 s_waitcnt lgkmcnt(8)
 v_mfma_f32_16x16x32_bf16 v[48:51], v[80:83], v[216:219], v[48:51]
 ds_read_b64_tr_b16 v[72:73], v20 offset:24576
 ds_read_b64_tr_b16 v[74:75], v20 offset:25600
 v_mfma_f32_16x16x32_bf16 v[52:55], v[80:83], v[220:223], v[52:55]
 buffer_load_dwordx4 v[180:183], v7, s[16:19], s42 offen offset:3072 sc1
 s_mov_b32 s42, 28672
 v_mfma_f32_16x16x32_bf16 v[60:63], v[84:87], v[220:223], v[60:63]
 ds_read_b64_tr_b16 v[76:77], v21 offset:24576
 ds_read_b64_tr_b16 v[78:79], v21 offset:25600
 v_mfma_f32_16x16x32_bf16 v[56:59], v[84:87], v[216:219], v[56:59]
 buffer_load_dwordx4 v[184:187], v6, s[16:19], s42 offen offset:0 sc1
 s_waitcnt vmcnt(17) lgkmcnt(8)
 v_mfma_f32_16x16x32_bf16 v[32:35], v[88:91], v[224:227], v[32:35]
 ds_read_b64_tr_b16 v[80:81], v22 offset:24576
 ds_read_b64_tr_b16 v[82:83], v22 offset:25600
 v_mfma_f32_16x16x32_bf16 v[36:39], v[88:91], v[228:231], v[36:39]
 v_add_f32 v64, v64, v66
 v_add_f32 v65, v65, v67
 v_mfma_f32_16x16x32_bf16 v[44:47], v[92:95], v[228:231], v[44:47]
 ds_read_b64_tr_b16 v[84:85], v23 offset:24576
 ds_read_b64_tr_b16 v[86:87], v23 offset:25600
 v_mfma_f32_16x16x32_bf16 v[40:43], v[92:95], v[224:227], v[40:43]
 buffer_load_dwordx4 v[188:191], v7, s[16:19], s42 offen offset:0 sc1
 s_waitcnt lgkmcnt(8)
 v_mfma_f32_16x16x32_bf16 v[48:51], v[96:99], v[224:227], v[48:51]
 ds_read_b64_tr_b16 v[88:89], v20 offset:28672
 ds_read_b64_tr_b16 v[90:91], v20 offset:29696
 v_mfma_f32_16x16x32_bf16 v[52:55], v[96:99], v[228:231], v[52:55]
 s_mov_b32 s40, 1966080
 s_add_u32 m0, s45, 0
 v_mfma_f32_16x16x32_bf16 v[60:63], v[100:103], v[228:231], v[60:63]
 ds_read_b64_tr_b16 v[92:93], v21 offset:28672
 ds_read_b64_tr_b16 v[94:95], v21 offset:29696
 v_mfma_f32_16x16x32_bf16 v[56:59], v[100:103], v[224:227], v[56:59]
 buffer_load_dwordx4 v26, s[20:23], s40 offen offset:0 lds
 s_waitcnt vmcnt(17) lgkmcnt(8)
 v_mfma_f32_16x16x32_bf16 v[32:35], v[72:75], v[232:235], v[32:35]
 ds_read_b64_tr_b16 v[96:97], v22 offset:28672
 ds_read_b64_tr_b16 v[98:99], v22 offset:29696
 v_mfma_f32_16x16x32_bf16 v[36:39], v[72:75], v[236:239], v[36:39]
 buffer_load_dwordx4 v27, s[20:23], s40 offen offset:1024 lds
 v_add_f32 v64, v64, v65
 v_mfma_f32_16x16x32_bf16 v[44:47], v[76:79], v[236:239], v[44:47]
 ds_read_b64_tr_b16 v[100:101], v23 offset:28672
 ds_read_b64_tr_b16 v[102:103], v23 offset:29696
 v_mfma_f32_16x16x32_bf16 v[40:43], v[76:79], v[232:235], v[40:43]
 v_mov_b32 v65, v64
 s_waitcnt lgkmcnt(8)
 v_mfma_f32_16x16x32_bf16 v[48:51], v[80:83], v[232:235], v[48:51]
 ds_read_b64_tr_b16 v[72:73], v20 offset:32768
 ds_read_b64_tr_b16 v[74:75], v20 offset:33792
 v_mfma_f32_16x16x32_bf16 v[52:55], v[80:83], v[236:239], v[52:55]
 buffer_load_dwordx4 v[192:195], v6, s[16:19], s42 offen offset:1024 sc1
 v_mfma_f32_16x16x32_bf16 v[60:63], v[84:87], v[236:239], v[60:63]
 ds_read_b64_tr_b16 v[76:77], v21 offset:32768
 ds_read_b64_tr_b16 v[78:79], v21 offset:33792
 v_mfma_f32_16x16x32_bf16 v[56:59], v[84:87], v[232:235], v[56:59]
 s_nop 1
 s_waitcnt vmcnt(17) lgkmcnt(8)
 v_mfma_f32_16x16x32_bf16 v[32:35], v[88:91], v[240:243], v[32:35]
 ds_read_b64_tr_b16 v[80:81], v22 offset:32768
 ds_read_b64_tr_b16 v[82:83], v22 offset:33792
 v_mfma_f32_16x16x32_bf16 v[36:39], v[88:91], v[244:247], v[36:39]
 buffer_load_dwordx4 v[196:199], v7, s[16:19], s42 offen offset:1024 sc1
 v_permlane32_swap_b32 v64, v65
 v_mfma_f32_16x16x32_bf16 v[44:47], v[92:95], v[244:247], v[44:47]
 ds_read_b64_tr_b16 v[84:85], v23 offset:32768
 ds_read_b64_tr_b16 v[86:87], v23 offset:33792
 v_mfma_f32_16x16x32_bf16 v[40:43], v[92:95], v[240:243], v[40:43]
 v_add_f32 v64, v64, v65
 s_waitcnt lgkmcnt(8)
 v_mfma_f32_16x16x32_bf16 v[48:51], v[96:99], v[240:243], v[48:51]
 ds_read_b64_tr_b16 v[88:89], v20 offset:36864
 ds_read_b64_tr_b16 v[90:91], v20 offset:37888
 v_mfma_f32_16x16x32_bf16 v[52:55], v[96:99], v[244:247], v[52:55]
 buffer_load_dwordx4 v[200:203], v6, s[16:19], s42 offen offset:2048 sc1
 v_add_f32 v144, v144, v64
 v_mfma_f32_16x16x32_bf16 v[60:63], v[100:103], v[244:247], v[60:63]
 ds_read_b64_tr_b16 v[92:93], v21 offset:36864
 ds_read_b64_tr_b16 v[94:95], v21 offset:37888
 v_mfma_f32_16x16x32_bf16 v[56:59], v[100:103], v[240:243], v[56:59]
 buffer_load_dwordx4 v[204:207], v7, s[16:19], s42 offen offset:2048 sc1
 s_waitcnt vmcnt(18) lgkmcnt(8)
 v_mfma_f32_16x16x32_bf16 v[32:35], v[72:75], v[152:155], v[32:35]
 ds_read_b64_tr_b16 v[96:97], v22 offset:36864
 ds_read_b64_tr_b16 v[98:99], v22 offset:37888
 v_mfma_f32_16x16x32_bf16 v[36:39], v[72:75], v[156:159], v[36:39]
 v_sub_f32 v112, v112, v144
 v_sub_f32 v113, v113, v144
 v_mfma_f32_16x16x32_bf16 v[44:47], v[76:79], v[156:159], v[44:47]
 ds_read_b64_tr_b16 v[100:101], v23 offset:36864
 ds_read_b64_tr_b16 v[102:103], v23 offset:37888
 v_mfma_f32_16x16x32_bf16 v[40:43], v[76:79], v[152:155], v[40:43]
 buffer_load_dwordx4 v[208:211], v6, s[16:19], s42 offen offset:3072 sc1
 s_waitcnt lgkmcnt(8)
 v_mfma_f32_16x16x32_bf16 v[48:51], v[80:83], v[152:155], v[48:51]
 s_waitcnt vmcnt(17)
 s_barrier
 ds_read_b64_tr_b16 v[72:73], v20 offset:40960
 v_mfma_f32_16x16x32_bf16 v[52:55], v[80:83], v[156:159], v[52:55]
 ds_read_b64_tr_b16 v[74:75], v20 offset:41984
 v_mfma_f32_16x16x32_bf16 v[60:63], v[84:87], v[156:159], v[60:63]
 ds_read_b64_tr_b16 v[76:77], v21 offset:40960
 ds_read_b64_tr_b16 v[78:79], v21 offset:41984
 v_mfma_f32_16x16x32_bf16 v[56:59], v[84:87], v[152:155], v[56:59]
 buffer_load_dwordx4 v[212:215], v7, s[16:19], s42 offen offset:3072 sc1
 s_waitcnt vmcnt(16) lgkmcnt(8)
 v_mfma_f32_16x16x32_bf16 v[32:35], v[88:91], v[160:163], v[32:35]
 ds_read_b64_tr_b16 v[80:81], v22 offset:40960
 ds_read_b64_tr_b16 v[82:83], v22 offset:41984
 v_mfma_f32_16x16x32_bf16 v[36:39], v[88:91], v[164:167], v[36:39]
 v_sub_f32 v114, v114, v144
 v_sub_f32 v115, v115, v144
 v_mfma_f32_16x16x32_bf16 v[44:47], v[92:95], v[164:167], v[44:47]
 ds_read_b64_tr_b16 v[84:85], v23 offset:40960
 ds_read_b64_tr_b16 v[86:87], v23 offset:41984
 v_mfma_f32_16x16x32_bf16 v[40:43], v[92:95], v[160:163], v[40:43]
 v_sub_f32 v116, v116, v144
 s_waitcnt lgkmcnt(8)
 v_mfma_f32_16x16x32_bf16 v[48:51], v[96:99], v[160:163], v[48:51]
 ds_read_b64_tr_b16 v[88:89], v20 offset:45056
 ds_read_b64_tr_b16 v[90:91], v20 offset:46080
 v_mfma_f32_16x16x32_bf16 v[52:55], v[96:99], v[164:167], v[52:55]
 v_sub_f32 v117, v117, v144
 v_sub_f32 v118, v118, v144
 v_mfma_f32_16x16x32_bf16 v[60:63], v[100:103], v[164:167], v[60:63]
 ds_read_b64_tr_b16 v[92:93], v21 offset:45056
 ds_read_b64_tr_b16 v[94:95], v21 offset:46080
 v_mfma_f32_16x16x32_bf16 v[56:59], v[100:103], v[160:163], v[56:59]
 v_sub_f32 v119, v119, v144
 s_waitcnt vmcnt(14) lgkmcnt(8)
 v_mfma_f32_16x16x32_bf16 v[32:35], v[72:75], v[168:171], v[32:35]
 ds_read_b64_tr_b16 v[96:97], v22 offset:45056
 ds_read_b64_tr_b16 v[98:99], v22 offset:46080
 v_mfma_f32_16x16x32_bf16 v[36:39], v[72:75], v[172:175], v[36:39]
 v_sub_f32 v120, v120, v144
 v_sub_f32 v121, v121, v144
 v_mfma_f32_16x16x32_bf16 v[44:47], v[76:79], v[172:175], v[44:47]
 ds_read_b64_tr_b16 v[100:101], v23 offset:45056
 ds_read_b64_tr_b16 v[102:103], v23 offset:46080
 v_mfma_f32_16x16x32_bf16 v[40:43], v[76:79], v[168:171], v[40:43]
 v_sub_f32 v122, v122, v144
 s_waitcnt lgkmcnt(8)
 v_mfma_f32_16x16x32_bf16 v[48:51], v[80:83], v[168:171], v[48:51]
 s_waitcnt vmcnt(12)
 s_barrier
 ds_read_b64_tr_b16 v[72:73], v20 offset:49152
 v_mfma_f32_16x16x32_bf16 v[52:55], v[80:83], v[172:175], v[52:55]
 ds_read_b64_tr_b16 v[74:75], v20 offset:50176
 v_mfma_f32_16x16x32_bf16 v[60:63], v[84:87], v[172:175], v[60:63]
 ds_read_b64_tr_b16 v[76:77], v21 offset:49152
 ds_read_b64_tr_b16 v[78:79], v21 offset:50176
 v_mfma_f32_16x16x32_bf16 v[56:59], v[84:87], v[168:171], v[56:59]
 v_sub_f32 v123, v123, v144
 s_waitcnt vmcnt(10) lgkmcnt(8)
 v_mfma_f32_16x16x32_bf16 v[32:35], v[88:91], v[176:179], v[32:35]
 ds_read_b64_tr_b16 v[80:81], v22 offset:49152
 ds_read_b64_tr_b16 v[82:83], v22 offset:50176
 v_mfma_f32_16x16x32_bf16 v[36:39], v[88:91], v[180:183], v[36:39]
 v_sub_f32 v124, v124, v144
 v_sub_f32 v125, v125, v144
 v_mfma_f32_16x16x32_bf16 v[44:47], v[92:95], v[180:183], v[44:47]
 ds_read_b64_tr_b16 v[84:85], v23 offset:49152
 ds_read_b64_tr_b16 v[86:87], v23 offset:50176
 v_mfma_f32_16x16x32_bf16 v[40:43], v[92:95], v[176:179], v[40:43]
 v_sub_f32 v126, v126, v144
 s_waitcnt lgkmcnt(8)
 v_mfma_f32_16x16x32_bf16 v[48:51], v[96:99], v[176:179], v[48:51]
 ds_read_b64_tr_b16 v[88:89], v20 offset:53248
 ds_read_b64_tr_b16 v[90:91], v20 offset:54272
 v_mfma_f32_16x16x32_bf16 v[52:55], v[96:99], v[180:183], v[52:55]
 v_sub_f32 v127, v127, v144
 v_sub_f32 v128, v128, v144
 v_mfma_f32_16x16x32_bf16 v[60:63], v[100:103], v[180:183], v[60:63]
 ds_read_b64_tr_b16 v[92:93], v21 offset:53248
 ds_read_b64_tr_b16 v[94:95], v21 offset:54272
 v_mfma_f32_16x16x32_bf16 v[56:59], v[100:103], v[176:179], v[56:59]
 v_sub_f32 v129, v129, v144
 s_waitcnt vmcnt(8) lgkmcnt(8)
 v_mfma_f32_16x16x32_bf16 v[32:35], v[72:75], v[184:187], v[32:35]
 ds_read_b64_tr_b16 v[96:97], v22 offset:53248
 ds_read_b64_tr_b16 v[98:99], v22 offset:54272
 v_mfma_f32_16x16x32_bf16 v[36:39], v[72:75], v[188:191], v[36:39]
 v_sub_f32 v130, v130, v144
 v_sub_f32 v131, v131, v144
 v_mfma_f32_16x16x32_bf16 v[44:47], v[76:79], v[188:191], v[44:47]
 ds_read_b64_tr_b16 v[100:101], v23 offset:53248
 ds_read_b64_tr_b16 v[102:103], v23 offset:54272
 v_mfma_f32_16x16x32_bf16 v[40:43], v[76:79], v[184:187], v[40:43]
 v_sub_f32 v132, v132, v144
 s_waitcnt lgkmcnt(8)
 v_mfma_f32_16x16x32_bf16 v[48:51], v[80:83], v[184:187], v[48:51]
 s_waitcnt vmcnt(6)
 s_barrier
 ds_read_b64_tr_b16 v[72:73], v16 offset:0
 v_mfma_f32_16x16x32_bf16 v[52:55], v[80:83], v[188:191], v[52:55]
 ds_read_b64_tr_b16 v[74:75], v16 offset:1024
 v_mfma_f32_16x16x32_bf16 v[60:63], v[84:87], v[188:191], v[60:63]
 ds_read_b64_tr_b16 v[76:77], v17 offset:0
 ds_read_b64_tr_b16 v[78:79], v17 offset:1024
 v_mfma_f32_16x16x32_bf16 v[56:59], v[84:87], v[184:187], v[56:59]
 v_sub_f32 v133, v133, v144
 s_waitcnt vmcnt(4) lgkmcnt(8)
 v_mfma_f32_16x16x32_bf16 v[32:35], v[88:91], v[192:195], v[32:35]
 ds_read_b64_tr_b16 v[80:81], v18 offset:0
 ds_read_b64_tr_b16 v[82:83], v18 offset:1024
 v_mfma_f32_16x16x32_bf16 v[36:39], v[88:91], v[196:199], v[36:39]
 v_sub_f32 v134, v134, v144
 v_sub_f32 v135, v135, v144
 v_mfma_f32_16x16x32_bf16 v[44:47], v[92:95], v[196:199], v[44:47]
 ds_read_b64_tr_b16 v[84:85], v19 offset:0
 ds_read_b64_tr_b16 v[86:87], v19 offset:1024
 v_mfma_f32_16x16x32_bf16 v[40:43], v[92:95], v[192:195], v[40:43]
 v_sub_f32 v136, v136, v144
 s_waitcnt lgkmcnt(8)
 v_mfma_f32_16x16x32_bf16 v[48:51], v[96:99], v[192:195], v[48:51]
 ds_read_b64_tr_b16 v[88:89], v16 offset:4096
 ds_read_b64_tr_b16 v[90:91], v16 offset:5120
 s_branch m_ps_p2_1
m_pad_p2_1:
 s_branch m_reta_p2
m_ps_p2_1:
 v_mfma_f32_16x16x32_bf16 v[52:55], v[96:99], v[196:199], v[52:55]
 v_sub_f32 v137, v137, v144
 v_sub_f32 v138, v138, v144
 v_mfma_f32_16x16x32_bf16 v[60:63], v[100:103], v[196:199], v[60:63]
 ds_read_b64_tr_b16 v[92:93], v17 offset:4096
 ds_read_b64_tr_b16 v[94:95], v17 offset:5120
 v_mfma_f32_16x16x32_bf16 v[56:59], v[100:103], v[192:195], v[56:59]
 v_sub_f32 v139, v139, v144
 s_waitcnt vmcnt(2) lgkmcnt(8)
 v_mfma_f32_16x16x32_bf16 v[32:35], v[72:75], v[200:203], v[32:35]
 ds_read_b64_tr_b16 v[96:97], v18 offset:4096
 ds_read_b64_tr_b16 v[98:99], v18 offset:5120
 v_mfma_f32_16x16x32_bf16 v[36:39], v[72:75], v[204:207], v[36:39]
 v_sub_f32 v140, v140, v144
 v_sub_f32 v141, v141, v144
 v_mfma_f32_16x16x32_bf16 v[44:47], v[76:79], v[204:207], v[44:47]
 ds_read_b64_tr_b16 v[100:101], v19 offset:4096
 ds_read_b64_tr_b16 v[102:103], v19 offset:5120
 v_mfma_f32_16x16x32_bf16 v[40:43], v[76:79], v[200:203], v[40:43]
 v_sub_f32 v142, v142, v144
 s_waitcnt lgkmcnt(8)
 v_mfma_f32_16x16x32_bf16 v[48:51], v[80:83], v[200:203], v[48:51]
 v_sub_f32 v143, v143, v144
 v_mfma_f32_16x16x32_bf16 v[52:55], v[80:83], v[204:207], v[52:55]
 v_mfma_f32_16x16x32_bf16 v[60:63], v[84:87], v[204:207], v[60:63]
 v_mfma_f32_16x16x32_bf16 v[56:59], v[84:87], v[200:203], v[56:59]
 s_waitcnt vmcnt(0) lgkmcnt(4)
 v_mfma_f32_16x16x32_bf16 v[32:35], v[88:91], v[208:211], v[32:35]
 v_mfma_f32_16x16x32_bf16 v[36:39], v[88:91], v[212:215], v[36:39]
 v_mfma_f32_16x16x32_bf16 v[44:47], v[92:95], v[212:215], v[44:47]
 v_mfma_f32_16x16x32_bf16 v[40:43], v[92:95], v[208:211], v[40:43]
 s_waitcnt lgkmcnt(0)
 v_mfma_f32_16x16x32_bf16 v[48:51], v[96:99], v[208:211], v[48:51]
 v_mfma_f32_16x16x32_bf16 v[52:55], v[96:99], v[212:215], v[52:55]
 v_mfma_f32_16x16x32_bf16 v[60:63], v[100:103], v[212:215], v[60:63]
 v_mfma_f32_16x16x32_bf16 v[56:59], v[100:103], v[208:211], v[56:59]
 s_barrier
 s_nop 1
 v_permlane16_swap_b32 v32, v36
 v_permlane16_swap_b32 v33, v37
 v_permlane16_swap_b32 v34, v38
 v_permlane16_swap_b32 v35, v39
 v_add_f32 v32, v32, v112
 v_add_f32 v33, v33, v113
 v_add_f32 v34, v34, v114
 v_add_f32 v35, v35, v115
 v_add_f32 v36, v36, v116
 v_add_f32 v37, v37, v117
 v_add_f32 v38, v38, v118
 v_add_f32 v39, v39, v119
 v_cvt_pk_bf16_f32 v72, v32, v33
 v_cvt_pk_bf16_f32 v73, v34, v35
 v_cvt_pk_bf16_f32 v74, v36, v37
 v_cvt_pk_bf16_f32 v75, v38, v39
 buffer_store_dwordx4 v[72:75], v12, s[84:87], 0 offen offset:0 sc1
 v_permlane16_swap_b32 v40, v44
 v_permlane16_swap_b32 v41, v45
 v_permlane16_swap_b32 v42, v46
 v_permlane16_swap_b32 v43, v47
 v_add_f32 v40, v40, v120
 v_add_f32 v41, v41, v121
 v_add_f32 v42, v42, v122
 v_add_f32 v43, v43, v123
 v_add_f32 v44, v44, v124
 v_add_f32 v45, v45, v125
 v_add_f32 v46, v46, v126
 v_add_f32 v47, v47, v127
 v_cvt_pk_bf16_f32 v76, v40, v41
 v_cvt_pk_bf16_f32 v77, v42, v43
 v_cvt_pk_bf16_f32 v78, v44, v45
 v_cvt_pk_bf16_f32 v79, v46, v47
 buffer_store_dwordx4 v[76:79], v12, s[84:87], 0 offen offset:512 sc1
 v_permlane16_swap_b32 v48, v52
 v_permlane16_swap_b32 v49, v53
 v_permlane16_swap_b32 v50, v54
 v_permlane16_swap_b32 v51, v55
 v_add_f32 v48, v48, v128
 v_add_f32 v49, v49, v129
 v_add_f32 v50, v50, v130
 v_add_f32 v51, v51, v131
 v_add_f32 v52, v52, v132
 v_add_f32 v53, v53, v133
 v_add_f32 v54, v54, v134
 v_add_f32 v55, v55, v135
 v_cvt_pk_bf16_f32 v80, v48, v49
 v_cvt_pk_bf16_f32 v81, v50, v51
 v_cvt_pk_bf16_f32 v82, v52, v53
 v_cvt_pk_bf16_f32 v83, v54, v55
 buffer_store_dwordx4 v[80:83], v12, s[84:87], 0 offen offset:1024 sc1
 v_permlane16_swap_b32 v56, v60
 v_permlane16_swap_b32 v57, v61
 v_permlane16_swap_b32 v58, v62
 v_permlane16_swap_b32 v59, v63
 v_add_f32 v56, v56, v136
 v_add_f32 v57, v57, v137
 v_add_f32 v58, v58, v138
 v_add_f32 v59, v59, v139
 v_add_f32 v60, v60, v140
 v_add_f32 v61, v61, v141
 v_add_f32 v62, v62, v142
 v_add_f32 v63, v63, v143
 v_cvt_pk_bf16_f32 v84, v56, v57
 v_cvt_pk_bf16_f32 v85, v58, v59
 v_cvt_pk_bf16_f32 v86, v60, v61
 v_cvt_pk_bf16_f32 v87, v62, v63
 buffer_store_dwordx4 v[84:87], v12, s[84:87], 0 offen offset:1536 sc1
 v_mul_f32 v20, v32, v32
 v_mul_f32 v21, v33, v33
 v_fmac_f32 v20, v34, v34
 v_fmac_f32 v21, v35, v35
 v_fmac_f32 v20, v36, v36
 v_fmac_f32 v21, v37, v37
 v_fmac_f32 v20, v38, v38
 v_fmac_f32 v21, v39, v39
 v_fmac_f32 v20, v40, v40
 v_fmac_f32 v21, v41, v41
 v_fmac_f32 v20, v42, v42
 v_fmac_f32 v21, v43, v43
 v_fmac_f32 v20, v44, v44
 v_fmac_f32 v21, v45, v45
 v_fmac_f32 v20, v46, v46
 v_fmac_f32 v21, v47, v47
 v_fmac_f32 v20, v48, v48
 v_fmac_f32 v21, v49, v49
 v_fmac_f32 v20, v50, v50
 v_fmac_f32 v21, v51, v51
 v_fmac_f32 v20, v52, v52
 v_fmac_f32 v21, v53, v53
 v_fmac_f32 v20, v54, v54
 v_fmac_f32 v21, v55, v55
 v_fmac_f32 v20, v56, v56
 v_fmac_f32 v21, v57, v57
 v_fmac_f32 v20, v58, v58
 v_fmac_f32 v21, v59, v59
 v_fmac_f32 v20, v60, v60
 v_fmac_f32 v21, v61, v61
 v_fmac_f32 v20, v62, v62
 v_fmac_f32 v21, v63, v63
 v_add_f32 v20, v20, v21
 v_mov_b32 v21, v20
 s_lshl_b32 s39, s30, 6
 s_cmp_eq_u32 s30, 0
 v_permlane32_swap_b32 v20, v21
 s_cselect_b32 s46, s46, 0x40000000
 v_add_f32 v20, v20, v21
 s_mov_b32 exec_hi, 0
 buffer_store_dword v20, v5, s[88:91], s39 offen sc1
 buffer_store_dword v144, v13, s[88:91], s46 offen sc1
 s_mov_b32 exec_hi, -1
 s_lshl_b32 s58, s29, 4
 s_add_u32 s58, s58, s30
 s_lshl_b32 s58, s58, 7
 s_add_u32 s58, s58, 0x10000
 s_add_u32 s60, s82, 0x2080000
 s_addc_u32 s61, s83, 0
 s_mov_b32 s62, 262144
 s_mov_b32 s63, 0x20000
 v_cmp_eq_u32 vcc, 0, v0
 v_mov_b32 v25, 0x40000000
 s_nop 0
 v_cndmask_b32 v25, v25, 0, vcc
 s_cmp_eq_u32 s10, 1
 s_cbranch_scc1 m_pad_p3_0
 s_cmp_eq_u32 s10, 2
 s_cbranch_scc1 m_pad_p3_1
 s_cmp_eq_u32 s10, 3
 s_cbranch_scc1 m_pad_p3_2
 s_branch m_pad_p3_3
m_reta_p3:
 s_waitcnt vmcnt(0)
 s_barrier
 s_cmp_lg_u32 s10, 0
 s_cbranch_scc1 L_pub_p3
 v_mov_b32 v26, s8
 v_mov_b32 v27, s9
 buffer_store_dwordx2 v[26:27], v25, s[60:63], s58 offen sc1
L_pub_p3:
 s_and_b32 s29, s11, 1
 s_lshl_b32 s29, s29, 2
 s_and_b32 s30, s28, 3
 s_add_u32 s29, s29, s30
 s_lshr_b32 s30, s11, 1
 s_lshl_b32 s30, s30, 3
 s_lshr_b32 s31, s28, 2
 s_add_u32 s30, s30, s31
 s_and_b32 s31, s10, 1
 s_mul_i32 s32, s31, 114688
 s_movk_i32 s34, 7168
 s_mul_i32 s35, s30, 224
 s_lshl_b32 s38, s10, 12
 s_cmp_ge_u32 s10, 2
 s_cselect_b32 s96, s74, s72
 s_cselect_b32 s97, s75, s73
 s_add_u32 s12, s96, s35
 s_addc_u32 s13, s97, 0
 s_sub_u32 s14, 7340032, s35
 s_mov_b32 s15, 0x20000
 v_add_u32 v11, 0, v0
 v_mul_u32_u24 v10, 4682, v11
 v_lshrrev_b32 v10, 16, v10
 v_mul_u32_u24 v14, 14, v10
 v_sub_u32 v11, v11, v14
 v_and_b32 v14, 3, v10
 v_and_b32 v15, 4, v10
 v_lshl_add_u32 v14, v15, 1, v14
 v_bfe_u32 v15, v10, 3, 1
 v_lshl_add_u32 v14, v15, 2, v14
 v_mul_u32_u24 v10, s34, v14
 v_lshl_add_u32 v2, v11, 4, v10
 s_sub_u32 s33, s32, 0
 v_add_u32 v2, s33, v2
 v_add_u32 v11, 64, v0
 v_mul_u32_u24 v10, 4682, v11
 v_lshrrev_b32 v10, 16, v10
 v_mul_u32_u24 v14, 14, v10
 v_sub_u32 v11, v11, v14
 v_and_b32 v14, 3, v10
 v_and_b32 v15, 4, v10
 v_lshl_add_u32 v14, v15, 1, v14
 v_bfe_u32 v15, v10, 3, 1
 v_lshl_add_u32 v14, v15, 2, v14
 v_mul_u32_u24 v10, s34, v14
 v_lshl_add_u32 v3, v11, 4, v10
 s_sub_u32 s33, s32, 1024
 v_add_u32 v3, s33, v3
 v_add_u32 v11, 128, v0
 v_mul_u32_u24 v10, 4682, v11
 v_lshrrev_b32 v10, 16, v10
 v_mul_u32_u24 v14, 14, v10
 v_sub_u32 v11, v11, v14
 v_and_b32 v14, 3, v10
 v_and_b32 v15, 4, v10
 v_lshl_add_u32 v14, v15, 1, v14
 v_bfe_u32 v15, v10, 3, 1
 v_lshl_add_u32 v14, v15, 2, v14
 v_mul_u32_u24 v10, s34, v14
 v_lshl_add_u32 v4, v11, 4, v10
 s_sub_u32 s33, s32, 2048
 v_add_u32 v4, s33, v4
 v_add_u32 v11, 192, v0
 v_mul_u32_u24 v10, 4682, v11
 v_lshrrev_b32 v10, 16, v10
 v_mul_u32_u24 v14, 14, v10
 v_sub_u32 v11, v11, v14
 v_and_b32 v14, 3, v10
 v_and_b32 v15, 4, v10
 v_lshl_add_u32 v14, v15, 1, v14
 v_bfe_u32 v15, v10, 3, 1
 v_lshl_add_u32 v14, v15, 2, v14
 v_mul_u32_u24 v10, s34, v14
 v_lshl_add_u32 v5, v11, 4, v10
 s_sub_u32 s33, s32, 3072
 v_add_u32 v5, s33, v5
 v_cmp_lt_u32 vcc, 31, v0
 v_mov_b32 v11, 0x40000000
 s_nop 0
 v_cndmask_b32 v5, v5, v11, vcc
 s_mov_b32 s40, 0
 s_add_u32 m0, s38, 0
 s_nop 0
 buffer_load_dwordx4 v2, s[12:15], s40 offen offset:0 lds
 buffer_load_dwordx4 v3, s[12:15], s40 offen offset:1024 lds
 buffer_load_dwordx4 v4, s[12:15], s40 offen offset:2048 lds
 buffer_load_dwordx4 v5, s[12:15], s40 offen offset:3072 lds
 s_mov_b32 s40, 229376
 s_add_u32 m0, s38, 16384
 s_nop 0
 buffer_load_dwordx4 v2, s[12:15], s40 offen offset:0 lds
 buffer_load_dwordx4 v3, s[12:15], s40 offen offset:1024 lds
 buffer_load_dwordx4 v4, s[12:15], s40 offen offset:2048 lds
 buffer_load_dwordx4 v5, s[12:15], s40 offen offset:3072 lds
 s_mov_b32 s40, 458752
 s_add_u32 m0, s38, 32768
 s_nop 0
 buffer_load_dwordx4 v2, s[12:15], s40 offen offset:0 lds
 buffer_load_dwordx4 v3, s[12:15], s40 offen offset:1024 lds
 buffer_load_dwordx4 v4, s[12:15], s40 offen offset:2048 lds
 buffer_load_dwordx4 v5, s[12:15], s40 offen offset:3072 lds
 s_mov_b32 s40, 688128
 s_add_u32 m0, s38, 49152
 s_nop 0
 buffer_load_dwordx4 v2, s[12:15], s40 offen offset:0 lds
 buffer_load_dwordx4 v3, s[12:15], s40 offen offset:1024 lds
 buffer_load_dwordx4 v4, s[12:15], s40 offen offset:2048 lds
 buffer_load_dwordx4 v5, s[12:15], s40 offen offset:3072 lds
 v_add_u32 v8, 0x10000, v6
 v_add_u32 v9, 0x18000, v6
 s_lshl_b32 s36, s29, 4
 s_lshl_b32 s37, s10, 2
 s_add_u32 s36, s36, s37
 s_lshl_b32 s37, s36, 15
 s_add_u32 s37, s37, 0x800000
 s_add_u32 s16, s82, s37
 s_addc_u32 s17, s83, 0
 s_mov_b32 s18, 131072
 s_mov_b32 s19, 0x20000
 v_lshrrev_b32 v11, 5, v0
 v_lshlrev_b32 v10, 12, v11
 v_bfe_u32 v12, v0, 2, 3
 v_mul_u32_u24 v12, 224, v12
 v_add_u32 v10, v10, v12
 v_and_b32 v12, 3, v0
 v_lshl_add_u32 v10, v12, 3, v10
 v_add_u32 v11, 0x10000, v10
 s_mul_i32 s37, s36, 114688
 s_mul_i32 s39, s30, 3584
 s_add_u32 s37, s37, s39
 s_add_u32 s37, s37, 0x1000000
 s_add_u32 s24, s82, s37
 s_addc_u32 s25, s83, 0
 s_mov_b32 s26, 458752
 s_mov_b32 s27, 0x20000
 s_mov_b32 s47, 229376
 v_bfe_u32 v13, v0, 4, 1
 s_mov_b32 s46, 114688
 v_mul_lo_u32 v13, v13, s46
 v_lshrrev_b32 v12, 5, v0
 v_lshl_add_u32 v13, v12, 8, v13
 v_and_b32 v12, 15, v0
 v_lshl_add_u32 v12, v12, 4, v13
 s_lshl_b32 s37, s36, 10
 s_add_u32 s37, s37, 0x2000000
 s_add_u32 s20, s82, s37
 s_addc_u32 s21, s83, 0
 s_mov_b32 s22, 4096
 s_mov_b32 s23, 0x20000
 v_lshlrev_b32 v13, 2, v0
 s_lshl_b32 s57, s2, 2
 s_add_u32 s57, s57, s10
 s_mul_i32 s56, s57, 56
 v_min_u32 v14, 55, v0
 v_add_u32 v15, s56, v14
 v_lshlrev_b32 v15, 7, v15
 s_mov_b32 s92, s76
 s_mov_b32 s93, s77
 s_mov_b32 s94, 7340032
 s_mov_b32 s95, 0x20000
 s_mov_b32 s98, 7340032
 s_mov_b32 s99, 0x20000
 s_lshl_b32 s56, s31, 8
 s_add_u32 s56, s56, s2
 s_mul_i32 s56, s56, 48
 s_add_u32 s56, s56, 32768
 v_min_u32 v14, 47, v0
 v_add_u32 v14, s56, v14
 v_lshlrev_b32 v14, 7, v14
 s_getpc_b64 s[60:61]
pc_p3:
 s_lshr_b32 s62, s2, 3
 s_lshl_b32 s62, s62, 2
 s_add_u32 s62, s62, s10
 s_lshl_b32 s62, s62, 9
 s_add_u32 s62, s62, 16384
 s_min_u32 s62, s62, L_done-pc_p3-512
 v_and_b32 v26, 3, v0
 v_lshl_add_u32 v26, v26, 7, s62
 v_add_co_u32 v26, vcc, s60, v26
 v_mov_b32 v27, s61
 s_nop 0
 v_addc_co_u32 v27, vcc, 0, v27, vcc
 v_accvgpr_write_b32 a176, v26
 v_accvgpr_write_b32 a177, v27
 s_and_b32 s56, s28, 3
 s_cmp_eq_u32 s56, 0
 s_cselect_b32 s48, 0, 0x40000000
 s_cmp_eq_u32 s56, 1
 s_cselect_b32 s49, 0, 0x40000000
 s_cmp_eq_u32 s56, 2
 s_cselect_b32 s50, 0, 0x40000000
 s_cmp_eq_u32 s56, 3
 s_cselect_b32 s51, 0, 0x40000000
 s_lshl_b32 s59, s29, 12
 s_add_u32 s59, s59, 0x10000
 s_add_u32 s60, s82, 0x2080000
 s_addc_u32 s61, s83, 0
 s_mov_b32 s62, 262144
 s_mov_b32 s63, 0x20000
 s_cmp_lg_u32 s10, 0
 s_cbranch_scc1 L_warm_p3
 v_min_u32 v16, 31, v0
 v_lshlrev_b32 v16, 7, v16
 v_add_u32 v16, s59, v16
 v_max_i32 v16, 0, v16
 s_mov_b32 s57, 0
L_poll_p3:
 buffer_load_dwordx2 v[18:19], v16, s[60:63], 0 offen sc1
 s_waitcnt vmcnt(0)
 v_cmp_ne_u64 vcc, s[8:9], v[18:19]
 s_add_u32 s57, s57, 1
 s_cbranch_vccz L_go_p3
 s_sleep 1
 s_cmp_gt_u32 s57, 0x40000
 s_cbranch_scc0 L_poll_p3
 s_branch L_go_p3
L_warm_p3:
 s_cmp_eq_u32 s10, 1
 s_cbranch_scc1 m_pad_p3_4
 s_cmp_eq_u32 s10, 2
 s_cbranch_scc1 m_pad_p3_5
 s_branch m_pad_p3_6
m_ret_p3:
 s_waitcnt vmcnt(0)
L_go_p3:
 s_barrier
 s_mov_b32 s42, 0
 buffer_load_dwordx4 a[32:35], v6, s[16:19], s42 offen offset:0 sc1
 buffer_load_dwordx4 a[36:39], v7, s[16:19], s42 offen offset:0 sc1
 buffer_load_dwordx4 a[40:43], v8, s[16:19], s42 offen offset:0 sc1
 buffer_load_dwordx4 a[44:47], v9, s[16:19], s42 offen offset:0 sc1
 buffer_load_dwordx4 a[48:51], v6, s[16:19], s42 offen offset:1024 sc1
 buffer_load_dwordx4 a[52:55], v7, s[16:19], s42 offen offset:1024 sc1
 buffer_load_dwordx4 a[56:59], v8, s[16:19], s42 offen offset:1024 sc1
 buffer_load_dwordx4 a[60:63], v9, s[16:19], s42 offen offset:1024 sc1
 ds_read_b64_tr_b16 a[0:1], v10 offset:0
 ds_read_b64_tr_b16 a[2:3], v10 offset:1792
 ds_read_b64_tr_b16 a[4:5], v10 offset:16384
 ds_read_b64_tr_b16 a[6:7], v10 offset:18176
 ds_read_b64_tr_b16 a[8:9], v10 offset:8192
 ds_read_b64_tr_b16 a[10:11], v10 offset:9984
 ds_read_b64_tr_b16 a[12:13], v10 offset:24576
 ds_read_b64_tr_b16 a[14:15], v10 offset:26368
 ds_read_b64_tr_b16 a[16:17], v10 offset:32
 ds_read_b64_tr_b16 a[18:19], v10 offset:1824
 ds_read_b64_tr_b16 a[20:21], v10 offset:16416
 ds_read_b64_tr_b16 a[22:23], v10 offset:18208
 s_waitcnt vmcnt(4) lgkmcnt(8)
 v_mfma_f32_16x16x32_bf16 v[32:35], a[0:3], a[32:35], 0
 ds_read_b64_tr_b16 a[24:25], v10 offset:8224
 s_waitcnt vmcnt(0)
 v_mfma_f32_16x16x32_bf16 v[32:35], a[4:7], a[48:51], v[32:35]
 ds_read_b64_tr_b16 a[26:27], v10 offset:10016
 buffer_load_dwordx4 a[64:67], v6, s[16:19], s42 offen offset:2048 sc1
 v_mfma_f32_16x16x32_bf16 v[36:39], a[4:7], a[52:55], 0
 v_mfma_f32_16x16x32_bf16 v[36:39], a[0:3], a[36:39], v[36:39]
 v_mfma_f32_16x16x32_bf16 v[40:43], a[0:3], a[40:43], 0
 ds_read_b64_tr_b16 a[28:29], v10 offset:24608
 ds_read_b64_tr_b16 a[30:31], v10 offset:26400
 v_mfma_f32_16x16x32_bf16 v[40:43], a[4:7], a[56:59], v[40:43]
 buffer_load_dwordx4 a[68:71], v7, s[16:19], s42 offen offset:2048 sc1
 v_mfma_f32_16x16x32_bf16 v[44:47], a[4:7], a[60:63], 0
 v_mfma_f32_16x16x32_bf16 v[44:47], a[0:3], a[44:47], v[44:47]
 s_waitcnt lgkmcnt(8)
 v_mfma_f32_16x16x32_bf16 v[60:63], a[8:11], a[44:47], 0
 ds_read_b64_tr_b16 a[0:1], v10 offset:64
 ds_read_b64_tr_b16 a[2:3], v10 offset:1856
 v_mfma_f32_16x16x32_bf16 v[60:63], a[12:15], a[60:63], v[60:63]
 buffer_load_dwordx4 a[72:75], v8, s[16:19], s42 offen offset:2048 sc1
 v_mfma_f32_16x16x32_bf16 v[56:59], a[12:15], a[56:59], 0
 v_mfma_f32_16x16x32_bf16 v[56:59], a[8:11], a[40:43], v[56:59]
 v_mfma_f32_16x16x32_bf16 v[52:55], a[8:11], a[36:39], 0
 ds_read_b64_tr_b16 a[4:5], v10 offset:16448
 ds_read_b64_tr_b16 a[6:7], v10 offset:18240
 v_mfma_f32_16x16x32_bf16 v[52:55], a[12:15], a[52:55], v[52:55]
 buffer_load_dwordx4 a[76:79], v9, s[16:19], s42 offen offset:2048 sc1
 v_mfma_f32_16x16x32_bf16 v[48:51], a[12:15], a[48:51], 0
 v_mfma_f32_16x16x32_bf16 v[48:51], a[8:11], a[32:35], v[48:51]
 s_waitcnt lgkmcnt(8)
 v_mfma_f32_16x16x32_bf16 v[64:67], a[16:19], a[32:35], 0
 ds_read_b64_tr_b16 a[8:9], v10 offset:8256
 ds_read_b64_tr_b16 a[10:11], v10 offset:10048
 v_mfma_f32_16x16x32_bf16 v[64:67], a[20:23], a[48:51], v[64:67]
 buffer_load_dwordx4 a[80:83], v6, s[16:19], s42 offen offset:3072 sc1
 v_mfma_f32_16x16x32_bf16 v[68:71], a[20:23], a[52:55], 0
 v_mfma_f32_16x16x32_bf16 v[68:71], a[16:19], a[36:39], v[68:71]
 v_mfma_f32_16x16x32_bf16 v[72:75], a[16:19], a[40:43], 0
 ds_read_b64_tr_b16 a[12:13], v10 offset:24640
 ds_read_b64_tr_b16 a[14:15], v10 offset:26432
 v_mfma_f32_16x16x32_bf16 v[72:75], a[20:23], a[56:59], v[72:75]
 buffer_load_dwordx4 a[84:87], v7, s[16:19], s42 offen offset:3072 sc1
 v_mfma_f32_16x16x32_bf16 v[76:79], a[20:23], a[60:63], 0
 v_mfma_f32_16x16x32_bf16 v[76:79], a[16:19], a[44:47], v[76:79]
 s_waitcnt lgkmcnt(8)
 v_mfma_f32_16x16x32_bf16 v[92:95], a[24:27], a[44:47], 0
 ds_read_b64_tr_b16 a[16:17], v10 offset:96
 ds_read_b64_tr_b16 a[18:19], v10 offset:1888
 v_mfma_f32_16x16x32_bf16 v[92:95], a[28:31], a[60:63], v[92:95]
 buffer_load_dwordx4 a[88:91], v8, s[16:19], s42 offen offset:3072 sc1
 v_mfma_f32_16x16x32_bf16 v[88:91], a[28:31], a[56:59], 0
 v_mfma_f32_16x16x32_bf16 v[88:91], a[24:27], a[40:43], v[88:91]
 v_mfma_f32_16x16x32_bf16 v[84:87], a[24:27], a[36:39], 0
 ds_read_b64_tr_b16 a[20:21], v10 offset:16480
 ds_read_b64_tr_b16 a[22:23], v10 offset:18272
 v_mfma_f32_16x16x32_bf16 v[84:87], a[28:31], a[52:55], v[84:87]
 buffer_load_dwordx4 a[92:95], v9, s[16:19], s42 offen offset:3072 sc1
 v_mfma_f32_16x16x32_bf16 v[80:83], a[28:31], a[48:51], 0
 s_mov_b32 s40, 917504
 s_add_u32 m0, s38, 65536
 v_mfma_f32_16x16x32_bf16 v[80:83], a[24:27], a[32:35], v[80:83]
 s_waitcnt lgkmcnt(8)
 v_mfma_f32_16x16x32_bf16 v[96:99], a[0:3], a[32:35], 0
 ds_read_b64_tr_b16 a[24:25], v10 offset:8288
 ds_read_b64_tr_b16 a[26:27], v10 offset:10080
 v_mfma_f32_16x16x32_bf16 v[96:99], a[4:7], a[48:51], v[96:99]
 buffer_load_dwordx4 v2, s[12:15], s40 offen offset:0 lds
 v_mfma_f32_16x16x32_bf16 v[100:103], a[4:7], a[52:55], 0
 v_mfma_f32_16x16x32_bf16 v[100:103], a[0:3], a[36:39], v[100:103]
 v_mfma_f32_16x16x32_bf16 v[104:107], a[0:3], a[40:43], 0
 ds_read_b64_tr_b16 a[28:29], v10 offset:24672
 ds_read_b64_tr_b16 a[30:31], v10 offset:26464
 v_mfma_f32_16x16x32_bf16 v[104:107], a[4:7], a[56:59], v[104:107]
 buffer_load_dwordx4 v3, s[12:15], s40 offen offset:1024 lds
 v_mfma_f32_16x16x32_bf16 v[108:111], a[4:7], a[60:63], 0
 v_mfma_f32_16x16x32_bf16 v[108:111], a[0:3], a[44:47], v[108:111]
 s_waitcnt lgkmcnt(8)
 v_mfma_f32_16x16x32_bf16 v[124:127], a[8:11], a[44:47], 0
 ds_read_b64_tr_b16 a[0:1], v10 offset:128
 ds_read_b64_tr_b16 a[2:3], v10 offset:1920
 v_mfma_f32_16x16x32_bf16 v[124:127], a[12:15], a[60:63], v[124:127]
 buffer_load_dwordx4 v4, s[12:15], s40 offen offset:2048 lds
 v_mfma_f32_16x16x32_bf16 v[120:123], a[12:15], a[56:59], 0
 v_mfma_f32_16x16x32_bf16 v[120:123], a[8:11], a[40:43], v[120:123]
 v_mfma_f32_16x16x32_bf16 v[116:119], a[8:11], a[36:39], 0
 ds_read_b64_tr_b16 a[4:5], v10 offset:16512
 ds_read_b64_tr_b16 a[6:7], v10 offset:18304
 v_mfma_f32_16x16x32_bf16 v[116:119], a[12:15], a[52:55], v[116:119]
 buffer_load_dwordx4 v5, s[12:15], s40 offen offset:3072 lds
 v_mfma_f32_16x16x32_bf16 v[112:115], a[12:15], a[48:51], 0
 v_mfma_f32_16x16x32_bf16 v[112:115], a[8:11], a[32:35], v[112:115]
 s_waitcnt lgkmcnt(8)
 v_mfma_f32_16x16x32_bf16 v[128:131], a[16:19], a[32:35], 0
 ds_read_b64_tr_b16 a[8:9], v10 offset:8320
 ds_read_b64_tr_b16 a[10:11], v10 offset:10112
 v_mfma_f32_16x16x32_bf16 v[128:131], a[20:23], a[48:51], v[128:131]
 s_mov_b32 s40, 1146880
 s_add_u32 m0, s38, 81920
 v_mfma_f32_16x16x32_bf16 v[132:135], a[20:23], a[52:55], 0
 v_mfma_f32_16x16x32_bf16 v[132:135], a[16:19], a[36:39], v[132:135]
 buffer_load_dwordx4 v2, s[12:15], s40 offen offset:0 lds
 v_mfma_f32_16x16x32_bf16 v[136:139], a[16:19], a[40:43], 0
 ds_read_b64_tr_b16 a[12:13], v10 offset:24704
 ds_read_b64_tr_b16 a[14:15], v10 offset:26496
 v_mfma_f32_16x16x32_bf16 v[136:139], a[20:23], a[56:59], v[136:139]
 v_mfma_f32_16x16x32_bf16 v[140:143], a[20:23], a[60:63], 0
 v_mfma_f32_16x16x32_bf16 v[140:143], a[16:19], a[44:47], v[140:143]
 s_waitcnt lgkmcnt(8)
 v_mfma_f32_16x16x32_bf16 v[156:159], a[24:27], a[44:47], 0
 ds_read_b64_tr_b16 a[16:17], v10 offset:160
 ds_read_b64_tr_b16 a[18:19], v10 offset:1952
 v_mfma_f32_16x16x32_bf16 v[156:159], a[28:31], a[60:63], v[156:159]
 buffer_load_dwordx4 v3, s[12:15], s40 offen offset:1024 lds
 v_mfma_f32_16x16x32_bf16 v[152:155], a[28:31], a[56:59], 0
 v_mfma_f32_16x16x32_bf16 v[152:155], a[24:27], a[40:43], v[152:155]
 v_mfma_f32_16x16x32_bf16 v[148:151], a[24:27], a[36:39], 0
 ds_read_b64_tr_b16 a[20:21], v10 offset:16544
 ds_read_b64_tr_b16 a[22:23], v10 offset:18336
 v_mfma_f32_16x16x32_bf16 v[148:151], a[28:31], a[52:55], v[148:151]
 v_mfma_f32_16x16x32_bf16 v[144:147], a[28:31], a[48:51], 0
 v_mfma_f32_16x16x32_bf16 v[144:147], a[24:27], a[32:35], v[144:147]
 buffer_load_dwordx4 v4, s[12:15], s40 offen offset:2048 lds
 s_waitcnt lgkmcnt(8)
 v_mfma_f32_16x16x32_bf16 v[160:163], a[0:3], a[32:35], 0
 ds_read_b64_tr_b16 a[24:25], v10 offset:8352
 ds_read_b64_tr_b16 a[26:27], v10 offset:10144
 v_mfma_f32_16x16x32_bf16 v[160:163], a[4:7], a[48:51], v[160:163]
 v_mfma_f32_16x16x32_bf16 v[164:167], a[4:7], a[52:55], 0
 v_mfma_f32_16x16x32_bf16 v[164:167], a[0:3], a[36:39], v[164:167]
 v_mfma_f32_16x16x32_bf16 v[168:171], a[0:3], a[40:43], 0
 ds_read_b64_tr_b16 a[28:29], v10 offset:24736
 ds_read_b64_tr_b16 a[30:31], v10 offset:26528
 v_mfma_f32_16x16x32_bf16 v[168:171], a[4:7], a[56:59], v[168:171]
 buffer_load_dwordx4 v5, s[12:15], s40 offen offset:3072 lds
 v_mfma_f32_16x16x32_bf16 v[172:175], a[4:7], a[60:63], 0
 v_mfma_f32_16x16x32_bf16 v[172:175], a[0:3], a[44:47], v[172:175]
 s_waitcnt lgkmcnt(8)
 v_mfma_f32_16x16x32_bf16 v[188:191], a[8:11], a[44:47], 0
 ds_read_b64_tr_b16 a[0:1], v10 offset:192
 ds_read_b64_tr_b16 a[2:3], v10 offset:1984
 v_mfma_f32_16x16x32_bf16 v[188:191], a[12:15], a[60:63], v[188:191]
 s_mov_b32 s42, 4096
 v_mfma_f32_16x16x32_bf16 v[184:187], a[12:15], a[56:59], 0
 v_mfma_f32_16x16x32_bf16 v[184:187], a[8:11], a[40:43], v[184:187]
 buffer_load_dwordx4 a[96:99], v6, s[16:19], s42 offen offset:0 sc1
 v_mfma_f32_16x16x32_bf16 v[180:183], a[8:11], a[36:39], 0
 ds_read_b64_tr_b16 a[4:5], v10 offset:16576
 ds_read_b64_tr_b16 a[6:7], v10 offset:18368
 v_mfma_f32_16x16x32_bf16 v[180:183], a[12:15], a[52:55], v[180:183]
 v_mfma_f32_16x16x32_bf16 v[176:179], a[12:15], a[48:51], 0
 v_mfma_f32_16x16x32_bf16 v[176:179], a[8:11], a[32:35], v[176:179]
 s_waitcnt lgkmcnt(8)
 v_mfma_f32_16x16x32_bf16 v[192:195], a[16:19], a[32:35], 0
 ds_read_b64_tr_b16 a[8:9], v10 offset:8384
 ds_read_b64_tr_b16 a[10:11], v10 offset:10176
 v_mfma_f32_16x16x32_bf16 v[192:195], a[20:23], a[48:51], v[192:195]
 buffer_load_dwordx4 a[100:103], v7, s[16:19], s42 offen offset:0 sc1
 v_mfma_f32_16x16x32_bf16 v[196:199], a[20:23], a[52:55], 0
 v_mfma_f32_16x16x32_bf16 v[196:199], a[16:19], a[36:39], v[196:199]
 v_mfma_f32_16x16x32_bf16 v[200:203], a[16:19], a[40:43], 0
 ds_read_b64_tr_b16 a[12:13], v10 offset:24768
 ds_read_b64_tr_b16 a[14:15], v10 offset:26560
 v_mfma_f32_16x16x32_bf16 v[200:203], a[20:23], a[56:59], v[200:203]
 v_mfma_f32_16x16x32_bf16 v[204:207], a[20:23], a[60:63], 0
 v_mfma_f32_16x16x32_bf16 v[204:207], a[16:19], a[44:47], v[204:207]
 buffer_load_dwordx4 a[104:107], v8, s[16:19], s42 offen offset:0 sc1
 s_waitcnt lgkmcnt(8)
 v_mfma_f32_16x16x32_bf16 v[220:223], a[24:27], a[44:47], 0
 ds_read_b64_tr_b16 a[16:17], v10 offset:32768
 ds_read_b64_tr_b16 a[18:19], v10 offset:34560
 v_mfma_f32_16x16x32_bf16 v[220:223], a[28:31], a[60:63], v[220:223]
 v_mfma_f32_16x16x32_bf16 v[216:219], a[28:31], a[56:59], 0
 v_mfma_f32_16x16x32_bf16 v[216:219], a[24:27], a[40:43], v[216:219]
 v_mfma_f32_16x16x32_bf16 v[212:215], a[24:27], a[36:39], 0
 ds_read_b64_tr_b16 a[20:21], v10 offset:49152
 ds_read_b64_tr_b16 a[22:23], v10 offset:50944
 v_mfma_f32_16x16x32_bf16 v[212:215], a[28:31], a[52:55], v[212:215]
 buffer_load_dwordx4 a[108:111], v9, s[16:19], s42 offen offset:0 sc1
 v_mfma_f32_16x16x32_bf16 v[208:211], a[28:31], a[48:51], 0
 v_mfma_f32_16x16x32_bf16 v[208:211], a[24:27], a[32:35], v[208:211]
 s_waitcnt lgkmcnt(8)
 v_mfma_f32_16x16x32_bf16 v[224:227], a[0:3], a[32:35], 0
 ds_read_b64_tr_b16 a[24:25], v10 offset:40960
 ds_read_b64_tr_b16 a[26:27], v10 offset:42752
 v_mfma_f32_16x16x32_bf16 v[224:227], a[4:7], a[48:51], v[224:227]
 v_mfma_f32_16x16x32_bf16 v[228:231], a[4:7], a[52:55], 0
 v_mfma_f32_16x16x32_bf16 v[228:231], a[0:3], a[36:39], v[228:231]
 buffer_load_dwordx4 a[112:115], v6, s[16:19], s42 offen offset:1024 sc1
 v_mfma_f32_16x16x32_bf16 v[232:235], a[0:3], a[40:43], 0
 ds_read_b64_tr_b16 a[28:29], v10 offset:57344
 ds_read_b64_tr_b16 a[30:31], v10 offset:59136
 v_mfma_f32_16x16x32_bf16 v[232:235], a[4:7], a[56:59], v[232:235]
 v_mfma_f32_16x16x32_bf16 v[236:239], a[4:7], a[60:63], 0
 v_mfma_f32_16x16x32_bf16 v[236:239], a[0:3], a[44:47], v[236:239]
 s_waitcnt lgkmcnt(8)
 v_mfma_f32_16x16x32_bf16 v[252:255], a[8:11], a[44:47], 0
 ds_read_b64_tr_b16 a[0:1], v10 offset:32800
 ds_read_b64_tr_b16 a[2:3], v10 offset:34592
 v_mfma_f32_16x16x32_bf16 v[252:255], a[12:15], a[60:63], v[252:255]
 buffer_load_dwordx4 a[116:119], v7, s[16:19], s42 offen offset:1024 sc1
 v_mfma_f32_16x16x32_bf16 v[248:251], a[12:15], a[56:59], 0
 v_mfma_f32_16x16x32_bf16 v[248:251], a[8:11], a[40:43], v[248:251]
 v_mfma_f32_16x16x32_bf16 v[244:247], a[8:11], a[36:39], 0
 ds_read_b64_tr_b16 a[4:5], v10 offset:49184
 ds_read_b64_tr_b16 a[6:7], v10 offset:50976
 v_mfma_f32_16x16x32_bf16 v[244:247], a[12:15], a[52:55], v[244:247]
 s_barrier
 v_mfma_f32_16x16x32_bf16 v[240:243], a[12:15], a[48:51], 0
 v_mfma_f32_16x16x32_bf16 v[240:243], a[8:11], a[32:35], v[240:243]
 buffer_load_dwordx4 a[120:123], v8, s[16:19], s42 offen offset:1024 sc1
 s_waitcnt vmcnt(19) lgkmcnt(8)
 v_mfma_f32_16x16x32_bf16 v[32:35], a[16:19], a[64:67], v[32:35]
 ds_read_b64_tr_b16 a[8:9], v10 offset:40992
 s_waitcnt vmcnt(15)
 v_mfma_f32_16x16x32_bf16 v[32:35], a[20:23], a[80:83], v[32:35]
 ds_read_b64_tr_b16 a[10:11], v10 offset:42784
 v_mfma_f32_16x16x32_bf16 v[36:39], a[20:23], a[84:87], v[36:39]
 v_mfma_f32_16x16x32_bf16 v[36:39], a[16:19], a[68:71], v[36:39]
 v_mfma_f32_16x16x32_bf16 v[40:43], a[16:19], a[72:75], v[40:43]
 ds_read_b64_tr_b16 a[12:13], v10 offset:57376
 ds_read_b64_tr_b16 a[14:15], v10 offset:59168
 v_mfma_f32_16x16x32_bf16 v[40:43], a[20:23], a[88:91], v[40:43]
 buffer_load_dwordx4 a[124:127], v9, s[16:19], s42 offen offset:1024 sc1
 v_mfma_f32_16x16x32_bf16 v[44:47], a[20:23], a[92:95], v[44:47]
 v_mfma_f32_16x16x32_bf16 v[44:47], a[16:19], a[76:79], v[44:47]
 s_waitcnt lgkmcnt(8)
 v_mfma_f32_16x16x32_bf16 v[60:63], a[24:27], a[76:79], v[60:63]
 ds_read_b64_tr_b16 a[16:17], v10 offset:32832
 ds_read_b64_tr_b16 a[18:19], v10 offset:34624
 s_branch m_ps_p3_0
m_pad_p3_0:
 s_branch m_reta_p3
m_ps_p3_0:
 v_mfma_f32_16x16x32_bf16 v[60:63], a[28:31], a[92:95], v[60:63]
 s_mov_b32 s40, 1376256
 s_add_u32 m0, s38, 98304
 v_mfma_f32_16x16x32_bf16 v[56:59], a[28:31], a[88:91], v[56:59]
 v_mfma_f32_16x16x32_bf16 v[56:59], a[24:27], a[72:75], v[56:59]
 buffer_load_dwordx4 v2, s[12:15], s40 offen offset:0 lds
 v_mfma_f32_16x16x32_bf16 v[52:55], a[24:27], a[68:71], v[52:55]
 ds_read_b64_tr_b16 a[20:21], v10 offset:49216
 ds_read_b64_tr_b16 a[22:23], v10 offset:51008
 v_mfma_f32_16x16x32_bf16 v[52:55], a[28:31], a[84:87], v[52:55]
 v_mfma_f32_16x16x32_bf16 v[48:51], a[28:31], a[80:83], v[48:51]
 v_mfma_f32_16x16x32_bf16 v[48:51], a[24:27], a[64:67], v[48:51]
 s_waitcnt lgkmcnt(8)
 v_mfma_f32_16x16x32_bf16 v[64:67], a[0:3], a[64:67], v[64:67]
 ds_read_b64_tr_b16 a[24:25], v10 offset:41024
 ds_read_b64_tr_b16 a[26:27], v10 offset:42816
 v_mfma_f32_16x16x32_bf16 v[64:67], a[4:7], a[80:83], v[64:67]
 buffer_load_dwordx4 v3, s[12:15], s40 offen offset:1024 lds
 v_mfma_f32_16x16x32_bf16 v[68:71], a[4:7], a[84:87], v[68:71]
 v_mfma_f32_16x16x32_bf16 v[68:71], a[0:3], a[68:71], v[68:71]
 v_mfma_f32_16x16x32_bf16 v[72:75], a[0:3], a[72:75], v[72:75]
 ds_read_b64_tr_b16 a[28:29], v10 offset:57408
 ds_read_b64_tr_b16 a[30:31], v10 offset:59200
 v_mfma_f32_16x16x32_bf16 v[72:75], a[4:7], a[88:91], v[72:75]
 v_mfma_f32_16x16x32_bf16 v[76:79], a[4:7], a[92:95], v[76:79]
 v_mfma_f32_16x16x32_bf16 v[76:79], a[0:3], a[76:79], v[76:79]
 buffer_load_dwordx4 v4, s[12:15], s40 offen offset:2048 lds
 s_waitcnt lgkmcnt(8)
 v_mfma_f32_16x16x32_bf16 v[92:95], a[8:11], a[76:79], v[92:95]
 ds_read_b64_tr_b16 a[0:1], v10 offset:32864
 ds_read_b64_tr_b16 a[2:3], v10 offset:34656
 v_mfma_f32_16x16x32_bf16 v[92:95], a[12:15], a[92:95], v[92:95]
 v_mfma_f32_16x16x32_bf16 v[88:91], a[12:15], a[88:91], v[88:91]
 v_mfma_f32_16x16x32_bf16 v[88:91], a[8:11], a[72:75], v[88:91]
 v_mfma_f32_16x16x32_bf16 v[84:87], a[8:11], a[68:71], v[84:87]
 ds_read_b64_tr_b16 a[4:5], v10 offset:49248
 ds_read_b64_tr_b16 a[6:7], v10 offset:51040
 v_mfma_f32_16x16x32_bf16 v[84:87], a[12:15], a[84:87], v[84:87]
 buffer_load_dwordx4 v5, s[12:15], s40 offen offset:3072 lds
 v_mfma_f32_16x16x32_bf16 v[80:83], a[12:15], a[80:83], v[80:83]
 v_mfma_f32_16x16x32_bf16 v[80:83], a[8:11], a[64:67], v[80:83]
 s_waitcnt lgkmcnt(8)
 v_mfma_f32_16x16x32_bf16 v[96:99], a[16:19], a[64:67], v[96:99]
 ds_read_b64_tr_b16 a[8:9], v10 offset:41056
 ds_read_b64_tr_b16 a[10:11], v10 offset:42848
 v_mfma_f32_16x16x32_bf16 v[96:99], a[20:23], a[80:83], v[96:99]
 s_mov_b32 s40, 1605632
 s_add_u32 m0, s38, 114688
 v_mfma_f32_16x16x32_bf16 v[100:103], a[20:23], a[84:87], v[100:103]
 v_mfma_f32_16x16x32_bf16 v[100:103], a[16:19], a[68:71], v[100:103]
 buffer_load_dwordx4 v2, s[12:15], s40 offen offset:0 lds
 v_mfma_f32_16x16x32_bf16 v[104:107], a[16:19], a[72:75], v[104:107]
 ds_read_b64_tr_b16 a[12:13], v10 offset:57440
 ds_read_b64_tr_b16 a[14:15], v10 offset:59232
 v_mfma_f32_16x16x32_bf16 v[104:107], a[20:23], a[88:91], v[104:107]
 v_mfma_f32_16x16x32_bf16 v[108:111], a[20:23], a[92:95], v[108:111]
 v_mfma_f32_16x16x32_bf16 v[108:111], a[16:19], a[76:79], v[108:111]
 s_waitcnt lgkmcnt(8)
 v_mfma_f32_16x16x32_bf16 v[124:127], a[24:27], a[76:79], v[124:127]
 ds_read_b64_tr_b16 a[16:17], v10 offset:32896
 ds_read_b64_tr_b16 a[18:19], v10 offset:34688
 v_mfma_f32_16x16x32_bf16 v[124:127], a[28:31], a[92:95], v[124:127]
 buffer_load_dwordx4 v3, s[12:15], s40 offen offset:1024 lds
 v_mfma_f32_16x16x32_bf16 v[120:123], a[28:31], a[88:91], v[120:123]
 v_mfma_f32_16x16x32_bf16 v[120:123], a[24:27], a[72:75], v[120:123]
 v_mfma_f32_16x16x32_bf16 v[116:119], a[24:27], a[68:71], v[116:119]
 ds_read_b64_tr_b16 a[20:21], v10 offset:49280
 ds_read_b64_tr_b16 a[22:23], v10 offset:51072
 v_mfma_f32_16x16x32_bf16 v[116:119], a[28:31], a[84:87], v[116:119]
 v_mfma_f32_16x16x32_bf16 v[112:115], a[28:31], a[80:83], v[112:115]
 v_mfma_f32_16x16x32_bf16 v[112:115], a[24:27], a[64:67], v[112:115]
 buffer_load_dwordx4 v4, s[12:15], s40 offen offset:2048 lds
 s_waitcnt lgkmcnt(8)
 v_mfma_f32_16x16x32_bf16 v[128:131], a[0:3], a[64:67], v[128:131]
 ds_read_b64_tr_b16 a[24:25], v10 offset:41088
 ds_read_b64_tr_b16 a[26:27], v10 offset:42880
 v_mfma_f32_16x16x32_bf16 v[128:131], a[4:7], a[80:83], v[128:131]
 v_mfma_f32_16x16x32_bf16 v[132:135], a[4:7], a[84:87], v[132:135]
 v_mfma_f32_16x16x32_bf16 v[132:135], a[0:3], a[68:71], v[132:135]
 v_mfma_f32_16x16x32_bf16 v[136:139], a[0:3], a[72:75], v[136:139]
 ds_read_b64_tr_b16 a[28:29], v10 offset:57472
 ds_read_b64_tr_b16 a[30:31], v10 offset:59264
 v_mfma_f32_16x16x32_bf16 v[136:139], a[4:7], a[88:91], v[136:139]
 buffer_load_dwordx4 v5, s[12:15], s40 offen offset:3072 lds
 v_mfma_f32_16x16x32_bf16 v[140:143], a[4:7], a[92:95], v[140:143]
 v_mfma_f32_16x16x32_bf16 v[140:143], a[0:3], a[76:79], v[140:143]
 s_waitcnt lgkmcnt(8)
 v_mfma_f32_16x16x32_bf16 v[156:159], a[8:11], a[76:79], v[156:159]
 ds_read_b64_tr_b16 a[0:1], v10 offset:32928
 ds_read_b64_tr_b16 a[2:3], v10 offset:34720
 v_mfma_f32_16x16x32_bf16 v[156:159], a[12:15], a[92:95], v[156:159]
 v_mfma_f32_16x16x32_bf16 v[152:155], a[12:15], a[88:91], v[152:155]
 v_mfma_f32_16x16x32_bf16 v[152:155], a[8:11], a[72:75], v[152:155]
 buffer_load_dwordx4 a[128:131], v6, s[16:19], s42 offen offset:2048 sc1
 v_mfma_f32_16x16x32_bf16 v[148:151], a[8:11], a[68:71], v[148:151]
 ds_read_b64_tr_b16 a[4:5], v10 offset:49312
 ds_read_b64_tr_b16 a[6:7], v10 offset:51104
 v_mfma_f32_16x16x32_bf16 v[148:151], a[12:15], a[84:87], v[148:151]
 v_mfma_f32_16x16x32_bf16 v[144:147], a[12:15], a[80:83], v[144:147]
 v_mfma_f32_16x16x32_bf16 v[144:147], a[8:11], a[64:67], v[144:147]
 s_waitcnt lgkmcnt(8)
 v_mfma_f32_16x16x32_bf16 v[160:163], a[16:19], a[64:67], v[160:163]
 ds_read_b64_tr_b16 a[8:9], v10 offset:41120
 ds_read_b64_tr_b16 a[10:11], v10 offset:42912
 v_mfma_f32_16x16x32_bf16 v[160:163], a[20:23], a[80:83], v[160:163]
 buffer_load_dwordx4 a[132:135], v7, s[16:19], s42 offen offset:2048 sc1
 v_mfma_f32_16x16x32_bf16 v[164:167], a[20:23], a[84:87], v[164:167]
 v_mfma_f32_16x16x32_bf16 v[164:167], a[16:19], a[68:71], v[164:167]
 buffer_load_dword a160, v13, s[20:23], 0 offen offset:0 sc1
 v_mfma_f32_16x16x32_bf16 v[168:171], a[16:19], a[72:75], v[168:171]
 ds_read_b64_tr_b16 a[12:13], v10 offset:57504
 ds_read_b64_tr_b16 a[14:15], v10 offset:59296
 v_mfma_f32_16x16x32_bf16 v[168:171], a[20:23], a[88:91], v[168:171]
 v_mfma_f32_16x16x32_bf16 v[172:175], a[20:23], a[92:95], v[172:175]
 v_mfma_f32_16x16x32_bf16 v[172:175], a[16:19], a[76:79], v[172:175]
 buffer_load_dwordx4 a[136:139], v8, s[16:19], s42 offen offset:2048 sc1
 s_waitcnt lgkmcnt(8)
 v_mfma_f32_16x16x32_bf16 v[188:191], a[24:27], a[76:79], v[188:191]
 ds_read_b64_tr_b16 a[16:17], v10 offset:32960
 ds_read_b64_tr_b16 a[18:19], v10 offset:34752
 v_mfma_f32_16x16x32_bf16 v[188:191], a[28:31], a[92:95], v[188:191]
 v_mfma_f32_16x16x32_bf16 v[184:187], a[28:31], a[88:91], v[184:187]
 v_mfma_f32_16x16x32_bf16 v[184:187], a[24:27], a[72:75], v[184:187]
 v_mfma_f32_16x16x32_bf16 v[180:183], a[24:27], a[68:71], v[180:183]
 ds_read_b64_tr_b16 a[20:21], v10 offset:49344
 ds_read_b64_tr_b16 a[22:23], v10 offset:51136
 v_mfma_f32_16x16x32_bf16 v[180:183], a[28:31], a[84:87], v[180:183]
 buffer_load_dwordx4 a[140:143], v9, s[16:19], s42 offen offset:2048 sc1
 v_mfma_f32_16x16x32_bf16 v[176:179], a[28:31], a[80:83], v[176:179]
 v_mfma_f32_16x16x32_bf16 v[176:179], a[24:27], a[64:67], v[176:179]
 s_waitcnt lgkmcnt(8)
 v_mfma_f32_16x16x32_bf16 v[192:195], a[0:3], a[64:67], v[192:195]
 ds_read_b64_tr_b16 a[24:25], v10 offset:41152
 ds_read_b64_tr_b16 a[26:27], v10 offset:42944
 v_mfma_f32_16x16x32_bf16 v[192:195], a[4:7], a[80:83], v[192:195]
 v_mfma_f32_16x16x32_bf16 v[196:199], a[4:7], a[84:87], v[196:199]
 v_mfma_f32_16x16x32_bf16 v[196:199], a[0:3], a[68:71], v[196:199]
 buffer_load_dwordx4 a[144:147], v6, s[16:19], s42 offen offset:3072 sc1
 v_mfma_f32_16x16x32_bf16 v[200:203], a[0:3], a[72:75], v[200:203]
 ds_read_b64_tr_b16 a[28:29], v10 offset:57536
 ds_read_b64_tr_b16 a[30:31], v10 offset:59328
 v_mfma_f32_16x16x32_bf16 v[200:203], a[4:7], a[88:91], v[200:203]
 v_mfma_f32_16x16x32_bf16 v[204:207], a[4:7], a[92:95], v[204:207]
 v_mfma_f32_16x16x32_bf16 v[204:207], a[0:3], a[76:79], v[204:207]
 s_waitcnt lgkmcnt(8)
 v_mfma_f32_16x16x32_bf16 v[220:223], a[8:11], a[76:79], v[220:223]
 s_waitcnt vmcnt(22)
 s_barrier
 ds_read_b64_tr_b16 a[0:1], v11 offset:0
 v_mfma_f32_16x16x32_bf16 v[220:223], a[12:15], a[92:95], v[220:223]
 ds_read_b64_tr_b16 a[2:3], v11 offset:1792
 buffer_load_dwordx4 a[148:151], v7, s[16:19], s42 offen offset:3072 sc1
 v_mfma_f32_16x16x32_bf16 v[216:219], a[12:15], a[88:91], v[216:219]
 v_mfma_f32_16x16x32_bf16 v[216:219], a[8:11], a[72:75], v[216:219]
 v_mfma_f32_16x16x32_bf16 v[212:215], a[8:11], a[68:71], v[212:215]
 ds_read_b64_tr_b16 a[4:5], v11 offset:16384
 ds_read_b64_tr_b16 a[6:7], v11 offset:18176
 v_mfma_f32_16x16x32_bf16 v[212:215], a[12:15], a[84:87], v[212:215]
 v_mfma_f32_16x16x32_bf16 v[208:211], a[12:15], a[80:83], v[208:211]
 v_mfma_f32_16x16x32_bf16 v[208:211], a[8:11], a[64:67], v[208:211]
 buffer_load_dword a161, v13, s[20:23], 0 offen offset:256 sc1
 buffer_load_dwordx4 a[152:155], v8, s[16:19], s42 offen offset:3072 sc1
 s_waitcnt lgkmcnt(8)
 v_mfma_f32_16x16x32_bf16 v[224:227], a[16:19], a[64:67], v[224:227]
 ds_read_b64_tr_b16 a[8:9], v11 offset:8192
 ds_read_b64_tr_b16 a[10:11], v11 offset:9984
 v_mfma_f32_16x16x32_bf16 v[224:227], a[20:23], a[80:83], v[224:227]
 v_mfma_f32_16x16x32_bf16 v[228:231], a[20:23], a[84:87], v[228:231]
 v_mfma_f32_16x16x32_bf16 v[228:231], a[16:19], a[68:71], v[228:231]
 v_mfma_f32_16x16x32_bf16 v[232:235], a[16:19], a[72:75], v[232:235]
 ds_read_b64_tr_b16 a[12:13], v11 offset:24576
 ds_read_b64_tr_b16 a[14:15], v11 offset:26368
 v_mfma_f32_16x16x32_bf16 v[232:235], a[20:23], a[88:91], v[232:235]
 buffer_load_dwordx4 a[156:159], v9, s[16:19], s42 offen offset:3072 sc1
 v_mfma_f32_16x16x32_bf16 v[236:239], a[20:23], a[92:95], v[236:239]
 v_mfma_f32_16x16x32_bf16 v[236:239], a[16:19], a[76:79], v[236:239]
 s_waitcnt lgkmcnt(8)
 v_mfma_f32_16x16x32_bf16 v[252:255], a[24:27], a[76:79], v[252:255]
 ds_read_b64_tr_b16 a[16:17], v11 offset:32
 ds_read_b64_tr_b16 a[18:19], v11 offset:1824
 v_mfma_f32_16x16x32_bf16 v[252:255], a[28:31], a[92:95], v[252:255]
 s_mov_b32 s40, 1835008
 s_add_u32 m0, s38, 0
 v_mfma_f32_16x16x32_bf16 v[248:251], a[28:31], a[88:91], v[248:251]
 v_mfma_f32_16x16x32_bf16 v[248:251], a[24:27], a[72:75], v[248:251]
 buffer_load_dwordx4 v2, s[12:15], s40 offen offset:0 lds
 v_mfma_f32_16x16x32_bf16 v[244:247], a[24:27], a[68:71], v[244:247]
 ds_read_b64_tr_b16 a[20:21], v11 offset:16416
 ds_read_b64_tr_b16 a[22:23], v11 offset:18208
 v_mfma_f32_16x16x32_bf16 v[244:247], a[28:31], a[84:87], v[244:247]
 s_barrier
 v_mfma_f32_16x16x32_bf16 v[240:243], a[28:31], a[80:83], v[240:243]
 v_mfma_f32_16x16x32_bf16 v[240:243], a[24:27], a[64:67], v[240:243]
 s_waitcnt vmcnt(23) lgkmcnt(8)
 v_mfma_f32_16x16x32_bf16 v[32:35], a[0:3], a[96:99], v[32:35]
 ds_read_b64_tr_b16 a[24:25], v11 offset:8224
 s_waitcnt vmcnt(19)
 v_mfma_f32_16x16x32_bf16 v[32:35], a[4:7], a[112:115], v[32:35]
 ds_read_b64_tr_b16 a[26:27], v11 offset:10016
 buffer_load_dwordx4 v3, s[12:15], s40 offen offset:1024 lds
 v_mfma_f32_16x16x32_bf16 v[36:39], a[4:7], a[116:119], v[36:39]
 v_mfma_f32_16x16x32_bf16 v[36:39], a[0:3], a[100:103], v[36:39]
 buffer_load_dword v31, v14, s[96:99], s48 offen
 v_mfma_f32_16x16x32_bf16 v[40:43], a[0:3], a[104:107], v[40:43]
 ds_read_b64_tr_b16 a[28:29], v11 offset:24608
 ds_read_b64_tr_b16 a[30:31], v11 offset:26400
 v_mfma_f32_16x16x32_bf16 v[40:43], a[4:7], a[120:123], v[40:43]
 v_mfma_f32_16x16x32_bf16 v[44:47], a[4:7], a[124:127], v[44:47]
 v_mfma_f32_16x16x32_bf16 v[44:47], a[0:3], a[108:111], v[44:47]
 buffer_load_dwordx4 v4, s[12:15], s40 offen offset:2048 lds
 s_waitcnt lgkmcnt(8)
 v_mfma_f32_16x16x32_bf16 v[60:63], a[8:11], a[108:111], v[60:63]
 ds_read_b64_tr_b16 a[0:1], v11 offset:64
 ds_read_b64_tr_b16 a[2:3], v11 offset:1856
 v_mfma_f32_16x16x32_bf16 v[60:63], a[12:15], a[124:127], v[60:63]
 v_mfma_f32_16x16x32_bf16 v[56:59], a[12:15], a[120:123], v[56:59]
 v_mfma_f32_16x16x32_bf16 v[56:59], a[8:11], a[104:107], v[56:59]
 buffer_load_dword a162, v13, s[20:23], 0 offen offset:512 sc1
 v_mfma_f32_16x16x32_bf16 v[52:55], a[8:11], a[100:103], v[52:55]
 ds_read_b64_tr_b16 a[4:5], v11 offset:16448
 ds_read_b64_tr_b16 a[6:7], v11 offset:18240
 v_mfma_f32_16x16x32_bf16 v[52:55], a[12:15], a[116:119], v[52:55]
 buffer_load_dwordx4 v5, s[12:15], s40 offen offset:3072 lds
 v_mfma_f32_16x16x32_bf16 v[48:51], a[12:15], a[112:115], v[48:51]
 v_mfma_f32_16x16x32_bf16 v[48:51], a[8:11], a[96:99], v[48:51]
 s_waitcnt lgkmcnt(8)
 v_mfma_f32_16x16x32_bf16 v[64:67], a[16:19], a[96:99], v[64:67]
 ds_read_b64_tr_b16 a[8:9], v11 offset:8256
 ds_read_b64_tr_b16 a[10:11], v11 offset:10048
 v_mfma_f32_16x16x32_bf16 v[64:67], a[20:23], a[112:115], v[64:67]
 s_mov_b32 s40, 2064384
 s_add_u32 m0, s38, 16384
 v_mfma_f32_16x16x32_bf16 v[68:71], a[20:23], a[116:119], v[68:71]
 v_mfma_f32_16x16x32_bf16 v[68:71], a[16:19], a[100:103], v[68:71]
 buffer_load_dwordx4 v2, s[12:15], s40 offen offset:0 lds
 v_mfma_f32_16x16x32_bf16 v[72:75], a[16:19], a[104:107], v[72:75]
 ds_read_b64_tr_b16 a[12:13], v11 offset:24640
 ds_read_b64_tr_b16 a[14:15], v11 offset:26432
 v_mfma_f32_16x16x32_bf16 v[72:75], a[20:23], a[120:123], v[72:75]
 v_mfma_f32_16x16x32_bf16 v[76:79], a[20:23], a[124:127], v[76:79]
 v_mfma_f32_16x16x32_bf16 v[76:79], a[16:19], a[108:111], v[76:79]
 s_waitcnt lgkmcnt(8)
 v_mfma_f32_16x16x32_bf16 v[92:95], a[24:27], a[108:111], v[92:95]
 ds_read_b64_tr_b16 a[16:17], v11 offset:96
 ds_read_b64_tr_b16 a[18:19], v11 offset:1888
 v_mfma_f32_16x16x32_bf16 v[92:95], a[28:31], a[124:127], v[92:95]
 buffer_load_dwordx4 v3, s[12:15], s40 offen offset:1024 lds
 v_mfma_f32_16x16x32_bf16 v[88:91], a[28:31], a[120:123], v[88:91]
 v_mfma_f32_16x16x32_bf16 v[88:91], a[24:27], a[104:107], v[88:91]
 v_mfma_f32_16x16x32_bf16 v[84:87], a[24:27], a[100:103], v[84:87]
 ds_read_b64_tr_b16 a[20:21], v11 offset:16480
 ds_read_b64_tr_b16 a[22:23], v11 offset:18272
 v_mfma_f32_16x16x32_bf16 v[84:87], a[28:31], a[116:119], v[84:87]
 v_mfma_f32_16x16x32_bf16 v[80:83], a[28:31], a[112:115], v[80:83]
 v_mfma_f32_16x16x32_bf16 v[80:83], a[24:27], a[96:99], v[80:83]
 buffer_load_dwordx4 v4, s[12:15], s40 offen offset:2048 lds
 s_waitcnt lgkmcnt(8)
 v_mfma_f32_16x16x32_bf16 v[96:99], a[0:3], a[96:99], v[96:99]
 ds_read_b64_tr_b16 a[24:25], v11 offset:8288
 ds_read_b64_tr_b16 a[26:27], v11 offset:10080
 v_mfma_f32_16x16x32_bf16 v[96:99], a[4:7], a[112:115], v[96:99]
 v_mfma_f32_16x16x32_bf16 v[100:103], a[4:7], a[116:119], v[100:103]
 v_mfma_f32_16x16x32_bf16 v[100:103], a[0:3], a[100:103], v[100:103]
 v_mfma_f32_16x16x32_bf16 v[104:107], a[0:3], a[104:107], v[104:107]
 ds_read_b64_tr_b16 a[28:29], v11 offset:24672
 ds_read_b64_tr_b16 a[30:31], v11 offset:26464
 v_mfma_f32_16x16x32_bf16 v[104:107], a[4:7], a[120:123], v[104:107]
 buffer_load_dwordx4 v5, s[12:15], s40 offen offset:3072 lds
 v_mfma_f32_16x16x32_bf16 v[108:111], a[4:7], a[124:127], v[108:111]
 v_mfma_f32_16x16x32_bf16 v[108:111], a[0:3], a[108:111], v[108:111]
 buffer_load_dword a163, v13, s[20:23], 0 offen offset:768 sc1
 s_waitcnt lgkmcnt(8)
 v_mfma_f32_16x16x32_bf16 v[124:127], a[8:11], a[108:111], v[124:127]
 ds_read_b64_tr_b16 a[0:1], v11 offset:128
 ds_read_b64_tr_b16 a[2:3], v11 offset:1920
 v_mfma_f32_16x16x32_bf16 v[124:127], a[12:15], a[124:127], v[124:127]
 s_mov_b32 s42, 8192
 v_mfma_f32_16x16x32_bf16 v[120:123], a[12:15], a[120:123], v[120:123]
 v_mfma_f32_16x16x32_bf16 v[120:123], a[8:11], a[104:107], v[120:123]
 buffer_load_dwordx4 a[32:35], v6, s[16:19], s42 offen offset:0 sc1
 v_mfma_f32_16x16x32_bf16 v[116:119], a[8:11], a[100:103], v[116:119]
 ds_read_b64_tr_b16 a[4:5], v11 offset:16512
 ds_read_b64_tr_b16 a[6:7], v11 offset:18304
 v_mfma_f32_16x16x32_bf16 v[116:119], a[12:15], a[116:119], v[116:119]
 v_mfma_f32_16x16x32_bf16 v[112:115], a[12:15], a[112:115], v[112:115]
 v_mfma_f32_16x16x32_bf16 v[112:115], a[8:11], a[96:99], v[112:115]
 s_waitcnt lgkmcnt(8)
 v_mfma_f32_16x16x32_bf16 v[128:131], a[16:19], a[96:99], v[128:131]
 ds_read_b64_tr_b16 a[8:9], v11 offset:8320
 ds_read_b64_tr_b16 a[10:11], v11 offset:10112
 v_mfma_f32_16x16x32_bf16 v[128:131], a[20:23], a[112:115], v[128:131]
 buffer_load_dwordx4 a[36:39], v7, s[16:19], s42 offen offset:0 sc1
 v_mfma_f32_16x16x32_bf16 v[132:135], a[20:23], a[116:119], v[132:135]
 v_mfma_f32_16x16x32_bf16 v[132:135], a[16:19], a[100:103], v[132:135]
 v_mfma_f32_16x16x32_bf16 v[136:139], a[16:19], a[104:107], v[136:139]
 ds_read_b64_tr_b16 a[12:13], v11 offset:24704
 ds_read_b64_tr_b16 a[14:15], v11 offset:26496
 v_mfma_f32_16x16x32_bf16 v[136:139], a[20:23], a[120:123], v[136:139]
 v_mfma_f32_16x16x32_bf16 v[140:143], a[20:23], a[124:127], v[140:143]
 v_mfma_f32_16x16x32_bf16 v[140:143], a[16:19], a[108:111], v[140:143]
 buffer_load_dwordx4 a[40:43], v8, s[16:19], s42 offen offset:0 sc1
 s_waitcnt lgkmcnt(8)
 v_mfma_f32_16x16x32_bf16 v[156:159], a[24:27], a[108:111], v[156:159]
 ds_read_b64_tr_b16 a[16:17], v11 offset:160
 ds_read_b64_tr_b16 a[18:19], v11 offset:1952
 v_mfma_f32_16x16x32_bf16 v[156:159], a[28:31], a[124:127], v[156:159]
 v_mfma_f32_16x16x32_bf16 v[152:155], a[28:31], a[120:123], v[152:155]
 v_mfma_f32_16x16x32_bf16 v[152:155], a[24:27], a[104:107], v[152:155]
 v_mfma_f32_16x16x32_bf16 v[148:151], a[24:27], a[100:103], v[148:151]
 ds_read_b64_tr_b16 a[20:21], v11 offset:16544
 ds_read_b64_tr_b16 a[22:23], v11 offset:18336
 v_mfma_f32_16x16x32_bf16 v[148:151], a[28:31], a[116:119], v[148:151]
 buffer_load_dwordx4 a[44:47], v9, s[16:19], s42 offen offset:0 sc1
 v_mfma_f32_16x16x32_bf16 v[144:147], a[28:31], a[112:115], v[144:147]
 v_mfma_f32_16x16x32_bf16 v[144:147], a[24:27], a[96:99], v[144:147]
 s_waitcnt lgkmcnt(8)
 v_mfma_f32_16x16x32_bf16 v[160:163], a[0:3], a[96:99], v[160:163]
 ds_read_b64_tr_b16 a[24:25], v11 offset:8352
 ds_read_b64_tr_b16 a[26:27], v11 offset:10144
 v_mfma_f32_16x16x32_bf16 v[160:163], a[4:7], a[112:115], v[160:163]
 v_mfma_f32_16x16x32_bf16 v[164:167], a[4:7], a[116:119], v[164:167]
 v_mfma_f32_16x16x32_bf16 v[164:167], a[0:3], a[100:103], v[164:167]
 buffer_load_dword a164, v13, s[20:23], 0 offen offset:1024 sc1
 buffer_load_dwordx4 a[48:51], v6, s[16:19], s42 offen offset:1024 sc1
 v_mfma_f32_16x16x32_bf16 v[168:171], a[0:3], a[104:107], v[168:171]
 ds_read_b64_tr_b16 a[28:29], v11 offset:24736
 ds_read_b64_tr_b16 a[30:31], v11 offset:26528
 v_mfma_f32_16x16x32_bf16 v[168:171], a[4:7], a[120:123], v[168:171]
 v_mfma_f32_16x16x32_bf16 v[172:175], a[4:7], a[124:127], v[172:175]
 v_mfma_f32_16x16x32_bf16 v[172:175], a[0:3], a[108:111], v[172:175]
 s_waitcnt lgkmcnt(8)
 v_mfma_f32_16x16x32_bf16 v[188:191], a[8:11], a[108:111], v[188:191]
 ds_read_b64_tr_b16 a[0:1], v11 offset:192
 ds_read_b64_tr_b16 a[2:3], v11 offset:1984
 v_mfma_f32_16x16x32_bf16 v[188:191], a[12:15], a[124:127], v[188:191]
 buffer_load_dwordx4 a[52:55], v7, s[16:19], s42 offen offset:1024 sc1
 v_mfma_f32_16x16x32_bf16 v[184:187], a[12:15], a[120:123], v[184:187]
 v_mfma_f32_16x16x32_bf16 v[184:187], a[8:11], a[104:107], v[184:187]
 v_mfma_f32_16x16x32_bf16 v[180:183], a[8:11], a[100:103], v[180:183]
 ds_read_b64_tr_b16 a[4:5], v11 offset:16576
 ds_read_b64_tr_b16 a[6:7], v11 offset:18368
 v_mfma_f32_16x16x32_bf16 v[180:183], a[12:15], a[116:119], v[180:183]
 v_mfma_f32_16x16x32_bf16 v[176:179], a[12:15], a[112:115], v[176:179]
 v_mfma_f32_16x16x32_bf16 v[176:179], a[8:11], a[96:99], v[176:179]
 buffer_load_dwordx4 a[56:59], v8, s[16:19], s42 offen offset:1024 sc1
 s_waitcnt lgkmcnt(8)
 v_mfma_f32_16x16x32_bf16 v[192:195], a[16:19], a[96:99], v[192:195]
 ds_read_b64_tr_b16 a[8:9], v11 offset:8384
 ds_read_b64_tr_b16 a[10:11], v11 offset:10176
 v_mfma_f32_16x16x32_bf16 v[192:195], a[20:23], a[112:115], v[192:195]
 v_mfma_f32_16x16x32_bf16 v[196:199], a[20:23], a[116:119], v[196:199]
 v_mfma_f32_16x16x32_bf16 v[196:199], a[16:19], a[100:103], v[196:199]
 v_mfma_f32_16x16x32_bf16 v[200:203], a[16:19], a[104:107], v[200:203]
 ds_read_b64_tr_b16 a[12:13], v11 offset:24768
 ds_read_b64_tr_b16 a[14:15], v11 offset:26560
 v_mfma_f32_16x16x32_bf16 v[200:203], a[20:23], a[120:123], v[200:203]
 buffer_load_dwordx4 a[60:63], v9, s[16:19], s42 offen offset:1024 sc1
 v_mfma_f32_16x16x32_bf16 v[204:207], a[20:23], a[124:127], v[204:207]
 v_mfma_f32_16x16x32_bf16 v[204:207], a[16:19], a[108:111], v[204:207]
 s_waitcnt lgkmcnt(8)
 v_mfma_f32_16x16x32_bf16 v[220:223], a[24:27], a[108:111], v[220:223]
 s_waitcnt vmcnt(30)
 s_barrier
 ds_read_b64_tr_b16 a[16:17], v11 offset:32768
 v_mfma_f32_16x16x32_bf16 v[220:223], a[28:31], a[124:127], v[220:223]
 ds_read_b64_tr_b16 a[18:19], v11 offset:34560
 s_mov_b32 s40, 2293760
 v_mfma_f32_16x16x32_bf16 v[216:219], a[28:31], a[120:123], v[216:219]
 s_add_u32 m0, s38, 32768
 v_mfma_f32_16x16x32_bf16 v[216:219], a[24:27], a[104:107], v[216:219]
 buffer_load_dwordx4 v2, s[12:15], s40 offen offset:0 lds
 v_mfma_f32_16x16x32_bf16 v[212:215], a[24:27], a[100:103], v[212:215]
 ds_read_b64_tr_b16 a[20:21], v11 offset:49152
 ds_read_b64_tr_b16 a[22:23], v11 offset:50944
 v_mfma_f32_16x16x32_bf16 v[212:215], a[28:31], a[116:119], v[212:215]
 v_mfma_f32_16x16x32_bf16 v[208:211], a[28:31], a[112:115], v[208:211]
 v_mfma_f32_16x16x32_bf16 v[208:211], a[24:27], a[96:99], v[208:211]
 buffer_load_dword a165, v13, s[20:23], 0 offen offset:1280 sc1
 s_waitcnt lgkmcnt(8)
 v_mfma_f32_16x16x32_bf16 v[224:227], a[0:3], a[96:99], v[224:227]
 ds_read_b64_tr_b16 a[24:25], v11 offset:40960
 ds_read_b64_tr_b16 a[26:27], v11 offset:42752
 v_mfma_f32_16x16x32_bf16 v[224:227], a[4:7], a[112:115], v[224:227]
 buffer_load_dwordx4 v3, s[12:15], s40 offen offset:1024 lds
 v_mfma_f32_16x16x32_bf16 v[228:231], a[4:7], a[116:119], v[228:231]
 v_mfma_f32_16x16x32_bf16 v[228:231], a[0:3], a[100:103], v[228:231]
 v_mfma_f32_16x16x32_bf16 v[232:235], a[0:3], a[104:107], v[232:235]
 ds_read_b64_tr_b16 a[28:29], v11 offset:57344
 ds_read_b64_tr_b16 a[30:31], v11 offset:59136
 v_mfma_f32_16x16x32_bf16 v[232:235], a[4:7], a[120:123], v[232:235]
 v_mfma_f32_16x16x32_bf16 v[236:239], a[4:7], a[124:127], v[236:239]
 v_mfma_f32_16x16x32_bf16 v[236:239], a[0:3], a[108:111], v[236:239]
 buffer_load_dwordx4 v4, s[12:15], s40 offen offset:2048 lds
 s_waitcnt lgkmcnt(8)
 v_mfma_f32_16x16x32_bf16 v[252:255], a[8:11], a[108:111], v[252:255]
 ds_read_b64_tr_b16 a[0:1], v11 offset:32800
 ds_read_b64_tr_b16 a[2:3], v11 offset:34592
 v_mfma_f32_16x16x32_bf16 v[252:255], a[12:15], a[124:127], v[252:255]
 v_mfma_f32_16x16x32_bf16 v[248:251], a[12:15], a[120:123], v[248:251]
 v_mfma_f32_16x16x32_bf16 v[248:251], a[8:11], a[104:107], v[248:251]
 v_mfma_f32_16x16x32_bf16 v[244:247], a[8:11], a[100:103], v[244:247]
 ds_read_b64_tr_b16 a[4:5], v11 offset:49184
 ds_read_b64_tr_b16 a[6:7], v11 offset:50976
 v_mfma_f32_16x16x32_bf16 v[244:247], a[12:15], a[116:119], v[244:247]
 s_barrier
 buffer_load_dwordx4 v5, s[12:15], s40 offen offset:3072 lds
 v_mfma_f32_16x16x32_bf16 v[240:243], a[12:15], a[112:115], v[240:243]
 v_mfma_f32_16x16x32_bf16 v[240:243], a[8:11], a[96:99], v[240:243]
 s_waitcnt vmcnt(30) lgkmcnt(8)
 v_mfma_f32_16x16x32_bf16 v[32:35], a[16:19], a[128:131], v[32:35]
 ds_read_b64_tr_b16 a[8:9], v11 offset:40992
 s_waitcnt vmcnt(25)
 v_mfma_f32_16x16x32_bf16 v[32:35], a[20:23], a[144:147], v[32:35]
 ds_read_b64_tr_b16 a[10:11], v11 offset:42784
 s_mov_b32 s40, 2523136
 v_mfma_f32_16x16x32_bf16 v[36:39], a[20:23], a[148:151], v[36:39]
 s_add_u32 m0, s38, 49152
 v_mfma_f32_16x16x32_bf16 v[36:39], a[16:19], a[132:135], v[36:39]
 buffer_load_dword v31, v14, s[96:99], s49 offen
 buffer_load_dwordx4 v2, s[12:15], s40 offen offset:0 lds
 v_mfma_f32_16x16x32_bf16 v[40:43], a[16:19], a[136:139], v[40:43]
 ds_read_b64_tr_b16 a[12:13], v11 offset:57376
 ds_read_b64_tr_b16 a[14:15], v11 offset:59168
 v_mfma_f32_16x16x32_bf16 v[40:43], a[20:23], a[152:155], v[40:43]
 v_mfma_f32_16x16x32_bf16 v[44:47], a[20:23], a[156:159], v[44:47]
 v_mfma_f32_16x16x32_bf16 v[44:47], a[16:19], a[140:143], v[44:47]
 s_waitcnt lgkmcnt(8)
 v_mfma_f32_16x16x32_bf16 v[60:63], a[24:27], a[140:143], v[60:63]
 ds_read_b64_tr_b16 a[16:17], v11 offset:32832
 ds_read_b64_tr_b16 a[18:19], v11 offset:34624
 v_mfma_f32_16x16x32_bf16 v[60:63], a[28:31], a[156:159], v[60:63]
 buffer_load_dwordx4 v3, s[12:15], s40 offen offset:1024 lds
 v_mfma_f32_16x16x32_bf16 v[56:59], a[28:31], a[152:155], v[56:59]
 v_mfma_f32_16x16x32_bf16 v[56:59], a[24:27], a[136:139], v[56:59]
 buffer_load_dword a166, v13, s[20:23], 0 offen offset:1536 sc1
 v_mfma_f32_16x16x32_bf16 v[52:55], a[24:27], a[132:135], v[52:55]
 ds_read_b64_tr_b16 a[20:21], v11 offset:49216
 ds_read_b64_tr_b16 a[22:23], v11 offset:51008
 v_mfma_f32_16x16x32_bf16 v[52:55], a[28:31], a[148:151], v[52:55]
 v_mfma_f32_16x16x32_bf16 v[48:51], a[28:31], a[144:147], v[48:51]
 v_mfma_f32_16x16x32_bf16 v[48:51], a[24:27], a[128:131], v[48:51]
 buffer_load_dwordx4 v4, s[12:15], s40 offen offset:2048 lds
 s_waitcnt lgkmcnt(8)
 v_mfma_f32_16x16x32_bf16 v[64:67], a[0:3], a[128:131], v[64:67]
 ds_read_b64_tr_b16 a[24:25], v11 offset:41024
 ds_read_b64_tr_b16 a[26:27], v11 offset:42816
 v_mfma_f32_16x16x32_bf16 v[64:67], a[4:7], a[144:147], v[64:67]
 v_mfma_f32_16x16x32_bf16 v[68:71], a[4:7], a[148:151], v[68:71]
 v_mfma_f32_16x16x32_bf16 v[68:71], a[0:3], a[132:135], v[68:71]
 v_mfma_f32_16x16x32_bf16 v[72:75], a[0:3], a[136:139], v[72:75]
 ds_read_b64_tr_b16 a[28:29], v11 offset:57408
 ds_read_b64_tr_b16 a[30:31], v11 offset:59200
 v_mfma_f32_16x16x32_bf16 v[72:75], a[4:7], a[152:155], v[72:75]
 buffer_load_dwordx4 v5, s[12:15], s40 offen offset:3072 lds
 v_mfma_f32_16x16x32_bf16 v[76:79], a[4:7], a[156:159], v[76:79]
 v_mfma_f32_16x16x32_bf16 v[76:79], a[0:3], a[140:143], v[76:79]
 s_waitcnt lgkmcnt(8)
 v_mfma_f32_16x16x32_bf16 v[92:95], a[8:11], a[140:143], v[92:95]
 ds_read_b64_tr_b16 a[0:1], v11 offset:32864
 ds_read_b64_tr_b16 a[2:3], v11 offset:34656
 v_mfma_f32_16x16x32_bf16 v[92:95], a[12:15], a[156:159], v[92:95]
 v_mfma_f32_16x16x32_bf16 v[88:91], a[12:15], a[152:155], v[88:91]
 v_mfma_f32_16x16x32_bf16 v[88:91], a[8:11], a[136:139], v[88:91]
 buffer_load_dwordx4 a[64:67], v6, s[16:19], s42 offen offset:2048 sc1
 v_mfma_f32_16x16x32_bf16 v[84:87], a[8:11], a[132:135], v[84:87]
 ds_read_b64_tr_b16 a[4:5], v11 offset:49248
 ds_read_b64_tr_b16 a[6:7], v11 offset:51040
 v_mfma_f32_16x16x32_bf16 v[84:87], a[12:15], a[148:151], v[84:87]
 v_mfma_f32_16x16x32_bf16 v[80:83], a[12:15], a[144:147], v[80:83]
 v_mfma_f32_16x16x32_bf16 v[80:83], a[8:11], a[128:131], v[80:83]
 s_waitcnt lgkmcnt(8)
 v_mfma_f32_16x16x32_bf16 v[96:99], a[16:19], a[128:131], v[96:99]
 ds_read_b64_tr_b16 a[8:9], v11 offset:41056
 ds_read_b64_tr_b16 a[10:11], v11 offset:42848
 v_mfma_f32_16x16x32_bf16 v[96:99], a[20:23], a[144:147], v[96:99]
 buffer_load_dwordx4 a[68:71], v7, s[16:19], s42 offen offset:2048 sc1
 v_mfma_f32_16x16x32_bf16 v[100:103], a[20:23], a[148:151], v[100:103]
 v_mfma_f32_16x16x32_bf16 v[100:103], a[16:19], a[132:135], v[100:103]
 v_mfma_f32_16x16x32_bf16 v[104:107], a[16:19], a[136:139], v[104:107]
 ds_read_b64_tr_b16 a[12:13], v11 offset:57440
 ds_read_b64_tr_b16 a[14:15], v11 offset:59232
 v_mfma_f32_16x16x32_bf16 v[104:107], a[20:23], a[152:155], v[104:107]
 v_mfma_f32_16x16x32_bf16 v[108:111], a[20:23], a[156:159], v[108:111]
 v_mfma_f32_16x16x32_bf16 v[108:111], a[16:19], a[140:143], v[108:111]
 buffer_load_dword a167, v13, s[20:23], 0 offen offset:1792 sc1
 buffer_load_dwordx4 a[72:75], v8, s[16:19], s42 offen offset:2048 sc1
 s_waitcnt lgkmcnt(8)
 v_mfma_f32_16x16x32_bf16 v[124:127], a[24:27], a[140:143], v[124:127]
 ds_read_b64_tr_b16 a[16:17], v11 offset:32896
 ds_read_b64_tr_b16 a[18:19], v11 offset:34688
 v_mfma_f32_16x16x32_bf16 v[124:127], a[28:31], a[156:159], v[124:127]
 v_mfma_f32_16x16x32_bf16 v[120:123], a[28:31], a[152:155], v[120:123]
 v_mfma_f32_16x16x32_bf16 v[120:123], a[24:27], a[136:139], v[120:123]
 v_mfma_f32_16x16x32_bf16 v[116:119], a[24:27], a[132:135], v[116:119]
 ds_read_b64_tr_b16 a[20:21], v11 offset:49280
 ds_read_b64_tr_b16 a[22:23], v11 offset:51072
 v_mfma_f32_16x16x32_bf16 v[116:119], a[28:31], a[148:151], v[116:119]
 buffer_load_dwordx4 a[76:79], v9, s[16:19], s42 offen offset:2048 sc1
 v_mfma_f32_16x16x32_bf16 v[112:115], a[28:31], a[144:147], v[112:115]
 v_mfma_f32_16x16x32_bf16 v[112:115], a[24:27], a[128:131], v[112:115]
 s_waitcnt lgkmcnt(8)
 v_mfma_f32_16x16x32_bf16 v[128:131], a[0:3], a[128:131], v[128:131]
 ds_read_b64_tr_b16 a[24:25], v11 offset:41088
 ds_read_b64_tr_b16 a[26:27], v11 offset:42880
 v_mfma_f32_16x16x32_bf16 v[128:131], a[4:7], a[144:147], v[128:131]
 v_mfma_f32_16x16x32_bf16 v[132:135], a[4:7], a[148:151], v[132:135]
 v_mfma_f32_16x16x32_bf16 v[132:135], a[0:3], a[132:135], v[132:135]
 buffer_load_dwordx4 a[80:83], v6, s[16:19], s42 offen offset:3072 sc1
 v_mfma_f32_16x16x32_bf16 v[136:139], a[0:3], a[136:139], v[136:139]
 ds_read_b64_tr_b16 a[28:29], v11 offset:57472
 ds_read_b64_tr_b16 a[30:31], v11 offset:59264
 v_mfma_f32_16x16x32_bf16 v[136:139], a[4:7], a[152:155], v[136:139]
 v_mfma_f32_16x16x32_bf16 v[140:143], a[4:7], a[156:159], v[140:143]
 v_mfma_f32_16x16x32_bf16 v[140:143], a[0:3], a[140:143], v[140:143]
 s_waitcnt lgkmcnt(8)
 v_mfma_f32_16x16x32_bf16 v[156:159], a[8:11], a[140:143], v[156:159]
 ds_read_b64_tr_b16 a[0:1], v11 offset:32928
 ds_read_b64_tr_b16 a[2:3], v11 offset:34720
 v_mfma_f32_16x16x32_bf16 v[156:159], a[12:15], a[156:159], v[156:159]
 buffer_load_dwordx4 a[84:87], v7, s[16:19], s42 offen offset:3072 sc1
 v_mfma_f32_16x16x32_bf16 v[152:155], a[12:15], a[152:155], v[152:155]
 v_mfma_f32_16x16x32_bf16 v[152:155], a[8:11], a[136:139], v[152:155]
 v_mfma_f32_16x16x32_bf16 v[148:151], a[8:11], a[132:135], v[148:151]
 ds_read_b64_tr_b16 a[4:5], v11 offset:49312
 ds_read_b64_tr_b16 a[6:7], v11 offset:51104
 v_mfma_f32_16x16x32_bf16 v[148:151], a[12:15], a[148:151], v[148:151]
 v_mfma_f32_16x16x32_bf16 v[144:147], a[12:15], a[144:147], v[144:147]
 v_mfma_f32_16x16x32_bf16 v[144:147], a[8:11], a[128:131], v[144:147]
 buffer_load_dwordx4 a[88:91], v8, s[16:19], s42 offen offset:3072 sc1
 s_waitcnt lgkmcnt(8)
 v_mfma_f32_16x16x32_bf16 v[160:163], a[16:19], a[128:131], v[160:163]
 ds_read_b64_tr_b16 a[8:9], v11 offset:41120
 ds_read_b64_tr_b16 a[10:11], v11 offset:42912
 s_branch m_ps_p3_1
m_pad_p3_1:
 s_branch m_reta_p3
m_ps_p3_1:
 v_mfma_f32_16x16x32_bf16 v[160:163], a[20:23], a[144:147], v[160:163]
 v_mfma_f32_16x16x32_bf16 v[164:167], a[20:23], a[148:151], v[164:167]
 v_mfma_f32_16x16x32_bf16 v[164:167], a[16:19], a[132:135], v[164:167]
 buffer_load_dword a168, v13, s[20:23], 0 offen offset:2048 sc1
 v_mfma_f32_16x16x32_bf16 v[168:171], a[16:19], a[136:139], v[168:171]
 ds_read_b64_tr_b16 a[12:13], v11 offset:57504
 ds_read_b64_tr_b16 a[14:15], v11 offset:59296
 v_mfma_f32_16x16x32_bf16 v[168:171], a[20:23], a[152:155], v[168:171]
 buffer_load_dwordx4 a[92:95], v9, s[16:19], s42 offen offset:3072 sc1
 v_mfma_f32_16x16x32_bf16 v[172:175], a[20:23], a[156:159], v[172:175]
 v_mfma_f32_16x16x32_bf16 v[172:175], a[16:19], a[140:143], v[172:175]
 s_waitcnt lgkmcnt(8)
 v_mfma_f32_16x16x32_bf16 v[188:191], a[24:27], a[140:143], v[188:191]
 ds_read_b64_tr_b16 a[16:17], v11 offset:32960
 ds_read_b64_tr_b16 a[18:19], v11 offset:34752
 v_mfma_f32_16x16x32_bf16 v[188:191], a[28:31], a[156:159], v[188:191]
 s_mov_b32 s40, 2752512
 s_add_u32 m0, s38, 65536
 v_mfma_f32_16x16x32_bf16 v[184:187], a[28:31], a[152:155], v[184:187]
 v_mfma_f32_16x16x32_bf16 v[184:187], a[24:27], a[136:139], v[184:187]
 buffer_load_dwordx4 v2, s[12:15], s40 offen offset:0 lds
 v_mfma_f32_16x16x32_bf16 v[180:183], a[24:27], a[132:135], v[180:183]
 ds_read_b64_tr_b16 a[20:21], v11 offset:49344
 ds_read_b64_tr_b16 a[22:23], v11 offset:51136
 v_mfma_f32_16x16x32_bf16 v[180:183], a[28:31], a[148:151], v[180:183]
 v_mfma_f32_16x16x32_bf16 v[176:179], a[28:31], a[144:147], v[176:179]
 v_mfma_f32_16x16x32_bf16 v[176:179], a[24:27], a[128:131], v[176:179]
 s_waitcnt lgkmcnt(8)
 v_mfma_f32_16x16x32_bf16 v[192:195], a[0:3], a[128:131], v[192:195]
 ds_read_b64_tr_b16 a[24:25], v11 offset:41152
 ds_read_b64_tr_b16 a[26:27], v11 offset:42944
 v_mfma_f32_16x16x32_bf16 v[192:195], a[4:7], a[144:147], v[192:195]
 buffer_load_dwordx4 v3, s[12:15], s40 offen offset:1024 lds
 v_mfma_f32_16x16x32_bf16 v[196:199], a[4:7], a[148:151], v[196:199]
 v_mfma_f32_16x16x32_bf16 v[196:199], a[0:3], a[132:135], v[196:199]
 v_mfma_f32_16x16x32_bf16 v[200:203], a[0:3], a[136:139], v[200:203]
 ds_read_b64_tr_b16 a[28:29], v11 offset:57536
 ds_read_b64_tr_b16 a[30:31], v11 offset:59328
 v_mfma_f32_16x16x32_bf16 v[200:203], a[4:7], a[152:155], v[200:203]
 v_mfma_f32_16x16x32_bf16 v[204:207], a[4:7], a[156:159], v[204:207]
 v_mfma_f32_16x16x32_bf16 v[204:207], a[0:3], a[140:143], v[204:207]
 buffer_load_dwordx4 v4, s[12:15], s40 offen offset:2048 lds
 s_waitcnt lgkmcnt(8)
 v_mfma_f32_16x16x32_bf16 v[220:223], a[8:11], a[140:143], v[220:223]
 s_waitcnt vmcnt(34)
 s_barrier
 ds_read_b64_tr_b16 a[0:1], v10 offset:0
 v_mfma_f32_16x16x32_bf16 v[220:223], a[12:15], a[156:159], v[220:223]
 ds_read_b64_tr_b16 a[2:3], v10 offset:1792
 v_mfma_f32_16x16x32_bf16 v[216:219], a[12:15], a[152:155], v[216:219]
 v_mfma_f32_16x16x32_bf16 v[216:219], a[8:11], a[136:139], v[216:219]
 v_mfma_f32_16x16x32_bf16 v[212:215], a[8:11], a[132:135], v[212:215]
 ds_read_b64_tr_b16 a[4:5], v10 offset:16384
 ds_read_b64_tr_b16 a[6:7], v10 offset:18176
 v_mfma_f32_16x16x32_bf16 v[212:215], a[12:15], a[148:151], v[212:215]
 buffer_load_dwordx4 v5, s[12:15], s40 offen offset:3072 lds
 v_mfma_f32_16x16x32_bf16 v[208:211], a[12:15], a[144:147], v[208:211]
 v_mfma_f32_16x16x32_bf16 v[208:211], a[8:11], a[128:131], v[208:211]
 buffer_load_dword a169, v13, s[20:23], 0 offen offset:2304 sc1
 s_waitcnt lgkmcnt(8)
 v_mfma_f32_16x16x32_bf16 v[224:227], a[16:19], a[128:131], v[224:227]
 ds_read_b64_tr_b16 a[8:9], v10 offset:8192
 ds_read_b64_tr_b16 a[10:11], v10 offset:9984
 v_mfma_f32_16x16x32_bf16 v[224:227], a[20:23], a[144:147], v[224:227]
 s_mov_b32 s40, 2981888
 s_add_u32 m0, s38, 81920
 v_mfma_f32_16x16x32_bf16 v[228:231], a[20:23], a[148:151], v[228:231]
 v_mfma_f32_16x16x32_bf16 v[228:231], a[16:19], a[132:135], v[228:231]
 buffer_load_dwordx4 v2, s[12:15], s40 offen offset:0 lds
 v_mfma_f32_16x16x32_bf16 v[232:235], a[16:19], a[136:139], v[232:235]
 ds_read_b64_tr_b16 a[12:13], v10 offset:24576
 ds_read_b64_tr_b16 a[14:15], v10 offset:26368
 v_mfma_f32_16x16x32_bf16 v[232:235], a[20:23], a[152:155], v[232:235]
 v_mfma_f32_16x16x32_bf16 v[236:239], a[20:23], a[156:159], v[236:239]
 v_mfma_f32_16x16x32_bf16 v[236:239], a[16:19], a[140:143], v[236:239]
 s_waitcnt lgkmcnt(8)
 v_mfma_f32_16x16x32_bf16 v[252:255], a[24:27], a[140:143], v[252:255]
 ds_read_b64_tr_b16 a[16:17], v10 offset:32
 ds_read_b64_tr_b16 a[18:19], v10 offset:1824
 v_mfma_f32_16x16x32_bf16 v[252:255], a[28:31], a[156:159], v[252:255]
 buffer_load_dwordx4 v3, s[12:15], s40 offen offset:1024 lds
 v_mfma_f32_16x16x32_bf16 v[248:251], a[28:31], a[152:155], v[248:251]
 v_mfma_f32_16x16x32_bf16 v[248:251], a[24:27], a[136:139], v[248:251]
 v_mfma_f32_16x16x32_bf16 v[244:247], a[24:27], a[132:135], v[244:247]
 ds_read_b64_tr_b16 a[20:21], v10 offset:16416
 ds_read_b64_tr_b16 a[22:23], v10 offset:18208
 v_mfma_f32_16x16x32_bf16 v[244:247], a[28:31], a[148:151], v[244:247]
 s_barrier
 v_mfma_f32_16x16x32_bf16 v[240:243], a[28:31], a[144:147], v[240:243]
 v_mfma_f32_16x16x32_bf16 v[240:243], a[24:27], a[128:131], v[240:243]
 buffer_load_dwordx4 v4, s[12:15], s40 offen offset:2048 lds
 s_waitcnt vmcnt(34) lgkmcnt(8)
 v_mfma_f32_16x16x32_bf16 v[32:35], a[0:3], a[32:35], v[32:35]
 ds_read_b64_tr_b16 a[24:25], v10 offset:8224
 s_waitcnt vmcnt(29)
 v_mfma_f32_16x16x32_bf16 v[32:35], a[4:7], a[48:51], v[32:35]
 ds_read_b64_tr_b16 a[26:27], v10 offset:10016
 v_mfma_f32_16x16x32_bf16 v[36:39], a[4:7], a[52:55], v[36:39]
 v_mfma_f32_16x16x32_bf16 v[36:39], a[0:3], a[36:39], v[36:39]
 buffer_load_dword v31, v14, s[96:99], s50 offen
 v_mfma_f32_16x16x32_bf16 v[40:43], a[0:3], a[40:43], v[40:43]
 ds_read_b64_tr_b16 a[28:29], v10 offset:24608
 ds_read_b64_tr_b16 a[30:31], v10 offset:26400
 v_mfma_f32_16x16x32_bf16 v[40:43], a[4:7], a[56:59], v[40:43]
 buffer_load_dwordx4 v5, s[12:15], s40 offen offset:3072 lds
 v_mfma_f32_16x16x32_bf16 v[44:47], a[4:7], a[60:63], v[44:47]
 v_mfma_f32_16x16x32_bf16 v[44:47], a[0:3], a[44:47], v[44:47]
 s_waitcnt lgkmcnt(8)
 v_mfma_f32_16x16x32_bf16 v[60:63], a[8:11], a[44:47], v[60:63]
 ds_read_b64_tr_b16 a[0:1], v10 offset:64
 ds_read_b64_tr_b16 a[2:3], v10 offset:1856
 v_mfma_f32_16x16x32_bf16 v[60:63], a[12:15], a[60:63], v[60:63]
 s_mov_b32 s42, 12288
 v_mfma_f32_16x16x32_bf16 v[56:59], a[12:15], a[56:59], v[56:59]
 v_mfma_f32_16x16x32_bf16 v[56:59], a[8:11], a[40:43], v[56:59]
 buffer_load_dword a170, v13, s[20:23], 0 offen offset:2560 sc1
 buffer_load_dwordx4 a[96:99], v6, s[16:19], s42 offen offset:0 sc1
 v_mfma_f32_16x16x32_bf16 v[52:55], a[8:11], a[36:39], v[52:55]
 ds_read_b64_tr_b16 a[4:5], v10 offset:16448
 ds_read_b64_tr_b16 a[6:7], v10 offset:18240
 v_mfma_f32_16x16x32_bf16 v[52:55], a[12:15], a[52:55], v[52:55]
 v_mfma_f32_16x16x32_bf16 v[48:51], a[12:15], a[48:51], v[48:51]
 v_mfma_f32_16x16x32_bf16 v[48:51], a[8:11], a[32:35], v[48:51]
 s_waitcnt lgkmcnt(8)
 v_mfma_f32_16x16x32_bf16 v[64:67], a[16:19], a[32:35], v[64:67]
 ds_read_b64_tr_b16 a[8:9], v10 offset:8256
 ds_read_b64_tr_b16 a[10:11], v10 offset:10048
 v_mfma_f32_16x16x32_bf16 v[64:67], a[20:23], a[48:51], v[64:67]
 buffer_load_dwordx4 a[100:103], v7, s[16:19], s42 offen offset:0 sc1
 v_mfma_f32_16x16x32_bf16 v[68:71], a[20:23], a[52:55], v[68:71]
 v_mfma_f32_16x16x32_bf16 v[68:71], a[16:19], a[36:39], v[68:71]
 v_mfma_f32_16x16x32_bf16 v[72:75], a[16:19], a[40:43], v[72:75]
 ds_read_b64_tr_b16 a[12:13], v10 offset:24640
 ds_read_b64_tr_b16 a[14:15], v10 offset:26432
 v_mfma_f32_16x16x32_bf16 v[72:75], a[20:23], a[56:59], v[72:75]
 v_mfma_f32_16x16x32_bf16 v[76:79], a[20:23], a[60:63], v[76:79]
 v_mfma_f32_16x16x32_bf16 v[76:79], a[16:19], a[44:47], v[76:79]
 buffer_load_dwordx4 a[104:107], v8, s[16:19], s42 offen offset:0 sc1
 s_waitcnt lgkmcnt(8)
 v_mfma_f32_16x16x32_bf16 v[92:95], a[24:27], a[44:47], v[92:95]
 ds_read_b64_tr_b16 a[16:17], v10 offset:96
 ds_read_b64_tr_b16 a[18:19], v10 offset:1888
 v_mfma_f32_16x16x32_bf16 v[92:95], a[28:31], a[60:63], v[92:95]
 v_mfma_f32_16x16x32_bf16 v[88:91], a[28:31], a[56:59], v[88:91]
 v_mfma_f32_16x16x32_bf16 v[88:91], a[24:27], a[40:43], v[88:91]
 v_mfma_f32_16x16x32_bf16 v[84:87], a[24:27], a[36:39], v[84:87]
 ds_read_b64_tr_b16 a[20:21], v10 offset:16480
 ds_read_b64_tr_b16 a[22:23], v10 offset:18272
 v_mfma_f32_16x16x32_bf16 v[84:87], a[28:31], a[52:55], v[84:87]
 buffer_load_dwordx4 a[108:111], v9, s[16:19], s42 offen offset:0 sc1
 v_mfma_f32_16x16x32_bf16 v[80:83], a[28:31], a[48:51], v[80:83]
 v_mfma_f32_16x16x32_bf16 v[80:83], a[24:27], a[32:35], v[80:83]
 s_waitcnt lgkmcnt(8)
 v_mfma_f32_16x16x32_bf16 v[96:99], a[0:3], a[32:35], v[96:99]
 ds_read_b64_tr_b16 a[24:25], v10 offset:8288
 ds_read_b64_tr_b16 a[26:27], v10 offset:10080
 v_mfma_f32_16x16x32_bf16 v[96:99], a[4:7], a[48:51], v[96:99]
 v_mfma_f32_16x16x32_bf16 v[100:103], a[4:7], a[52:55], v[100:103]
 v_mfma_f32_16x16x32_bf16 v[100:103], a[0:3], a[36:39], v[100:103]
 buffer_load_dwordx4 a[112:115], v6, s[16:19], s42 offen offset:1024 sc1
 v_mfma_f32_16x16x32_bf16 v[104:107], a[0:3], a[40:43], v[104:107]
 ds_read_b64_tr_b16 a[28:29], v10 offset:24672
 ds_read_b64_tr_b16 a[30:31], v10 offset:26464
 v_mfma_f32_16x16x32_bf16 v[104:107], a[4:7], a[56:59], v[104:107]
 v_mfma_f32_16x16x32_bf16 v[108:111], a[4:7], a[60:63], v[108:111]
 v_mfma_f32_16x16x32_bf16 v[108:111], a[0:3], a[44:47], v[108:111]
 buffer_load_dword a171, v13, s[20:23], 0 offen offset:2816 sc1
 s_waitcnt lgkmcnt(8)
 v_mfma_f32_16x16x32_bf16 v[124:127], a[8:11], a[44:47], v[124:127]
 ds_read_b64_tr_b16 a[0:1], v10 offset:128
 ds_read_b64_tr_b16 a[2:3], v10 offset:1920
 v_mfma_f32_16x16x32_bf16 v[124:127], a[12:15], a[60:63], v[124:127]
 buffer_load_dwordx4 a[116:119], v7, s[16:19], s42 offen offset:1024 sc1
 v_mfma_f32_16x16x32_bf16 v[120:123], a[12:15], a[56:59], v[120:123]
 v_mfma_f32_16x16x32_bf16 v[120:123], a[8:11], a[40:43], v[120:123]
 v_mfma_f32_16x16x32_bf16 v[116:119], a[8:11], a[36:39], v[116:119]
 ds_read_b64_tr_b16 a[4:5], v10 offset:16512
 ds_read_b64_tr_b16 a[6:7], v10 offset:18304
 v_mfma_f32_16x16x32_bf16 v[116:119], a[12:15], a[52:55], v[116:119]
 v_mfma_f32_16x16x32_bf16 v[112:115], a[12:15], a[48:51], v[112:115]
 v_mfma_f32_16x16x32_bf16 v[112:115], a[8:11], a[32:35], v[112:115]
 buffer_load_dwordx4 a[120:123], v8, s[16:19], s42 offen offset:1024 sc1
 s_waitcnt lgkmcnt(8)
 v_mfma_f32_16x16x32_bf16 v[128:131], a[16:19], a[32:35], v[128:131]
 ds_read_b64_tr_b16 a[8:9], v10 offset:8320
 ds_read_b64_tr_b16 a[10:11], v10 offset:10112
 v_mfma_f32_16x16x32_bf16 v[128:131], a[20:23], a[48:51], v[128:131]
 v_mfma_f32_16x16x32_bf16 v[132:135], a[20:23], a[52:55], v[132:135]
 v_mfma_f32_16x16x32_bf16 v[132:135], a[16:19], a[36:39], v[132:135]
 v_mfma_f32_16x16x32_bf16 v[136:139], a[16:19], a[40:43], v[136:139]
 ds_read_b64_tr_b16 a[12:13], v10 offset:24704
 ds_read_b64_tr_b16 a[14:15], v10 offset:26496
 v_mfma_f32_16x16x32_bf16 v[136:139], a[20:23], a[56:59], v[136:139]
 buffer_load_dwordx4 a[124:127], v9, s[16:19], s42 offen offset:1024 sc1
 v_mfma_f32_16x16x32_bf16 v[140:143], a[20:23], a[60:63], v[140:143]
 v_mfma_f32_16x16x32_bf16 v[140:143], a[16:19], a[44:47], v[140:143]
 s_waitcnt lgkmcnt(8)
 v_mfma_f32_16x16x32_bf16 v[156:159], a[24:27], a[44:47], v[156:159]
 ds_read_b64_tr_b16 a[16:17], v10 offset:160
 ds_read_b64_tr_b16 a[18:19], v10 offset:1952
 v_mfma_f32_16x16x32_bf16 v[156:159], a[28:31], a[60:63], v[156:159]
 s_mov_b32 s40, 3211264
 s_add_u32 m0, s38, 98304
 v_mfma_f32_16x16x32_bf16 v[152:155], a[28:31], a[56:59], v[152:155]
 v_mfma_f32_16x16x32_bf16 v[152:155], a[24:27], a[40:43], v[152:155]
 buffer_load_dwordx4 v2, s[12:15], s40 offen offset:0 lds
 v_mfma_f32_16x16x32_bf16 v[148:151], a[24:27], a[36:39], v[148:151]
 ds_read_b64_tr_b16 a[20:21], v10 offset:16544
 ds_read_b64_tr_b16 a[22:23], v10 offset:18336
 v_mfma_f32_16x16x32_bf16 v[148:151], a[28:31], a[52:55], v[148:151]
 v_mfma_f32_16x16x32_bf16 v[144:147], a[28:31], a[48:51], v[144:147]
 v_mfma_f32_16x16x32_bf16 v[144:147], a[24:27], a[32:35], v[144:147]
 s_waitcnt lgkmcnt(8)
 v_mfma_f32_16x16x32_bf16 v[160:163], a[0:3], a[32:35], v[160:163]
 ds_read_b64_tr_b16 a[24:25], v10 offset:8352
 ds_read_b64_tr_b16 a[26:27], v10 offset:10144
 v_mfma_f32_16x16x32_bf16 v[160:163], a[4:7], a[48:51], v[160:163]
 buffer_load_dwordx4 v3, s[12:15], s40 offen offset:1024 lds
 v_mfma_f32_16x16x32_bf16 v[164:167], a[4:7], a[52:55], v[164:167]
 v_mfma_f32_16x16x32_bf16 v[164:167], a[0:3], a[36:39], v[164:167]
 buffer_load_dword a172, v13, s[20:23], 0 offen offset:3072 sc1
 v_mfma_f32_16x16x32_bf16 v[168:171], a[0:3], a[40:43], v[168:171]
 ds_read_b64_tr_b16 a[28:29], v10 offset:24736
 ds_read_b64_tr_b16 a[30:31], v10 offset:26528
 v_mfma_f32_16x16x32_bf16 v[168:171], a[4:7], a[56:59], v[168:171]
 v_mfma_f32_16x16x32_bf16 v[172:175], a[4:7], a[60:63], v[172:175]
 v_mfma_f32_16x16x32_bf16 v[172:175], a[0:3], a[44:47], v[172:175]
 buffer_load_dwordx4 v4, s[12:15], s40 offen offset:2048 lds
 s_waitcnt lgkmcnt(8)
 v_mfma_f32_16x16x32_bf16 v[188:191], a[8:11], a[44:47], v[188:191]
 ds_read_b64_tr_b16 a[0:1], v10 offset:192
 ds_read_b64_tr_b16 a[2:3], v10 offset:1984
 v_mfma_f32_16x16x32_bf16 v[188:191], a[12:15], a[60:63], v[188:191]
 v_mfma_f32_16x16x32_bf16 v[184:187], a[12:15], a[56:59], v[184:187]
 v_mfma_f32_16x16x32_bf16 v[184:187], a[8:11], a[40:43], v[184:187]
 v_mfma_f32_16x16x32_bf16 v[180:183], a[8:11], a[36:39], v[180:183]
 ds_read_b64_tr_b16 a[4:5], v10 offset:16576
 ds_read_b64_tr_b16 a[6:7], v10 offset:18368
 v_mfma_f32_16x16x32_bf16 v[180:183], a[12:15], a[52:55], v[180:183]
 buffer_load_dwordx4 v5, s[12:15], s40 offen offset:3072 lds
 v_mfma_f32_16x16x32_bf16 v[176:179], a[12:15], a[48:51], v[176:179]
 v_mfma_f32_16x16x32_bf16 v[176:179], a[8:11], a[32:35], v[176:179]
 s_waitcnt lgkmcnt(8)
 v_mfma_f32_16x16x32_bf16 v[192:195], a[16:19], a[32:35], v[192:195]
 ds_read_b64_tr_b16 a[8:9], v10 offset:8384
 ds_read_b64_tr_b16 a[10:11], v10 offset:10176
 v_mfma_f32_16x16x32_bf16 v[192:195], a[20:23], a[48:51], v[192:195]
 s_mov_b32 s40, 3440640
 s_add_u32 m0, s38, 114688
 v_mfma_f32_16x16x32_bf16 v[196:199], a[20:23], a[52:55], v[196:199]
 v_mfma_f32_16x16x32_bf16 v[196:199], a[16:19], a[36:39], v[196:199]
 buffer_load_dwordx4 v2, s[12:15], s40 offen offset:0 lds
 v_mfma_f32_16x16x32_bf16 v[200:203], a[16:19], a[40:43], v[200:203]
 ds_read_b64_tr_b16 a[12:13], v10 offset:24768
 ds_read_b64_tr_b16 a[14:15], v10 offset:26560
 v_mfma_f32_16x16x32_bf16 v[200:203], a[20:23], a[56:59], v[200:203]
 v_mfma_f32_16x16x32_bf16 v[204:207], a[20:23], a[60:63], v[204:207]
 v_mfma_f32_16x16x32_bf16 v[204:207], a[16:19], a[44:47], v[204:207]
 s_waitcnt lgkmcnt(8)
 v_mfma_f32_16x16x32_bf16 v[220:223], a[24:27], a[44:47], v[220:223]
 s_waitcnt vmcnt(36)
 s_barrier
 ds_read_b64_tr_b16 a[16:17], v10 offset:32768
 v_mfma_f32_16x16x32_bf16 v[220:223], a[28:31], a[60:63], v[220:223]
 ds_read_b64_tr_b16 a[18:19], v10 offset:34560
 buffer_load_dwordx4 v3, s[12:15], s40 offen offset:1024 lds
 v_mfma_f32_16x16x32_bf16 v[216:219], a[28:31], a[56:59], v[216:219]
 v_mfma_f32_16x16x32_bf16 v[216:219], a[24:27], a[40:43], v[216:219]
 v_mfma_f32_16x16x32_bf16 v[212:215], a[24:27], a[36:39], v[212:215]
 ds_read_b64_tr_b16 a[20:21], v10 offset:49152
 ds_read_b64_tr_b16 a[22:23], v10 offset:50944
 v_mfma_f32_16x16x32_bf16 v[212:215], a[28:31], a[52:55], v[212:215]
 v_mfma_f32_16x16x32_bf16 v[208:211], a[28:31], a[48:51], v[208:211]
 v_mfma_f32_16x16x32_bf16 v[208:211], a[24:27], a[32:35], v[208:211]
 buffer_load_dword a173, v13, s[20:23], 0 offen offset:3328 sc1
 buffer_load_dwordx4 v4, s[12:15], s40 offen offset:2048 lds
 s_waitcnt lgkmcnt(8)
 v_mfma_f32_16x16x32_bf16 v[224:227], a[0:3], a[32:35], v[224:227]
 ds_read_b64_tr_b16 a[24:25], v10 offset:40960
 ds_read_b64_tr_b16 a[26:27], v10 offset:42752
 v_mfma_f32_16x16x32_bf16 v[224:227], a[4:7], a[48:51], v[224:227]
 v_mfma_f32_16x16x32_bf16 v[228:231], a[4:7], a[52:55], v[228:231]
 v_mfma_f32_16x16x32_bf16 v[228:231], a[0:3], a[36:39], v[228:231]
 v_mfma_f32_16x16x32_bf16 v[232:235], a[0:3], a[40:43], v[232:235]
 ds_read_b64_tr_b16 a[28:29], v10 offset:57344
 ds_read_b64_tr_b16 a[30:31], v10 offset:59136
 v_mfma_f32_16x16x32_bf16 v[232:235], a[4:7], a[56:59], v[232:235]
 buffer_load_dwordx4 v5, s[12:15], s40 offen offset:3072 lds
 v_mfma_f32_16x16x32_bf16 v[236:239], a[4:7], a[60:63], v[236:239]
 v_mfma_f32_16x16x32_bf16 v[236:239], a[0:3], a[44:47], v[236:239]
 s_waitcnt lgkmcnt(8)
 v_mfma_f32_16x16x32_bf16 v[252:255], a[8:11], a[44:47], v[252:255]
 ds_read_b64_tr_b16 a[0:1], v10 offset:32800
 ds_read_b64_tr_b16 a[2:3], v10 offset:34592
 v_mfma_f32_16x16x32_bf16 v[252:255], a[12:15], a[60:63], v[252:255]
 v_mfma_f32_16x16x32_bf16 v[248:251], a[12:15], a[56:59], v[248:251]
 v_mfma_f32_16x16x32_bf16 v[248:251], a[8:11], a[40:43], v[248:251]
 buffer_load_dwordx4 a[128:131], v6, s[16:19], s42 offen offset:2048 sc1
 v_mfma_f32_16x16x32_bf16 v[244:247], a[8:11], a[36:39], v[244:247]
 ds_read_b64_tr_b16 a[4:5], v10 offset:49184
 ds_read_b64_tr_b16 a[6:7], v10 offset:50976
 v_mfma_f32_16x16x32_bf16 v[244:247], a[12:15], a[52:55], v[244:247]
 s_barrier
 v_mfma_f32_16x16x32_bf16 v[240:243], a[12:15], a[48:51], v[240:243]
 v_mfma_f32_16x16x32_bf16 v[240:243], a[8:11], a[32:35], v[240:243]
 s_waitcnt vmcnt(36) lgkmcnt(8)
 v_mfma_f32_16x16x32_bf16 v[32:35], a[16:19], a[64:67], v[32:35]
 ds_read_b64_tr_b16 a[8:9], v10 offset:40992
 s_waitcnt vmcnt(31)
 v_mfma_f32_16x16x32_bf16 v[32:35], a[20:23], a[80:83], v[32:35]
 ds_read_b64_tr_b16 a[10:11], v10 offset:42784
 buffer_load_dwordx4 a[132:135], v7, s[16:19], s42 offen offset:2048 sc1
 v_mfma_f32_16x16x32_bf16 v[36:39], a[20:23], a[84:87], v[36:39]
 v_mfma_f32_16x16x32_bf16 v[36:39], a[16:19], a[68:71], v[36:39]
 buffer_load_dword v31, v14, s[96:99], s51 offen
 v_mfma_f32_16x16x32_bf16 v[40:43], a[16:19], a[72:75], v[40:43]
 ds_read_b64_tr_b16 a[12:13], v10 offset:57376
 ds_read_b64_tr_b16 a[14:15], v10 offset:59168
 v_mfma_f32_16x16x32_bf16 v[40:43], a[20:23], a[88:91], v[40:43]
 v_mfma_f32_16x16x32_bf16 v[44:47], a[20:23], a[92:95], v[44:47]
 v_mfma_f32_16x16x32_bf16 v[44:47], a[16:19], a[76:79], v[44:47]
 buffer_load_dwordx4 a[136:139], v8, s[16:19], s42 offen offset:2048 sc1
 s_waitcnt lgkmcnt(8)
 v_mfma_f32_16x16x32_bf16 v[60:63], a[24:27], a[76:79], v[60:63]
 ds_read_b64_tr_b16 a[16:17], v10 offset:32832
 ds_read_b64_tr_b16 a[18:19], v10 offset:34624
 v_mfma_f32_16x16x32_bf16 v[60:63], a[28:31], a[92:95], v[60:63]
 v_mfma_f32_16x16x32_bf16 v[56:59], a[28:31], a[88:91], v[56:59]
 v_mfma_f32_16x16x32_bf16 v[56:59], a[24:27], a[72:75], v[56:59]
 buffer_load_dword a174, v13, s[20:23], 0 offen offset:3584 sc1
 v_mfma_f32_16x16x32_bf16 v[52:55], a[24:27], a[68:71], v[52:55]
 ds_read_b64_tr_b16 a[20:21], v10 offset:49216
 ds_read_b64_tr_b16 a[22:23], v10 offset:51008
 v_mfma_f32_16x16x32_bf16 v[52:55], a[28:31], a[84:87], v[52:55]
 buffer_load_dwordx4 a[140:143], v9, s[16:19], s42 offen offset:2048 sc1
 v_mfma_f32_16x16x32_bf16 v[48:51], a[28:31], a[80:83], v[48:51]
 v_mfma_f32_16x16x32_bf16 v[48:51], a[24:27], a[64:67], v[48:51]
 s_waitcnt lgkmcnt(8)
 v_mfma_f32_16x16x32_bf16 v[64:67], a[0:3], a[64:67], v[64:67]
 ds_read_b64_tr_b16 a[24:25], v10 offset:41024
 ds_read_b64_tr_b16 a[26:27], v10 offset:42816
 v_mfma_f32_16x16x32_bf16 v[64:67], a[4:7], a[80:83], v[64:67]
 v_mfma_f32_16x16x32_bf16 v[68:71], a[4:7], a[84:87], v[68:71]
 v_mfma_f32_16x16x32_bf16 v[68:71], a[0:3], a[68:71], v[68:71]
 buffer_load_dwordx4 a[144:147], v6, s[16:19], s42 offen offset:3072 sc1
 v_mfma_f32_16x16x32_bf16 v[72:75], a[0:3], a[72:75], v[72:75]
 ds_read_b64_tr_b16 a[28:29], v10 offset:57408
 ds_read_b64_tr_b16 a[30:31], v10 offset:59200
 v_mfma_f32_16x16x32_bf16 v[72:75], a[4:7], a[88:91], v[72:75]
 v_mfma_f32_16x16x32_bf16 v[76:79], a[4:7], a[92:95], v[76:79]
 v_mfma_f32_16x16x32_bf16 v[76:79], a[0:3], a[76:79], v[76:79]
 s_waitcnt lgkmcnt(8)
 v_mfma_f32_16x16x32_bf16 v[92:95], a[8:11], a[76:79], v[92:95]
 ds_read_b64_tr_b16 a[0:1], v10 offset:32864
 ds_read_b64_tr_b16 a[2:3], v10 offset:34656
 v_mfma_f32_16x16x32_bf16 v[92:95], a[12:15], a[92:95], v[92:95]
 buffer_load_dwordx4 a[148:151], v7, s[16:19], s42 offen offset:3072 sc1
 v_mfma_f32_16x16x32_bf16 v[88:91], a[12:15], a[88:91], v[88:91]
 v_mfma_f32_16x16x32_bf16 v[88:91], a[8:11], a[72:75], v[88:91]
 v_mfma_f32_16x16x32_bf16 v[84:87], a[8:11], a[68:71], v[84:87]
 ds_read_b64_tr_b16 a[4:5], v10 offset:49248
 ds_read_b64_tr_b16 a[6:7], v10 offset:51040
 v_mfma_f32_16x16x32_bf16 v[84:87], a[12:15], a[84:87], v[84:87]
 v_mfma_f32_16x16x32_bf16 v[80:83], a[12:15], a[80:83], v[80:83]
 v_mfma_f32_16x16x32_bf16 v[80:83], a[8:11], a[64:67], v[80:83]
 buffer_load_dwordx4 a[152:155], v8, s[16:19], s42 offen offset:3072 sc1
 s_waitcnt lgkmcnt(8)
 v_mfma_f32_16x16x32_bf16 v[96:99], a[16:19], a[64:67], v[96:99]
 ds_read_b64_tr_b16 a[8:9], v10 offset:41056
 ds_read_b64_tr_b16 a[10:11], v10 offset:42848
 v_mfma_f32_16x16x32_bf16 v[96:99], a[20:23], a[80:83], v[96:99]
 v_mfma_f32_16x16x32_bf16 v[100:103], a[20:23], a[84:87], v[100:103]
 v_mfma_f32_16x16x32_bf16 v[100:103], a[16:19], a[68:71], v[100:103]
 v_mfma_f32_16x16x32_bf16 v[104:107], a[16:19], a[72:75], v[104:107]
 ds_read_b64_tr_b16 a[12:13], v10 offset:57440
 ds_read_b64_tr_b16 a[14:15], v10 offset:59232
 v_mfma_f32_16x16x32_bf16 v[104:107], a[20:23], a[88:91], v[104:107]
 buffer_load_dwordx4 a[156:159], v9, s[16:19], s42 offen offset:3072 sc1
 v_mfma_f32_16x16x32_bf16 v[108:111], a[20:23], a[92:95], v[108:111]
 v_mfma_f32_16x16x32_bf16 v[108:111], a[16:19], a[76:79], v[108:111]
 buffer_load_dword a175, v13, s[20:23], 0 offen offset:3840 sc1
 s_waitcnt lgkmcnt(8)
 v_mfma_f32_16x16x32_bf16 v[124:127], a[24:27], a[76:79], v[124:127]
 ds_read_b64_tr_b16 a[16:17], v10 offset:32896
 ds_read_b64_tr_b16 a[18:19], v10 offset:34688
 v_mfma_f32_16x16x32_bf16 v[124:127], a[28:31], a[92:95], v[124:127]
 s_mov_b32 s40, 3670016
 s_add_u32 m0, s38, 0
 v_mfma_f32_16x16x32_bf16 v[120:123], a[28:31], a[88:91], v[120:123]
 v_mfma_f32_16x16x32_bf16 v[120:123], a[24:27], a[72:75], v[120:123]
 buffer_load_dwordx4 v2, s[12:15], s40 offen offset:0 lds
 v_mfma_f32_16x16x32_bf16 v[116:119], a[24:27], a[68:71], v[116:119]
 ds_read_b64_tr_b16 a[20:21], v10 offset:49280
 ds_read_b64_tr_b16 a[22:23], v10 offset:51072
 v_mfma_f32_16x16x32_bf16 v[116:119], a[28:31], a[84:87], v[116:119]
 v_mfma_f32_16x16x32_bf16 v[112:115], a[28:31], a[80:83], v[112:115]
 v_mfma_f32_16x16x32_bf16 v[112:115], a[24:27], a[64:67], v[112:115]
 s_waitcnt lgkmcnt(8)
 v_mfma_f32_16x16x32_bf16 v[128:131], a[0:3], a[64:67], v[128:131]
 ds_read_b64_tr_b16 a[24:25], v10 offset:41088
 ds_read_b64_tr_b16 a[26:27], v10 offset:42880
 v_mfma_f32_16x16x32_bf16 v[128:131], a[4:7], a[80:83], v[128:131]
 buffer_load_dwordx4 v3, s[12:15], s40 offen offset:1024 lds
 v_mfma_f32_16x16x32_bf16 v[132:135], a[4:7], a[84:87], v[132:135]
 v_mfma_f32_16x16x32_bf16 v[132:135], a[0:3], a[68:71], v[132:135]
 v_mfma_f32_16x16x32_bf16 v[136:139], a[0:3], a[72:75], v[136:139]
 ds_read_b64_tr_b16 a[28:29], v10 offset:57472
 ds_read_b64_tr_b16 a[30:31], v10 offset:59264
 v_mfma_f32_16x16x32_bf16 v[136:139], a[4:7], a[88:91], v[136:139]
 v_mfma_f32_16x16x32_bf16 v[140:143], a[4:7], a[92:95], v[140:143]
 v_mfma_f32_16x16x32_bf16 v[140:143], a[0:3], a[76:79], v[140:143]
 buffer_load_dwordx4 v4, s[12:15], s40 offen offset:2048 lds
 s_waitcnt lgkmcnt(8)
 v_mfma_f32_16x16x32_bf16 v[156:159], a[8:11], a[76:79], v[156:159]
 ds_read_b64_tr_b16 a[0:1], v10 offset:32928
 ds_read_b64_tr_b16 a[2:3], v10 offset:34720
 v_mfma_f32_16x16x32_bf16 v[156:159], a[12:15], a[92:95], v[156:159]
 v_mfma_f32_16x16x32_bf16 v[152:155], a[12:15], a[88:91], v[152:155]
 v_mfma_f32_16x16x32_bf16 v[152:155], a[8:11], a[72:75], v[152:155]
 v_mfma_f32_16x16x32_bf16 v[148:151], a[8:11], a[68:71], v[148:151]
 ds_read_b64_tr_b16 a[4:5], v10 offset:49312
 ds_read_b64_tr_b16 a[6:7], v10 offset:51104
 v_mfma_f32_16x16x32_bf16 v[148:151], a[12:15], a[84:87], v[148:151]
 buffer_load_dwordx4 v5, s[12:15], s40 offen offset:3072 lds
 v_mfma_f32_16x16x32_bf16 v[144:147], a[12:15], a[80:83], v[144:147]
 v_mfma_f32_16x16x32_bf16 v[144:147], a[8:11], a[64:67], v[144:147]
 s_waitcnt lgkmcnt(8)
 v_mfma_f32_16x16x32_bf16 v[160:163], a[16:19], a[64:67], v[160:163]
 ds_read_b64_tr_b16 a[8:9], v10 offset:41120
 ds_read_b64_tr_b16 a[10:11], v10 offset:42912
 v_mfma_f32_16x16x32_bf16 v[160:163], a[20:23], a[80:83], v[160:163]
 s_mov_b32 s40, 3899392
 s_add_u32 m0, s38, 16384
 v_mfma_f32_16x16x32_bf16 v[164:167], a[20:23], a[84:87], v[164:167]
 v_mfma_f32_16x16x32_bf16 v[164:167], a[16:19], a[68:71], v[164:167]
 buffer_load_dwordx4 v2, s[12:15], s40 offen offset:0 lds
 v_mfma_f32_16x16x32_bf16 v[168:171], a[16:19], a[72:75], v[168:171]
 ds_read_b64_tr_b16 a[12:13], v10 offset:57504
 ds_read_b64_tr_b16 a[14:15], v10 offset:59296
 v_mfma_f32_16x16x32_bf16 v[168:171], a[20:23], a[88:91], v[168:171]
 v_mfma_f32_16x16x32_bf16 v[172:175], a[20:23], a[92:95], v[172:175]
 v_mfma_f32_16x16x32_bf16 v[172:175], a[16:19], a[76:79], v[172:175]
 s_waitcnt lgkmcnt(8)
 v_mfma_f32_16x16x32_bf16 v[188:191], a[24:27], a[76:79], v[188:191]
 ds_read_b64_tr_b16 a[16:17], v10 offset:32960
 ds_read_b64_tr_b16 a[18:19], v10 offset:34752
 v_mfma_f32_16x16x32_bf16 v[188:191], a[28:31], a[92:95], v[188:191]
 buffer_load_dwordx4 v3, s[12:15], s40 offen offset:1024 lds
 v_mfma_f32_16x16x32_bf16 v[184:187], a[28:31], a[88:91], v[184:187]
 v_mfma_f32_16x16x32_bf16 v[184:187], a[24:27], a[72:75], v[184:187]
 v_mfma_f32_16x16x32_bf16 v[180:183], a[24:27], a[68:71], v[180:183]
 ds_read_b64_tr_b16 a[20:21], v10 offset:49344
 ds_read_b64_tr_b16 a[22:23], v10 offset:51136
 v_mfma_f32_16x16x32_bf16 v[180:183], a[28:31], a[84:87], v[180:183]
 v_mfma_f32_16x16x32_bf16 v[176:179], a[28:31], a[80:83], v[176:179]
 v_mfma_f32_16x16x32_bf16 v[176:179], a[24:27], a[64:67], v[176:179]
 buffer_load_dwordx4 v4, s[12:15], s40 offen offset:2048 lds
 s_waitcnt lgkmcnt(8)
 v_mfma_f32_16x16x32_bf16 v[192:195], a[0:3], a[64:67], v[192:195]
 ds_read_b64_tr_b16 a[24:25], v10 offset:41152
 ds_read_b64_tr_b16 a[26:27], v10 offset:42944
 v_mfma_f32_16x16x32_bf16 v[192:195], a[4:7], a[80:83], v[192:195]
 v_mfma_f32_16x16x32_bf16 v[196:199], a[4:7], a[84:87], v[196:199]
 v_mfma_f32_16x16x32_bf16 v[196:199], a[0:3], a[68:71], v[196:199]
 v_mfma_f32_16x16x32_bf16 v[200:203], a[0:3], a[72:75], v[200:203]
 ds_read_b64_tr_b16 a[28:29], v10 offset:57536
 ds_read_b64_tr_b16 a[30:31], v10 offset:59328
 v_mfma_f32_16x16x32_bf16 v[200:203], a[4:7], a[88:91], v[200:203]
 buffer_load_dwordx4 v5, s[12:15], s40 offen offset:3072 lds
 v_mfma_f32_16x16x32_bf16 v[204:207], a[4:7], a[92:95], v[204:207]
 v_mfma_f32_16x16x32_bf16 v[204:207], a[0:3], a[76:79], v[204:207]
 s_waitcnt lgkmcnt(8)
 v_mfma_f32_16x16x32_bf16 v[220:223], a[8:11], a[76:79], v[220:223]
 s_waitcnt vmcnt(39)
 s_barrier
 ds_read_b64_tr_b16 a[0:1], v11 offset:0
 v_mfma_f32_16x16x32_bf16 v[220:223], a[12:15], a[92:95], v[220:223]
 ds_read_b64_tr_b16 a[2:3], v11 offset:1792
 s_mov_b32 s42, 16384
 v_mfma_f32_16x16x32_bf16 v[216:219], a[12:15], a[88:91], v[216:219]
 v_mfma_f32_16x16x32_bf16 v[216:219], a[8:11], a[72:75], v[216:219]
 buffer_load_dwordx4 a[32:35], v6, s[16:19], s42 offen offset:0 sc1
 v_mfma_f32_16x16x32_bf16 v[212:215], a[8:11], a[68:71], v[212:215]
 ds_read_b64_tr_b16 a[4:5], v11 offset:16384
 ds_read_b64_tr_b16 a[6:7], v11 offset:18176
 v_mfma_f32_16x16x32_bf16 v[212:215], a[12:15], a[84:87], v[212:215]
 v_mfma_f32_16x16x32_bf16 v[208:211], a[12:15], a[80:83], v[208:211]
 v_mfma_f32_16x16x32_bf16 v[208:211], a[8:11], a[64:67], v[208:211]
 s_waitcnt lgkmcnt(8)
 v_mfma_f32_16x16x32_bf16 v[224:227], a[16:19], a[64:67], v[224:227]
 ds_read_b64_tr_b16 a[8:9], v11 offset:8192
 ds_read_b64_tr_b16 a[10:11], v11 offset:9984
 v_mfma_f32_16x16x32_bf16 v[224:227], a[20:23], a[80:83], v[224:227]
 buffer_load_dwordx4 a[36:39], v7, s[16:19], s42 offen offset:0 sc1
 v_mfma_f32_16x16x32_bf16 v[228:231], a[20:23], a[84:87], v[228:231]
 v_mfma_f32_16x16x32_bf16 v[228:231], a[16:19], a[68:71], v[228:231]
 v_mfma_f32_16x16x32_bf16 v[232:235], a[16:19], a[72:75], v[232:235]
 ds_read_b64_tr_b16 a[12:13], v11 offset:24576
 ds_read_b64_tr_b16 a[14:15], v11 offset:26368
 v_mfma_f32_16x16x32_bf16 v[232:235], a[20:23], a[88:91], v[232:235]
 v_mfma_f32_16x16x32_bf16 v[236:239], a[20:23], a[92:95], v[236:239]
 v_mfma_f32_16x16x32_bf16 v[236:239], a[16:19], a[76:79], v[236:239]
 buffer_load_dwordx4 a[40:43], v8, s[16:19], s42 offen offset:0 sc1
 s_waitcnt lgkmcnt(8)
 v_mfma_f32_16x16x32_bf16 v[252:255], a[24:27], a[76:79], v[252:255]
 ds_read_b64_tr_b16 a[16:17], v11 offset:32
 ds_read_b64_tr_b16 a[18:19], v11 offset:1824
 v_mfma_f32_16x16x32_bf16 v[252:255], a[28:31], a[92:95], v[252:255]
 v_mfma_f32_16x16x32_bf16 v[248:251], a[28:31], a[88:91], v[248:251]
 v_mfma_f32_16x16x32_bf16 v[248:251], a[24:27], a[72:75], v[248:251]
 v_mfma_f32_16x16x32_bf16 v[244:247], a[24:27], a[68:71], v[244:247]
 ds_read_b64_tr_b16 a[20:21], v11 offset:16416
 ds_read_b64_tr_b16 a[22:23], v11 offset:18208
 v_mfma_f32_16x16x32_bf16 v[244:247], a[28:31], a[84:87], v[244:247]
 s_barrier
 buffer_load_dwordx4 a[44:47], v9, s[16:19], s42 offen offset:0 sc1
 v_mfma_f32_16x16x32_bf16 v[240:243], a[28:31], a[80:83], v[240:243]
 v_mfma_f32_16x16x32_bf16 v[240:243], a[24:27], a[64:67], v[240:243]
 s_waitcnt vmcnt(38) lgkmcnt(8)
 v_mfma_f32_16x16x32_bf16 v[32:35], a[0:3], a[96:99], v[32:35]
 ds_read_b64_tr_b16 a[24:25], v11 offset:8224
 s_waitcnt vmcnt(33)
 v_mfma_f32_16x16x32_bf16 v[32:35], a[4:7], a[112:115], v[32:35]
 ds_read_b64_tr_b16 a[26:27], v11 offset:10016
 v_mfma_f32_16x16x32_bf16 v[36:39], a[4:7], a[116:119], v[36:39]
 v_mfma_f32_16x16x32_bf16 v[36:39], a[0:3], a[100:103], v[36:39]
 buffer_load_dwordx4 a[48:51], v6, s[16:19], s42 offen offset:1024 sc1
 v_mfma_f32_16x16x32_bf16 v[40:43], a[0:3], a[104:107], v[40:43]
 ds_read_b64_tr_b16 a[28:29], v11 offset:24608
 ds_read_b64_tr_b16 a[30:31], v11 offset:26400
 v_mfma_f32_16x16x32_bf16 v[40:43], a[4:7], a[120:123], v[40:43]
 s_branch m_ps_p3_2
m_pad_p3_2:
 s_branch m_reta_p3
m_ps_p3_2:
 v_mfma_f32_16x16x32_bf16 v[44:47], a[4:7], a[124:127], v[44:47]
 v_mfma_f32_16x16x32_bf16 v[44:47], a[0:3], a[108:111], v[44:47]
 s_waitcnt lgkmcnt(8)
 v_mfma_f32_16x16x32_bf16 v[60:63], a[8:11], a[108:111], v[60:63]
 ds_read_b64_tr_b16 a[0:1], v11 offset:64
 ds_read_b64_tr_b16 a[2:3], v11 offset:1856
 v_mfma_f32_16x16x32_bf16 v[60:63], a[12:15], a[124:127], v[60:63]
 buffer_load_dwordx4 a[52:55], v7, s[16:19], s42 offen offset:1024 sc1
 v_mfma_f32_16x16x32_bf16 v[56:59], a[12:15], a[120:123], v[56:59]
 v_mfma_f32_16x16x32_bf16 v[56:59], a[8:11], a[104:107], v[56:59]
 v_mfma_f32_16x16x32_bf16 v[52:55], a[8:11], a[100:103], v[52:55]
 ds_read_b64_tr_b16 a[4:5], v11 offset:16448
 ds_read_b64_tr_b16 a[6:7], v11 offset:18240
 v_mfma_f32_16x16x32_bf16 v[52:55], a[12:15], a[116:119], v[52:55]
 v_mfma_f32_16x16x32_bf16 v[48:51], a[12:15], a[112:115], v[48:51]
 v_mfma_f32_16x16x32_bf16 v[48:51], a[8:11], a[96:99], v[48:51]
 buffer_load_dwordx4 a[56:59], v8, s[16:19], s42 offen offset:1024 sc1
 s_waitcnt lgkmcnt(8)
 v_mfma_f32_16x16x32_bf16 v[64:67], a[16:19], a[96:99], v[64:67]
 ds_read_b64_tr_b16 a[8:9], v11 offset:8256
 ds_read_b64_tr_b16 a[10:11], v11 offset:10048
 v_mfma_f32_16x16x32_bf16 v[64:67], a[20:23], a[112:115], v[64:67]
 v_mfma_f32_16x16x32_bf16 v[68:71], a[20:23], a[116:119], v[68:71]
 v_mfma_f32_16x16x32_bf16 v[68:71], a[16:19], a[100:103], v[68:71]
 v_mfma_f32_16x16x32_bf16 v[72:75], a[16:19], a[104:107], v[72:75]
 ds_read_b64_tr_b16 a[12:13], v11 offset:24640
 ds_read_b64_tr_b16 a[14:15], v11 offset:26432
 s_waitcnt vmcnt(15)
 v_mfma_f32_16x16x32_bf16 v[72:75], a[20:23], a[120:123], v[72:75]
 buffer_load_dwordx4 a[60:63], v9, s[16:19], s42 offen offset:1024 sc1
 v_accvgpr_read_b32 v16, a160
 v_mfma_f32_16x16x32_bf16 v[76:79], a[20:23], a[124:127], v[76:79]
 v_accvgpr_read_b32 v17, a161
 v_accvgpr_read_b32 v24, a162
 v_mfma_f32_16x16x32_bf16 v[76:79], a[16:19], a[108:111], v[76:79]
 v_accvgpr_read_b32 v25, a163
 s_waitcnt lgkmcnt(8)
 v_mfma_f32_16x16x32_bf16 v[92:95], a[24:27], a[108:111], v[92:95]
 ds_read_b64_tr_b16 a[16:17], v11 offset:96
 ds_read_b64_tr_b16 a[18:19], v11 offset:1888
 v_mfma_f32_16x16x32_bf16 v[92:95], a[28:31], a[124:127], v[92:95]
 s_mov_b32 s40, 4128768
 s_add_u32 m0, s38, 32768
 v_mfma_f32_16x16x32_bf16 v[88:91], a[28:31], a[120:123], v[88:91]
 v_add_f32 v16, v16, v17
 v_add_f32 v24, v24, v25
 v_mfma_f32_16x16x32_bf16 v[88:91], a[24:27], a[104:107], v[88:91]
 buffer_load_dwordx4 v2, s[12:15], s40 offen offset:0 lds
 v_add_f32 v16, v16, v24
 v_mfma_f32_16x16x32_bf16 v[84:87], a[24:27], a[100:103], v[84:87]
 ds_read_b64_tr_b16 a[20:21], v11 offset:16480
 ds_read_b64_tr_b16 a[22:23], v11 offset:18272
 v_mfma_f32_16x16x32_bf16 v[84:87], a[28:31], a[116:119], v[84:87]
 v_mov_b32 v17, v16
 v_mfma_f32_16x16x32_bf16 v[80:83], a[28:31], a[112:115], v[80:83]
 s_nop 1
 v_permlane16_swap_b32 v16, v17
 v_mfma_f32_16x16x32_bf16 v[80:83], a[24:27], a[96:99], v[80:83]
 v_add_f32 v16, v16, v17
 s_waitcnt lgkmcnt(8)
 v_mfma_f32_16x16x32_bf16 v[96:99], a[0:3], a[96:99], v[96:99]
 ds_read_b64_tr_b16 a[24:25], v11 offset:8288
 ds_read_b64_tr_b16 a[26:27], v11 offset:10080
 v_mfma_f32_16x16x32_bf16 v[96:99], a[4:7], a[112:115], v[96:99]
 buffer_load_dwordx4 v3, s[12:15], s40 offen offset:1024 lds
 v_mov_b32 v17, v16
 v_mfma_f32_16x16x32_bf16 v[100:103], a[4:7], a[116:119], v[100:103]
 s_nop 1
 v_mfma_f32_16x16x32_bf16 v[100:103], a[0:3], a[100:103], v[100:103]
 v_permlane32_swap_b32 v16, v17
 v_add_f32 v16, v16, v17
 v_mfma_f32_16x16x32_bf16 v[104:107], a[0:3], a[104:107], v[104:107]
 ds_read_b64_tr_b16 a[28:29], v11 offset:24672
 ds_read_b64_tr_b16 a[30:31], v11 offset:26464
 v_mfma_f32_16x16x32_bf16 v[104:107], a[4:7], a[120:123], v[104:107]
 v_mov_b32 v17, 0x3727c5ac
 v_fmac_f32 v17, 0x3a800000, v16
 v_mfma_f32_16x16x32_bf16 v[108:111], a[4:7], a[124:127], v[108:111]
 v_rsq_f32 v16, v17
 v_mfma_f32_16x16x32_bf16 v[108:111], a[0:3], a[108:111], v[108:111]
 buffer_load_dwordx4 v4, s[12:15], s40 offen offset:2048 lds
 s_waitcnt lgkmcnt(8)
 v_mfma_f32_16x16x32_bf16 v[124:127], a[8:11], a[108:111], v[124:127]
 ds_read_b64_tr_b16 a[0:1], v11 offset:128
 ds_read_b64_tr_b16 a[2:3], v11 offset:1920
 v_mfma_f32_16x16x32_bf16 v[124:127], a[12:15], a[124:127], v[124:127]
 v_sqrt_f32 v17, v17
 v_mfma_f32_16x16x32_bf16 v[120:123], a[12:15], a[120:123], v[120:123]
 v_mul_f32 v16, 0xbfb8aa3b, v16
 v_accvgpr_read_b32 v18, a164
 v_mfma_f32_16x16x32_bf16 v[120:123], a[8:11], a[104:107], v[120:123]
 v_accvgpr_read_b32 v19, a165
 v_accvgpr_read_b32 v24, a166
 v_mfma_f32_16x16x32_bf16 v[116:119], a[8:11], a[100:103], v[116:119]
 ds_read_b64_tr_b16 a[4:5], v11 offset:16512
 ds_read_b64_tr_b16 a[6:7], v11 offset:18304
 v_mfma_f32_16x16x32_bf16 v[116:119], a[12:15], a[116:119], v[116:119]
 buffer_load_dwordx4 v5, s[12:15], s40 offen offset:3072 lds
 v_accvgpr_read_b32 v25, a167
 v_mfma_f32_16x16x32_bf16 v[112:115], a[12:15], a[112:115], v[112:115]
 v_add_f32 v18, v18, v19
 v_add_f32 v24, v24, v25
 v_mfma_f32_16x16x32_bf16 v[112:115], a[8:11], a[96:99], v[112:115]
 v_add_f32 v18, v18, v24
 s_waitcnt lgkmcnt(8)
 v_mfma_f32_16x16x32_bf16 v[128:131], a[16:19], a[96:99], v[128:131]
 ds_read_b64_tr_b16 a[8:9], v11 offset:8320
 ds_read_b64_tr_b16 a[10:11], v11 offset:10112
 v_mfma_f32_16x16x32_bf16 v[128:131], a[20:23], a[112:115], v[128:131]
 s_mov_b32 s40, 4358144
 s_add_u32 m0, s38, 49152
 v_mfma_f32_16x16x32_bf16 v[132:135], a[20:23], a[116:119], v[132:135]
 v_mov_b32 v19, v18
 v_mfma_f32_16x16x32_bf16 v[132:135], a[16:19], a[100:103], v[132:135]
 buffer_load_dwordx4 v2, s[12:15], s40 offen offset:0 lds
 s_nop 1
 v_mfma_f32_16x16x32_bf16 v[136:139], a[16:19], a[104:107], v[136:139]
 ds_read_b64_tr_b16 a[12:13], v11 offset:24704
 ds_read_b64_tr_b16 a[14:15], v11 offset:26496
 v_mfma_f32_16x16x32_bf16 v[136:139], a[20:23], a[120:123], v[136:139]
 v_permlane16_swap_b32 v18, v19
 v_add_f32 v18, v18, v19
 v_mfma_f32_16x16x32_bf16 v[140:143], a[20:23], a[124:127], v[140:143]
 v_mov_b32 v19, v18
 v_mfma_f32_16x16x32_bf16 v[140:143], a[16:19], a[108:111], v[140:143]
 s_nop 1
 s_waitcnt lgkmcnt(8)
 v_mfma_f32_16x16x32_bf16 v[156:159], a[24:27], a[108:111], v[156:159]
 ds_read_b64_tr_b16 a[16:17], v11 offset:160
 ds_read_b64_tr_b16 a[18:19], v11 offset:1952
 v_mfma_f32_16x16x32_bf16 v[156:159], a[28:31], a[124:127], v[156:159]
 buffer_load_dwordx4 v3, s[12:15], s40 offen offset:1024 lds
 v_permlane32_swap_b32 v18, v19
 v_mfma_f32_16x16x32_bf16 v[152:155], a[28:31], a[120:123], v[152:155]
 v_add_f32 v18, v18, v19
 v_mov_b32 v19, 0x3727c5ac
 v_mfma_f32_16x16x32_bf16 v[152:155], a[24:27], a[104:107], v[152:155]
 v_fmac_f32 v19, 0x3a800000, v18
 v_mfma_f32_16x16x32_bf16 v[148:151], a[24:27], a[100:103], v[148:151]
 ds_read_b64_tr_b16 a[20:21], v11 offset:16544
 ds_read_b64_tr_b16 a[22:23], v11 offset:18336
 v_mfma_f32_16x16x32_bf16 v[148:151], a[28:31], a[116:119], v[148:151]
 v_rsq_f32 v18, v19
 v_mfma_f32_16x16x32_bf16 v[144:147], a[28:31], a[112:115], v[144:147]
 v_sqrt_f32 v19, v19
 v_mul_f32 v18, 0xbfb8aa3b, v18
 v_mfma_f32_16x16x32_bf16 v[144:147], a[24:27], a[96:99], v[144:147]
 buffer_load_dwordx4 v4, s[12:15], s40 offen offset:2048 lds
 s_waitcnt lgkmcnt(8)
 v_mfma_f32_16x16x32_bf16 v[160:163], a[0:3], a[96:99], v[160:163]
 ds_read_b64_tr_b16 a[24:25], v11 offset:8352
 ds_read_b64_tr_b16 a[26:27], v11 offset:10144
 v_mfma_f32_16x16x32_bf16 v[160:163], a[4:7], a[112:115], v[160:163]
 v_accvgpr_read_b32 v20, a168
 v_accvgpr_read_b32 v21, a169
 v_mfma_f32_16x16x32_bf16 v[164:167], a[4:7], a[116:119], v[164:167]
 v_accvgpr_read_b32 v24, a170
 v_accvgpr_read_b32 v25, a171
 v_mfma_f32_16x16x32_bf16 v[164:167], a[0:3], a[100:103], v[164:167]
 v_add_f32 v20, v20, v21
 v_add_f32 v24, v24, v25
 v_mfma_f32_16x16x32_bf16 v[168:171], a[0:3], a[104:107], v[168:171]
 ds_read_b64_tr_b16 a[28:29], v11 offset:24736
 ds_read_b64_tr_b16 a[30:31], v11 offset:26528
 v_mfma_f32_16x16x32_bf16 v[168:171], a[4:7], a[120:123], v[168:171]
 buffer_load_dwordx4 v5, s[12:15], s40 offen offset:3072 lds
 v_add_f32 v20, v20, v24
 v_mfma_f32_16x16x32_bf16 v[172:175], a[4:7], a[124:127], v[172:175]
 v_mov_b32 v21, v20
 v_mfma_f32_16x16x32_bf16 v[172:175], a[0:3], a[108:111], v[172:175]
 s_nop 1
 s_waitcnt lgkmcnt(8)
 v_mfma_f32_16x16x32_bf16 v[188:191], a[8:11], a[108:111], v[188:191]
 ds_read_b64_tr_b16 a[0:1], v11 offset:192
 ds_read_b64_tr_b16 a[2:3], v11 offset:1984
 v_mfma_f32_16x16x32_bf16 v[188:191], a[12:15], a[124:127], v[188:191]
 v_permlane16_swap_b32 v20, v21
 v_add_f32 v20, v20, v21
 v_mfma_f32_16x16x32_bf16 v[184:187], a[12:15], a[120:123], v[184:187]
 v_mov_b32 v21, v20
 v_mfma_f32_16x16x32_bf16 v[184:187], a[8:11], a[104:107], v[184:187]
 buffer_load_dwordx4 a[64:67], v6, s[16:19], s42 offen offset:2048 sc1
 s_nop 1
 v_mfma_f32_16x16x32_bf16 v[180:183], a[8:11], a[100:103], v[180:183]
 ds_read_b64_tr_b16 a[4:5], v11 offset:16576
 ds_read_b64_tr_b16 a[6:7], v11 offset:18368
 v_mfma_f32_16x16x32_bf16 v[180:183], a[12:15], a[116:119], v[180:183]
 v_permlane32_swap_b32 v20, v21
 v_add_f32 v20, v20, v21
 v_mfma_f32_16x16x32_bf16 v[176:179], a[12:15], a[112:115], v[176:179]
 v_mov_b32 v21, 0x3727c5ac
 v_fmac_f32 v21, 0x3a800000, v20
 v_mfma_f32_16x16x32_bf16 v[176:179], a[8:11], a[96:99], v[176:179]
 s_waitcnt lgkmcnt(8)
 v_mfma_f32_16x16x32_bf16 v[192:195], a[16:19], a[96:99], v[192:195]
 ds_read_b64_tr_b16 a[8:9], v11 offset:8384
 ds_read_b64_tr_b16 a[10:11], v11 offset:10176
 v_mfma_f32_16x16x32_bf16 v[192:195], a[20:23], a[112:115], v[192:195]
 buffer_load_dwordx4 a[68:71], v7, s[16:19], s42 offen offset:2048 sc1
 v_rsq_f32 v20, v21
 v_mfma_f32_16x16x32_bf16 v[196:199], a[20:23], a[116:119], v[196:199]
 v_sqrt_f32 v21, v21
 v_mfma_f32_16x16x32_bf16 v[196:199], a[16:19], a[100:103], v[196:199]
 v_mul_f32 v20, 0xbfb8aa3b, v20
 v_accvgpr_read_b32 v22, a172
 v_mfma_f32_16x16x32_bf16 v[200:203], a[16:19], a[104:107], v[200:203]
 ds_read_b64_tr_b16 a[12:13], v11 offset:24768
 ds_read_b64_tr_b16 a[14:15], v11 offset:26560
 v_mfma_f32_16x16x32_bf16 v[200:203], a[20:23], a[120:123], v[200:203]
 v_accvgpr_read_b32 v23, a173
 v_accvgpr_read_b32 v24, a174
 v_mfma_f32_16x16x32_bf16 v[204:207], a[20:23], a[124:127], v[204:207]
 v_accvgpr_read_b32 v25, a175
 v_add_f32 v22, v22, v23
 v_mfma_f32_16x16x32_bf16 v[204:207], a[16:19], a[108:111], v[204:207]
 buffer_load_dwordx4 a[72:75], v8, s[16:19], s42 offen offset:2048 sc1
 s_waitcnt lgkmcnt(8)
 v_mfma_f32_16x16x32_bf16 v[220:223], a[24:27], a[108:111], v[220:223]
 s_barrier
 ds_read_b64_tr_b16 a[16:17], v11 offset:32768
 v_mfma_f32_16x16x32_bf16 v[220:223], a[28:31], a[124:127], v[220:223]
 ds_read_b64_tr_b16 a[18:19], v11 offset:34560
 v_mfma_f32_16x16x32_bf16 v[216:219], a[28:31], a[120:123], v[216:219]
 v_add_f32 v24, v24, v25
 v_add_f32 v22, v22, v24
 v_mfma_f32_16x16x32_bf16 v[216:219], a[24:27], a[104:107], v[216:219]
 v_mov_b32 v23, v22
 v_mfma_f32_16x16x32_bf16 v[212:215], a[24:27], a[100:103], v[212:215]
 ds_read_b64_tr_b16 a[20:21], v11 offset:49152
 ds_read_b64_tr_b16 a[22:23], v11 offset:50944
 v_mfma_f32_16x16x32_bf16 v[212:215], a[28:31], a[116:119], v[212:215]
 buffer_load_dwordx4 a[76:79], v9, s[16:19], s42 offen offset:2048 sc1
 s_nop 1
 v_mfma_f32_16x16x32_bf16 v[208:211], a[28:31], a[112:115], v[208:211]
 v_permlane16_swap_b32 v22, v23
 v_add_f32 v22, v22, v23
 v_mfma_f32_16x16x32_bf16 v[208:211], a[24:27], a[96:99], v[208:211]
 v_mov_b32 v23, v22
 s_waitcnt lgkmcnt(8)
 v_mfma_f32_16x16x32_bf16 v[224:227], a[0:3], a[96:99], v[224:227]
 ds_read_b64_tr_b16 a[24:25], v11 offset:40960
 ds_read_b64_tr_b16 a[26:27], v11 offset:42752
 v_mfma_f32_16x16x32_bf16 v[224:227], a[4:7], a[112:115], v[224:227]
 s_nop 1
 v_mfma_f32_16x16x32_bf16 v[228:231], a[4:7], a[116:119], v[228:231]
 v_permlane32_swap_b32 v22, v23
 v_add_f32 v22, v22, v23
 v_mfma_f32_16x16x32_bf16 v[228:231], a[0:3], a[100:103], v[228:231]
 buffer_load_dwordx4 a[80:83], v6, s[16:19], s42 offen offset:3072 sc1
 v_mov_b32 v23, 0x3727c5ac
 v_mfma_f32_16x16x32_bf16 v[232:235], a[0:3], a[104:107], v[232:235]
 ds_read_b64_tr_b16 a[28:29], v11 offset:57344
 ds_read_b64_tr_b16 a[30:31], v11 offset:59136
 v_mfma_f32_16x16x32_bf16 v[232:235], a[4:7], a[120:123], v[232:235]
 v_fmac_f32 v23, 0x3a800000, v22
 v_mfma_f32_16x16x32_bf16 v[236:239], a[4:7], a[124:127], v[236:239]
 v_rsq_f32 v22, v23
 v_mfma_f32_16x16x32_bf16 v[236:239], a[0:3], a[108:111], v[236:239]
 v_sqrt_f32 v23, v23
 s_waitcnt lgkmcnt(8)
 v_mfma_f32_16x16x32_bf16 v[252:255], a[8:11], a[108:111], v[252:255]
 ds_read_b64_tr_b16 a[0:1], v11 offset:32800
 ds_read_b64_tr_b16 a[2:3], v11 offset:34592
 v_mfma_f32_16x16x32_bf16 v[252:255], a[12:15], a[124:127], v[252:255]
 buffer_load_dwordx4 a[84:87], v7, s[16:19], s42 offen offset:3072 sc1
 v_mul_f32 v22, 0xbfb8aa3b, v22
 v_mfma_f32_16x16x32_bf16 v[248:251], a[12:15], a[120:123], v[248:251]
 v_mfma_f32_16x16x32_bf16 v[248:251], a[8:11], a[104:107], v[248:251]
 v_mfma_f32_16x16x32_bf16 v[244:247], a[8:11], a[100:103], v[244:247]
 ds_read_b64_tr_b16 a[4:5], v11 offset:49184
 ds_read_b64_tr_b16 a[6:7], v11 offset:50976
 v_mfma_f32_16x16x32_bf16 v[244:247], a[12:15], a[116:119], v[244:247]
 s_barrier
 v_mfma_f32_16x16x32_bf16 v[240:243], a[12:15], a[112:115], v[240:243]
 v_mfma_f32_16x16x32_bf16 v[240:243], a[8:11], a[96:99], v[240:243]
 buffer_load_dwordx4 a[88:91], v8, s[16:19], s42 offen offset:3072 sc1
 s_waitcnt lgkmcnt(8)
 v_mfma_f32_16x16x32_bf16 v[32:35], a[16:19], a[128:131], v[32:35]
 ds_read_b64_tr_b16 a[8:9], v11 offset:40992
 v_mfma_f32_16x16x32_bf16 v[32:35], a[20:23], a[144:147], v[32:35]
 ds_read_b64_tr_b16 a[10:11], v11 offset:42784
 v_mfma_f32_16x16x32_bf16 v[36:39], a[20:23], a[148:151], v[36:39]
 v_mfma_f32_16x16x32_bf16 v[36:39], a[16:19], a[132:135], v[36:39]
 v_mfma_f32_16x16x32_bf16 v[40:43], a[16:19], a[136:139], v[40:43]
 ds_read_b64_tr_b16 a[12:13], v11 offset:57376
 ds_read_b64_tr_b16 a[14:15], v11 offset:59168
 v_mfma_f32_16x16x32_bf16 v[40:43], a[20:23], a[152:155], v[40:43]
 buffer_load_dwordx4 a[92:95], v9, s[16:19], s42 offen offset:3072 sc1
 v_mfma_f32_16x16x32_bf16 v[44:47], a[20:23], a[156:159], v[44:47]
 v_mfma_f32_16x16x32_bf16 v[44:47], a[16:19], a[140:143], v[44:47]
 s_waitcnt lgkmcnt(8)
 v_mfma_f32_16x16x32_bf16 v[60:63], a[24:27], a[140:143], v[60:63]
 ds_read_b64_tr_b16 a[16:17], v11 offset:32832
 ds_read_b64_tr_b16 a[18:19], v11 offset:34624
 v_mfma_f32_16x16x32_bf16 v[60:63], a[28:31], a[156:159], v[60:63]
 s_mov_b32 s40, 4587520
 s_add_u32 m0, s38, 65536
 v_mfma_f32_16x16x32_bf16 v[56:59], a[28:31], a[152:155], v[56:59]
 v_mfma_f32_16x16x32_bf16 v[56:59], a[24:27], a[136:139], v[56:59]
 buffer_load_dwordx4 v2, s[12:15], s40 offen offset:0 lds
 v_mfma_f32_16x16x32_bf16 v[52:55], a[24:27], a[132:135], v[52:55]
 ds_read_b64_tr_b16 a[20:21], v11 offset:49216
 ds_read_b64_tr_b16 a[22:23], v11 offset:51008
 v_mfma_f32_16x16x32_bf16 v[52:55], a[28:31], a[148:151], v[52:55]
 v_mfma_f32_16x16x32_bf16 v[48:51], a[28:31], a[144:147], v[48:51]
 v_mfma_f32_16x16x32_bf16 v[48:51], a[24:27], a[128:131], v[48:51]
 s_waitcnt lgkmcnt(8)
 v_mfma_f32_16x16x32_bf16 v[64:67], a[0:3], a[128:131], v[64:67]
 ds_read_b64_tr_b16 a[24:25], v11 offset:41024
 ds_read_b64_tr_b16 a[26:27], v11 offset:42816
 v_mfma_f32_16x16x32_bf16 v[64:67], a[4:7], a[144:147], v[64:67]
 buffer_load_dwordx4 v3, s[12:15], s40 offen offset:1024 lds
 v_mfma_f32_16x16x32_bf16 v[68:71], a[4:7], a[148:151], v[68:71]
 v_mfma_f32_16x16x32_bf16 v[68:71], a[0:3], a[132:135], v[68:71]
 v_mfma_f32_16x16x32_bf16 v[72:75], a[0:3], a[136:139], v[72:75]
 ds_read_b64_tr_b16 a[28:29], v11 offset:57408
 ds_read_b64_tr_b16 a[30:31], v11 offset:59200
 v_mfma_f32_16x16x32_bf16 v[72:75], a[4:7], a[152:155], v[72:75]
 v_mfma_f32_16x16x32_bf16 v[76:79], a[4:7], a[156:159], v[76:79]
 v_mfma_f32_16x16x32_bf16 v[76:79], a[0:3], a[140:143], v[76:79]
 buffer_load_dwordx4 v4, s[12:15], s40 offen offset:2048 lds
 s_waitcnt lgkmcnt(8)
 v_mfma_f32_16x16x32_bf16 v[92:95], a[8:11], a[140:143], v[92:95]
 ds_read_b64_tr_b16 a[0:1], v11 offset:32864
 ds_read_b64_tr_b16 a[2:3], v11 offset:34656
 v_mfma_f32_16x16x32_bf16 v[92:95], a[12:15], a[156:159], v[92:95]
 v_mfma_f32_16x16x32_bf16 v[88:91], a[12:15], a[152:155], v[88:91]
 v_mfma_f32_16x16x32_bf16 v[88:91], a[8:11], a[136:139], v[88:91]
 v_mfma_f32_16x16x32_bf16 v[84:87], a[8:11], a[132:135], v[84:87]
 ds_read_b64_tr_b16 a[4:5], v11 offset:49248
 ds_read_b64_tr_b16 a[6:7], v11 offset:51040
 v_mfma_f32_16x16x32_bf16 v[84:87], a[12:15], a[148:151], v[84:87]
 buffer_load_dwordx4 v5, s[12:15], s40 offen offset:3072 lds
 v_mfma_f32_16x16x32_bf16 v[80:83], a[12:15], a[144:147], v[80:83]
 v_mfma_f32_16x16x32_bf16 v[80:83], a[8:11], a[128:131], v[80:83]
 s_waitcnt lgkmcnt(8)
 v_mfma_f32_16x16x32_bf16 v[96:99], a[16:19], a[128:131], v[96:99]
 ds_read_b64_tr_b16 a[8:9], v11 offset:41056
 ds_read_b64_tr_b16 a[10:11], v11 offset:42848
 v_mfma_f32_16x16x32_bf16 v[96:99], a[20:23], a[144:147], v[96:99]
 s_mov_b32 s40, 4816896
 s_add_u32 m0, s38, 81920
 v_mfma_f32_16x16x32_bf16 v[100:103], a[20:23], a[148:151], v[100:103]
 v_mfma_f32_16x16x32_bf16 v[100:103], a[16:19], a[132:135], v[100:103]
 buffer_load_dwordx4 v2, s[12:15], s40 offen offset:0 lds
 v_mfma_f32_16x16x32_bf16 v[104:107], a[16:19], a[136:139], v[104:107]
 ds_read_b64_tr_b16 a[12:13], v11 offset:57440
 ds_read_b64_tr_b16 a[14:15], v11 offset:59232
 v_mfma_f32_16x16x32_bf16 v[104:107], a[20:23], a[152:155], v[104:107]
 v_mfma_f32_16x16x32_bf16 v[108:111], a[20:23], a[156:159], v[108:111]
 v_mfma_f32_16x16x32_bf16 v[108:111], a[16:19], a[140:143], v[108:111]
 s_waitcnt lgkmcnt(8)
 v_mfma_f32_16x16x32_bf16 v[124:127], a[24:27], a[140:143], v[124:127]
 ds_read_b64_tr_b16 a[16:17], v11 offset:32896
 ds_read_b64_tr_b16 a[18:19], v11 offset:34688
 v_mfma_f32_16x16x32_bf16 v[124:127], a[28:31], a[156:159], v[124:127]
 buffer_load_dwordx4 v3, s[12:15], s40 offen offset:1024 lds
 v_mfma_f32_16x16x32_bf16 v[120:123], a[28:31], a[152:155], v[120:123]
 v_mfma_f32_16x16x32_bf16 v[120:123], a[24:27], a[136:139], v[120:123]
 v_mfma_f32_16x16x32_bf16 v[116:119], a[24:27], a[132:135], v[116:119]
 ds_read_b64_tr_b16 a[20:21], v11 offset:49280
 ds_read_b64_tr_b16 a[22:23], v11 offset:51072
 v_mfma_f32_16x16x32_bf16 v[116:119], a[28:31], a[148:151], v[116:119]
 v_mfma_f32_16x16x32_bf16 v[112:115], a[28:31], a[144:147], v[112:115]
 v_mfma_f32_16x16x32_bf16 v[112:115], a[24:27], a[128:131], v[112:115]
 buffer_load_dwordx4 v4, s[12:15], s40 offen offset:2048 lds
 s_waitcnt lgkmcnt(8)
 v_mfma_f32_16x16x32_bf16 v[128:131], a[0:3], a[128:131], v[128:131]
 ds_read_b64_tr_b16 a[24:25], v11 offset:41088
 ds_read_b64_tr_b16 a[26:27], v11 offset:42880
 v_mfma_f32_16x16x32_bf16 v[128:131], a[4:7], a[144:147], v[128:131]
 v_mfma_f32_16x16x32_bf16 v[132:135], a[4:7], a[148:151], v[132:135]
 v_mfma_f32_16x16x32_bf16 v[132:135], a[0:3], a[132:135], v[132:135]
 v_mfma_f32_16x16x32_bf16 v[136:139], a[0:3], a[136:139], v[136:139]
 ds_read_b64_tr_b16 a[28:29], v11 offset:57472
 ds_read_b64_tr_b16 a[30:31], v11 offset:59264
 v_mfma_f32_16x16x32_bf16 v[136:139], a[4:7], a[152:155], v[136:139]
 buffer_load_dwordx4 v5, s[12:15], s40 offen offset:3072 lds
 v_mfma_f32_16x16x32_bf16 v[140:143], a[4:7], a[156:159], v[140:143]
 v_mfma_f32_16x16x32_bf16 v[140:143], a[0:3], a[140:143], v[140:143]
 s_waitcnt lgkmcnt(8)
 v_mfma_f32_16x16x32_bf16 v[156:159], a[8:11], a[140:143], v[156:159]
 ds_read_b64_tr_b16 a[0:1], v11 offset:32928
 ds_read_b64_tr_b16 a[2:3], v11 offset:34720
 v_mfma_f32_16x16x32_bf16 v[156:159], a[12:15], a[156:159], v[156:159]
 s_mov_b32 s42, 20480
 v_mfma_f32_16x16x32_bf16 v[152:155], a[12:15], a[152:155], v[152:155]
 v_mfma_f32_16x16x32_bf16 v[152:155], a[8:11], a[136:139], v[152:155]
 buffer_load_dwordx4 a[96:99], v6, s[16:19], s42 offen offset:0 sc1
 v_mfma_f32_16x16x32_bf16 v[148:151], a[8:11], a[132:135], v[148:151]
 ds_read_b64_tr_b16 a[4:5], v11 offset:49312
 ds_read_b64_tr_b16 a[6:7], v11 offset:51104
 v_mfma_f32_16x16x32_bf16 v[148:151], a[12:15], a[148:151], v[148:151]
 v_mfma_f32_16x16x32_bf16 v[144:147], a[12:15], a[144:147], v[144:147]
 v_mfma_f32_16x16x32_bf16 v[144:147], a[8:11], a[128:131], v[144:147]
 s_waitcnt lgkmcnt(8)
 v_mfma_f32_16x16x32_bf16 v[160:163], a[16:19], a[128:131], v[160:163]
 ds_read_b64_tr_b16 a[8:9], v11 offset:41120
 ds_read_b64_tr_b16 a[10:11], v11 offset:42912
 v_mfma_f32_16x16x32_bf16 v[160:163], a[20:23], a[144:147], v[160:163]
 buffer_load_dwordx4 a[100:103], v7, s[16:19], s42 offen offset:0 sc1
 v_mfma_f32_16x16x32_bf16 v[164:167], a[20:23], a[148:151], v[164:167]
 v_mfma_f32_16x16x32_bf16 v[164:167], a[16:19], a[132:135], v[164:167]
 v_mfma_f32_16x16x32_bf16 v[168:171], a[16:19], a[136:139], v[168:171]
 ds_read_b64_tr_b16 a[12:13], v11 offset:57504
 ds_read_b64_tr_b16 a[14:15], v11 offset:59296
 v_mfma_f32_16x16x32_bf16 v[168:171], a[20:23], a[152:155], v[168:171]
 v_mfma_f32_16x16x32_bf16 v[172:175], a[20:23], a[156:159], v[172:175]
 v_mfma_f32_16x16x32_bf16 v[172:175], a[16:19], a[140:143], v[172:175]
 buffer_load_dwordx4 a[104:107], v8, s[16:19], s42 offen offset:0 sc1
 s_waitcnt lgkmcnt(8)
 v_mfma_f32_16x16x32_bf16 v[188:191], a[24:27], a[140:143], v[188:191]
 ds_read_b64_tr_b16 a[16:17], v11 offset:32960
 ds_read_b64_tr_b16 a[18:19], v11 offset:34752
 v_mfma_f32_16x16x32_bf16 v[188:191], a[28:31], a[156:159], v[188:191]
 v_mfma_f32_16x16x32_bf16 v[184:187], a[28:31], a[152:155], v[184:187]
 v_mfma_f32_16x16x32_bf16 v[184:187], a[24:27], a[136:139], v[184:187]
 v_mfma_f32_16x16x32_bf16 v[180:183], a[24:27], a[132:135], v[180:183]
 ds_read_b64_tr_b16 a[20:21], v11 offset:49344
 ds_read_b64_tr_b16 a[22:23], v11 offset:51136
 v_mfma_f32_16x16x32_bf16 v[180:183], a[28:31], a[148:151], v[180:183]
 buffer_load_dwordx4 a[108:111], v9, s[16:19], s42 offen offset:0 sc1
 v_mfma_f32_16x16x32_bf16 v[176:179], a[28:31], a[144:147], v[176:179]
 v_mfma_f32_16x16x32_bf16 v[176:179], a[24:27], a[128:131], v[176:179]
 s_waitcnt lgkmcnt(8)
 v_mfma_f32_16x16x32_bf16 v[192:195], a[0:3], a[128:131], v[192:195]
 ds_read_b64_tr_b16 a[24:25], v11 offset:41152
 ds_read_b64_tr_b16 a[26:27], v11 offset:42944
 v_mfma_f32_16x16x32_bf16 v[192:195], a[4:7], a[144:147], v[192:195]
 v_mfma_f32_16x16x32_bf16 v[196:199], a[4:7], a[148:151], v[196:199]
 v_mfma_f32_16x16x32_bf16 v[196:199], a[0:3], a[132:135], v[196:199]
 buffer_load_dwordx4 a[112:115], v6, s[16:19], s42 offen offset:1024 sc1
 v_mfma_f32_16x16x32_bf16 v[200:203], a[0:3], a[136:139], v[200:203]
 ds_read_b64_tr_b16 a[28:29], v11 offset:57536
 ds_read_b64_tr_b16 a[30:31], v11 offset:59328
 v_mfma_f32_16x16x32_bf16 v[200:203], a[4:7], a[152:155], v[200:203]
 v_mfma_f32_16x16x32_bf16 v[204:207], a[4:7], a[156:159], v[204:207]
 v_mfma_f32_16x16x32_bf16 v[204:207], a[0:3], a[140:143], v[204:207]
 s_waitcnt lgkmcnt(8)
 v_mfma_f32_16x16x32_bf16 v[220:223], a[8:11], a[140:143], v[220:223]
 s_waitcnt vmcnt(37)
 s_barrier
 ds_read_b64_tr_b16 a[0:1], v10 offset:0
 v_mfma_f32_16x16x32_bf16 v[220:223], a[12:15], a[156:159], v[220:223]
 ds_read_b64_tr_b16 a[2:3], v10 offset:1792
 buffer_load_dwordx4 a[116:119], v7, s[16:19], s42 offen offset:1024 sc1
 v_mfma_f32_16x16x32_bf16 v[216:219], a[12:15], a[152:155], v[216:219]
 v_mfma_f32_16x16x32_bf16 v[216:219], a[8:11], a[136:139], v[216:219]
 v_mfma_f32_16x16x32_bf16 v[212:215], a[8:11], a[132:135], v[212:215]
 ds_read_b64_tr_b16 a[4:5], v10 offset:16384
 ds_read_b64_tr_b16 a[6:7], v10 offset:18176
 v_mfma_f32_16x16x32_bf16 v[212:215], a[12:15], a[148:151], v[212:215]
 v_mfma_f32_16x16x32_bf16 v[208:211], a[12:15], a[144:147], v[208:211]
 v_mfma_f32_16x16x32_bf16 v[208:211], a[8:11], a[128:131], v[208:211]
 buffer_load_dwordx4 a[120:123], v8, s[16:19], s42 offen offset:1024 sc1
 s_waitcnt lgkmcnt(8)
 v_mfma_f32_16x16x32_bf16 v[224:227], a[16:19], a[128:131], v[224:227]
 ds_read_b64_tr_b16 a[8:9], v10 offset:8192
 ds_read_b64_tr_b16 a[10:11], v10 offset:9984
 v_mfma_f32_16x16x32_bf16 v[224:227], a[20:23], a[144:147], v[224:227]
 v_mfma_f32_16x16x32_bf16 v[228:231], a[20:23], a[148:151], v[228:231]
 v_mfma_f32_16x16x32_bf16 v[228:231], a[16:19], a[132:135], v[228:231]
 v_mfma_f32_16x16x32_bf16 v[232:235], a[16:19], a[136:139], v[232:235]
 ds_read_b64_tr_b16 a[12:13], v10 offset:24576
 ds_read_b64_tr_b16 a[14:15], v10 offset:26368
 v_mfma_f32_16x16x32_bf16 v[232:235], a[20:23], a[152:155], v[232:235]
 buffer_load_dwordx4 a[124:127], v9, s[16:19], s42 offen offset:1024 sc1
 v_mfma_f32_16x16x32_bf16 v[236:239], a[20:23], a[156:159], v[236:239]
 v_mfma_f32_16x16x32_bf16 v[236:239], a[16:19], a[140:143], v[236:239]
 s_waitcnt lgkmcnt(8)
 v_mfma_f32_16x16x32_bf16 v[252:255], a[24:27], a[140:143], v[252:255]
 ds_read_b64_tr_b16 a[16:17], v10 offset:32
 ds_read_b64_tr_b16 a[18:19], v10 offset:1824
 v_mfma_f32_16x16x32_bf16 v[252:255], a[28:31], a[156:159], v[252:255]
 v_mfma_f32_16x16x32_bf16 v[248:251], a[28:31], a[152:155], v[248:251]
 v_mfma_f32_16x16x32_bf16 v[248:251], a[24:27], a[136:139], v[248:251]
 buffer_load_dwordx4 a[140:143], v9, s[16:19], s42 offen offset:2048 sc1
 v_mfma_f32_16x16x32_bf16 v[244:247], a[24:27], a[132:135], v[244:247]
 ds_read_b64_tr_b16 a[20:21], v10 offset:16416
 ds_read_b64_tr_b16 a[22:23], v10 offset:18208
 v_mfma_f32_16x16x32_bf16 v[244:247], a[28:31], a[148:151], v[244:247]
 s_barrier
 v_mfma_f32_16x16x32_bf16 v[240:243], a[28:31], a[144:147], v[240:243]
 s_mov_b32 s40, 5046272
 s_add_u32 m0, s38, 98304
 v_mfma_f32_16x16x32_bf16 v[240:243], a[24:27], a[128:131], v[240:243]
 s_waitcnt vmcnt(37) lgkmcnt(8)
 v_mfma_f32_16x16x32_bf16 v[32:35], a[0:3], a[32:35], v[32:35]
 ds_read_b64_tr_b16 a[24:25], v10 offset:8224
 s_waitcnt vmcnt(33)
 v_mfma_f32_16x16x32_bf16 v[32:35], a[4:7], a[48:51], v[32:35]
 ds_read_b64_tr_b16 a[26:27], v10 offset:10016
 buffer_load_dwordx4 v2, s[12:15], s40 offen offset:0 lds
 v_mfma_f32_16x16x32_bf16 v[36:39], a[4:7], a[52:55], v[36:39]
 v_mfma_f32_16x16x32_bf16 v[36:39], a[0:3], a[36:39], v[36:39]
 v_mfma_f32_16x16x32_bf16 v[40:43], a[0:3], a[40:43], v[40:43]
 ds_read_b64_tr_b16 a[28:29], v10 offset:24608
 ds_read_b64_tr_b16 a[30:31], v10 offset:26400
 v_mfma_f32_16x16x32_bf16 v[40:43], a[4:7], a[56:59], v[40:43]
 v_mfma_f32_16x16x32_bf16 v[44:47], a[4:7], a[60:63], v[44:47]
 v_mfma_f32_16x16x32_bf16 v[44:47], a[0:3], a[44:47], v[44:47]
 buffer_load_dwordx4 v3, s[12:15], s40 offen offset:1024 lds
 s_waitcnt lgkmcnt(8)
 v_mfma_f32_16x16x32_bf16 v[60:63], a[8:11], a[44:47], v[60:63]
 ds_read_b64_tr_b16 a[0:1], v10 offset:64
 ds_read_b64_tr_b16 a[2:3], v10 offset:1856
 v_mfma_f32_16x16x32_bf16 v[60:63], a[12:15], a[60:63], v[60:63]
 v_mfma_f32_16x16x32_bf16 v[56:59], a[12:15], a[56:59], v[56:59]
 v_mfma_f32_16x16x32_bf16 v[56:59], a[8:11], a[40:43], v[56:59]
 v_mfma_f32_16x16x32_bf16 v[52:55], a[8:11], a[36:39], v[52:55]
 ds_read_b64_tr_b16 a[4:5], v10 offset:16448
 ds_read_b64_tr_b16 a[6:7], v10 offset:18240
 v_mfma_f32_16x16x32_bf16 v[52:55], a[12:15], a[52:55], v[52:55]
 buffer_load_dwordx4 v4, s[12:15], s40 offen offset:2048 lds
 v_mfma_f32_16x16x32_bf16 v[48:51], a[12:15], a[48:51], v[48:51]
 v_mfma_f32_16x16x32_bf16 v[48:51], a[8:11], a[32:35], v[48:51]
 s_waitcnt lgkmcnt(8)
 v_mfma_f32_16x16x32_bf16 v[64:67], a[16:19], a[32:35], v[64:67]
 ds_read_b64_tr_b16 a[8:9], v10 offset:8256
 ds_read_b64_tr_b16 a[10:11], v10 offset:10048
 v_mfma_f32_16x16x32_bf16 v[64:67], a[20:23], a[48:51], v[64:67]
 v_mfma_f32_16x16x32_bf16 v[68:71], a[20:23], a[52:55], v[68:71]
 v_mfma_f32_16x16x32_bf16 v[68:71], a[16:19], a[36:39], v[68:71]
 buffer_load_dwordx4 v5, s[12:15], s40 offen offset:3072 lds
 v_mfma_f32_16x16x32_bf16 v[72:75], a[16:19], a[40:43], v[72:75]
 ds_read_b64_tr_b16 a[12:13], v10 offset:24640
 ds_read_b64_tr_b16 a[14:15], v10 offset:26432
 v_mfma_f32_16x16x32_bf16 v[72:75], a[20:23], a[56:59], v[72:75]
 v_mfma_f32_16x16x32_bf16 v[76:79], a[20:23], a[60:63], v[76:79]
 s_mov_b32 s40, 5275648
 s_add_u32 m0, s38, 114688
 v_mfma_f32_16x16x32_bf16 v[76:79], a[16:19], a[44:47], v[76:79]
 s_waitcnt lgkmcnt(8)
 v_mfma_f32_16x16x32_bf16 v[92:95], a[24:27], a[44:47], v[92:95]
 ds_read_b64_tr_b16 a[16:17], v10 offset:96
 ds_read_b64_tr_b16 a[18:19], v10 offset:1888
 v_mfma_f32_16x16x32_bf16 v[92:95], a[28:31], a[60:63], v[92:95]
 buffer_load_dwordx4 v2, s[12:15], s40 offen offset:0 lds
 v_mfma_f32_16x16x32_bf16 v[88:91], a[28:31], a[56:59], v[88:91]
 v_mfma_f32_16x16x32_bf16 v[88:91], a[24:27], a[40:43], v[88:91]
 v_mfma_f32_16x16x32_bf16 v[84:87], a[24:27], a[36:39], v[84:87]
 ds_read_b64_tr_b16 a[20:21], v10 offset:16480
 ds_read_b64_tr_b16 a[22:23], v10 offset:18272
 v_mfma_f32_16x16x32_bf16 v[84:87], a[28:31], a[52:55], v[84:87]
 v_mfma_f32_16x16x32_bf16 v[80:83], a[28:31], a[48:51], v[80:83]
 v_mfma_f32_16x16x32_bf16 v[80:83], a[24:27], a[32:35], v[80:83]
 buffer_load_dwordx4 v3, s[12:15], s40 offen offset:1024 lds
 s_waitcnt lgkmcnt(8)
 v_mfma_f32_16x16x32_bf16 v[96:99], a[0:3], a[32:35], v[96:99]
 ds_read_b64_tr_b16 a[24:25], v10 offset:8288
 ds_read_b64_tr_b16 a[26:27], v10 offset:10080
 v_mfma_f32_16x16x32_bf16 v[96:99], a[4:7], a[48:51], v[96:99]
 v_mfma_f32_16x16x32_bf16 v[100:103], a[4:7], a[52:55], v[100:103]
 v_mfma_f32_16x16x32_bf16 v[100:103], a[0:3], a[36:39], v[100:103]
 v_mfma_f32_16x16x32_bf16 v[104:107], a[0:3], a[40:43], v[104:107]
 ds_read_b64_tr_b16 a[28:29], v10 offset:24672
 ds_read_b64_tr_b16 a[30:31], v10 offset:26464
 s_branch m_ps_p3_3
m_pad_p3_3:
 s_branch m_reta_p3
m_ps_p3_3:
 v_mfma_f32_16x16x32_bf16 v[104:107], a[4:7], a[56:59], v[104:107]
 buffer_load_dwordx4 v4, s[12:15], s40 offen offset:2048 lds
 v_mfma_f32_16x16x32_bf16 v[108:111], a[4:7], a[60:63], v[108:111]
 v_mfma_f32_16x16x32_bf16 v[108:111], a[0:3], a[44:47], v[108:111]
 s_waitcnt lgkmcnt(8)
 v_mfma_f32_16x16x32_bf16 v[124:127], a[8:11], a[44:47], v[124:127]
 ds_read_b64_tr_b16 a[0:1], v10 offset:128
 ds_read_b64_tr_b16 a[2:3], v10 offset:1920
 v_mfma_f32_16x16x32_bf16 v[124:127], a[12:15], a[60:63], v[124:127]
 v_mfma_f32_16x16x32_bf16 v[120:123], a[12:15], a[56:59], v[120:123]
 v_mfma_f32_16x16x32_bf16 v[120:123], a[8:11], a[40:43], v[120:123]
 buffer_load_dwordx4 v5, s[12:15], s40 offen offset:3072 lds
 v_mfma_f32_16x16x32_bf16 v[116:119], a[8:11], a[36:39], v[116:119]
 ds_read_b64_tr_b16 a[4:5], v10 offset:16512
 ds_read_b64_tr_b16 a[6:7], v10 offset:18304
 v_mfma_f32_16x16x32_bf16 v[116:119], a[12:15], a[52:55], v[116:119]
 v_mfma_f32_16x16x32_bf16 v[112:115], a[12:15], a[48:51], v[112:115]
 v_mfma_f32_16x16x32_bf16 v[112:115], a[8:11], a[32:35], v[112:115]
 s_waitcnt lgkmcnt(8)
 v_mfma_f32_16x16x32_bf16 v[128:131], a[16:19], a[32:35], v[128:131]
 ds_read_b64_tr_b16 a[8:9], v10 offset:8320
 ds_read_b64_tr_b16 a[10:11], v10 offset:10112
 v_mfma_f32_16x16x32_bf16 v[128:131], a[20:23], a[48:51], v[128:131]
 buffer_load_dwordx4 a[128:131], v6, s[16:19], s42 offen offset:2048 sc1
 v_mfma_f32_16x16x32_bf16 v[132:135], a[20:23], a[52:55], v[132:135]
 v_mfma_f32_16x16x32_bf16 v[132:135], a[16:19], a[36:39], v[132:135]
 v_mfma_f32_16x16x32_bf16 v[136:139], a[16:19], a[40:43], v[136:139]
 ds_read_b64_tr_b16 a[12:13], v10 offset:24704
 ds_read_b64_tr_b16 a[14:15], v10 offset:26496
 v_mfma_f32_16x16x32_bf16 v[136:139], a[20:23], a[56:59], v[136:139]
 v_mfma_f32_16x16x32_bf16 v[140:143], a[20:23], a[60:63], v[140:143]
 v_mfma_f32_16x16x32_bf16 v[140:143], a[16:19], a[44:47], v[140:143]
 buffer_load_dwordx4 a[132:135], v7, s[16:19], s42 offen offset:2048 sc1
 s_waitcnt lgkmcnt(8)
 v_mfma_f32_16x16x32_bf16 v[156:159], a[24:27], a[44:47], v[156:159]
 ds_read_b64_tr_b16 a[16:17], v10 offset:160
 ds_read_b64_tr_b16 a[18:19], v10 offset:1952
 s_add_u32 s88, s82, 0x2400000
 s_addc_u32 s89, s83, 0
 s_mov_b32 s90, 4194304
 s_mov_b32 s91, 0x20000
 s_lshl_b32 s44, s2, 14
 s_add_u32 s44, s44, s38
 v_mfma_f32_16x16x32_bf16 v[156:159], a[28:31], a[60:63], v[156:159]
 v_mfma_f32_16x16x32_bf16 v[152:155], a[28:31], a[56:59], v[152:155]
 v_accvgpr_write_b32 a160, -1
 v_accvgpr_write_b32 a161, -1
 v_accvgpr_write_b32 a162, -1
 v_accvgpr_write_b32 a163, -1
 v_mfma_f32_16x16x32_bf16 v[152:155], a[24:27], a[40:43], v[152:155]
 v_mfma_f32_16x16x32_bf16 v[148:151], a[24:27], a[36:39], v[148:151]
 ds_read_b64_tr_b16 a[20:21], v10 offset:16544
 ds_read_b64_tr_b16 a[22:23], v10 offset:18336
 v_mfma_f32_16x16x32_bf16 v[148:151], a[28:31], a[52:55], v[148:151]
 buffer_load_dwordx4 a[136:139], v8, s[16:19], s42 offen offset:2048 sc1
 v_mfma_f32_16x16x32_bf16 v[144:147], a[28:31], a[48:51], v[144:147]
 v_mfma_f32_16x16x32_bf16 v[144:147], a[24:27], a[32:35], v[144:147]
 s_waitcnt lgkmcnt(8)
 v_mfma_f32_16x16x32_bf16 v[160:163], a[0:3], a[32:35], v[160:163]
 ds_read_b64_tr_b16 a[24:25], v10 offset:8352
 ds_read_b64_tr_b16 a[26:27], v10 offset:10144
 v_mfma_f32_16x16x32_bf16 v[160:163], a[4:7], a[48:51], v[160:163]
 v_mfma_f32_16x16x32_bf16 v[164:167], a[4:7], a[52:55], v[164:167]
 v_mfma_f32_16x16x32_bf16 v[164:167], a[0:3], a[36:39], v[164:167]
 buffer_load_dwordx4 a[144:147], v6, s[16:19], s42 offen offset:3072 sc1
 v_mfma_f32_16x16x32_bf16 v[168:171], a[0:3], a[40:43], v[168:171]
 ds_read_b64_tr_b16 a[28:29], v10 offset:24736
 ds_read_b64_tr_b16 a[30:31], v10 offset:26528
 v_mfma_f32_16x16x32_bf16 v[168:171], a[4:7], a[56:59], v[168:171]
 v_mfma_f32_16x16x32_bf16 v[172:175], a[4:7], a[60:63], v[172:175]
 v_mfma_f32_16x16x32_bf16 v[172:175], a[0:3], a[44:47], v[172:175]
 s_waitcnt lgkmcnt(8)
 v_mfma_f32_16x16x32_bf16 v[188:191], a[8:11], a[44:47], v[188:191]
 ds_read_b64_tr_b16 a[0:1], v10 offset:192
 ds_read_b64_tr_b16 a[2:3], v10 offset:1984
 v_mfma_f32_16x16x32_bf16 v[188:191], a[12:15], a[60:63], v[188:191]
 buffer_load_dwordx4 a[148:151], v7, s[16:19], s42 offen offset:3072 sc1
 v_mfma_f32_16x16x32_bf16 v[184:187], a[12:15], a[56:59], v[184:187]
 v_mfma_f32_16x16x32_bf16 v[184:187], a[8:11], a[40:43], v[184:187]
 v_mfma_f32_16x16x32_bf16 v[180:183], a[8:11], a[36:39], v[180:183]
 ds_read_b64_tr_b16 a[4:5], v10 offset:16576
 ds_read_b64_tr_b16 a[6:7], v10 offset:18368
 v_mfma_f32_16x16x32_bf16 v[180:183], a[12:15], a[52:55], v[180:183]
 v_mfma_f32_16x16x32_bf16 v[176:179], a[12:15], a[48:51], v[176:179]
 v_mfma_f32_16x16x32_bf16 v[176:179], a[8:11], a[32:35], v[176:179]
 buffer_load_dwordx4 a[152:155], v8, s[16:19], s42 offen offset:3072 sc1
 s_waitcnt lgkmcnt(8)
 v_mfma_f32_16x16x32_bf16 v[192:195], a[16:19], a[32:35], v[192:195]
 ds_read_b64_tr_b16 a[8:9], v10 offset:8384
 ds_read_b64_tr_b16 a[10:11], v10 offset:10176
 v_mfma_f32_16x16x32_bf16 v[192:195], a[20:23], a[48:51], v[192:195]
 v_mfma_f32_16x16x32_bf16 v[196:199], a[20:23], a[52:55], v[196:199]
 v_mfma_f32_16x16x32_bf16 v[196:199], a[16:19], a[36:39], v[196:199]
 v_mfma_f32_16x16x32_bf16 v[200:203], a[16:19], a[40:43], v[200:203]
 ds_read_b64_tr_b16 a[12:13], v10 offset:24768
 ds_read_b64_tr_b16 a[14:15], v10 offset:26560
 v_mfma_f32_16x16x32_bf16 v[200:203], a[20:23], a[56:59], v[200:203]
 buffer_load_dwordx4 a[156:159], v9, s[16:19], s42 offen offset:3072 sc1
 v_mfma_f32_16x16x32_bf16 v[204:207], a[20:23], a[60:63], v[204:207]
 v_mfma_f32_16x16x32_bf16 v[204:207], a[16:19], a[44:47], v[204:207]
 s_waitcnt lgkmcnt(8)
 v_mfma_f32_16x16x32_bf16 v[220:223], a[24:27], a[44:47], v[220:223]
 s_waitcnt vmcnt(40)
 s_barrier
 ds_read_b64_tr_b16 a[16:17], v10 offset:32768
 v_mfma_f32_16x16x32_bf16 v[220:223], a[28:31], a[60:63], v[220:223]
 ds_read_b64_tr_b16 a[18:19], v10 offset:34560
 v_mfma_f32_16x16x32_bf16 v[216:219], a[28:31], a[56:59], v[216:219]
 v_mfma_f32_16x16x32_bf16 v[216:219], a[24:27], a[40:43], v[216:219]
 v_mfma_f32_16x16x32_bf16 v[212:215], a[24:27], a[36:39], v[212:215]
 ds_read_b64_tr_b16 a[20:21], v10 offset:49152
 ds_read_b64_tr_b16 a[22:23], v10 offset:50944
 v_mfma_f32_16x16x32_bf16 v[212:215], a[28:31], a[52:55], v[212:215]
 v_mfma_f32_16x16x32_bf16 v[208:211], a[28:31], a[48:51], v[208:211]
 v_mfma_f32_16x16x32_bf16 v[208:211], a[24:27], a[32:35], v[208:211]
 s_waitcnt lgkmcnt(8)
 v_mfma_f32_16x16x32_bf16 v[224:227], a[0:3], a[32:35], v[224:227]
 ds_read_b64_tr_b16 a[24:25], v10 offset:40960
 ds_read_b64_tr_b16 a[26:27], v10 offset:42752
 v_mfma_f32_16x16x32_bf16 v[224:227], a[4:7], a[48:51], v[224:227]
 v_mfma_f32_16x16x32_bf16 v[228:231], a[4:7], a[52:55], v[228:231]
 v_mfma_f32_16x16x32_bf16 v[228:231], a[0:3], a[36:39], v[228:231]
 v_mfma_f32_16x16x32_bf16 v[232:235], a[0:3], a[40:43], v[232:235]
 ds_read_b64_tr_b16 a[28:29], v10 offset:57344
 ds_read_b64_tr_b16 a[30:31], v10 offset:59136
 v_mfma_f32_16x16x32_bf16 v[232:235], a[4:7], a[56:59], v[232:235]
 v_mfma_f32_16x16x32_bf16 v[236:239], a[4:7], a[60:63], v[236:239]
 v_mfma_f32_16x16x32_bf16 v[236:239], a[0:3], a[44:47], v[236:239]
 s_mov_b32 s42, 24576
 s_waitcnt lgkmcnt(8)
 v_mfma_f32_16x16x32_bf16 v[252:255], a[8:11], a[44:47], v[252:255]
 ds_read_b64_tr_b16 a[0:1], v10 offset:32800
 ds_read_b64_tr_b16 a[2:3], v10 offset:34592
 v_mfma_f32_16x16x32_bf16 v[252:255], a[12:15], a[60:63], v[252:255]
 buffer_load_dwordx4 a[44:47], v9, s[16:19], s42 offen offset:0 sc1
 v_mfma_f32_16x16x32_bf16 v[248:251], a[12:15], a[56:59], v[248:251]
 v_mfma_f32_16x16x32_bf16 v[248:251], a[8:11], a[40:43], v[248:251]
 v_mfma_f32_16x16x32_bf16 v[244:247], a[8:11], a[36:39], v[244:247]
 ds_read_b64_tr_b16 a[4:5], v10 offset:49184
 ds_read_b64_tr_b16 a[6:7], v10 offset:50976
 v_mfma_f32_16x16x32_bf16 v[244:247], a[12:15], a[52:55], v[244:247]
 s_barrier
 s_mov_b32 s40, 5505024
 v_mfma_f32_16x16x32_bf16 v[240:243], a[12:15], a[48:51], v[240:243]
 s_add_u32 m0, s38, 0
 v_mfma_f32_16x16x32_bf16 v[240:243], a[8:11], a[32:35], v[240:243]
 buffer_load_dwordx4 v2, s[12:15], s40 offen offset:0 lds
 s_waitcnt vmcnt(38) lgkmcnt(8)
 v_mfma_f32_16x16x32_bf16 v[32:35], a[16:19], a[64:67], v[32:35]
 ds_read_b64_tr_b16 a[8:9], v10 offset:40992
 s_waitcnt vmcnt(34)
 v_mfma_f32_16x16x32_bf16 v[32:35], a[20:23], a[80:83], v[32:35]
 ds_read_b64_tr_b16 a[10:11], v10 offset:42784
 v_mfma_f32_16x16x32_bf16 v[36:39], a[20:23], a[84:87], v[36:39]
 v_mfma_f32_16x16x32_bf16 v[36:39], a[16:19], a[68:71], v[36:39]
 v_mfma_f32_16x16x32_bf16 v[40:43], a[16:19], a[72:75], v[40:43]
 ds_read_b64_tr_b16 a[12:13], v10 offset:57376
 ds_read_b64_tr_b16 a[14:15], v10 offset:59168
 v_mfma_f32_16x16x32_bf16 v[40:43], a[20:23], a[88:91], v[40:43]
 buffer_load_dwordx4 v3, s[12:15], s40 offen offset:1024 lds
 v_mfma_f32_16x16x32_bf16 v[44:47], a[20:23], a[92:95], v[44:47]
 v_mfma_f32_16x16x32_bf16 v[44:47], a[16:19], a[76:79], v[44:47]
 buffer_store_dwordx4 a[160:163], v6, s[88:91], s44 offen offset:0 sc1
 s_waitcnt lgkmcnt(8)
 v_mfma_f32_16x16x32_bf16 v[60:63], a[24:27], a[76:79], v[60:63]
 ds_read_b64_tr_b16 a[16:17], v10 offset:32832
 ds_read_b64_tr_b16 a[18:19], v10 offset:34624
 v_mfma_f32_16x16x32_bf16 v[60:63], a[28:31], a[92:95], v[60:63]
 v_mfma_f32_16x16x32_bf16 v[56:59], a[28:31], a[88:91], v[56:59]
 v_mfma_f32_16x16x32_bf16 v[56:59], a[24:27], a[72:75], v[56:59]
 buffer_load_dwordx4 v4, s[12:15], s40 offen offset:2048 lds
 v_mfma_f32_16x16x32_bf16 v[52:55], a[24:27], a[68:71], v[52:55]
 ds_read_b64_tr_b16 a[20:21], v10 offset:49216
 ds_read_b64_tr_b16 a[22:23], v10 offset:51008
 v_mfma_f32_16x16x32_bf16 v[52:55], a[28:31], a[84:87], v[52:55]
 v_mfma_f32_16x16x32_bf16 v[48:51], a[28:31], a[80:83], v[48:51]
 v_mfma_f32_16x16x32_bf16 v[48:51], a[24:27], a[64:67], v[48:51]
 s_waitcnt lgkmcnt(8)
 v_mfma_f32_16x16x32_bf16 v[64:67], a[0:3], a[64:67], v[64:67]
 ds_read_b64_tr_b16 a[24:25], v10 offset:41024
 ds_read_b64_tr_b16 a[26:27], v10 offset:42816
 v_mfma_f32_16x16x32_bf16 v[64:67], a[4:7], a[80:83], v[64:67]
 buffer_load_dwordx4 v5, s[12:15], s40 offen offset:3072 lds
 v_mfma_f32_16x16x32_bf16 v[68:71], a[4:7], a[84:87], v[68:71]
 v_mfma_f32_16x16x32_bf16 v[68:71], a[0:3], a[68:71], v[68:71]
 v_mfma_f32_16x16x32_bf16 v[72:75], a[0:3], a[72:75], v[72:75]
 ds_read_b64_tr_b16 a[28:29], v10 offset:57408
 ds_read_b64_tr_b16 a[30:31], v10 offset:59200
 v_mfma_f32_16x16x32_bf16 v[72:75], a[4:7], a[88:91], v[72:75]
 s_mov_b32 s40, 5734400
 s_add_u32 m0, s38, 16384
 v_mfma_f32_16x16x32_bf16 v[76:79], a[4:7], a[92:95], v[76:79]
 v_mfma_f32_16x16x32_bf16 v[76:79], a[0:3], a[76:79], v[76:79]
 buffer_load_dwordx4 v2, s[12:15], s40 offen offset:0 lds
 s_waitcnt lgkmcnt(8)
 v_mfma_f32_16x16x32_bf16 v[92:95], a[8:11], a[76:79], v[92:95]
 ds_read_b64_tr_b16 a[0:1], v10 offset:32864
 ds_read_b64_tr_b16 a[2:3], v10 offset:34656
 v_mfma_f32_16x16x32_bf16 v[92:95], a[12:15], a[92:95], v[92:95]
 v_mfma_f32_16x16x32_bf16 v[88:91], a[12:15], a[88:91], v[88:91]
 v_mfma_f32_16x16x32_bf16 v[88:91], a[8:11], a[72:75], v[88:91]
 v_mfma_f32_16x16x32_bf16 v[84:87], a[8:11], a[68:71], v[84:87]
 ds_read_b64_tr_b16 a[4:5], v10 offset:49248
 ds_read_b64_tr_b16 a[6:7], v10 offset:51040
 v_mfma_f32_16x16x32_bf16 v[84:87], a[12:15], a[84:87], v[84:87]
 buffer_load_dwordx4 v3, s[12:15], s40 offen offset:1024 lds
 v_mfma_f32_16x16x32_bf16 v[80:83], a[12:15], a[80:83], v[80:83]
 v_mfma_f32_16x16x32_bf16 v[80:83], a[8:11], a[64:67], v[80:83]
 s_waitcnt lgkmcnt(8)
 v_mfma_f32_16x16x32_bf16 v[96:99], a[16:19], a[64:67], v[96:99]
 ds_read_b64_tr_b16 a[8:9], v10 offset:41056
 ds_read_b64_tr_b16 a[10:11], v10 offset:42848
 v_mfma_f32_16x16x32_bf16 v[96:99], a[20:23], a[80:83], v[96:99]
 v_mfma_f32_16x16x32_bf16 v[100:103], a[20:23], a[84:87], v[100:103]
 v_mfma_f32_16x16x32_bf16 v[100:103], a[16:19], a[68:71], v[100:103]
 buffer_load_dwordx4 v4, s[12:15], s40 offen offset:2048 lds
 v_mfma_f32_16x16x32_bf16 v[104:107], a[16:19], a[72:75], v[104:107]
 ds_read_b64_tr_b16 a[12:13], v10 offset:57440
 ds_read_b64_tr_b16 a[14:15], v10 offset:59232
 v_mfma_f32_16x16x32_bf16 v[104:107], a[20:23], a[88:91], v[104:107]
 v_mfma_f32_16x16x32_bf16 v[108:111], a[20:23], a[92:95], v[108:111]
 v_mfma_f32_16x16x32_bf16 v[108:111], a[16:19], a[76:79], v[108:111]
 s_waitcnt lgkmcnt(8)
 v_mfma_f32_16x16x32_bf16 v[124:127], a[24:27], a[76:79], v[124:127]
 ds_read_b64_tr_b16 a[16:17], v10 offset:32896
 ds_read_b64_tr_b16 a[18:19], v10 offset:34688
 v_mfma_f32_16x16x32_bf16 v[124:127], a[28:31], a[92:95], v[124:127]
 buffer_load_dwordx4 v5, s[12:15], s40 offen offset:3072 lds
 v_mfma_f32_16x16x32_bf16 v[120:123], a[28:31], a[88:91], v[120:123]
 v_mfma_f32_16x16x32_bf16 v[120:123], a[24:27], a[72:75], v[120:123]
 v_mfma_f32_16x16x32_bf16 v[116:119], a[24:27], a[68:71], v[116:119]
 ds_read_b64_tr_b16 a[20:21], v10 offset:49280
 ds_read_b64_tr_b16 a[22:23], v10 offset:51072
 v_mfma_f32_16x16x32_bf16 v[116:119], a[28:31], a[84:87], v[116:119]
 v_mfma_f32_16x16x32_bf16 v[112:115], a[28:31], a[80:83], v[112:115]
 v_mfma_f32_16x16x32_bf16 v[112:115], a[24:27], a[64:67], v[112:115]
 buffer_load_dwordx4 a[32:35], v6, s[16:19], s42 offen offset:0 sc1
 s_waitcnt lgkmcnt(8)
 v_mfma_f32_16x16x32_bf16 v[128:131], a[0:3], a[64:67], v[128:131]
 ds_read_b64_tr_b16 a[24:25], v10 offset:41088
 ds_read_b64_tr_b16 a[26:27], v10 offset:42880
 v_mfma_f32_16x16x32_bf16 v[128:131], a[4:7], a[80:83], v[128:131]
 v_mfma_f32_16x16x32_bf16 v[132:135], a[4:7], a[84:87], v[132:135]
 v_mfma_f32_16x16x32_bf16 v[132:135], a[0:3], a[68:71], v[132:135]
 v_mfma_f32_16x16x32_bf16 v[136:139], a[0:3], a[72:75], v[136:139]
 ds_read_b64_tr_b16 a[28:29], v10 offset:57472
 ds_read_b64_tr_b16 a[30:31], v10 offset:59264
 v_mfma_f32_16x16x32_bf16 v[136:139], a[4:7], a[88:91], v[136:139]
 buffer_load_dwordx4 a[36:39], v7, s[16:19], s42 offen offset:0 sc1
 v_mfma_f32_16x16x32_bf16 v[140:143], a[4:7], a[92:95], v[140:143]
 v_mfma_f32_16x16x32_bf16 v[140:143], a[0:3], a[76:79], v[140:143]
 s_waitcnt lgkmcnt(8)
 v_mfma_f32_16x16x32_bf16 v[156:159], a[8:11], a[76:79], v[156:159]
 ds_read_b64_tr_b16 a[0:1], v10 offset:32928
 ds_read_b64_tr_b16 a[2:3], v10 offset:34720
 v_mfma_f32_16x16x32_bf16 v[156:159], a[12:15], a[92:95], v[156:159]
 v_mfma_f32_16x16x32_bf16 v[152:155], a[12:15], a[88:91], v[152:155]
 v_mfma_f32_16x16x32_bf16 v[152:155], a[8:11], a[72:75], v[152:155]
 buffer_load_dwordx4 a[40:43], v8, s[16:19], s42 offen offset:0 sc1
 v_mfma_f32_16x16x32_bf16 v[148:151], a[8:11], a[68:71], v[148:151]
 ds_read_b64_tr_b16 a[4:5], v10 offset:49312
 ds_read_b64_tr_b16 a[6:7], v10 offset:51104
 v_mfma_f32_16x16x32_bf16 v[148:151], a[12:15], a[84:87], v[148:151]
 v_mfma_f32_16x16x32_bf16 v[144:147], a[12:15], a[80:83], v[144:147]
 v_mfma_f32_16x16x32_bf16 v[144:147], a[8:11], a[64:67], v[144:147]
 buffer_store_dwordx4 a[160:163], v6, s[88:91], s44 offen offset:1024 sc1
 s_waitcnt lgkmcnt(8)
 v_mfma_f32_16x16x32_bf16 v[160:163], a[16:19], a[64:67], v[160:163]
 ds_read_b64_tr_b16 a[8:9], v10 offset:41120
 ds_read_b64_tr_b16 a[10:11], v10 offset:42912
 v_mfma_f32_16x16x32_bf16 v[160:163], a[20:23], a[80:83], v[160:163]
 buffer_load_dwordx4 a[48:51], v6, s[16:19], s42 offen offset:1024 sc1
 v_mfma_f32_16x16x32_bf16 v[164:167], a[20:23], a[84:87], v[164:167]
 v_mfma_f32_16x16x32_bf16 v[164:167], a[16:19], a[68:71], v[164:167]
 v_mfma_f32_16x16x32_bf16 v[168:171], a[16:19], a[72:75], v[168:171]
 ds_read_b64_tr_b16 a[12:13], v10 offset:57504
 ds_read_b64_tr_b16 a[14:15], v10 offset:59296
 v_mfma_f32_16x16x32_bf16 v[168:171], a[20:23], a[88:91], v[168:171]
 v_mfma_f32_16x16x32_bf16 v[172:175], a[20:23], a[92:95], v[172:175]
 v_mfma_f32_16x16x32_bf16 v[172:175], a[16:19], a[76:79], v[172:175]
 buffer_load_dwordx4 a[52:55], v7, s[16:19], s42 offen offset:1024 sc1
 s_waitcnt lgkmcnt(8)
 v_mfma_f32_16x16x32_bf16 v[188:191], a[24:27], a[76:79], v[188:191]
 ds_read_b64_tr_b16 a[16:17], v10 offset:32960
 ds_read_b64_tr_b16 a[18:19], v10 offset:34752
 v_mfma_f32_16x16x32_bf16 v[188:191], a[28:31], a[92:95], v[188:191]
 v_mfma_f32_16x16x32_bf16 v[184:187], a[28:31], a[88:91], v[184:187]
 v_mfma_f32_16x16x32_bf16 v[184:187], a[24:27], a[72:75], v[184:187]
 v_mfma_f32_16x16x32_bf16 v[180:183], a[24:27], a[68:71], v[180:183]
 ds_read_b64_tr_b16 a[20:21], v10 offset:49344
 ds_read_b64_tr_b16 a[22:23], v10 offset:51136
 v_mfma_f32_16x16x32_bf16 v[180:183], a[28:31], a[84:87], v[180:183]
 buffer_load_dwordx4 a[56:59], v8, s[16:19], s42 offen offset:1024 sc1
 v_mfma_f32_16x16x32_bf16 v[176:179], a[28:31], a[80:83], v[176:179]
 v_mfma_f32_16x16x32_bf16 v[176:179], a[24:27], a[64:67], v[176:179]
 s_waitcnt lgkmcnt(8)
 v_mfma_f32_16x16x32_bf16 v[192:195], a[0:3], a[64:67], v[192:195]
 ds_read_b64_tr_b16 a[24:25], v10 offset:41152
 ds_read_b64_tr_b16 a[26:27], v10 offset:42944
 v_mfma_f32_16x16x32_bf16 v[192:195], a[4:7], a[80:83], v[192:195]
 v_mfma_f32_16x16x32_bf16 v[196:199], a[4:7], a[84:87], v[196:199]
 v_mfma_f32_16x16x32_bf16 v[196:199], a[0:3], a[68:71], v[196:199]
 buffer_load_dwordx4 a[60:63], v9, s[16:19], s42 offen offset:1024 sc1
 v_mfma_f32_16x16x32_bf16 v[200:203], a[0:3], a[72:75], v[200:203]
 ds_read_b64_tr_b16 a[28:29], v10 offset:57536
 ds_read_b64_tr_b16 a[30:31], v10 offset:59328
 v_mfma_f32_16x16x32_bf16 v[200:203], a[4:7], a[88:91], v[200:203]
 v_mfma_f32_16x16x32_bf16 v[204:207], a[4:7], a[92:95], v[204:207]
 v_mfma_f32_16x16x32_bf16 v[204:207], a[0:3], a[76:79], v[204:207]
 s_waitcnt lgkmcnt(8)
 v_mfma_f32_16x16x32_bf16 v[220:223], a[8:11], a[76:79], v[220:223]
 s_waitcnt vmcnt(42)
 s_barrier
 ds_read_b64_tr_b16 a[0:1], v11 offset:0
 v_mfma_f32_16x16x32_bf16 v[220:223], a[12:15], a[92:95], v[220:223]
 ds_read_b64_tr_b16 a[2:3], v11 offset:1792
 v_mfma_f32_16x16x32_bf16 v[216:219], a[12:15], a[88:91], v[216:219]
 v_mfma_f32_16x16x32_bf16 v[216:219], a[8:11], a[72:75], v[216:219]
 v_mfma_f32_16x16x32_bf16 v[212:215], a[8:11], a[68:71], v[212:215]
 ds_read_b64_tr_b16 a[4:5], v11 offset:16384
 ds_read_b64_tr_b16 a[6:7], v11 offset:18176
 v_mfma_f32_16x16x32_bf16 v[212:215], a[12:15], a[84:87], v[212:215]
 v_mfma_f32_16x16x32_bf16 v[208:211], a[12:15], a[80:83], v[208:211]
 v_mfma_f32_16x16x32_bf16 v[208:211], a[8:11], a[64:67], v[208:211]
 s_waitcnt lgkmcnt(8)
 v_mfma_f32_16x16x32_bf16 v[224:227], a[16:19], a[64:67], v[224:227]
 ds_read_b64_tr_b16 a[8:9], v11 offset:8192
 ds_read_b64_tr_b16 a[10:11], v11 offset:9984
 v_mfma_f32_16x16x32_bf16 v[224:227], a[20:23], a[80:83], v[224:227]
 v_mfma_f32_16x16x32_bf16 v[228:231], a[20:23], a[84:87], v[228:231]
 v_mfma_f32_16x16x32_bf16 v[228:231], a[16:19], a[68:71], v[228:231]
 v_mfma_f32_16x16x32_bf16 v[232:235], a[16:19], a[72:75], v[232:235]
 ds_read_b64_tr_b16 a[12:13], v11 offset:24576
 ds_read_b64_tr_b16 a[14:15], v11 offset:26368
 v_mfma_f32_16x16x32_bf16 v[232:235], a[20:23], a[88:91], v[232:235]
 v_mfma_f32_16x16x32_bf16 v[236:239], a[20:23], a[92:95], v[236:239]
 v_mfma_f32_16x16x32_bf16 v[236:239], a[16:19], a[76:79], v[236:239]
 s_waitcnt lgkmcnt(8)
 v_mfma_f32_16x16x32_bf16 v[252:255], a[24:27], a[76:79], v[252:255]
 ds_read_b64_tr_b16 a[16:17], v11 offset:32
 ds_read_b64_tr_b16 a[18:19], v11 offset:1824
 v_mfma_f32_16x16x32_bf16 v[252:255], a[28:31], a[92:95], v[252:255]
 buffer_load_dwordx4 a[76:79], v9, s[16:19], s42 offen offset:2048 sc1
 v_mfma_f32_16x16x32_bf16 v[248:251], a[28:31], a[88:91], v[248:251]
 v_mfma_f32_16x16x32_bf16 v[248:251], a[24:27], a[72:75], v[248:251]
 v_mfma_f32_16x16x32_bf16 v[244:247], a[24:27], a[68:71], v[244:247]
 ds_read_b64_tr_b16 a[20:21], v11 offset:16416
 ds_read_b64_tr_b16 a[22:23], v11 offset:18208
 v_mfma_f32_16x16x32_bf16 v[244:247], a[28:31], a[84:87], v[244:247]
 s_barrier
 s_mov_b32 s40, 5963776
 v_mfma_f32_16x16x32_bf16 v[240:243], a[28:31], a[80:83], v[240:243]
 s_add_u32 m0, s38, 32768
 v_mfma_f32_16x16x32_bf16 v[240:243], a[24:27], a[64:67], v[240:243]
 buffer_load_dwordx4 v2, s[12:15], s40 offen offset:0 lds
 s_waitcnt vmcnt(40) lgkmcnt(8)
 v_mfma_f32_16x16x32_bf16 v[32:35], a[0:3], a[96:99], v[32:35]
 ds_read_b64_tr_b16 a[24:25], v11 offset:8224
 s_waitcnt vmcnt(36)
 v_mfma_f32_16x16x32_bf16 v[32:35], a[4:7], a[112:115], v[32:35]
 ds_read_b64_tr_b16 a[26:27], v11 offset:10016
 v_mfma_f32_16x16x32_bf16 v[36:39], a[4:7], a[116:119], v[36:39]
 v_accvgpr_read_b32 v26, a176
 v_accvgpr_read_b32 v27, a177
 v_mfma_f32_16x16x32_bf16 v[36:39], a[0:3], a[100:103], v[36:39]
 global_load_dword v31, v[26:27], off
 v_mfma_f32_16x16x32_bf16 v[40:43], a[0:3], a[104:107], v[40:43]
 ds_read_b64_tr_b16 a[28:29], v11 offset:24608
 ds_read_b64_tr_b16 a[30:31], v11 offset:26400
 v_mfma_f32_16x16x32_bf16 v[40:43], a[4:7], a[120:123], v[40:43]
 buffer_load_dwordx4 v3, s[12:15], s40 offen offset:1024 lds
 v_mfma_f32_16x16x32_bf16 v[44:47], a[4:7], a[124:127], v[44:47]
 v_mfma_f32_16x16x32_bf16 v[44:47], a[0:3], a[108:111], v[44:47]
 buffer_store_dwordx4 a[160:163], v6, s[88:91], s44 offen offset:2048 sc1
 s_waitcnt lgkmcnt(8)
 v_mfma_f32_16x16x32_bf16 v[60:63], a[8:11], a[108:111], v[60:63]
 ds_read_b64_tr_b16 a[0:1], v11 offset:64
 ds_read_b64_tr_b16 a[2:3], v11 offset:1856
 v_mfma_f32_16x16x32_bf16 v[60:63], a[12:15], a[124:127], v[60:63]
 v_mfma_f32_16x16x32_bf16 v[56:59], a[12:15], a[120:123], v[56:59]
 v_mfma_f32_16x16x32_bf16 v[56:59], a[8:11], a[104:107], v[56:59]
 buffer_load_dwordx4 v4, s[12:15], s40 offen offset:2048 lds
 v_mfma_f32_16x16x32_bf16 v[52:55], a[8:11], a[100:103], v[52:55]
 ds_read_b64_tr_b16 a[4:5], v11 offset:16448
 ds_read_b64_tr_b16 a[6:7], v11 offset:18240
 v_mfma_f32_16x16x32_bf16 v[52:55], a[12:15], a[116:119], v[52:55]
 v_mfma_f32_16x16x32_bf16 v[48:51], a[12:15], a[112:115], v[48:51]
 v_mfma_f32_16x16x32_bf16 v[48:51], a[8:11], a[96:99], v[48:51]
 s_waitcnt lgkmcnt(8)
 v_mfma_f32_16x16x32_bf16 v[64:67], a[16:19], a[96:99], v[64:67]
 ds_read_b64_tr_b16 a[8:9], v11 offset:8256
 ds_read_b64_tr_b16 a[10:11], v11 offset:10048
 v_mfma_f32_16x16x32_bf16 v[64:67], a[20:23], a[112:115], v[64:67]
 buffer_load_dwordx4 v5, s[12:15], s40 offen offset:3072 lds
 v_mfma_f32_16x16x32_bf16 v[68:71], a[20:23], a[116:119], v[68:71]
 v_mfma_f32_16x16x32_bf16 v[68:71], a[16:19], a[100:103], v[68:71]
 v_mfma_f32_16x16x32_bf16 v[72:75], a[16:19], a[104:107], v[72:75]
 ds_read_b64_tr_b16 a[12:13], v11 offset:24640
 ds_read_b64_tr_b16 a[14:15], v11 offset:26432
 v_mfma_f32_16x16x32_bf16 v[72:75], a[20:23], a[120:123], v[72:75]
 s_mov_b32 s40, 6193152
 s_add_u32 m0, s38, 49152
 v_mfma_f32_16x16x32_bf16 v[76:79], a[20:23], a[124:127], v[76:79]
 v_mfma_f32_16x16x32_bf16 v[76:79], a[16:19], a[108:111], v[76:79]
 buffer_load_dwordx4 v2, s[12:15], s40 offen offset:0 lds
 s_waitcnt lgkmcnt(8)
 v_mfma_f32_16x16x32_bf16 v[92:95], a[24:27], a[108:111], v[92:95]
 ds_read_b64_tr_b16 a[16:17], v11 offset:96
 ds_read_b64_tr_b16 a[18:19], v11 offset:1888
 v_mfma_f32_16x16x32_bf16 v[92:95], a[28:31], a[124:127], v[92:95]
 v_mfma_f32_16x16x32_bf16 v[88:91], a[28:31], a[120:123], v[88:91]
 v_mfma_f32_16x16x32_bf16 v[88:91], a[24:27], a[104:107], v[88:91]
 v_mfma_f32_16x16x32_bf16 v[84:87], a[24:27], a[100:103], v[84:87]
 ds_read_b64_tr_b16 a[20:21], v11 offset:16480
 ds_read_b64_tr_b16 a[22:23], v11 offset:18272
 v_mfma_f32_16x16x32_bf16 v[84:87], a[28:31], a[116:119], v[84:87]
 buffer_load_dwordx4 v3, s[12:15], s40 offen offset:1024 lds
 v_mfma_f32_16x16x32_bf16 v[80:83], a[28:31], a[112:115], v[80:83]
 v_mfma_f32_16x16x32_bf16 v[80:83], a[24:27], a[96:99], v[80:83]
 s_waitcnt lgkmcnt(8)
 v_mfma_f32_16x16x32_bf16 v[96:99], a[0:3], a[96:99], v[96:99]
 ds_read_b64_tr_b16 a[24:25], v11 offset:8288
 ds_read_b64_tr_b16 a[26:27], v11 offset:10080
 v_mfma_f32_16x16x32_bf16 v[96:99], a[4:7], a[112:115], v[96:99]
 v_mfma_f32_16x16x32_bf16 v[100:103], a[4:7], a[116:119], v[100:103]
 v_mfma_f32_16x16x32_bf16 v[100:103], a[0:3], a[100:103], v[100:103]
 buffer_load_dwordx4 v4, s[12:15], s40 offen offset:2048 lds
 v_mfma_f32_16x16x32_bf16 v[104:107], a[0:3], a[104:107], v[104:107]
 ds_read_b64_tr_b16 a[28:29], v11 offset:24672
 ds_read_b64_tr_b16 a[30:31], v11 offset:26464
 v_mfma_f32_16x16x32_bf16 v[104:107], a[4:7], a[120:123], v[104:107]
 v_mfma_f32_16x16x32_bf16 v[108:111], a[4:7], a[124:127], v[108:111]
 v_mfma_f32_16x16x32_bf16 v[108:111], a[0:3], a[108:111], v[108:111]
 s_waitcnt lgkmcnt(8)
 v_mfma_f32_16x16x32_bf16 v[124:127], a[8:11], a[108:111], v[124:127]
 ds_read_b64_tr_b16 a[0:1], v11 offset:128
 ds_read_b64_tr_b16 a[2:3], v11 offset:1920
 v_mfma_f32_16x16x32_bf16 v[124:127], a[12:15], a[124:127], v[124:127]
 buffer_load_dwordx4 v5, s[12:15], s40 offen offset:3072 lds
 v_mfma_f32_16x16x32_bf16 v[120:123], a[12:15], a[120:123], v[120:123]
 v_mfma_f32_16x16x32_bf16 v[120:123], a[8:11], a[104:107], v[120:123]
 v_mfma_f32_16x16x32_bf16 v[116:119], a[8:11], a[100:103], v[116:119]
 ds_read_b64_tr_b16 a[4:5], v11 offset:16512
 ds_read_b64_tr_b16 a[6:7], v11 offset:18304
 v_mfma_f32_16x16x32_bf16 v[116:119], a[12:15], a[116:119], v[116:119]
 v_mfma_f32_16x16x32_bf16 v[112:115], a[12:15], a[112:115], v[112:115]
 v_mfma_f32_16x16x32_bf16 v[112:115], a[8:11], a[96:99], v[112:115]
 buffer_load_dwordx4 a[64:67], v6, s[16:19], s42 offen offset:2048 sc1
 s_waitcnt lgkmcnt(8)
 v_mfma_f32_16x16x32_bf16 v[128:131], a[16:19], a[96:99], v[128:131]
 ds_read_b64_tr_b16 a[8:9], v11 offset:8320
 ds_read_b64_tr_b16 a[10:11], v11 offset:10112
 v_mfma_f32_16x16x32_bf16 v[128:131], a[20:23], a[112:115], v[128:131]
 v_mfma_f32_16x16x32_bf16 v[132:135], a[20:23], a[116:119], v[132:135]
 v_mfma_f32_16x16x32_bf16 v[132:135], a[16:19], a[100:103], v[132:135]
 v_mfma_f32_16x16x32_bf16 v[136:139], a[16:19], a[104:107], v[136:139]
 ds_read_b64_tr_b16 a[12:13], v11 offset:24704
 ds_read_b64_tr_b16 a[14:15], v11 offset:26496
 v_mfma_f32_16x16x32_bf16 v[136:139], a[20:23], a[120:123], v[136:139]
 buffer_load_dwordx4 a[68:71], v7, s[16:19], s42 offen offset:2048 sc1
 v_mfma_f32_16x16x32_bf16 v[140:143], a[20:23], a[124:127], v[140:143]
 v_mfma_f32_16x16x32_bf16 v[140:143], a[16:19], a[108:111], v[140:143]
 s_waitcnt lgkmcnt(8)
 v_mfma_f32_16x16x32_bf16 v[156:159], a[24:27], a[108:111], v[156:159]
 ds_read_b64_tr_b16 a[16:17], v11 offset:160
 ds_read_b64_tr_b16 a[18:19], v11 offset:1952
 v_mfma_f32_16x16x32_bf16 v[156:159], a[28:31], a[124:127], v[156:159]
 v_mfma_f32_16x16x32_bf16 v[152:155], a[28:31], a[120:123], v[152:155]
 v_mfma_f32_16x16x32_bf16 v[152:155], a[24:27], a[104:107], v[152:155]
 buffer_load_dwordx4 a[72:75], v8, s[16:19], s42 offen offset:2048 sc1
 v_mfma_f32_16x16x32_bf16 v[148:151], a[24:27], a[100:103], v[148:151]
 ds_read_b64_tr_b16 a[20:21], v11 offset:16544
 ds_read_b64_tr_b16 a[22:23], v11 offset:18336
 v_mfma_f32_16x16x32_bf16 v[148:151], a[28:31], a[116:119], v[148:151]
 v_mfma_f32_16x16x32_bf16 v[144:147], a[28:31], a[112:115], v[144:147]
 v_mfma_f32_16x16x32_bf16 v[144:147], a[24:27], a[96:99], v[144:147]
 buffer_store_dwordx4 a[160:163], v6, s[88:91], s44 offen offset:3072 sc1
 s_waitcnt lgkmcnt(8)
 v_mfma_f32_16x16x32_bf16 v[160:163], a[0:3], a[96:99], v[160:163]
 ds_read_b64_tr_b16 a[24:25], v11 offset:8352
 ds_read_b64_tr_b16 a[26:27], v11 offset:10144
 v_mfma_f32_16x16x32_bf16 v[160:163], a[4:7], a[112:115], v[160:163]
 buffer_load_dwordx4 a[80:83], v6, s[16:19], s42 offen offset:3072 sc1
 v_mfma_f32_16x16x32_bf16 v[164:167], a[4:7], a[116:119], v[164:167]
 v_mfma_f32_16x16x32_bf16 v[164:167], a[0:3], a[100:103], v[164:167]
 v_mfma_f32_16x16x32_bf16 v[168:171], a[0:3], a[104:107], v[168:171]
 ds_read_b64_tr_b16 a[28:29], v11 offset:24736
 ds_read_b64_tr_b16 a[30:31], v11 offset:26528
 v_mfma_f32_16x16x32_bf16 v[168:171], a[4:7], a[120:123], v[168:171]
 v_mfma_f32_16x16x32_bf16 v[172:175], a[4:7], a[124:127], v[172:175]
 v_mfma_f32_16x16x32_bf16 v[172:175], a[0:3], a[108:111], v[172:175]
 buffer_load_dwordx4 a[84:87], v7, s[16:19], s42 offen offset:3072 sc1
 s_waitcnt lgkmcnt(8)
 v_mfma_f32_16x16x32_bf16 v[188:191], a[8:11], a[108:111], v[188:191]
 ds_read_b64_tr_b16 a[0:1], v11 offset:192
 ds_read_b64_tr_b16 a[2:3], v11 offset:1984
 v_mfma_f32_16x16x32_bf16 v[188:191], a[12:15], a[124:127], v[188:191]
 v_mfma_f32_16x16x32_bf16 v[184:187], a[12:15], a[120:123], v[184:187]
 v_mfma_f32_16x16x32_bf16 v[184:187], a[8:11], a[104:107], v[184:187]
 v_mfma_f32_16x16x32_bf16 v[180:183], a[8:11], a[100:103], v[180:183]
 ds_read_b64_tr_b16 a[4:5], v11 offset:16576
 ds_read_b64_tr_b16 a[6:7], v11 offset:18368
 v_mfma_f32_16x16x32_bf16 v[180:183], a[12:15], a[116:119], v[180:183]
 buffer_load_dwordx4 a[88:91], v8, s[16:19], s42 offen offset:3072 sc1
 v_mfma_f32_16x16x32_bf16 v[176:179], a[12:15], a[112:115], v[176:179]
 v_mfma_f32_16x16x32_bf16 v[176:179], a[8:11], a[96:99], v[176:179]
 s_waitcnt lgkmcnt(8)
 v_mfma_f32_16x16x32_bf16 v[192:195], a[16:19], a[96:99], v[192:195]
 ds_read_b64_tr_b16 a[8:9], v11 offset:8384
 ds_read_b64_tr_b16 a[10:11], v11 offset:10176
 v_mfma_f32_16x16x32_bf16 v[192:195], a[20:23], a[112:115], v[192:195]
 v_mfma_f32_16x16x32_bf16 v[196:199], a[20:23], a[116:119], v[196:199]
 v_mfma_f32_16x16x32_bf16 v[196:199], a[16:19], a[100:103], v[196:199]
 buffer_load_dwordx4 a[92:95], v9, s[16:19], s42 offen offset:3072 sc1
 v_mfma_f32_16x16x32_bf16 v[200:203], a[16:19], a[104:107], v[200:203]
 ds_read_b64_tr_b16 a[12:13], v11 offset:24768
 ds_read_b64_tr_b16 a[14:15], v11 offset:26560
 v_mfma_f32_16x16x32_bf16 v[200:203], a[20:23], a[120:123], v[200:203]
 v_mfma_f32_16x16x32_bf16 v[204:207], a[20:23], a[124:127], v[204:207]
 v_mfma_f32_16x16x32_bf16 v[204:207], a[16:19], a[108:111], v[204:207]
 s_waitcnt lgkmcnt(8)
 v_mfma_f32_16x16x32_bf16 v[220:223], a[24:27], a[108:111], v[220:223]
 s_waitcnt vmcnt(44)
 s_barrier
 ds_read_b64_tr_b16 a[16:17], v11 offset:32768
 v_mfma_f32_16x16x32_bf16 v[220:223], a[28:31], a[124:127], v[220:223]
 ds_read_b64_tr_b16 a[18:19], v11 offset:34560
 v_mfma_f32_16x16x32_bf16 v[216:219], a[28:31], a[120:123], v[216:219]
 v_mfma_f32_16x16x32_bf16 v[216:219], a[24:27], a[104:107], v[216:219]
 v_mfma_f32_16x16x32_bf16 v[212:215], a[24:27], a[100:103], v[212:215]
 ds_read_b64_tr_b16 a[20:21], v11 offset:49152
 ds_read_b64_tr_b16 a[22:23], v11 offset:50944
 v_mfma_f32_16x16x32_bf16 v[212:215], a[28:31], a[116:119], v[212:215]
 v_mfma_f32_16x16x32_bf16 v[208:211], a[28:31], a[112:115], v[208:211]
 v_mfma_f32_16x16x32_bf16 v[208:211], a[24:27], a[96:99], v[208:211]
 s_waitcnt lgkmcnt(8)
 v_mfma_f32_16x16x32_bf16 v[224:227], a[0:3], a[96:99], v[224:227]
 ds_read_b64_tr_b16 a[24:25], v11 offset:40960
 ds_read_b64_tr_b16 a[26:27], v11 offset:42752
 s_branch m_ps_p3_4
m_pad_p3_4:
 s_branch m_pad_p3_7
m_ps_p3_4:
 v_mfma_f32_16x16x32_bf16 v[224:227], a[4:7], a[112:115], v[224:227]
 v_mfma_f32_16x16x32_bf16 v[228:231], a[4:7], a[116:119], v[228:231]
 v_mfma_f32_16x16x32_bf16 v[228:231], a[0:3], a[100:103], v[228:231]
 v_mfma_f32_16x16x32_bf16 v[232:235], a[0:3], a[104:107], v[232:235]
 ds_read_b64_tr_b16 a[28:29], v11 offset:57344
 ds_read_b64_tr_b16 a[30:31], v11 offset:59136
 v_mfma_f32_16x16x32_bf16 v[232:235], a[4:7], a[120:123], v[232:235]
 v_mfma_f32_16x16x32_bf16 v[236:239], a[4:7], a[124:127], v[236:239]
 v_mfma_f32_16x16x32_bf16 v[236:239], a[0:3], a[108:111], v[236:239]
 s_mov_b32 s42, 28672
 s_waitcnt lgkmcnt(8)
 v_mfma_f32_16x16x32_bf16 v[252:255], a[8:11], a[108:111], v[252:255]
 ds_read_b64_tr_b16 a[0:1], v11 offset:32800
 ds_read_b64_tr_b16 a[2:3], v11 offset:34592
 v_mfma_f32_16x16x32_bf16 v[252:255], a[12:15], a[124:127], v[252:255]
 buffer_load_dwordx4 a[108:111], v9, s[16:19], s42 offen offset:0 sc1
 v_mfma_f32_16x16x32_bf16 v[248:251], a[12:15], a[120:123], v[248:251]
 v_mfma_f32_16x16x32_bf16 v[248:251], a[8:11], a[104:107], v[248:251]
 v_mfma_f32_16x16x32_bf16 v[244:247], a[8:11], a[100:103], v[244:247]
 ds_read_b64_tr_b16 a[4:5], v11 offset:49184
 ds_read_b64_tr_b16 a[6:7], v11 offset:50976
 v_mfma_f32_16x16x32_bf16 v[244:247], a[12:15], a[116:119], v[244:247]
 s_barrier
 s_mov_b32 s40, 6422528
 v_mfma_f32_16x16x32_bf16 v[240:243], a[12:15], a[112:115], v[240:243]
 s_add_u32 m0, s38, 65536
 v_mfma_f32_16x16x32_bf16 v[240:243], a[8:11], a[96:99], v[240:243]
 buffer_load_dwordx4 v2, s[12:15], s40 offen offset:0 lds
 s_waitcnt vmcnt(43) lgkmcnt(8)
 v_mfma_f32_16x16x32_bf16 v[32:35], a[16:19], a[128:131], v[32:35]
 ds_read_b64_tr_b16 a[8:9], v11 offset:40992
 s_waitcnt vmcnt(39)
 v_mfma_f32_16x16x32_bf16 v[32:35], a[20:23], a[144:147], v[32:35]
 ds_read_b64_tr_b16 a[10:11], v11 offset:42784
 v_mfma_f32_16x16x32_bf16 v[36:39], a[20:23], a[148:151], v[36:39]
 v_mfma_f32_16x16x32_bf16 v[36:39], a[16:19], a[132:135], v[36:39]
 v_mfma_f32_16x16x32_bf16 v[40:43], a[16:19], a[136:139], v[40:43]
 ds_read_b64_tr_b16 a[12:13], v11 offset:57376
 ds_read_b64_tr_b16 a[14:15], v11 offset:59168
 v_mfma_f32_16x16x32_bf16 v[40:43], a[20:23], a[152:155], v[40:43]
 buffer_load_dwordx4 v3, s[12:15], s40 offen offset:1024 lds
 v_mfma_f32_16x16x32_bf16 v[44:47], a[20:23], a[156:159], v[44:47]
 v_mfma_f32_16x16x32_bf16 v[44:47], a[16:19], a[140:143], v[44:47]
 s_waitcnt lgkmcnt(8)
 v_mfma_f32_16x16x32_bf16 v[60:63], a[24:27], a[140:143], v[60:63]
 ds_read_b64_tr_b16 a[16:17], v11 offset:32832
 ds_read_b64_tr_b16 a[18:19], v11 offset:34624
 v_mfma_f32_16x16x32_bf16 v[60:63], a[28:31], a[156:159], v[60:63]
 v_mfma_f32_16x16x32_bf16 v[56:59], a[28:31], a[152:155], v[56:59]
 v_mfma_f32_16x16x32_bf16 v[56:59], a[24:27], a[136:139], v[56:59]
 buffer_load_dwordx4 v4, s[12:15], s40 offen offset:2048 lds
 v_mfma_f32_16x16x32_bf16 v[52:55], a[24:27], a[132:135], v[52:55]
 ds_read_b64_tr_b16 a[20:21], v11 offset:49216
 ds_read_b64_tr_b16 a[22:23], v11 offset:51008
 v_mfma_f32_16x16x32_bf16 v[52:55], a[28:31], a[148:151], v[52:55]
 v_mfma_f32_16x16x32_bf16 v[48:51], a[28:31], a[144:147], v[48:51]
 v_mfma_f32_16x16x32_bf16 v[48:51], a[24:27], a[128:131], v[48:51]
 s_waitcnt lgkmcnt(8)
 v_mfma_f32_16x16x32_bf16 v[64:67], a[0:3], a[128:131], v[64:67]
 ds_read_b64_tr_b16 a[24:25], v11 offset:41024
 ds_read_b64_tr_b16 a[26:27], v11 offset:42816
 v_mfma_f32_16x16x32_bf16 v[64:67], a[4:7], a[144:147], v[64:67]
 buffer_load_dwordx4 v5, s[12:15], s40 offen offset:3072 lds
 v_mfma_f32_16x16x32_bf16 v[68:71], a[4:7], a[148:151], v[68:71]
 v_mfma_f32_16x16x32_bf16 v[68:71], a[0:3], a[132:135], v[68:71]
 v_mfma_f32_16x16x32_bf16 v[72:75], a[0:3], a[136:139], v[72:75]
 ds_read_b64_tr_b16 a[28:29], v11 offset:57408
 ds_read_b64_tr_b16 a[30:31], v11 offset:59200
 v_mfma_f32_16x16x32_bf16 v[72:75], a[4:7], a[152:155], v[72:75]
 s_mov_b32 s40, 6651904
 s_add_u32 m0, s38, 81920
 v_mfma_f32_16x16x32_bf16 v[76:79], a[4:7], a[156:159], v[76:79]
 v_mfma_f32_16x16x32_bf16 v[76:79], a[0:3], a[140:143], v[76:79]
 buffer_load_dwordx4 v2, s[12:15], s40 offen offset:0 lds
 s_waitcnt lgkmcnt(8)
 v_mfma_f32_16x16x32_bf16 v[92:95], a[8:11], a[140:143], v[92:95]
 ds_read_b64_tr_b16 a[0:1], v11 offset:32864
 ds_read_b64_tr_b16 a[2:3], v11 offset:34656
 v_mfma_f32_16x16x32_bf16 v[92:95], a[12:15], a[156:159], v[92:95]
 v_mfma_f32_16x16x32_bf16 v[88:91], a[12:15], a[152:155], v[88:91]
 v_mfma_f32_16x16x32_bf16 v[88:91], a[8:11], a[136:139], v[88:91]
 v_mfma_f32_16x16x32_bf16 v[84:87], a[8:11], a[132:135], v[84:87]
 ds_read_b64_tr_b16 a[4:5], v11 offset:49248
 ds_read_b64_tr_b16 a[6:7], v11 offset:51040
 v_mfma_f32_16x16x32_bf16 v[84:87], a[12:15], a[148:151], v[84:87]
 buffer_load_dwordx4 v3, s[12:15], s40 offen offset:1024 lds
 v_mfma_f32_16x16x32_bf16 v[80:83], a[12:15], a[144:147], v[80:83]
 v_mfma_f32_16x16x32_bf16 v[80:83], a[8:11], a[128:131], v[80:83]
 s_waitcnt lgkmcnt(8)
 v_mfma_f32_16x16x32_bf16 v[96:99], a[16:19], a[128:131], v[96:99]
 ds_read_b64_tr_b16 a[8:9], v11 offset:41056
 ds_read_b64_tr_b16 a[10:11], v11 offset:42848
 v_mfma_f32_16x16x32_bf16 v[96:99], a[20:23], a[144:147], v[96:99]
 v_mfma_f32_16x16x32_bf16 v[100:103], a[20:23], a[148:151], v[100:103]
 v_mfma_f32_16x16x32_bf16 v[100:103], a[16:19], a[132:135], v[100:103]
 buffer_load_dwordx4 v4, s[12:15], s40 offen offset:2048 lds
 v_mfma_f32_16x16x32_bf16 v[104:107], a[16:19], a[136:139], v[104:107]
 ds_read_b64_tr_b16 a[12:13], v11 offset:57440
 ds_read_b64_tr_b16 a[14:15], v11 offset:59232
 v_mfma_f32_16x16x32_bf16 v[104:107], a[20:23], a[152:155], v[104:107]
 v_mfma_f32_16x16x32_bf16 v[108:111], a[20:23], a[156:159], v[108:111]
 v_mfma_f32_16x16x32_bf16 v[108:111], a[16:19], a[140:143], v[108:111]
 s_waitcnt lgkmcnt(8)
 v_mfma_f32_16x16x32_bf16 v[124:127], a[24:27], a[140:143], v[124:127]
 ds_read_b64_tr_b16 a[16:17], v11 offset:32896
 ds_read_b64_tr_b16 a[18:19], v11 offset:34688
 v_mfma_f32_16x16x32_bf16 v[124:127], a[28:31], a[156:159], v[124:127]
 buffer_load_dwordx4 v5, s[12:15], s40 offen offset:3072 lds
 v_mfma_f32_16x16x32_bf16 v[120:123], a[28:31], a[152:155], v[120:123]
 v_mfma_f32_16x16x32_bf16 v[120:123], a[24:27], a[136:139], v[120:123]
 v_mfma_f32_16x16x32_bf16 v[116:119], a[24:27], a[132:135], v[116:119]
 ds_read_b64_tr_b16 a[20:21], v11 offset:49280
 ds_read_b64_tr_b16 a[22:23], v11 offset:51072
 v_mfma_f32_16x16x32_bf16 v[116:119], a[28:31], a[148:151], v[116:119]
 v_mfma_f32_16x16x32_bf16 v[112:115], a[28:31], a[144:147], v[112:115]
 v_mfma_f32_16x16x32_bf16 v[112:115], a[24:27], a[128:131], v[112:115]
 buffer_load_dwordx4 a[96:99], v6, s[16:19], s42 offen offset:0 sc1
 s_waitcnt lgkmcnt(8)
 v_mfma_f32_16x16x32_bf16 v[128:131], a[0:3], a[128:131], v[128:131]
 ds_read_b64_tr_b16 a[24:25], v11 offset:41088
 ds_read_b64_tr_b16 a[26:27], v11 offset:42880
 v_mfma_f32_16x16x32_bf16 v[128:131], a[4:7], a[144:147], v[128:131]
 v_mfma_f32_16x16x32_bf16 v[132:135], a[4:7], a[148:151], v[132:135]
 v_mfma_f32_16x16x32_bf16 v[132:135], a[0:3], a[132:135], v[132:135]
 v_mfma_f32_16x16x32_bf16 v[136:139], a[0:3], a[136:139], v[136:139]
 ds_read_b64_tr_b16 a[28:29], v11 offset:57472
 ds_read_b64_tr_b16 a[30:31], v11 offset:59264
 v_mfma_f32_16x16x32_bf16 v[136:139], a[4:7], a[152:155], v[136:139]
 buffer_load_dwordx4 a[100:103], v7, s[16:19], s42 offen offset:0 sc1
 v_mfma_f32_16x16x32_bf16 v[140:143], a[4:7], a[156:159], v[140:143]
 v_mfma_f32_16x16x32_bf16 v[140:143], a[0:3], a[140:143], v[140:143]
 s_waitcnt lgkmcnt(8)
 v_mfma_f32_16x16x32_bf16 v[156:159], a[8:11], a[140:143], v[156:159]
 ds_read_b64_tr_b16 a[0:1], v11 offset:32928
 ds_read_b64_tr_b16 a[2:3], v11 offset:34720
 v_mfma_f32_16x16x32_bf16 v[156:159], a[12:15], a[156:159], v[156:159]
 v_mfma_f32_16x16x32_bf16 v[152:155], a[12:15], a[152:155], v[152:155]
 v_mfma_f32_16x16x32_bf16 v[152:155], a[8:11], a[136:139], v[152:155]
 buffer_load_dwordx4 a[104:107], v8, s[16:19], s42 offen offset:0 sc1
 v_mfma_f32_16x16x32_bf16 v[148:151], a[8:11], a[132:135], v[148:151]
 ds_read_b64_tr_b16 a[4:5], v11 offset:49312
 ds_read_b64_tr_b16 a[6:7], v11 offset:51104
 v_mfma_f32_16x16x32_bf16 v[148:151], a[12:15], a[148:151], v[148:151]
 v_mfma_f32_16x16x32_bf16 v[144:147], a[12:15], a[144:147], v[144:147]
 v_mfma_f32_16x16x32_bf16 v[144:147], a[8:11], a[128:131], v[144:147]
 s_waitcnt lgkmcnt(8)
 v_mfma_f32_16x16x32_bf16 v[160:163], a[16:19], a[128:131], v[160:163]
 ds_read_b64_tr_b16 a[8:9], v11 offset:41120
 ds_read_b64_tr_b16 a[10:11], v11 offset:42912
 v_mfma_f32_16x16x32_bf16 v[160:163], a[20:23], a[144:147], v[160:163]
 buffer_load_dwordx4 a[112:115], v6, s[16:19], s42 offen offset:1024 sc1
 v_mfma_f32_16x16x32_bf16 v[164:167], a[20:23], a[148:151], v[164:167]
 v_mfma_f32_16x16x32_bf16 v[164:167], a[16:19], a[132:135], v[164:167]
 v_mfma_f32_16x16x32_bf16 v[168:171], a[16:19], a[136:139], v[168:171]
 ds_read_b64_tr_b16 a[12:13], v11 offset:57504
 ds_read_b64_tr_b16 a[14:15], v11 offset:59296
 v_mfma_f32_16x16x32_bf16 v[168:171], a[20:23], a[152:155], v[168:171]
 v_mfma_f32_16x16x32_bf16 v[172:175], a[20:23], a[156:159], v[172:175]
 v_mfma_f32_16x16x32_bf16 v[172:175], a[16:19], a[140:143], v[172:175]
 buffer_load_dwordx4 a[116:119], v7, s[16:19], s42 offen offset:1024 sc1
 s_waitcnt lgkmcnt(8)
 v_mfma_f32_16x16x32_bf16 v[188:191], a[24:27], a[140:143], v[188:191]
 ds_read_b64_tr_b16 a[16:17], v11 offset:32960
 ds_read_b64_tr_b16 a[18:19], v11 offset:34752
 v_mfma_f32_16x16x32_bf16 v[188:191], a[28:31], a[156:159], v[188:191]
 v_mfma_f32_16x16x32_bf16 v[184:187], a[28:31], a[152:155], v[184:187]
 v_mfma_f32_16x16x32_bf16 v[184:187], a[24:27], a[136:139], v[184:187]
 v_mfma_f32_16x16x32_bf16 v[180:183], a[24:27], a[132:135], v[180:183]
 ds_read_b64_tr_b16 a[20:21], v11 offset:49344
 ds_read_b64_tr_b16 a[22:23], v11 offset:51136
 v_mfma_f32_16x16x32_bf16 v[180:183], a[28:31], a[148:151], v[180:183]
 buffer_load_dwordx4 a[120:123], v8, s[16:19], s42 offen offset:1024 sc1
 v_mfma_f32_16x16x32_bf16 v[176:179], a[28:31], a[144:147], v[176:179]
 v_mfma_f32_16x16x32_bf16 v[176:179], a[24:27], a[128:131], v[176:179]
 s_waitcnt lgkmcnt(8)
 v_mfma_f32_16x16x32_bf16 v[192:195], a[0:3], a[128:131], v[192:195]
 ds_read_b64_tr_b16 a[24:25], v11 offset:41152
 ds_read_b64_tr_b16 a[26:27], v11 offset:42944
 v_mfma_f32_16x16x32_bf16 v[192:195], a[4:7], a[144:147], v[192:195]
 v_mfma_f32_16x16x32_bf16 v[196:199], a[4:7], a[148:151], v[196:199]
 v_mfma_f32_16x16x32_bf16 v[196:199], a[0:3], a[132:135], v[196:199]
 buffer_load_dwordx4 a[124:127], v9, s[16:19], s42 offen offset:1024 sc1
 v_mfma_f32_16x16x32_bf16 v[200:203], a[0:3], a[136:139], v[200:203]
 ds_read_b64_tr_b16 a[28:29], v11 offset:57536
 ds_read_b64_tr_b16 a[30:31], v11 offset:59328
 v_mfma_f32_16x16x32_bf16 v[200:203], a[4:7], a[152:155], v[200:203]
 v_mfma_f32_16x16x32_bf16 v[204:207], a[4:7], a[156:159], v[204:207]
 v_mfma_f32_16x16x32_bf16 v[204:207], a[0:3], a[140:143], v[204:207]
 s_waitcnt lgkmcnt(8)
 v_mfma_f32_16x16x32_bf16 v[220:223], a[8:11], a[140:143], v[220:223]
 s_waitcnt vmcnt(43)
 s_barrier
 ds_read_b64_tr_b16 a[0:1], v10 offset:0
 v_mfma_f32_16x16x32_bf16 v[220:223], a[12:15], a[156:159], v[220:223]
 ds_read_b64_tr_b16 a[2:3], v10 offset:1792
 v_mfma_f32_16x16x32_bf16 v[216:219], a[12:15], a[152:155], v[216:219]
 v_mfma_f32_16x16x32_bf16 v[216:219], a[8:11], a[136:139], v[216:219]
 v_mfma_f32_16x16x32_bf16 v[212:215], a[8:11], a[132:135], v[212:215]
 ds_read_b64_tr_b16 a[4:5], v10 offset:16384
 ds_read_b64_tr_b16 a[6:7], v10 offset:18176
 v_mfma_f32_16x16x32_bf16 v[212:215], a[12:15], a[148:151], v[212:215]
 v_mfma_f32_16x16x32_bf16 v[208:211], a[12:15], a[144:147], v[208:211]
 v_mfma_f32_16x16x32_bf16 v[208:211], a[8:11], a[128:131], v[208:211]
 s_waitcnt lgkmcnt(8)
 v_mfma_f32_16x16x32_bf16 v[224:227], a[16:19], a[128:131], v[224:227]
 ds_read_b64_tr_b16 a[8:9], v10 offset:8192
 ds_read_b64_tr_b16 a[10:11], v10 offset:9984
 v_mfma_f32_16x16x32_bf16 v[224:227], a[20:23], a[144:147], v[224:227]
 v_mfma_f32_16x16x32_bf16 v[228:231], a[20:23], a[148:151], v[228:231]
 v_mfma_f32_16x16x32_bf16 v[228:231], a[16:19], a[132:135], v[228:231]
 v_mfma_f32_16x16x32_bf16 v[232:235], a[16:19], a[136:139], v[232:235]
 ds_read_b64_tr_b16 a[12:13], v10 offset:24576
 ds_read_b64_tr_b16 a[14:15], v10 offset:26368
 v_mfma_f32_16x16x32_bf16 v[232:235], a[20:23], a[152:155], v[232:235]
 v_mfma_f32_16x16x32_bf16 v[236:239], a[20:23], a[156:159], v[236:239]
 v_mfma_f32_16x16x32_bf16 v[236:239], a[16:19], a[140:143], v[236:239]
 s_waitcnt lgkmcnt(8)
 v_mfma_f32_16x16x32_bf16 v[252:255], a[24:27], a[140:143], v[252:255]
 ds_read_b64_tr_b16 a[16:17], v10 offset:32
 ds_read_b64_tr_b16 a[18:19], v10 offset:1824
 v_mfma_f32_16x16x32_bf16 v[252:255], a[28:31], a[156:159], v[252:255]
 buffer_load_dwordx4 a[140:143], v9, s[16:19], s42 offen offset:2048 sc1
 v_mfma_f32_16x16x32_bf16 v[248:251], a[28:31], a[152:155], v[248:251]
 v_mfma_f32_16x16x32_bf16 v[248:251], a[24:27], a[136:139], v[248:251]
 v_mfma_f32_16x16x32_bf16 v[244:247], a[24:27], a[132:135], v[244:247]
 ds_read_b64_tr_b16 a[20:21], v10 offset:16416
 ds_read_b64_tr_b16 a[22:23], v10 offset:18208
 v_mfma_f32_16x16x32_bf16 v[244:247], a[28:31], a[148:151], v[244:247]
 s_barrier
 s_mov_b32 s40, 6881280
 v_mfma_f32_16x16x32_bf16 v[240:243], a[28:31], a[144:147], v[240:243]
 s_add_u32 m0, s38, 98304
 v_mfma_f32_16x16x32_bf16 v[240:243], a[24:27], a[128:131], v[240:243]
 buffer_load_dwordx4 v2, s[12:15], s40 offen offset:0 lds
 s_waitcnt vmcnt(42) lgkmcnt(8)
 v_mfma_f32_16x16x32_bf16 v[32:35], a[0:3], a[32:35], v[32:35]
 ds_read_b64_tr_b16 a[24:25], v10 offset:8224
 s_waitcnt vmcnt(37)
 v_mfma_f32_16x16x32_bf16 v[32:35], a[4:7], a[48:51], v[32:35]
 ds_read_b64_tr_b16 a[26:27], v10 offset:10016
 v_mfma_f32_16x16x32_bf16 v[36:39], a[4:7], a[52:55], v[36:39]
 v_mfma_f32_16x16x32_bf16 v[36:39], a[0:3], a[36:39], v[36:39]
 v_mfma_f32_16x16x32_bf16 v[40:43], a[0:3], a[40:43], v[40:43]
 ds_read_b64_tr_b16 a[28:29], v10 offset:24608
 ds_read_b64_tr_b16 a[30:31], v10 offset:26400
 v_mfma_f32_16x16x32_bf16 v[40:43], a[4:7], a[56:59], v[40:43]
 buffer_load_dwordx4 v3, s[12:15], s40 offen offset:1024 lds
 v_mfma_f32_16x16x32_bf16 v[44:47], a[4:7], a[60:63], v[44:47]
 v_mfma_f32_16x16x32_bf16 v[44:47], a[0:3], a[44:47], v[44:47]
 s_waitcnt lgkmcnt(8)
 v_mfma_f32_16x16x32_bf16 v[60:63], a[8:11], a[44:47], v[60:63]
 ds_read_b64_tr_b16 a[0:1], v10 offset:64
 ds_read_b64_tr_b16 a[2:3], v10 offset:1856
 v_mfma_f32_16x16x32_bf16 v[60:63], a[12:15], a[60:63], v[60:63]
 v_mfma_f32_16x16x32_bf16 v[56:59], a[12:15], a[56:59], v[56:59]
 v_mfma_f32_16x16x32_bf16 v[56:59], a[8:11], a[40:43], v[56:59]
 buffer_load_dwordx4 v4, s[12:15], s40 offen offset:2048 lds
 v_mfma_f32_16x16x32_bf16 v[52:55], a[8:11], a[36:39], v[52:55]
 ds_read_b64_tr_b16 a[4:5], v10 offset:16448
 ds_read_b64_tr_b16 a[6:7], v10 offset:18240
 v_mfma_f32_16x16x32_bf16 v[52:55], a[12:15], a[52:55], v[52:55]
 v_mfma_f32_16x16x32_bf16 v[48:51], a[12:15], a[48:51], v[48:51]
 v_mfma_f32_16x16x32_bf16 v[48:51], a[8:11], a[32:35], v[48:51]
 s_waitcnt lgkmcnt(8)
 v_mfma_f32_16x16x32_bf16 v[64:67], a[16:19], a[32:35], v[64:67]
 ds_read_b64_tr_b16 a[8:9], v10 offset:8256
 ds_read_b64_tr_b16 a[10:11], v10 offset:10048
 v_mfma_f32_16x16x32_bf16 v[64:67], a[20:23], a[48:51], v[64:67]
 buffer_load_dwordx4 v5, s[12:15], s40 offen offset:3072 lds
 v_mfma_f32_16x16x32_bf16 v[68:71], a[20:23], a[52:55], v[68:71]
 v_mfma_f32_16x16x32_bf16 v[68:71], a[16:19], a[36:39], v[68:71]
 v_mfma_f32_16x16x32_bf16 v[72:75], a[16:19], a[40:43], v[72:75]
 ds_read_b64_tr_b16 a[12:13], v10 offset:24640
 ds_read_b64_tr_b16 a[14:15], v10 offset:26432
 v_mfma_f32_16x16x32_bf16 v[72:75], a[20:23], a[56:59], v[72:75]
 s_mov_b32 s40, 7110656
 s_add_u32 m0, s38, 114688
 v_mfma_f32_16x16x32_bf16 v[76:79], a[20:23], a[60:63], v[76:79]
 v_mfma_f32_16x16x32_bf16 v[76:79], a[16:19], a[44:47], v[76:79]
 buffer_load_dwordx4 v2, s[12:15], s40 offen offset:0 lds
 s_waitcnt lgkmcnt(8)
 v_mfma_f32_16x16x32_bf16 v[92:95], a[24:27], a[44:47], v[92:95]
 ds_read_b64_tr_b16 a[16:17], v10 offset:96
 ds_read_b64_tr_b16 a[18:19], v10 offset:1888
 v_mfma_f32_16x16x32_bf16 v[92:95], a[28:31], a[60:63], v[92:95]
 v_mfma_f32_16x16x32_bf16 v[88:91], a[28:31], a[56:59], v[88:91]
 v_mfma_f32_16x16x32_bf16 v[88:91], a[24:27], a[40:43], v[88:91]
 v_mfma_f32_16x16x32_bf16 v[84:87], a[24:27], a[36:39], v[84:87]
 ds_read_b64_tr_b16 a[20:21], v10 offset:16480
 ds_read_b64_tr_b16 a[22:23], v10 offset:18272
 v_mfma_f32_16x16x32_bf16 v[84:87], a[28:31], a[52:55], v[84:87]
 buffer_load_dwordx4 v3, s[12:15], s40 offen offset:1024 lds
 v_mfma_f32_16x16x32_bf16 v[80:83], a[28:31], a[48:51], v[80:83]
 v_mfma_f32_16x16x32_bf16 v[80:83], a[24:27], a[32:35], v[80:83]
 s_waitcnt lgkmcnt(8)
 v_mfma_f32_16x16x32_bf16 v[96:99], a[0:3], a[32:35], v[96:99]
 ds_read_b64_tr_b16 a[24:25], v10 offset:8288
 ds_read_b64_tr_b16 a[26:27], v10 offset:10080
 v_mfma_f32_16x16x32_bf16 v[96:99], a[4:7], a[48:51], v[96:99]
 v_mfma_f32_16x16x32_bf16 v[100:103], a[4:7], a[52:55], v[100:103]
 v_mfma_f32_16x16x32_bf16 v[100:103], a[0:3], a[36:39], v[100:103]
 buffer_load_dwordx4 v4, s[12:15], s40 offen offset:2048 lds
 v_mfma_f32_16x16x32_bf16 v[104:107], a[0:3], a[40:43], v[104:107]
 ds_read_b64_tr_b16 a[28:29], v10 offset:24672
 ds_read_b64_tr_b16 a[30:31], v10 offset:26464
 v_mfma_f32_16x16x32_bf16 v[104:107], a[4:7], a[56:59], v[104:107]
 v_mfma_f32_16x16x32_bf16 v[108:111], a[4:7], a[60:63], v[108:111]
 v_mfma_f32_16x16x32_bf16 v[108:111], a[0:3], a[44:47], v[108:111]
 s_waitcnt lgkmcnt(8)
 v_mfma_f32_16x16x32_bf16 v[124:127], a[8:11], a[44:47], v[124:127]
 ds_read_b64_tr_b16 a[0:1], v10 offset:128
 ds_read_b64_tr_b16 a[2:3], v10 offset:1920
 v_mfma_f32_16x16x32_bf16 v[124:127], a[12:15], a[60:63], v[124:127]
 buffer_load_dwordx4 v5, s[12:15], s40 offen offset:3072 lds
 v_mfma_f32_16x16x32_bf16 v[120:123], a[12:15], a[56:59], v[120:123]
 v_mfma_f32_16x16x32_bf16 v[120:123], a[8:11], a[40:43], v[120:123]
 v_mfma_f32_16x16x32_bf16 v[116:119], a[8:11], a[36:39], v[116:119]
 ds_read_b64_tr_b16 a[4:5], v10 offset:16512
 ds_read_b64_tr_b16 a[6:7], v10 offset:18304
 v_mfma_f32_16x16x32_bf16 v[116:119], a[12:15], a[52:55], v[116:119]
 v_mfma_f32_16x16x32_bf16 v[112:115], a[12:15], a[48:51], v[112:115]
 v_mfma_f32_16x16x32_bf16 v[112:115], a[8:11], a[32:35], v[112:115]
 buffer_load_dwordx4 a[128:131], v6, s[16:19], s42 offen offset:2048 sc1
 s_waitcnt lgkmcnt(8)
 v_mfma_f32_16x16x32_bf16 v[128:131], a[16:19], a[32:35], v[128:131]
 ds_read_b64_tr_b16 a[8:9], v10 offset:8320
 ds_read_b64_tr_b16 a[10:11], v10 offset:10112
 v_mfma_f32_16x16x32_bf16 v[128:131], a[20:23], a[48:51], v[128:131]
 v_mfma_f32_16x16x32_bf16 v[132:135], a[20:23], a[52:55], v[132:135]
 v_mfma_f32_16x16x32_bf16 v[132:135], a[16:19], a[36:39], v[132:135]
 v_mfma_f32_16x16x32_bf16 v[136:139], a[16:19], a[40:43], v[136:139]
 ds_read_b64_tr_b16 a[12:13], v10 offset:24704
 ds_read_b64_tr_b16 a[14:15], v10 offset:26496
 v_mfma_f32_16x16x32_bf16 v[136:139], a[20:23], a[56:59], v[136:139]
 buffer_load_dwordx4 a[132:135], v7, s[16:19], s42 offen offset:2048 sc1
 v_mfma_f32_16x16x32_bf16 v[140:143], a[20:23], a[60:63], v[140:143]
 v_mfma_f32_16x16x32_bf16 v[140:143], a[16:19], a[44:47], v[140:143]
 s_waitcnt lgkmcnt(8)
 v_mfma_f32_16x16x32_bf16 v[156:159], a[24:27], a[44:47], v[156:159]
 ds_read_b64_tr_b16 a[16:17], v10 offset:160
 ds_read_b64_tr_b16 a[18:19], v10 offset:1952
 v_mfma_f32_16x16x32_bf16 v[156:159], a[28:31], a[60:63], v[156:159]
 v_mfma_f32_16x16x32_bf16 v[152:155], a[28:31], a[56:59], v[152:155]
 v_mfma_f32_16x16x32_bf16 v[152:155], a[24:27], a[40:43], v[152:155]
 buffer_load_dwordx4 a[136:139], v8, s[16:19], s42 offen offset:2048 sc1
 v_mfma_f32_16x16x32_bf16 v[148:151], a[24:27], a[36:39], v[148:151]
 ds_read_b64_tr_b16 a[20:21], v10 offset:16544
 ds_read_b64_tr_b16 a[22:23], v10 offset:18336
 v_mfma_f32_16x16x32_bf16 v[148:151], a[28:31], a[52:55], v[148:151]
 v_mfma_f32_16x16x32_bf16 v[144:147], a[28:31], a[48:51], v[144:147]
 v_mfma_f32_16x16x32_bf16 v[144:147], a[24:27], a[32:35], v[144:147]
 s_waitcnt lgkmcnt(8)
 v_mfma_f32_16x16x32_bf16 v[160:163], a[0:3], a[32:35], v[160:163]
 ds_read_b64_tr_b16 a[24:25], v10 offset:8352
 ds_read_b64_tr_b16 a[26:27], v10 offset:10144
 v_mfma_f32_16x16x32_bf16 v[160:163], a[4:7], a[48:51], v[160:163]
 buffer_load_dwordx4 a[144:147], v6, s[16:19], s42 offen offset:3072 sc1
 v_mfma_f32_16x16x32_bf16 v[164:167], a[4:7], a[52:55], v[164:167]
 v_mfma_f32_16x16x32_bf16 v[164:167], a[0:3], a[36:39], v[164:167]
 v_mfma_f32_16x16x32_bf16 v[168:171], a[0:3], a[40:43], v[168:171]
 ds_read_b64_tr_b16 a[28:29], v10 offset:24736
 ds_read_b64_tr_b16 a[30:31], v10 offset:26528
 v_mfma_f32_16x16x32_bf16 v[168:171], a[4:7], a[56:59], v[168:171]
 v_mfma_f32_16x16x32_bf16 v[172:175], a[4:7], a[60:63], v[172:175]
 v_mfma_f32_16x16x32_bf16 v[172:175], a[0:3], a[44:47], v[172:175]
 buffer_load_dwordx4 a[148:151], v7, s[16:19], s42 offen offset:3072 sc1
 s_waitcnt lgkmcnt(8)
 v_mfma_f32_16x16x32_bf16 v[188:191], a[8:11], a[44:47], v[188:191]
 ds_read_b64_tr_b16 a[0:1], v10 offset:192
 ds_read_b64_tr_b16 a[2:3], v10 offset:1984
 v_mfma_f32_16x16x32_bf16 v[188:191], a[12:15], a[60:63], v[188:191]
 v_mfma_f32_16x16x32_bf16 v[184:187], a[12:15], a[56:59], v[184:187]
 v_mfma_f32_16x16x32_bf16 v[184:187], a[8:11], a[40:43], v[184:187]
 v_mfma_f32_16x16x32_bf16 v[180:183], a[8:11], a[36:39], v[180:183]
 ds_read_b64_tr_b16 a[4:5], v10 offset:16576
 ds_read_b64_tr_b16 a[6:7], v10 offset:18368
 v_mfma_f32_16x16x32_bf16 v[180:183], a[12:15], a[52:55], v[180:183]
 buffer_load_dwordx4 a[152:155], v8, s[16:19], s42 offen offset:3072 sc1
 v_mfma_f32_16x16x32_bf16 v[176:179], a[12:15], a[48:51], v[176:179]
 v_mfma_f32_16x16x32_bf16 v[176:179], a[8:11], a[32:35], v[176:179]
 s_waitcnt lgkmcnt(8)
 v_mfma_f32_16x16x32_bf16 v[192:195], a[16:19], a[32:35], v[192:195]
 ds_read_b64_tr_b16 a[8:9], v10 offset:8384
 ds_read_b64_tr_b16 a[10:11], v10 offset:10176
 v_mfma_f32_16x16x32_bf16 v[192:195], a[20:23], a[48:51], v[192:195]
 v_mfma_f32_16x16x32_bf16 v[196:199], a[20:23], a[52:55], v[196:199]
 v_mfma_f32_16x16x32_bf16 v[196:199], a[16:19], a[36:39], v[196:199]
 buffer_load_dwordx4 a[156:159], v9, s[16:19], s42 offen offset:3072 sc1
 v_mfma_f32_16x16x32_bf16 v[200:203], a[16:19], a[40:43], v[200:203]
 ds_read_b64_tr_b16 a[12:13], v10 offset:24768
 ds_read_b64_tr_b16 a[14:15], v10 offset:26560
 v_mfma_f32_16x16x32_bf16 v[200:203], a[20:23], a[56:59], v[200:203]
 s_lshl_b32 s58, s29, 5
 s_add_u32 s58, s58, s30
 v_mfma_f32_16x16x32_bf16 v[204:207], a[20:23], a[60:63], v[204:207]
 s_lshl_b32 s58, s58, 7
 s_add_u32 s58, s58, 0x18000
 s_min_u32 s54, s10, 1
 v_mfma_f32_16x16x32_bf16 v[204:207], a[16:19], a[44:47], v[204:207]
 s_lshl_b32 s54, s54, 30
 s_waitcnt lgkmcnt(8)
 v_mfma_f32_16x16x32_bf16 v[220:223], a[24:27], a[44:47], v[220:223]
 s_waitcnt vmcnt(44)
 s_barrier
 ds_read_b64_tr_b16 a[16:17], v10 offset:32768
 v_mfma_f32_16x16x32_bf16 v[220:223], a[28:31], a[60:63], v[220:223]
 ds_read_b64_tr_b16 a[18:19], v10 offset:34560
 buffer_load_dword v15, v15, s[92:95], 0 offen
 v_mfma_f32_16x16x32_bf16 v[216:219], a[28:31], a[56:59], v[216:219]
 s_add_u32 s56, s54, s58
 v_mfma_f32_16x16x32_bf16 v[216:219], a[24:27], a[40:43], v[216:219]
 s_add_u32 s54, s56, 0x10000
 s_add_u32 s55, s56, 0x18000
 v_cmp_eq_u32 vcc, 0, v0
 v_mfma_f32_16x16x32_bf16 v[212:215], a[24:27], a[36:39], v[212:215]
 ds_read_b64_tr_b16 a[20:21], v10 offset:40960
 ds_read_b64_tr_b16 a[22:23], v10 offset:42752
 v_mfma_f32_16x16x32_bf16 v[212:215], a[28:31], a[52:55], v[212:215]
 v_mov_b32 v30, 0x40000000
 v_mov_b32 v28, s8
 v_mfma_f32_16x16x32_bf16 v[208:211], a[28:31], a[48:51], v[208:211]
 v_cndmask_b32 v30, v30, 0, vcc
 v_mov_b32 v29, s9
 v_mfma_f32_16x16x32_bf16 v[208:211], a[24:27], a[32:35], v[208:211]
 s_and_b32 s11, s2, 1
 s_bfe_u32 s29, s2, 0x10001
 s_waitcnt lgkmcnt(8)
 v_mfma_f32_16x16x32_bf16 v[224:227], a[0:3], a[32:35], v[224:227]
 s_waitcnt vmcnt(41)
 s_barrier
 ds_read_b64_tr_b16 a[24:25], v10 offset:49152
 v_mfma_f32_16x16x32_bf16 v[224:227], a[4:7], a[48:51], v[224:227]
 ds_read_b64_tr_b16 a[26:27], v10 offset:50944
 v_mfma_f32_16x16x32_bf16 v[228:231], a[4:7], a[52:55], v[228:231]
 s_lshl_b32 s29, s29, 3
 s_and_b32 s30, s28, 7
 v_mfma_f32_16x16x32_bf16 v[228:231], a[0:3], a[36:39], v[228:231]
 s_add_u32 s29, s29, s30
 s_bfe_u32 s30, s2, 0x10002
 v_mfma_f32_16x16x32_bf16 v[232:235], a[0:3], a[40:43], v[232:235]
 ds_read_b64_tr_b16 a[28:29], v10 offset:57344
 ds_read_b64_tr_b16 a[30:31], v10 offset:59136
 s_lshl_b32 s30, s30, 2
 v_mfma_f32_16x16x32_bf16 v[232:235], a[4:7], a[56:59], v[232:235]
 s_lshr_b32 s31, s28, 3
 s_add_u32 s30, s30, s31
 v_mfma_f32_16x16x32_bf16 v[236:239], a[4:7], a[60:63], v[236:239]
 s_lshl_b32 s30, s30, 1
 s_add_u32 s30, s30, s11
 v_mfma_f32_16x16x32_bf16 v[236:239], a[0:3], a[44:47], v[236:239]
 v_lshrrev_b32 v8, 5, v0
 s_waitcnt lgkmcnt(8)
 v_mfma_f32_16x16x32_bf16 v[252:255], a[8:11], a[44:47], v[252:255]
 s_waitcnt vmcnt(28)
 s_barrier
 ds_read_b64_tr_b16 a[0:1], v11 offset:0
 v_mfma_f32_16x16x32_bf16 v[252:255], a[12:15], a[60:63], v[252:255]
 ds_read_b64_tr_b16 a[2:3], v11 offset:1792
 v_lshlrev_b32 v8, 3, v8
 v_mfma_f32_16x16x32_bf16 v[248:251], a[12:15], a[56:59], v[248:251]
 v_bfe_u32 v13, v0, 3, 2
 v_add_u32 v8, v8, v13
 v_mfma_f32_16x16x32_bf16 v[248:251], a[8:11], a[40:43], v[248:251]
 s_lshl_b32 s32, s10, 4
 v_add_u32 v8, s32, v8
 v_mfma_f32_16x16x32_bf16 v[244:247], a[8:11], a[36:39], v[244:247]
 ds_read_b64_tr_b16 a[4:5], v11 offset:8192
 ds_read_b64_tr_b16 a[6:7], v11 offset:9984
 v_mfma_f32_16x16x32_bf16 v[244:247], a[12:15], a[52:55], v[244:247]
 v_bfe_u32 v13, v0, 4, 2
 v_lshlrev_b32 v13, 1, v13
 v_mfma_f32_16x16x32_bf16 v[240:243], a[12:15], a[48:51], v[240:243]
 v_and_b32 v14, 7, v0
 v_xor_b32 v13, v13, v14
 v_lshlrev_b32 v13, 4, v13
 v_mfma_f32_16x16x32_bf16 v[240:243], a[8:11], a[32:35], v[240:243]
 s_lshl_b32 s45, s10, 11
 s_waitcnt lgkmcnt(8)
 v_mfma_f32_16x16x32_bf16 v[32:35], a[16:19], a[64:67], v[32:35]
 s_waitcnt vmcnt(24)
 s_barrier
 ds_read_b64_tr_b16 a[8:9], v11 offset:16384
 v_mfma_f32_16x16x32_bf16 v[36:39], a[16:19], a[68:71], v[36:39]
 ds_read_b64_tr_b16 a[10:11], v11 offset:18176
 v_mfma_f32_16x16x32_bf16 v[40:43], a[16:19], a[72:75], v[40:43]
 s_xor_b32 s31, s30, 1
 s_lshr_b32 s34, s31, 3
 s_mul_i32 s34, s34, 458752
 v_mfma_f32_16x16x32_bf16 v[44:47], a[16:19], a[76:79], v[44:47]
 s_mul_i32 s39, s11, 229376
 s_add_u32 s34, s34, s39
 v_mfma_f32_16x16x32_bf16 v[60:63], a[20:23], a[76:79], v[60:63]
 ds_read_b64_tr_b16 a[12:13], v11 offset:24576
 ds_read_b64_tr_b16 a[14:15], v11 offset:26368
 v_mfma_f32_16x16x32_bf16 v[56:59], a[20:23], a[72:75], v[56:59]
 s_add_u32 s34, s34, 0x20ffc00
 s_lshl_b32 s39, s39, 4
 v_mfma_f32_16x16x32_bf16 v[52:55], a[20:23], a[68:71], v[52:55]
 s_lshl_b32 s35, s31, 7
 s_add_u32 s39, s39, s35
 v_mfma_f32_16x16x32_bf16 v[48:51], a[20:23], a[64:67], v[48:51]
 s_sub_u32 s22, 7341056, s39
 s_waitcnt lgkmcnt(8)
 v_mfma_f32_16x16x32_bf16 v[32:35], a[24:27], a[80:83], v[32:35]
 s_waitcnt vmcnt(12)
 s_barrier
 ds_read_b64_tr_b16 a[16:17], v11 offset:32768
 v_mfma_f32_16x16x32_bf16 v[36:39], a[24:27], a[84:87], v[36:39]
 ds_read_b64_tr_b16 a[18:19], v11 offset:34560
 v_mfma_f32_16x16x32_bf16 v[40:43], a[24:27], a[88:91], v[40:43]
 s_sub_u32 s39, s39, 1024
 s_subb_u32 s43, 0, 0
 s_movk_i32 s33, 2048
 v_mfma_f32_16x16x32_bf16 v[44:47], a[24:27], a[92:95], v[44:47]
 s_and_b32 s31, s31, 7
 v_mfma_f32_16x16x32_bf16 v[60:63], a[28:31], a[92:95], v[60:63]
 ds_read_b64_tr_b16 a[20:21], v11 offset:40960
 ds_read_b64_tr_b16 a[22:23], v11 offset:42752
 v_mfma_f32_16x16x32_bf16 v[56:59], a[28:31], a[88:91], v[56:59]
 s_cmp_eq_u32 s31, 3
 s_cselect_b32 s33, 128, s33
 s_cselect_b32 s39, s34, s39
 v_mfma_f32_16x16x32_bf16 v[52:55], a[28:31], a[84:87], v[52:55]
 v_mfma_f32_16x16x32_bf16 v[48:51], a[28:31], a[80:83], v[48:51]
 s_waitcnt lgkmcnt(8)
 v_mfma_f32_16x16x32_bf16 v[32:35], a[0:3], a[96:99], v[32:35]
 s_waitcnt vmcnt(8)
 s_barrier
 ds_read_b64_tr_b16 a[24:25], v11 offset:49152
 v_mfma_f32_16x16x32_bf16 v[36:39], a[0:3], a[100:103], v[36:39]
 ds_read_b64_tr_b16 a[26:27], v11 offset:50944
 v_mfma_f32_16x16x32_bf16 v[40:43], a[0:3], a[104:107], v[40:43]
 s_cmp_eq_u32 s31, 3
 s_cselect_b32 s43, 0, s43
 s_cselect_b32 s20, s82, s76
 v_mfma_f32_16x16x32_bf16 v[44:47], a[0:3], a[108:111], v[44:47]
 s_cmp_eq_u32 s31, 3
 s_cselect_b32 s21, s83, s77
 v_mfma_f32_16x16x32_bf16 v[60:63], a[4:7], a[108:111], v[60:63]
 ds_read_b64_tr_b16 a[28:29], v11 offset:57344
 ds_read_b64_tr_b16 a[30:31], v11 offset:59136
 v_mfma_f32_16x16x32_bf16 v[56:59], a[4:7], a[104:107], v[56:59]
 s_add_u32 s20, s20, s39
 s_addc_u32 s21, s21, s43
 s_mov_b32 s23, 0x20000
 v_mfma_f32_16x16x32_bf16 v[52:55], a[4:7], a[100:103], v[52:55]
 s_lshl_b32 s42, s33, 5
 s_lshr_b32 s32, s10, 1
 v_mfma_f32_16x16x32_bf16 v[48:51], a[4:7], a[96:99], v[48:51]
 s_mul_i32 s32, s32, 3
 s_waitcnt lgkmcnt(8)
 v_mfma_f32_16x16x32_bf16 v[32:35], a[8:11], a[112:115], v[32:35]
 ds_read_b64_tr_b16 a[0:1], v10 offset:32800
 ds_read_b64_tr_b16 a[2:3], v10 offset:34592
 v_mfma_f32_16x16x32_bf16 v[36:39], a[8:11], a[116:119], v[36:39]
 s_mul_i32 s51, s32, s42
 s_mul_i32 s53, s51, 2
 v_mul_u32_u24 v14, s33, v8
 v_mfma_f32_16x16x32_bf16 v[40:43], a[8:11], a[120:123], v[40:43]
 v_add_u32 v14, v14, v13
 s_branch m_ps_p3_5
m_pad_p3_5:
 s_branch m_ret_p3
m_ps_p3_5:
 v_add_u32 v4, 1024, v14
 v_mfma_f32_16x16x32_bf16 v[44:47], a[8:11], a[124:127], v[44:47]
 s_lshl_b32 s32, s33, 2
 v_add_u32 v5, s32, v14
 v_mfma_f32_16x16x32_bf16 v[60:63], a[12:15], a[124:127], v[60:63]
 ds_read_b64_tr_b16 a[4:5], v10 offset:40992
 ds_read_b64_tr_b16 a[6:7], v10 offset:42784
 v_mfma_f32_16x16x32_bf16 v[56:59], a[12:15], a[120:123], v[56:59]
 s_xor_b32 s31, s30, 0
 s_lshr_b32 s34, s31, 3
 s_mul_i32 s34, s34, 458752
 v_mfma_f32_16x16x32_bf16 v[52:55], a[12:15], a[116:119], v[52:55]
 s_mul_i32 s39, s11, 229376
 s_add_u32 s34, s34, s39
 v_mfma_f32_16x16x32_bf16 v[48:51], a[12:15], a[112:115], v[48:51]
 s_add_u32 s34, s34, 0x20ffc00
 s_waitcnt vmcnt(5) lgkmcnt(8)
 v_mfma_f32_16x16x32_bf16 v[32:35], a[16:19], a[128:131], v[32:35]
 ds_read_b64_tr_b16 a[8:9], v10 offset:49184
 ds_read_b64_tr_b16 a[10:11], v10 offset:50976
 v_mfma_f32_16x16x32_bf16 v[36:39], a[16:19], a[132:135], v[36:39]
 s_lshl_b32 s39, s39, 4
 s_lshl_b32 s35, s31, 7
 v_mfma_f32_16x16x32_bf16 v[40:43], a[16:19], a[136:139], v[40:43]
 s_add_u32 s39, s39, s35
 s_sub_u32 s14, 7341056, s39
 v_mfma_f32_16x16x32_bf16 v[44:47], a[16:19], a[140:143], v[44:47]
 s_sub_u32 s39, s39, 1024
 s_subb_u32 s43, 0, 0
 s_movk_i32 s33, 2048
 v_mfma_f32_16x16x32_bf16 v[60:63], a[20:23], a[140:143], v[60:63]
 ds_read_b64_tr_b16 a[12:13], v10 offset:57376
 ds_read_b64_tr_b16 a[14:15], v10 offset:59168
 v_mfma_f32_16x16x32_bf16 v[56:59], a[20:23], a[136:139], v[56:59]
 s_and_b32 s31, s31, 7
 v_mfma_f32_16x16x32_bf16 v[52:55], a[20:23], a[132:135], v[52:55]
 s_cmp_eq_u32 s31, 3
 s_cselect_b32 s33, 128, s33
 s_cselect_b32 s39, s34, s39
 v_mfma_f32_16x16x32_bf16 v[48:51], a[20:23], a[128:131], v[48:51]
 s_waitcnt vmcnt(1) lgkmcnt(8)
 v_mfma_f32_16x16x32_bf16 v[32:35], a[24:27], a[144:147], v[32:35]
 ds_read_b64_tr_b16 a[16:17], v11 offset:32
 ds_read_b64_tr_b16 a[18:19], v11 offset:1824
 v_mfma_f32_16x16x32_bf16 v[36:39], a[24:27], a[148:151], v[36:39]
 s_cmp_eq_u32 s31, 3
 s_cselect_b32 s43, 0, s43
 s_cselect_b32 s12, s82, s76
 v_mfma_f32_16x16x32_bf16 v[40:43], a[24:27], a[152:155], v[40:43]
 s_cmp_eq_u32 s31, 3
 s_cselect_b32 s13, s83, s77
 v_mfma_f32_16x16x32_bf16 v[44:47], a[24:27], a[156:159], v[44:47]
 s_add_u32 s12, s12, s39
 s_addc_u32 s13, s13, s43
 s_mov_b32 s15, 0x20000
 v_mfma_f32_16x16x32_bf16 v[60:63], a[28:31], a[156:159], v[60:63]
 ds_read_b64_tr_b16 a[20:21], v11 offset:8224
 ds_read_b64_tr_b16 a[22:23], v11 offset:10016
 v_mfma_f32_16x16x32_bf16 v[56:59], a[28:31], a[152:155], v[56:59]
 s_lshl_b32 s41, s33, 5
 s_lshr_b32 s32, s10, 1
 v_mfma_f32_16x16x32_bf16 v[52:55], a[28:31], a[148:151], v[52:55]
 s_mul_i32 s32, s32, 3
 s_mul_i32 s50, s32, s41
 v_mfma_f32_16x16x32_bf16 v[48:51], a[28:31], a[144:147], v[48:51]
 s_mul_i32 s52, s50, 2
 v_mul_u32_u24 v14, s33, v8
 v_add_u32 v14, v14, v13
 v_add_u32 v2, 1024, v14
 s_lshl_b32 s32, s33, 2
 v_add_u32 v3, s32, v14
 s_waitcnt lgkmcnt(8)
 v_mfma_f32_16x16x32_bf16 v[64:67], a[0:3], a[64:67], v[64:67]
 ds_read_b64_tr_b16 a[24:25], v11 offset:16416
 ds_read_b64_tr_b16 a[26:27], v11 offset:18208
 v_mul_f32 v32, v16, v32
 v_mfma_f32_16x16x32_bf16 v[68:71], a[0:3], a[68:71], v[68:71]
 v_mul_f32 v33, v16, v33
 v_mul_f32 v34, v16, v34
 v_mul_f32 v35, v16, v35
 v_mul_f32 v36, v18, v36
 v_mfma_f32_16x16x32_bf16 v[72:75], a[0:3], a[72:75], v[72:75]
 v_mul_f32 v37, v18, v37
 v_mul_f32 v38, v18, v38
 v_mul_f32 v39, v18, v39
 v_mfma_f32_16x16x32_bf16 v[76:79], a[0:3], a[76:79], v[76:79]
 v_exp_f32 v32, v32
 v_mfma_f32_16x16x32_bf16 v[92:95], a[4:7], a[76:79], v[92:95]
 ds_read_b64_tr_b16 a[28:29], v11 offset:24608
 ds_read_b64_tr_b16 a[30:31], v11 offset:26400
 v_exp_f32 v33, v33
 v_mfma_f32_16x16x32_bf16 v[88:91], a[4:7], a[72:75], v[88:91]
 v_exp_f32 v34, v34
 v_exp_f32 v35, v35
 v_mfma_f32_16x16x32_bf16 v[84:87], a[4:7], a[68:71], v[84:87]
 v_exp_f32 v36, v36
 v_mfma_f32_16x16x32_bf16 v[80:83], a[4:7], a[64:67], v[80:83]
 v_exp_f32 v37, v37
 s_waitcnt lgkmcnt(8)
 v_mfma_f32_16x16x32_bf16 v[64:67], a[8:11], a[80:83], v[64:67]
 ds_read_b64_tr_b16 a[0:1], v11 offset:32800
 ds_read_b64_tr_b16 a[2:3], v11 offset:34592
 v_exp_f32 v38, v38
 v_mfma_f32_16x16x32_bf16 v[68:71], a[8:11], a[84:87], v[68:71]
 v_exp_f32 v39, v39
 v_fma_f32 v32, v32, v17, v17
 v_fma_f32 v33, v33, v17, v17
 v_mfma_f32_16x16x32_bf16 v[72:75], a[8:11], a[88:91], v[72:75]
 v_fma_f32 v34, v34, v17, v17
 v_fma_f32 v35, v35, v17, v17
 v_fma_f32 v36, v36, v19, v19
 v_mfma_f32_16x16x32_bf16 v[76:79], a[8:11], a[92:95], v[76:79]
 v_fma_f32 v37, v37, v19, v19
 v_fma_f32 v38, v38, v19, v19
 v_fma_f32 v39, v39, v19, v19
 v_mfma_f32_16x16x32_bf16 v[92:95], a[12:15], a[92:95], v[92:95]
 ds_read_b64_tr_b16 a[4:5], v11 offset:40992
 ds_read_b64_tr_b16 a[6:7], v11 offset:42784
 v_rcp_f32 v32, v32
 v_mfma_f32_16x16x32_bf16 v[88:91], a[12:15], a[88:91], v[88:91]
 v_rcp_f32 v33, v33
 v_mfma_f32_16x16x32_bf16 v[84:87], a[12:15], a[84:87], v[84:87]
 v_rcp_f32 v34, v34
 v_rcp_f32 v35, v35
 v_mfma_f32_16x16x32_bf16 v[80:83], a[12:15], a[80:83], v[80:83]
 v_rcp_f32 v36, v36
 s_waitcnt lgkmcnt(8)
 v_mfma_f32_16x16x32_bf16 v[64:67], a[16:19], a[96:99], v[64:67]
 ds_read_b64_tr_b16 a[8:9], v11 offset:49184
 ds_read_b64_tr_b16 a[10:11], v11 offset:50976
 v_rcp_f32 v37, v37
 v_mfma_f32_16x16x32_bf16 v[68:71], a[16:19], a[100:103], v[68:71]
 v_rcp_f32 v38, v38
 v_mfma_f32_16x16x32_bf16 v[72:75], a[16:19], a[104:107], v[72:75]
 v_rcp_f32 v39, v39
 v_mul_f32 v32, v32, v48
 v_mul_f32 v33, v33, v49
 v_mfma_f32_16x16x32_bf16 v[76:79], a[16:19], a[108:111], v[76:79]
 v_mul_f32 v34, v34, v50
 v_mul_f32 v35, v35, v51
 v_mul_f32 v36, v36, v52
 v_mul_f32 v37, v37, v53
 v_mfma_f32_16x16x32_bf16 v[92:95], a[20:23], a[108:111], v[92:95]
 ds_read_b64_tr_b16 a[12:13], v11 offset:57376
 ds_read_b64_tr_b16 a[14:15], v11 offset:59168
 v_mul_f32 v38, v38, v54
 v_mfma_f32_16x16x32_bf16 v[88:91], a[20:23], a[104:107], v[88:91]
 v_mul_f32 v39, v39, v55
 v_cvt_pk_bf16_f32 v48, v32, v33
 v_cvt_pk_bf16_f32 v49, v34, v35
 v_mfma_f32_16x16x32_bf16 v[84:87], a[20:23], a[100:103], v[84:87]
 v_cvt_pk_bf16_f32 v50, v36, v37
 v_cvt_pk_bf16_f32 v51, v38, v39
 s_nop 1
 v_mfma_f32_16x16x32_bf16 v[80:83], a[20:23], a[96:99], v[80:83]
 v_permlane16_swap_b32 v48, v50
 v_permlane16_swap_b32 v49, v51
 s_waitcnt lgkmcnt(8)
 v_mfma_f32_16x16x32_bf16 v[64:67], a[24:27], a[112:115], v[64:67]
 ds_read_b64_tr_b16 a[16:17], v10 offset:32832
 ds_read_b64_tr_b16 a[18:19], v10 offset:34624
 buffer_store_dwordx4 v[48:51], v12, s[24:27], 0 offen offset:0 sc1
 v_mfma_f32_16x16x32_bf16 v[68:71], a[24:27], a[116:119], v[68:71]
 v_mul_f32 v40, v20, v40
 v_mul_f32 v41, v20, v41
 v_mul_f32 v42, v20, v42
 v_mul_f32 v43, v20, v43
 v_mfma_f32_16x16x32_bf16 v[72:75], a[24:27], a[120:123], v[72:75]
 v_mul_f32 v44, v22, v44
 v_mul_f32 v45, v22, v45
 v_mul_f32 v46, v22, v46
 v_mfma_f32_16x16x32_bf16 v[76:79], a[24:27], a[124:127], v[76:79]
 v_mul_f32 v47, v22, v47
 v_exp_f32 v40, v40
 v_mfma_f32_16x16x32_bf16 v[92:95], a[28:31], a[124:127], v[92:95]
 ds_read_b64_tr_b16 a[20:21], v10 offset:41024
 ds_read_b64_tr_b16 a[22:23], v10 offset:42816
 v_exp_f32 v41, v41
 v_mfma_f32_16x16x32_bf16 v[88:91], a[28:31], a[120:123], v[88:91]
 v_exp_f32 v42, v42
 v_mfma_f32_16x16x32_bf16 v[84:87], a[28:31], a[116:119], v[84:87]
 v_exp_f32 v43, v43
 v_exp_f32 v44, v44
 v_mfma_f32_16x16x32_bf16 v[80:83], a[28:31], a[112:115], v[80:83]
 v_exp_f32 v45, v45
 s_waitcnt lgkmcnt(8)
 v_mfma_f32_16x16x32_bf16 v[64:67], a[0:3], a[128:131], v[64:67]
 ds_read_b64_tr_b16 a[24:25], v10 offset:49216
 ds_read_b64_tr_b16 a[26:27], v10 offset:51008
 v_exp_f32 v46, v46
 v_mfma_f32_16x16x32_bf16 v[68:71], a[0:3], a[132:135], v[68:71]
 v_exp_f32 v47, v47
 v_fma_f32 v40, v40, v21, v21
 v_mfma_f32_16x16x32_bf16 v[72:75], a[0:3], a[136:139], v[72:75]
 v_fma_f32 v41, v41, v21, v21
 v_fma_f32 v42, v42, v21, v21
 v_fma_f32 v43, v43, v21, v21
 v_fma_f32 v44, v44, v23, v23
 v_mfma_f32_16x16x32_bf16 v[76:79], a[0:3], a[140:143], v[76:79]
 v_fma_f32 v45, v45, v23, v23
 v_fma_f32 v46, v46, v23, v23
 v_fma_f32 v47, v47, v23, v23
 v_mfma_f32_16x16x32_bf16 v[92:95], a[4:7], a[140:143], v[92:95]
 ds_read_b64_tr_b16 a[28:29], v10 offset:57408
 ds_read_b64_tr_b16 a[30:31], v10 offset:59200
 v_mfma_f32_16x16x32_bf16 v[88:91], a[4:7], a[136:139], v[88:91]
 v_rcp_f32 v40, v40
 v_rcp_f32 v41, v41
 v_mfma_f32_16x16x32_bf16 v[84:87], a[4:7], a[132:135], v[84:87]
 v_rcp_f32 v42, v42
 v_rcp_f32 v43, v43
 v_mfma_f32_16x16x32_bf16 v[80:83], a[4:7], a[128:131], v[80:83]
 v_rcp_f32 v44, v44
 s_waitcnt lgkmcnt(8)
 v_mfma_f32_16x16x32_bf16 v[64:67], a[8:11], a[144:147], v[64:67]
 ds_read_b64_tr_b16 a[0:1], v11 offset:64
 ds_read_b64_tr_b16 a[2:3], v11 offset:1856
 v_mfma_f32_16x16x32_bf16 v[68:71], a[8:11], a[148:151], v[68:71]
 v_rcp_f32 v45, v45
 v_rcp_f32 v46, v46
 v_mfma_f32_16x16x32_bf16 v[72:75], a[8:11], a[152:155], v[72:75]
 v_rcp_f32 v47, v47
 v_mul_f32 v40, v40, v56
 v_mul_f32 v41, v41, v57
 v_mfma_f32_16x16x32_bf16 v[76:79], a[8:11], a[156:159], v[76:79]
 v_mul_f32 v42, v42, v58
 v_mul_f32 v43, v43, v59
 v_mul_f32 v44, v44, v60
 v_mfma_f32_16x16x32_bf16 v[92:95], a[12:15], a[156:159], v[92:95]
 ds_read_b64_tr_b16 a[4:5], v11 offset:8256
 ds_read_b64_tr_b16 a[6:7], v11 offset:10048
 v_mul_f32 v45, v45, v61
 v_mfma_f32_16x16x32_bf16 v[88:91], a[12:15], a[152:155], v[88:91]
 v_mul_f32 v46, v46, v62
 v_mul_f32 v47, v47, v63
 v_cvt_pk_bf16_f32 v56, v40, v41
 v_cvt_pk_bf16_f32 v57, v42, v43
 v_mfma_f32_16x16x32_bf16 v[84:87], a[12:15], a[148:151], v[84:87]
 v_cvt_pk_bf16_f32 v58, v44, v45
 v_cvt_pk_bf16_f32 v59, v46, v47
 v_mfma_f32_16x16x32_bf16 v[80:83], a[12:15], a[144:147], v[80:83]
 s_nop 1
 v_permlane16_swap_b32 v56, v58
 v_permlane16_swap_b32 v57, v59
 buffer_store_dwordx4 v[56:59], v12, s[24:27], s47 offen offset:0 sc1
 s_waitcnt lgkmcnt(8)
 v_mfma_f32_16x16x32_bf16 v[96:99], a[16:19], a[64:67], v[96:99]
 ds_read_b64_tr_b16 a[8:9], v11 offset:16448
 ds_read_b64_tr_b16 a[10:11], v11 offset:18240
 v_mul_f32 v64, v16, v64
 v_mul_f32 v65, v16, v65
 v_mfma_f32_16x16x32_bf16 v[100:103], a[16:19], a[68:71], v[100:103]
 v_add_u32 v7, 114688, v6
 s_lshl_b32 s36, s29, 3
 v_mul_f32 v66, v16, v66
 v_mfma_f32_16x16x32_bf16 v[104:107], a[16:19], a[72:75], v[104:107]
 s_lshl_b32 s37, s10, 1
 s_add_u32 s36, s36, s37
 v_mul_f32 v67, v16, v67
 v_mul_f32 v68, v18, v68
 v_mfma_f32_16x16x32_bf16 v[108:111], a[16:19], a[76:79], v[108:111]
 s_mul_i32 s37, s36, 114688
 s_mul_i32 s39, s11, 57344
 v_mul_f32 v69, v18, v69
 v_mfma_f32_16x16x32_bf16 v[124:127], a[20:23], a[76:79], v[124:127]
 ds_read_b64_tr_b16 a[12:13], v11 offset:24640
 ds_read_b64_tr_b16 a[14:15], v11 offset:26432
 v_mul_f32 v70, v18, v70
 v_mul_f32 v71, v18, v71
 v_mfma_f32_16x16x32_bf16 v[120:123], a[20:23], a[72:75], v[120:123]
 s_add_u32 s37, s37, s39
 s_add_u32 s37, s37, 0x1000000
 v_mfma_f32_16x16x32_bf16 v[116:119], a[20:23], a[68:71], v[116:119]
 v_exp_f32 v64, v64
 v_exp_f32 v65, v65
 v_mfma_f32_16x16x32_bf16 v[112:115], a[20:23], a[64:67], v[112:115]
 v_exp_f32 v66, v66
 s_waitcnt lgkmcnt(8)
 v_mfma_f32_16x16x32_bf16 v[96:99], a[24:27], a[80:83], v[96:99]
 ds_read_b64_tr_b16 a[16:17], v11 offset:32832
 ds_read_b64_tr_b16 a[18:19], v11 offset:34624
 v_exp_f32 v67, v67
 v_mfma_f32_16x16x32_bf16 v[100:103], a[24:27], a[84:87], v[100:103]
 v_exp_f32 v68, v68
 v_exp_f32 v69, v69
 v_mfma_f32_16x16x32_bf16 v[104:107], a[24:27], a[88:91], v[104:107]
 v_exp_f32 v70, v70
 v_exp_f32 v71, v71
 v_mfma_f32_16x16x32_bf16 v[108:111], a[24:27], a[92:95], v[108:111]
 v_fma_f32 v64, v64, v17, v17
 v_fma_f32 v65, v65, v17, v17
 v_fma_f32 v66, v66, v17, v17
 v_mfma_f32_16x16x32_bf16 v[124:127], a[28:31], a[92:95], v[124:127]
 ds_read_b64_tr_b16 a[20:21], v11 offset:41024
 ds_read_b64_tr_b16 a[22:23], v11 offset:42816
 v_fma_f32 v67, v67, v17, v17
 v_fma_f32 v68, v68, v19, v19
 v_mfma_f32_16x16x32_bf16 v[120:123], a[28:31], a[88:91], v[120:123]
 v_fma_f32 v69, v69, v19, v19
 v_fma_f32 v70, v70, v19, v19
 v_fma_f32 v71, v71, v19, v19
 v_mfma_f32_16x16x32_bf16 v[116:119], a[28:31], a[84:87], v[116:119]
 v_rcp_f32 v64, v64
 v_rcp_f32 v65, v65
 v_mfma_f32_16x16x32_bf16 v[112:115], a[28:31], a[80:83], v[112:115]
 v_rcp_f32 v66, v66
 s_waitcnt lgkmcnt(8)
 v_mfma_f32_16x16x32_bf16 v[96:99], a[0:3], a[96:99], v[96:99]
 ds_read_b64_tr_b16 a[24:25], v11 offset:49216
 ds_read_b64_tr_b16 a[26:27], v11 offset:51008
 v_rcp_f32 v67, v67
 v_mfma_f32_16x16x32_bf16 v[100:103], a[0:3], a[100:103], v[100:103]
 v_rcp_f32 v68, v68
 v_mfma_f32_16x16x32_bf16 v[104:107], a[0:3], a[104:107], v[104:107]
 v_rcp_f32 v69, v69
 v_rcp_f32 v70, v70
 v_mfma_f32_16x16x32_bf16 v[108:111], a[0:3], a[108:111], v[108:111]
 v_rcp_f32 v71, v71
 v_mul_f32 v64, v64, v80
 v_mul_f32 v65, v65, v81
 v_mfma_f32_16x16x32_bf16 v[124:127], a[4:7], a[108:111], v[124:127]
 ds_read_b64_tr_b16 a[28:29], v11 offset:57408
 ds_read_b64_tr_b16 a[30:31], v11 offset:59200
 v_mul_f32 v66, v66, v82
 v_mul_f32 v67, v67, v83
 v_mfma_f32_16x16x32_bf16 v[120:123], a[4:7], a[104:107], v[120:123]
 v_mul_f32 v68, v68, v84
 v_mul_f32 v69, v69, v85
 v_mul_f32 v70, v70, v86
 v_mfma_f32_16x16x32_bf16 v[116:119], a[4:7], a[100:103], v[116:119]
 v_mul_f32 v71, v71, v87
 v_cvt_pk_bf16_f32 v80, v64, v65
 v_cvt_pk_bf16_f32 v81, v66, v67
 v_cvt_pk_bf16_f32 v82, v68, v69
 v_mfma_f32_16x16x32_bf16 v[112:115], a[4:7], a[96:99], v[112:115]
 v_cvt_pk_bf16_f32 v83, v70, v71
 s_waitcnt lgkmcnt(8)
 v_mfma_f32_16x16x32_bf16 v[96:99], a[8:11], a[112:115], v[96:99]
 ds_read_b64_tr_b16 a[0:1], v10 offset:32864
 ds_read_b64_tr_b16 a[2:3], v10 offset:34656
 s_nop 1
 v_permlane16_swap_b32 v80, v82
 v_mfma_f32_16x16x32_bf16 v[100:103], a[8:11], a[116:119], v[100:103]
 v_permlane16_swap_b32 v81, v83
 buffer_store_dwordx4 v[80:83], v12, s[24:27], 0 offen offset:512 sc1
 v_mul_f32 v72, v20, v72
 v_mfma_f32_16x16x32_bf16 v[104:107], a[8:11], a[120:123], v[104:107]
 v_mul_f32 v73, v20, v73
 v_mul_f32 v74, v20, v74
 v_mul_f32 v75, v20, v75
 v_mul_f32 v76, v22, v76
 v_mfma_f32_16x16x32_bf16 v[108:111], a[8:11], a[124:127], v[108:111]
 v_mul_f32 v77, v22, v77
 v_mul_f32 v78, v22, v78
 v_mul_f32 v79, v22, v79
 v_mfma_f32_16x16x32_bf16 v[124:127], a[12:15], a[124:127], v[124:127]
 ds_read_b64_tr_b16 a[4:5], v10 offset:41056
 ds_read_b64_tr_b16 a[6:7], v10 offset:42848
 v_exp_f32 v72, v72
 v_mfma_f32_16x16x32_bf16 v[120:123], a[12:15], a[120:123], v[120:123]
 v_exp_f32 v73, v73
 v_mfma_f32_16x16x32_bf16 v[116:119], a[12:15], a[116:119], v[116:119]
 v_exp_f32 v74, v74
 v_exp_f32 v75, v75
 v_mfma_f32_16x16x32_bf16 v[112:115], a[12:15], a[112:115], v[112:115]
 v_exp_f32 v76, v76
 s_waitcnt lgkmcnt(8)
 v_mfma_f32_16x16x32_bf16 v[96:99], a[16:19], a[128:131], v[96:99]
 ds_read_b64_tr_b16 a[8:9], v10 offset:49248
 ds_read_b64_tr_b16 a[10:11], v10 offset:51040
 v_exp_f32 v77, v77
 v_mfma_f32_16x16x32_bf16 v[100:103], a[16:19], a[132:135], v[100:103]
 v_exp_f32 v78, v78
 v_exp_f32 v79, v79
 v_mfma_f32_16x16x32_bf16 v[104:107], a[16:19], a[136:139], v[104:107]
 v_fma_f32 v72, v72, v21, v21
 v_fma_f32 v73, v73, v21, v21
 v_fma_f32 v74, v74, v21, v21
 v_fma_f32 v75, v75, v21, v21
 v_mfma_f32_16x16x32_bf16 v[108:111], a[16:19], a[140:143], v[108:111]
 v_fma_f32 v76, v76, v23, v23
 v_fma_f32 v77, v77, v23, v23
 v_fma_f32 v78, v78, v23, v23
 v_mfma_f32_16x16x32_bf16 v[124:127], a[20:23], a[140:143], v[124:127]
 ds_read_b64_tr_b16 a[12:13], v10 offset:57440
 ds_read_b64_tr_b16 a[14:15], v10 offset:59232
 v_fma_f32 v79, v79, v23, v23
 v_mfma_f32_16x16x32_bf16 v[120:123], a[20:23], a[136:139], v[120:123]
 v_rcp_f32 v72, v72
 v_rcp_f32 v73, v73
 v_mfma_f32_16x16x32_bf16 v[116:119], a[20:23], a[132:135], v[116:119]
 v_rcp_f32 v74, v74
 v_rcp_f32 v75, v75
 v_mfma_f32_16x16x32_bf16 v[112:115], a[20:23], a[128:131], v[112:115]
 v_rcp_f32 v76, v76
 s_waitcnt lgkmcnt(8)
 v_mfma_f32_16x16x32_bf16 v[96:99], a[24:27], a[144:147], v[96:99]
 ds_read_b64_tr_b16 a[16:17], v11 offset:96
 ds_read_b64_tr_b16 a[18:19], v11 offset:1888
 v_rcp_f32 v77, v77
 v_mfma_f32_16x16x32_bf16 v[100:103], a[24:27], a[148:151], v[100:103]
 v_rcp_f32 v78, v78
 v_mfma_f32_16x16x32_bf16 v[104:107], a[24:27], a[152:155], v[104:107]
 v_rcp_f32 v79, v79
 v_mul_f32 v72, v72, v88
 v_mul_f32 v73, v73, v89
 v_mul_f32 v74, v74, v90
 v_mfma_f32_16x16x32_bf16 v[108:111], a[24:27], a[156:159], v[108:111]
 v_mul_f32 v75, v75, v91
 v_mul_f32 v76, v76, v92
 v_mul_f32 v77, v77, v93
 v_mfma_f32_16x16x32_bf16 v[124:127], a[28:31], a[156:159], v[124:127]
 ds_read_b64_tr_b16 a[20:21], v11 offset:8288
 ds_read_b64_tr_b16 a[22:23], v11 offset:10080
 v_mul_f32 v78, v78, v94
 v_mul_f32 v79, v79, v95
 v_mfma_f32_16x16x32_bf16 v[120:123], a[28:31], a[152:155], v[120:123]
 v_cvt_pk_bf16_f32 v88, v72, v73
 v_cvt_pk_bf16_f32 v89, v74, v75
 v_cvt_pk_bf16_f32 v90, v76, v77
 v_mfma_f32_16x16x32_bf16 v[116:119], a[28:31], a[148:151], v[116:119]
 v_cvt_pk_bf16_f32 v91, v78, v79
 s_nop 1
 v_permlane16_swap_b32 v88, v90
 v_mfma_f32_16x16x32_bf16 v[112:115], a[28:31], a[144:147], v[112:115]
 v_permlane16_swap_b32 v89, v91
 buffer_store_dwordx4 v[88:91], v12, s[24:27], s47 offen offset:512 sc1
 s_waitcnt lgkmcnt(8)
 v_mfma_f32_16x16x32_bf16 v[128:131], a[0:3], a[64:67], v[128:131]
 ds_read_b64_tr_b16 a[24:25], v11 offset:16480
 ds_read_b64_tr_b16 a[26:27], v11 offset:18272
 v_mul_f32 v96, v16, v96
 v_mul_f32 v97, v16, v97
 v_mfma_f32_16x16x32_bf16 v[132:135], a[0:3], a[68:71], v[132:135]
 v_mul_f32 v98, v16, v98
 v_mul_f32 v99, v16, v99
 v_mul_f32 v100, v18, v100
 v_mfma_f32_16x16x32_bf16 v[136:139], a[0:3], a[72:75], v[136:139]
 v_mul_f32 v101, v18, v101
 v_mul_f32 v102, v18, v102
 v_mul_f32 v103, v18, v103
 v_mfma_f32_16x16x32_bf16 v[140:143], a[0:3], a[76:79], v[140:143]
 v_exp_f32 v96, v96
 v_exp_f32 v97, v97
 v_mfma_f32_16x16x32_bf16 v[156:159], a[4:7], a[76:79], v[156:159]
 ds_read_b64_tr_b16 a[28:29], v11 offset:24672
 ds_read_b64_tr_b16 a[30:31], v11 offset:26464
 v_exp_f32 v98, v98
 v_mfma_f32_16x16x32_bf16 v[152:155], a[4:7], a[72:75], v[152:155]
 v_exp_f32 v99, v99
 v_exp_f32 v100, v100
 v_mfma_f32_16x16x32_bf16 v[148:151], a[4:7], a[68:71], v[148:151]
 v_exp_f32 v101, v101
 v_exp_f32 v102, v102
 v_mfma_f32_16x16x32_bf16 v[144:147], a[4:7], a[64:67], v[144:147]
 v_exp_f32 v103, v103
 v_fma_f32 v96, v96, v17, v17
 s_waitcnt lgkmcnt(8)
 v_mfma_f32_16x16x32_bf16 v[128:131], a[8:11], a[80:83], v[128:131]
 ds_read_b64_tr_b16 a[0:1], v11 offset:32864
 ds_read_b64_tr_b16 a[2:3], v11 offset:34656
 v_fma_f32 v97, v97, v17, v17
 v_mfma_f32_16x16x32_bf16 v[132:135], a[8:11], a[84:87], v[132:135]
 v_fma_f32 v98, v98, v17, v17
 v_fma_f32 v99, v99, v17, v17
 v_fma_f32 v100, v100, v19, v19
 v_fma_f32 v101, v101, v19, v19
 v_mfma_f32_16x16x32_bf16 v[136:139], a[8:11], a[88:91], v[136:139]
 v_fma_f32 v102, v102, v19, v19
 v_fma_f32 v103, v103, v19, v19
 v_rcp_f32 v96, v96
 v_mfma_f32_16x16x32_bf16 v[140:143], a[8:11], a[92:95], v[140:143]
 v_rcp_f32 v97, v97
 v_mfma_f32_16x16x32_bf16 v[156:159], a[12:15], a[92:95], v[156:159]
 ds_read_b64_tr_b16 a[4:5], v11 offset:41056
 ds_read_b64_tr_b16 a[6:7], v11 offset:42848
 v_rcp_f32 v98, v98
 v_mfma_f32_16x16x32_bf16 v[152:155], a[12:15], a[88:91], v[152:155]
 v_rcp_f32 v99, v99
 v_rcp_f32 v100, v100
 v_mfma_f32_16x16x32_bf16 v[148:151], a[12:15], a[84:87], v[148:151]
 v_rcp_f32 v101, v101
 v_rcp_f32 v102, v102
 v_mfma_f32_16x16x32_bf16 v[144:147], a[12:15], a[80:83], v[144:147]
 v_rcp_f32 v103, v103
 v_mul_f32 v96, v96, v112
 s_waitcnt lgkmcnt(8)
 v_mfma_f32_16x16x32_bf16 v[128:131], a[16:19], a[96:99], v[128:131]
 ds_read_b64_tr_b16 a[8:9], v11 offset:49248
 ds_read_b64_tr_b16 a[10:11], v11 offset:51040
 v_mul_f32 v97, v97, v113
 v_mul_f32 v98, v98, v114
 v_mfma_f32_16x16x32_bf16 v[132:135], a[16:19], a[100:103], v[132:135]
 v_mul_f32 v99, v99, v115
 v_mul_f32 v100, v100, v116
 v_mul_f32 v101, v101, v117
 v_mfma_f32_16x16x32_bf16 v[136:139], a[16:19], a[104:107], v[136:139]
 v_mul_f32 v102, v102, v118
 v_mul_f32 v103, v103, v119
 v_cvt_pk_bf16_f32 v112, v96, v97
 v_cvt_pk_bf16_f32 v113, v98, v99
 v_mfma_f32_16x16x32_bf16 v[140:143], a[16:19], a[108:111], v[140:143]
 v_cvt_pk_bf16_f32 v114, v100, v101
 v_cvt_pk_bf16_f32 v115, v102, v103
 s_nop 1
 v_mfma_f32_16x16x32_bf16 v[156:159], a[20:23], a[108:111], v[156:159]
 ds_read_b64_tr_b16 a[12:13], v11 offset:57440
 ds_read_b64_tr_b16 a[14:15], v11 offset:59232
 v_permlane16_swap_b32 v112, v114
 v_mfma_f32_16x16x32_bf16 v[152:155], a[20:23], a[104:107], v[152:155]
 v_permlane16_swap_b32 v113, v115
 buffer_store_dwordx4 v[112:115], v12, s[24:27], 0 offen offset:1024 sc1
 v_mul_f32 v104, v20, v104
 v_mul_f32 v105, v20, v105
 v_mfma_f32_16x16x32_bf16 v[148:151], a[20:23], a[100:103], v[148:151]
 v_mul_f32 v106, v20, v106
 v_mul_f32 v107, v20, v107
 v_mul_f32 v108, v22, v108
 v_mul_f32 v109, v22, v109
 v_mfma_f32_16x16x32_bf16 v[144:147], a[20:23], a[96:99], v[144:147]
 v_mul_f32 v110, v22, v110
 v_mul_f32 v111, v22, v111
 s_waitcnt lgkmcnt(8)
 v_mfma_f32_16x16x32_bf16 v[128:131], a[24:27], a[112:115], v[128:131]
 ds_read_b64_tr_b16 a[16:17], v10 offset:32896
 ds_read_b64_tr_b16 a[18:19], v10 offset:34688
 v_exp_f32 v104, v104
 v_mfma_f32_16x16x32_bf16 v[132:135], a[24:27], a[116:119], v[132:135]
 v_exp_f32 v105, v105
 v_exp_f32 v106, v106
 v_mfma_f32_16x16x32_bf16 v[136:139], a[24:27], a[120:123], v[136:139]
 v_exp_f32 v107, v107
 v_exp_f32 v108, v108
 v_mfma_f32_16x16x32_bf16 v[140:143], a[24:27], a[124:127], v[140:143]
 v_exp_f32 v109, v109
 v_mfma_f32_16x16x32_bf16 v[156:159], a[28:31], a[124:127], v[156:159]
 ds_read_b64_tr_b16 a[20:21], v10 offset:41088
 ds_read_b64_tr_b16 a[22:23], v10 offset:42880
 v_exp_f32 v110, v110
 v_mfma_f32_16x16x32_bf16 v[152:155], a[28:31], a[120:123], v[152:155]
 v_exp_f32 v111, v111
 v_fma_f32 v104, v104, v21, v21
 v_fma_f32 v105, v105, v21, v21
 v_mfma_f32_16x16x32_bf16 v[148:151], a[28:31], a[116:119], v[148:151]
 v_fma_f32 v106, v106, v21, v21
 v_fma_f32 v107, v107, v21, v21
 v_fma_f32 v108, v108, v23, v23
 v_fma_f32 v109, v109, v23, v23
 v_mfma_f32_16x16x32_bf16 v[144:147], a[28:31], a[112:115], v[144:147]
 v_fma_f32 v110, v110, v23, v23
 v_fma_f32 v111, v111, v23, v23
 s_waitcnt lgkmcnt(8)
 v_mfma_f32_16x16x32_bf16 v[128:131], a[0:3], a[128:131], v[128:131]
 ds_read_b64_tr_b16 a[24:25], v10 offset:49280
 ds_read_b64_tr_b16 a[26:27], v10 offset:51072
 v_rcp_f32 v104, v104
 v_mfma_f32_16x16x32_bf16 v[132:135], a[0:3], a[132:135], v[132:135]
 v_rcp_f32 v105, v105
 v_rcp_f32 v106, v106
 v_mfma_f32_16x16x32_bf16 v[136:139], a[0:3], a[136:139], v[136:139]
 v_rcp_f32 v107, v107
 v_rcp_f32 v108, v108
 v_mfma_f32_16x16x32_bf16 v[140:143], a[0:3], a[140:143], v[140:143]
 v_rcp_f32 v109, v109
 v_rcp_f32 v110, v110
 v_mfma_f32_16x16x32_bf16 v[156:159], a[4:7], a[140:143], v[156:159]
 ds_read_b64_tr_b16 a[28:29], v10 offset:57472
 ds_read_b64_tr_b16 a[30:31], v10 offset:59264
 v_mfma_f32_16x16x32_bf16 v[152:155], a[4:7], a[136:139], v[152:155]
 v_rcp_f32 v111, v111
 v_mul_f32 v104, v104, v120
 v_mul_f32 v105, v105, v121
 v_mul_f32 v106, v106, v122
 v_mfma_f32_16x16x32_bf16 v[148:151], a[4:7], a[132:135], v[148:151]
 v_mul_f32 v107, v107, v123
 v_mul_f32 v108, v108, v124
 v_mul_f32 v109, v109, v125
 v_mfma_f32_16x16x32_bf16 v[144:147], a[4:7], a[128:131], v[144:147]
 v_mul_f32 v110, v110, v126
 v_mul_f32 v111, v111, v127
 v_cvt_pk_bf16_f32 v120, v104, v105
 s_waitcnt lgkmcnt(8)
 v_mfma_f32_16x16x32_bf16 v[128:131], a[8:11], a[144:147], v[128:131]
 ds_read_b64_tr_b16 a[0:1], v11 offset:128
 ds_read_b64_tr_b16 a[2:3], v11 offset:1920
 v_cvt_pk_bf16_f32 v121, v106, v107
 v_cvt_pk_bf16_f32 v122, v108, v109
 v_mfma_f32_16x16x32_bf16 v[132:135], a[8:11], a[148:151], v[132:135]
 v_cvt_pk_bf16_f32 v123, v110, v111
 s_nop 1
 v_permlane16_swap_b32 v120, v122
 v_mfma_f32_16x16x32_bf16 v[136:139], a[8:11], a[152:155], v[136:139]
 v_permlane16_swap_b32 v121, v123
 buffer_store_dwordx4 v[120:123], v12, s[24:27], s47 offen offset:1024 sc1
 v_mfma_f32_16x16x32_bf16 v[140:143], a[8:11], a[156:159], v[140:143]
 v_mfma_f32_16x16x32_bf16 v[156:159], a[12:15], a[156:159], v[156:159]
 ds_read_b64_tr_b16 a[4:5], v11 offset:8320
 ds_read_b64_tr_b16 a[6:7], v11 offset:10112
 v_mfma_f32_16x16x32_bf16 v[152:155], a[12:15], a[152:155], v[152:155]
 v_mfma_f32_16x16x32_bf16 v[148:151], a[12:15], a[148:151], v[148:151]
 v_mfma_f32_16x16x32_bf16 v[144:147], a[12:15], a[144:147], v[144:147]
 s_add_u32 s16, s82, s37
 s_addc_u32 s17, s83, 0
 s_mov_b32 s18, 229376
 s_mov_b32 s19, 0x20000
 s_lshr_b32 s59, s29, 1
 s_lshl_b32 s59, s59, 1
 s_add_u32 s59, s59, s11
 s_lshl_b32 s59, s59, 11
 s_add_u32 s59, s59, 0x18000
 v_min_u32 v24, 15, v0
 v_lshlrev_b32 v24, 7, v24
 v_add_u32 v24, s59, v24
 s_xor_b32 s58, s58, 0x4000
 v_cmp_eq_u32 vcc, 63, v0
 v_mov_b32 v25, s58
 s_mov_b32 s48, 0x10000
 v_cndmask_b32 v25, v24, v25, vcc
 s_mov_b32 s49, 0x18000
 s_waitcnt lgkmcnt(8)
 v_mfma_f32_16x16x32_bf16 v[160:163], a[16:19], a[64:67], v[160:163]
 ds_read_b64_tr_b16 a[8:9], v11 offset:16512
 ds_read_b64_tr_b16 a[10:11], v11 offset:18304
 v_mul_f32 v128, v16, v128
 v_mul_f32 v129, v16, v129
 v_mfma_f32_16x16x32_bf16 v[164:167], a[16:19], a[68:71], v[164:167]
 v_mul_f32 v130, v16, v130
 v_mul_f32 v131, v16, v131
 v_mul_f32 v132, v18, v132
 v_mfma_f32_16x16x32_bf16 v[168:171], a[16:19], a[72:75], v[168:171]
 v_mul_f32 v133, v18, v133
 v_mul_f32 v134, v18, v134
 v_mul_f32 v135, v18, v135
 v_mfma_f32_16x16x32_bf16 v[172:175], a[16:19], a[76:79], v[172:175]
 v_exp_f32 v128, v128
 v_exp_f32 v129, v129
 v_mfma_f32_16x16x32_bf16 v[188:191], a[20:23], a[76:79], v[188:191]
 ds_read_b64_tr_b16 a[12:13], v11 offset:24704
 ds_read_b64_tr_b16 a[14:15], v11 offset:26496
 v_exp_f32 v130, v130
 v_mfma_f32_16x16x32_bf16 v[184:187], a[20:23], a[72:75], v[184:187]
 s_mul_i32 s40, s42, 0
 s_add_u32 s40, s40, s51
 s_add_u32 m0, s45, 131072
 v_exp_f32 v131, v131
 v_mfma_f32_16x16x32_bf16 v[180:183], a[20:23], a[68:71], v[180:183]
 v_exp_f32 v132, v132
 v_exp_f32 v133, v133
 v_mfma_f32_16x16x32_bf16 v[176:179], a[20:23], a[64:67], v[176:179]
 buffer_load_dwordx4 v4, s[20:23], s40 offen offset:0 sc1 lds
 s_waitcnt lgkmcnt(8)
 v_mfma_f32_16x16x32_bf16 v[160:163], a[24:27], a[80:83], v[160:163]
 ds_read_b64_tr_b16 a[16:17], v11 offset:32896
 ds_read_b64_tr_b16 a[18:19], v11 offset:34688
 v_exp_f32 v134, v134
 v_mfma_f32_16x16x32_bf16 v[164:167], a[24:27], a[84:87], v[164:167]
 v_exp_f32 v135, v135
 v_fma_f32 v128, v128, v17, v17
 v_fma_f32 v129, v129, v17, v17
 s_branch m_ps_p3_6
m_pad_p3_6:
 s_branch m_ret_p3
m_ps_p3_6:
 v_mfma_f32_16x16x32_bf16 v[168:171], a[24:27], a[88:91], v[168:171]
 v_fma_f32 v130, v130, v17, v17
 v_fma_f32 v131, v131, v17, v17
 v_fma_f32 v132, v132, v19, v19
 v_fma_f32 v133, v133, v19, v19
 v_mfma_f32_16x16x32_bf16 v[172:175], a[24:27], a[92:95], v[172:175]
 v_fma_f32 v134, v134, v19, v19
 v_fma_f32 v135, v135, v19, v19
 v_rcp_f32 v128, v128
 v_mfma_f32_16x16x32_bf16 v[188:191], a[28:31], a[92:95], v[188:191]
 ds_read_b64_tr_b16 a[20:21], v11 offset:41088
 ds_read_b64_tr_b16 a[22:23], v11 offset:42880
 v_mfma_f32_16x16x32_bf16 v[184:187], a[28:31], a[88:91], v[184:187]
 buffer_load_dwordx4 v5, s[20:23], s40 offen offset:1024 sc1 lds
 v_rcp_f32 v129, v129
 v_rcp_f32 v130, v130
 v_mfma_f32_16x16x32_bf16 v[180:183], a[28:31], a[84:87], v[180:183]
 v_rcp_f32 v131, v131
 v_mfma_f32_16x16x32_bf16 v[176:179], a[28:31], a[80:83], v[176:179]
 v_rcp_f32 v132, v132
 v_rcp_f32 v133, v133
 s_waitcnt lgkmcnt(8)
 v_mfma_f32_16x16x32_bf16 v[160:163], a[0:3], a[96:99], v[160:163]
 ds_read_b64_tr_b16 a[24:25], v11 offset:49280
 ds_read_b64_tr_b16 a[26:27], v11 offset:51072
 v_mfma_f32_16x16x32_bf16 v[164:167], a[0:3], a[100:103], v[164:167]
 s_mul_i32 s40, s42, 7
 s_add_u32 s40, s40, s51
 s_add_u32 m0, s45, 139264
 v_rcp_f32 v134, v134
 v_mfma_f32_16x16x32_bf16 v[168:171], a[0:3], a[104:107], v[168:171]
 v_rcp_f32 v135, v135
 v_mul_f32 v128, v128, v144
 v_mul_f32 v129, v129, v145
 v_mfma_f32_16x16x32_bf16 v[172:175], a[0:3], a[108:111], v[172:175]
 buffer_load_dwordx4 v4, s[20:23], s40 offen offset:0 sc1 lds
 v_mul_f32 v130, v130, v146
 v_mul_f32 v131, v131, v147
 v_mul_f32 v132, v132, v148
 v_mfma_f32_16x16x32_bf16 v[188:191], a[4:7], a[108:111], v[188:191]
 ds_read_b64_tr_b16 a[28:29], v11 offset:57472
 ds_read_b64_tr_b16 a[30:31], v11 offset:59264
 v_mul_f32 v133, v133, v149
 v_mul_f32 v134, v134, v150
 v_mfma_f32_16x16x32_bf16 v[184:187], a[4:7], a[104:107], v[184:187]
 v_mul_f32 v135, v135, v151
 v_cvt_pk_bf16_f32 v144, v128, v129
 v_cvt_pk_bf16_f32 v145, v130, v131
 v_mfma_f32_16x16x32_bf16 v[180:183], a[4:7], a[100:103], v[180:183]
 v_cvt_pk_bf16_f32 v146, v132, v133
 v_cvt_pk_bf16_f32 v147, v134, v135
 s_nop 1
 v_mfma_f32_16x16x32_bf16 v[176:179], a[4:7], a[96:99], v[176:179]
 v_permlane16_swap_b32 v144, v146
 v_permlane16_swap_b32 v145, v147
 buffer_store_dwordx4 v[144:147], v12, s[24:27], 0 offen offset:1536 sc1
 s_waitcnt lgkmcnt(8)
 v_mfma_f32_16x16x32_bf16 v[160:163], a[8:11], a[112:115], v[160:163]
 ds_read_b64_tr_b16 a[0:1], v10 offset:32928
 ds_read_b64_tr_b16 a[2:3], v10 offset:34720
 v_mul_f32 v136, v20, v136
 v_mfma_f32_16x16x32_bf16 v[164:167], a[8:11], a[116:119], v[164:167]
 buffer_load_dwordx4 v5, s[20:23], s40 offen offset:1024 sc1 lds
 v_mul_f32 v137, v20, v137
 v_mul_f32 v138, v20, v138
 v_mul_f32 v139, v20, v139
 v_mfma_f32_16x16x32_bf16 v[168:171], a[8:11], a[120:123], v[168:171]
 v_mul_f32 v140, v22, v140
 v_mul_f32 v141, v22, v141
 v_mul_f32 v142, v22, v142
 v_mfma_f32_16x16x32_bf16 v[172:175], a[8:11], a[124:127], v[172:175]
 v_mul_f32 v143, v22, v143
 v_exp_f32 v136, v136
 v_mfma_f32_16x16x32_bf16 v[188:191], a[12:15], a[124:127], v[188:191]
 ds_read_b64_tr_b16 a[4:5], v10 offset:41120
 ds_read_b64_tr_b16 a[6:7], v10 offset:42912
 v_exp_f32 v137, v137
 v_mfma_f32_16x16x32_bf16 v[184:187], a[12:15], a[120:123], v[184:187]
 s_mul_i32 s40, s42, 14
 s_add_u32 s40, s40, s51
 s_add_u32 m0, s45, 147456
 v_exp_f32 v138, v138
 v_mfma_f32_16x16x32_bf16 v[180:183], a[12:15], a[116:119], v[180:183]
 v_exp_f32 v139, v139
 v_exp_f32 v140, v140
 v_mfma_f32_16x16x32_bf16 v[176:179], a[12:15], a[112:115], v[176:179]
 buffer_load_dwordx4 v4, s[20:23], s40 offen offset:0 sc1 lds
 v_exp_f32 v141, v141
 s_waitcnt lgkmcnt(8)
 v_mfma_f32_16x16x32_bf16 v[160:163], a[16:19], a[128:131], v[160:163]
 ds_read_b64_tr_b16 a[8:9], v10 offset:49312
 ds_read_b64_tr_b16 a[10:11], v10 offset:51104
 v_mfma_f32_16x16x32_bf16 v[164:167], a[16:19], a[132:135], v[164:167]
 v_exp_f32 v142, v142
 v_exp_f32 v143, v143
 v_fma_f32 v136, v136, v21, v21
 v_mfma_f32_16x16x32_bf16 v[168:171], a[16:19], a[136:139], v[168:171]
 v_fma_f32 v137, v137, v21, v21
 v_fma_f32 v138, v138, v21, v21
 v_fma_f32 v139, v139, v21, v21
 v_mfma_f32_16x16x32_bf16 v[172:175], a[16:19], a[140:143], v[172:175]
 v_fma_f32 v140, v140, v23, v23
 v_fma_f32 v141, v141, v23, v23
 v_fma_f32 v142, v142, v23, v23
 v_fma_f32 v143, v143, v23, v23
 s_waitcnt vmcnt(6)
 s_barrier
 buffer_store_dwordx2 v[28:29], v30, s[60:63], s54 offen sc1
 v_mfma_f32_16x16x32_bf16 v[188:191], a[20:23], a[140:143], v[188:191]
 ds_read_b64_tr_b16 a[12:13], v10 offset:57504
 ds_read_b64_tr_b16 a[14:15], v10 offset:59296
 v_rcp_f32 v136, v136
 v_mfma_f32_16x16x32_bf16 v[184:187], a[20:23], a[136:139], v[184:187]
 buffer_load_dwordx4 v5, s[20:23], s40 offen offset:1024 sc1 lds
 v_rcp_f32 v137, v137
 v_mfma_f32_16x16x32_bf16 v[180:183], a[20:23], a[132:135], v[180:183]
 v_rcp_f32 v138, v138
 v_rcp_f32 v139, v139
 v_mfma_f32_16x16x32_bf16 v[176:179], a[20:23], a[128:131], v[176:179]
 v_rcp_f32 v140, v140
 s_waitcnt lgkmcnt(8)
 v_mfma_f32_16x16x32_bf16 v[160:163], a[24:27], a[144:147], v[160:163]
 ds_read_b64_tr_b16 a[16:17], v11 offset:160
 ds_read_b64_tr_b16 a[18:19], v11 offset:1952
 v_rcp_f32 v141, v141
 v_mfma_f32_16x16x32_bf16 v[164:167], a[24:27], a[148:151], v[164:167]
 s_mul_i32 s40, s42, 21
 s_add_u32 s40, s40, s51
 s_add_u32 m0, s45, 155648
 v_rcp_f32 v142, v142
 v_mfma_f32_16x16x32_bf16 v[168:171], a[24:27], a[152:155], v[168:171]
 v_rcp_f32 v143, v143
 v_mul_f32 v136, v136, v152
 v_mfma_f32_16x16x32_bf16 v[172:175], a[24:27], a[156:159], v[172:175]
 buffer_load_dwordx4 v4, s[20:23], s40 offen offset:0 sc1 lds
 v_mul_f32 v137, v137, v153
 v_mul_f32 v138, v138, v154
 v_mul_f32 v139, v139, v155
 v_mfma_f32_16x16x32_bf16 v[188:191], a[28:31], a[156:159], v[188:191]
 ds_read_b64_tr_b16 a[20:21], v11 offset:8352
 ds_read_b64_tr_b16 a[22:23], v11 offset:10144
 v_mul_f32 v140, v140, v156
 v_mul_f32 v141, v141, v157
 v_mfma_f32_16x16x32_bf16 v[184:187], a[28:31], a[152:155], v[184:187]
 v_mul_f32 v142, v142, v158
 v_mul_f32 v143, v143, v159
 v_cvt_pk_bf16_f32 v152, v136, v137
 v_mfma_f32_16x16x32_bf16 v[180:183], a[28:31], a[148:151], v[180:183]
 v_cvt_pk_bf16_f32 v153, v138, v139
 v_cvt_pk_bf16_f32 v154, v140, v141
 v_cvt_pk_bf16_f32 v155, v142, v143
 v_mfma_f32_16x16x32_bf16 v[176:179], a[28:31], a[144:147], v[176:179]
 s_nop 1
 v_permlane16_swap_b32 v152, v154
 v_permlane16_swap_b32 v153, v155
 buffer_store_dwordx4 v[152:155], v12, s[24:27], s47 offen offset:1536 sc1
 s_waitcnt lgkmcnt(8)
 v_mfma_f32_16x16x32_bf16 v[192:195], a[0:3], a[64:67], v[192:195]
 ds_read_b64_tr_b16 a[24:25], v11 offset:16544
 ds_read_b64_tr_b16 a[26:27], v11 offset:18336
 v_mul_f32 v160, v16, v160
 v_mul_f32 v161, v16, v161
 v_mfma_f32_16x16x32_bf16 v[196:199], a[0:3], a[68:71], v[196:199]
 buffer_load_dwordx4 v5, s[20:23], s40 offen offset:1024 sc1 lds
 v_mul_f32 v162, v16, v162
 v_mul_f32 v163, v16, v163
 v_mul_f32 v164, v18, v164
 v_mfma_f32_16x16x32_bf16 v[200:203], a[0:3], a[72:75], v[200:203]
 v_mul_f32 v165, v18, v165
 v_mul_f32 v166, v18, v166
 v_mul_f32 v167, v18, v167
 v_exp_f32 v160, v160
 v_mfma_f32_16x16x32_bf16 v[204:207], a[0:3], a[76:79], v[204:207]
 v_lshrrev_b32 v140, 5, v0
 v_lshlrev_b32 v140, 11, v140
 v_exp_f32 v161, v161
 v_mfma_f32_16x16x32_bf16 v[220:223], a[4:7], a[76:79], v[220:223]
 ds_read_b64_tr_b16 a[28:29], v11 offset:24736
 ds_read_b64_tr_b16 a[30:31], v11 offset:26528
 v_exp_f32 v162, v162
 v_mfma_f32_16x16x32_bf16 v[216:219], a[4:7], a[72:75], v[216:219]
 s_mul_i32 s40, s42, 28
 s_add_u32 s40, s40, s51
 s_add_u32 m0, s45, 0
 v_exp_f32 v163, v163
 v_mfma_f32_16x16x32_bf16 v[212:215], a[4:7], a[68:71], v[212:215]
 v_bfe_u32 v141, v0, 2, 3
 v_lshl_add_u32 v140, v141, 7, v140
 v_exp_f32 v164, v164
 v_mfma_f32_16x16x32_bf16 v[208:211], a[4:7], a[64:67], v[208:211]
 buffer_load_dwordx4 v4, s[20:23], s40 offen offset:0 sc1 lds
 v_exp_f32 v165, v165
 s_waitcnt lgkmcnt(8)
 v_mfma_f32_16x16x32_bf16 v[192:195], a[8:11], a[80:83], v[192:195]
 ds_read_b64_tr_b16 a[0:1], v11 offset:32928
 ds_read_b64_tr_b16 a[2:3], v11 offset:34720
 v_exp_f32 v166, v166
 v_mfma_f32_16x16x32_bf16 v[196:199], a[8:11], a[84:87], v[196:199]
 v_and_b32 v141, 3, v0
 v_lshl_add_u32 v140, v141, 3, v140
 v_exp_f32 v167, v167
 v_fma_f32 v160, v160, v17, v17
 v_mfma_f32_16x16x32_bf16 v[200:203], a[8:11], a[88:91], v[200:203]
 v_bfe_u32 v141, v0, 3, 2
 v_xor_b32 v142, 0, v141
 v_fma_f32 v161, v161, v17, v17
 v_fma_f32 v162, v162, v17, v17
 v_mfma_f32_16x16x32_bf16 v[204:207], a[8:11], a[92:95], v[204:207]
 v_lshl_add_u32 v128, v142, 5, v140
 v_add_u32 v132, 0x10000, v128
 v_fma_f32 v163, v163, v17, v17
 v_fma_f32 v164, v164, v19, v19
 v_mfma_f32_16x16x32_bf16 v[220:223], a[12:15], a[92:95], v[220:223]
 ds_read_b64_tr_b16 a[4:5], v11 offset:41120
 ds_read_b64_tr_b16 a[6:7], v11 offset:42912
 v_fma_f32 v165, v165, v19, v19
 v_fma_f32 v166, v166, v19, v19
 v_mfma_f32_16x16x32_bf16 v[216:219], a[12:15], a[88:91], v[216:219]
 buffer_load_dwordx4 v5, s[20:23], s40 offen offset:1024 sc1 lds
 v_add_u32 v136, 0x20000, v128
 v_fma_f32 v167, v167, v19, v19
 v_mfma_f32_16x16x32_bf16 v[212:215], a[12:15], a[84:87], v[212:215]
 v_xor_b32 v142, 1, v141
 v_lshl_add_u32 v129, v142, 5, v140
 v_rcp_f32 v160, v160
 v_mfma_f32_16x16x32_bf16 v[208:211], a[12:15], a[80:83], v[208:211]
 v_add_u32 v133, 0x10000, v129
 v_rcp_f32 v161, v161
 s_waitcnt lgkmcnt(8)
 v_mfma_f32_16x16x32_bf16 v[192:195], a[16:19], a[96:99], v[192:195]
 ds_read_b64_tr_b16 a[8:9], v11 offset:49312
 ds_read_b64_tr_b16 a[10:11], v11 offset:51104
 v_rcp_f32 v162, v162
 v_mfma_f32_16x16x32_bf16 v[196:199], a[16:19], a[100:103], v[196:199]
 s_mul_i32 s40, s42, 35
 s_add_u32 s40, s40, s51
 s_add_u32 m0, s45, 8192
 v_rcp_f32 v163, v163
 v_mfma_f32_16x16x32_bf16 v[200:203], a[16:19], a[104:107], v[200:203]
 v_add_u32 v137, 0x20000, v129
 v_xor_b32 v142, 2, v141
 v_rcp_f32 v164, v164
 v_mfma_f32_16x16x32_bf16 v[204:207], a[16:19], a[108:111], v[204:207]
 buffer_load_dwordx4 v4, s[20:23], s40 offen offset:0 sc1 lds
 v_lshl_add_u32 v130, v142, 5, v140
 v_rcp_f32 v165, v165
 v_mfma_f32_16x16x32_bf16 v[220:223], a[20:23], a[108:111], v[220:223]
 ds_read_b64_tr_b16 a[12:13], v11 offset:57504
 ds_read_b64_tr_b16 a[14:15], v11 offset:59296
 v_rcp_f32 v166, v166
 v_mfma_f32_16x16x32_bf16 v[216:219], a[20:23], a[104:107], v[216:219]
 v_add_u32 v134, 0x10000, v130
 v_add_u32 v138, 0x20000, v130
 v_rcp_f32 v167, v167
 v_mul_f32 v160, v160, v176
 v_mfma_f32_16x16x32_bf16 v[212:215], a[20:23], a[100:103], v[212:215]
 v_xor_b32 v142, 3, v141
 v_lshl_add_u32 v131, v142, 5, v140
 v_mul_f32 v161, v161, v177
 v_mul_f32 v162, v162, v178
 v_mfma_f32_16x16x32_bf16 v[208:211], a[20:23], a[96:99], v[208:211]
 v_add_u32 v135, 0x10000, v131
 v_mul_f32 v163, v163, v179
 v_mul_f32 v164, v164, v180
 v_mul_f32 v165, v165, v181
 s_waitcnt lgkmcnt(8)
 v_mfma_f32_16x16x32_bf16 v[192:195], a[24:27], a[112:115], v[192:195]
 ds_read_b64_tr_b16 a[16:17], v10 offset:32960
 ds_read_b64_tr_b16 a[18:19], v10 offset:34752
 v_mul_f32 v166, v166, v182
 v_mul_f32 v167, v167, v183
 v_mfma_f32_16x16x32_bf16 v[196:199], a[24:27], a[116:119], v[196:199]
 buffer_load_dwordx4 v5, s[20:23], s40 offen offset:1024 sc1 lds
 v_add_u32 v139, 0x20000, v131
 v_cvt_pk_bf16_f32 v176, v160, v161
 v_cvt_pk_bf16_f32 v177, v162, v163
 v_mfma_f32_16x16x32_bf16 v[200:203], a[24:27], a[120:123], v[200:203]
 v_cvt_pk_bf16_f32 v178, v164, v165
 v_cvt_pk_bf16_f32 v179, v166, v167
 s_nop 1
 v_mfma_f32_16x16x32_bf16 v[204:207], a[24:27], a[124:127], v[204:207]
 buffer_load_dwordx2 v[26:27], v24, s[60:63], s48 offen sc1
 v_permlane16_swap_b32 v176, v178
 v_permlane16_swap_b32 v177, v179
 buffer_store_dwordx4 v[176:179], v12, s[24:27], 0 offen offset:2048 sc1
 v_mfma_f32_16x16x32_bf16 v[220:223], a[28:31], a[124:127], v[220:223]
 ds_read_b64_tr_b16 a[20:21], v10 offset:41152
 ds_read_b64_tr_b16 a[22:23], v10 offset:42944
 v_mul_f32 v168, v20, v168
 v_mul_f32 v169, v20, v169
 v_mfma_f32_16x16x32_bf16 v[216:219], a[28:31], a[120:123], v[216:219]
 s_mul_i32 s40, s42, 42
 s_add_u32 s40, s40, s51
 s_add_u32 m0, s45, 16384
 v_mul_f32 v170, v20, v170
 v_mul_f32 v171, v20, v171
 v_mul_f32 v172, v22, v172
 v_mfma_f32_16x16x32_bf16 v[212:215], a[28:31], a[116:119], v[212:215]
 v_mul_f32 v173, v22, v173
 v_mul_f32 v174, v22, v174
 v_mul_f32 v175, v22, v175
 v_mfma_f32_16x16x32_bf16 v[208:211], a[28:31], a[112:115], v[208:211]
 buffer_load_dwordx4 v4, s[20:23], s40 offen offset:0 sc1 lds
 v_exp_f32 v168, v168
 s_waitcnt lgkmcnt(8)
 v_mfma_f32_16x16x32_bf16 v[192:195], a[0:3], a[128:131], v[192:195]
 ds_read_b64_tr_b16 a[24:25], v10 offset:49344
 ds_read_b64_tr_b16 a[26:27], v10 offset:51136
 v_exp_f32 v169, v169
 v_mfma_f32_16x16x32_bf16 v[196:199], a[0:3], a[132:135], v[196:199]
 v_exp_f32 v170, v170
 v_exp_f32 v171, v171
 v_mfma_f32_16x16x32_bf16 v[200:203], a[0:3], a[136:139], v[200:203]
 v_exp_f32 v172, v172
 v_exp_f32 v173, v173
 v_mfma_f32_16x16x32_bf16 v[204:207], a[0:3], a[140:143], v[204:207]
 v_exp_f32 v174, v174
 v_exp_f32 v175, v175
 v_fma_f32 v168, v168, v21, v21
 v_mfma_f32_16x16x32_bf16 v[220:223], a[4:7], a[140:143], v[220:223]
 ds_read_b64_tr_b16 a[28:29], v10 offset:57536
 ds_read_b64_tr_b16 a[30:31], v10 offset:59328
 v_fma_f32 v169, v169, v21, v21
 v_fma_f32 v170, v170, v21, v21
 v_mfma_f32_16x16x32_bf16 v[216:219], a[4:7], a[136:139], v[216:219]
 buffer_load_dwordx4 v5, s[20:23], s40 offen offset:1024 sc1 lds
 v_fma_f32 v171, v171, v21, v21
 v_fma_f32 v172, v172, v23, v23
 v_fma_f32 v173, v173, v23, v23
 v_fma_f32 v174, v174, v23, v23
 v_mfma_f32_16x16x32_bf16 v[212:215], a[4:7], a[132:135], v[212:215]
 v_fma_f32 v175, v175, v23, v23
 v_rcp_f32 v168, v168
 v_mfma_f32_16x16x32_bf16 v[208:211], a[4:7], a[128:131], v[208:211]
 v_rcp_f32 v169, v169
 v_rcp_f32 v170, v170
 s_waitcnt lgkmcnt(8)
 v_mfma_f32_16x16x32_bf16 v[192:195], a[8:11], a[144:147], v[192:195]
 ds_read_b64_tr_b16 a[0:1], v11 offset:192
 ds_read_b64_tr_b16 a[2:3], v11 offset:1984
 v_rcp_f32 v171, v171
 v_mfma_f32_16x16x32_bf16 v[196:199], a[8:11], a[148:151], v[196:199]
 s_mul_i32 s40, s42, 49
 s_add_u32 s40, s40, s51
 s_add_u32 m0, s45, 24576
 v_rcp_f32 v172, v172
 v_mfma_f32_16x16x32_bf16 v[200:203], a[8:11], a[152:155], v[200:203]
 v_rcp_f32 v173, v173
 v_rcp_f32 v174, v174
 v_mfma_f32_16x16x32_bf16 v[204:207], a[8:11], a[156:159], v[204:207]
 buffer_load_dwordx4 v4, s[20:23], s40 offen offset:0 sc1 lds
 v_rcp_f32 v175, v175
 v_mul_f32 v168, v168, v184
 v_mul_f32 v169, v169, v185
 v_mfma_f32_16x16x32_bf16 v[220:223], a[12:15], a[156:159], v[220:223]
 ds_read_b64_tr_b16 a[4:5], v11 offset:8384
 ds_read_b64_tr_b16 a[6:7], v11 offset:10176
 v_mul_f32 v170, v170, v186
 v_mul_f32 v171, v171, v187
 v_mfma_f32_16x16x32_bf16 v[216:219], a[12:15], a[152:155], v[216:219]
 v_mul_f32 v172, v172, v188
 v_mul_f32 v173, v173, v189
 v_mul_f32 v174, v174, v190
 v_mul_f32 v175, v175, v191
 v_mfma_f32_16x16x32_bf16 v[212:215], a[12:15], a[148:151], v[212:215]
 v_cvt_pk_bf16_f32 v184, v168, v169
 v_cvt_pk_bf16_f32 v185, v170, v171
 v_cvt_pk_bf16_f32 v186, v172, v173
 v_cvt_pk_bf16_f32 v187, v174, v175
 v_mfma_f32_16x16x32_bf16 v[208:211], a[12:15], a[144:147], v[208:211]
 s_nop 1
 v_permlane16_swap_b32 v184, v186
 v_permlane16_swap_b32 v185, v187
 buffer_store_dwordx4 v[184:187], v12, s[24:27], s47 offen offset:2048 sc1
 s_waitcnt lgkmcnt(8)
 v_mfma_f32_16x16x32_bf16 v[224:227], a[16:19], a[64:67], v[224:227]
 ds_read_b64_tr_b16 a[8:9], v11 offset:16576
 ds_read_b64_tr_b16 a[10:11], v11 offset:18368
 v_mul_f32 v192, v16, v192
 v_mul_f32 v193, v16, v193
 v_mfma_f32_16x16x32_bf16 v[228:231], a[16:19], a[68:71], v[228:231]
 buffer_load_dwordx4 v5, s[20:23], s40 offen offset:1024 sc1 lds
 v_mul_f32 v194, v16, v194
 v_mul_f32 v195, v16, v195
 v_mul_f32 v196, v18, v196
 v_mfma_f32_16x16x32_bf16 v[232:235], a[16:19], a[72:75], v[232:235]
 v_mul_f32 v197, v18, v197
 v_mul_f32 v198, v18, v198
 v_mul_f32 v199, v18, v199
 v_mfma_f32_16x16x32_bf16 v[236:239], a[16:19], a[76:79], v[236:239]
 s_waitcnt vmcnt(6)
 v_cmp_ne_u64 vcc, s[8:9], v[26:27]
 s_mov_b32 s57, 0
 s_cbranch_vccz L_ok_f1
L_re_f1:
 buffer_load_dwordx2 v[26:27], v24, s[60:63], s48 offen sc1
 s_add_u32 s57, s57, 1
 s_waitcnt vmcnt(0)
 v_cmp_ne_u64 vcc, s[8:9], v[26:27]
 s_cmp_gt_u32 s57, 0x40000
 s_cbranch_vccz L_ok_f1
 s_cbranch_scc0 L_re_f1
L_ok_f1:
 v_mfma_f32_16x16x32_bf16 v[252:255], a[20:23], a[76:79], v[252:255]
 ds_read_b64_tr_b16 a[12:13], v11 offset:24768
 ds_read_b64_tr_b16 a[14:15], v11 offset:26560
 v_exp_f32 v192, v192
 v_mfma_f32_16x16x32_bf16 v[248:251], a[20:23], a[72:75], v[248:251]
 s_mov_b32 s46, 0
 v_exp_f32 v193, v193
 v_mfma_f32_16x16x32_bf16 v[244:247], a[20:23], a[68:71], v[244:247]
 v_exp_f32 v194, v194
 v_exp_f32 v195, v195
 v_mfma_f32_16x16x32_bf16 v[240:243], a[20:23], a[64:67], v[240:243]
 buffer_load_dwordx4 a[160:163], v6, s[16:19], s46 offen offset:0 sc1
 v_exp_f32 v196, v196
 s_waitcnt lgkmcnt(8)
 v_mfma_f32_16x16x32_bf16 v[224:227], a[24:27], a[80:83], v[224:227]
 ds_read_b64_tr_b16 a[16:17], v11 offset:32960
 ds_read_b64_tr_b16 a[18:19], v11 offset:34752
 v_exp_f32 v197, v197
 v_mfma_f32_16x16x32_bf16 v[228:231], a[24:27], a[84:87], v[228:231]
 v_exp_f32 v198, v198
 v_exp_f32 v199, v199
 v_fma_f32 v192, v192, v17, v17
 v_mfma_f32_16x16x32_bf16 v[232:235], a[24:27], a[88:91], v[232:235]
 buffer_load_dwordx4 a[164:167], v7, s[16:19], s46 offen offset:0 sc1
 v_fma_f32 v193, v193, v17, v17
 v_fma_f32 v194, v194, v17, v17
 v_fma_f32 v195, v195, v17, v17
 v_mfma_f32_16x16x32_bf16 v[236:239], a[24:27], a[92:95], v[236:239]
 s_mov_b32 s46, 4096
 v_fma_f32 v196, v196, v19, v19
 v_fma_f32 v197, v197, v19, v19
 v_mfma_f32_16x16x32_bf16 v[252:255], a[28:31], a[92:95], v[252:255]
 ds_read_b64_tr_b16 a[20:21], v11 offset:41152
 ds_read_b64_tr_b16 a[22:23], v11 offset:42944
 v_fma_f32 v198, v198, v19, v19
 v_fma_f32 v199, v199, v19, v19
 v_mfma_f32_16x16x32_bf16 v[248:251], a[28:31], a[88:91], v[248:251]
 buffer_load_dwordx4 a[168:171], v6, s[16:19], s46 offen offset:0 sc1
 v_rcp_f32 v192, v192
 v_mfma_f32_16x16x32_bf16 v[244:247], a[28:31], a[84:87], v[244:247]
 v_rcp_f32 v193, v193
 v_rcp_f32 v194, v194
 v_mfma_f32_16x16x32_bf16 v[240:243], a[28:31], a[80:83], v[240:243]
 v_rcp_f32 v195, v195
 v_rcp_f32 v196, v196
 s_waitcnt lgkmcnt(8)
 v_mfma_f32_16x16x32_bf16 v[224:227], a[0:3], a[96:99], v[224:227]
 ds_read_b64_tr_b16 a[24:25], v11 offset:49344
 ds_read_b64_tr_b16 a[26:27], v11 offset:51136
 v_rcp_f32 v197, v197
 v_mfma_f32_16x16x32_bf16 v[228:231], a[0:3], a[100:103], v[228:231]
 buffer_load_dwordx4 a[172:175], v7, s[16:19], s46 offen offset:0 sc1
 v_rcp_f32 v198, v198
 v_mfma_f32_16x16x32_bf16 v[232:235], a[0:3], a[104:107], v[232:235]
 v_rcp_f32 v199, v199
 v_mul_f32 v192, v192, v208
 v_mul_f32 v193, v193, v209
 v_mul_f32 v194, v194, v210
 v_mfma_f32_16x16x32_bf16 v[236:239], a[0:3], a[108:111], v[236:239]
 buffer_load_dwordx4 a[176:179], v6, s[16:19], s46 offen offset:3072 sc1
 v_mul_f32 v195, v195, v211
 v_mul_f32 v196, v196, v212
 v_mfma_f32_16x16x32_bf16 v[252:255], a[4:7], a[108:111], v[252:255]
 ds_read_b64_tr_b16 a[28:29], v11 offset:57536
 ds_read_b64_tr_b16 a[30:31], v11 offset:59328
 v_mul_f32 v197, v197, v213
 v_mul_f32 v198, v198, v214
 v_mfma_f32_16x16x32_bf16 v[248:251], a[4:7], a[104:107], v[248:251]
 v_mul_f32 v199, v199, v215
 v_cvt_pk_bf16_f32 v208, v192, v193
 v_cvt_pk_bf16_f32 v209, v194, v195
 v_cvt_pk_bf16_f32 v210, v196, v197
 v_mfma_f32_16x16x32_bf16 v[244:247], a[4:7], a[100:103], v[244:247]
 buffer_load_dwordx4 a[180:183], v7, s[16:19], s46 offen offset:3072 sc1
 v_cvt_pk_bf16_f32 v211, v198, v199
 s_nop 1
 v_mfma_f32_16x16x32_bf16 v[240:243], a[4:7], a[96:99], v[240:243]
 s_mov_b32 s46, 8192
 v_permlane16_swap_b32 v208, v210
 v_permlane16_swap_b32 v209, v211
 s_waitcnt lgkmcnt(8)
 v_mfma_f32_16x16x32_bf16 v[224:227], a[8:11], a[112:115], v[224:227]
 buffer_store_dwordx4 v[208:211], v12, s[24:27], 0 offen offset:2560 sc1
 v_mul_f32 v200, v20, v200
 v_mul_f32 v201, v20, v201
 v_mul_f32 v202, v20, v202
 v_mfma_f32_16x16x32_bf16 v[228:231], a[8:11], a[116:119], v[228:231]
 buffer_load_dwordx4 a[184:187], v6, s[16:19], s46 offen offset:3072 sc1
 v_mul_f32 v203, v20, v203
 v_mul_f32 v204, v22, v204
 v_mul_f32 v205, v22, v205
 v_mfma_f32_16x16x32_bf16 v[232:235], a[8:11], a[120:123], v[232:235]
 v_mul_f32 v206, v22, v206
 v_mul_f32 v207, v22, v207
 v_exp_f32 v200, v200
 v_mfma_f32_16x16x32_bf16 v[236:239], a[8:11], a[124:127], v[236:239]
 v_exp_f32 v201, v201
 v_exp_f32 v202, v202
 v_mfma_f32_16x16x32_bf16 v[252:255], a[12:15], a[124:127], v[252:255]
 buffer_load_dwordx4 a[188:191], v7, s[16:19], s46 offen offset:3072 sc1
 v_exp_f32 v203, v203
 v_mfma_f32_16x16x32_bf16 v[248:251], a[12:15], a[120:123], v[248:251]
 s_mov_b32 s46, 12288
 v_exp_f32 v204, v204
 v_exp_f32 v205, v205
 v_mfma_f32_16x16x32_bf16 v[244:247], a[12:15], a[116:119], v[244:247]
 v_exp_f32 v206, v206
 v_exp_f32 v207, v207
 v_mfma_f32_16x16x32_bf16 v[240:243], a[12:15], a[112:115], v[240:243]
 buffer_load_dwordx4 a[192:195], v6, s[16:19], s46 offen offset:2048 sc1
 v_fma_f32 v200, v200, v21, v21
 s_waitcnt lgkmcnt(4)
 v_mfma_f32_16x16x32_bf16 v[224:227], a[16:19], a[128:131], v[224:227]
 v_fma_f32 v201, v201, v21, v21
 v_fma_f32 v202, v202, v21, v21
 v_fma_f32 v203, v203, v21, v21
 v_fma_f32 v204, v204, v23, v23
 v_mfma_f32_16x16x32_bf16 v[228:231], a[16:19], a[132:135], v[228:231]
 v_fma_f32 v205, v205, v23, v23
 v_fma_f32 v206, v206, v23, v23
 v_fma_f32 v207, v207, v23, v23
 v_mfma_f32_16x16x32_bf16 v[232:235], a[16:19], a[136:139], v[232:235]
 buffer_load_dwordx4 a[196:199], v7, s[16:19], s46 offen offset:2048 sc1
 v_rcp_f32 v200, v200
 v_rcp_f32 v201, v201
 v_mfma_f32_16x16x32_bf16 v[236:239], a[16:19], a[140:143], v[236:239]
 s_mov_b32 s46, 16384
 v_rcp_f32 v202, v202
 s_waitcnt vmcnt(12)
 s_barrier
 buffer_store_dwordx2 v[28:29], v30, s[60:63], s55 offen sc1
 v_mfma_f32_16x16x32_bf16 v[252:255], a[20:23], a[140:143], v[252:255]
 s_barrier
 ds_read_b64_tr_b16 v[96:97], v136 offset:0
 v_rcp_f32 v203, v203
 v_mfma_f32_16x16x32_bf16 v[248:251], a[20:23], a[136:139], v[248:251]
 ds_read_b64_tr_b16 v[98:99], v136 offset:1024
 buffer_load_dwordx4 a[200:203], v6, s[16:19], s46 offen offset:2048 sc1
 v_rcp_f32 v204, v204
 v_mfma_f32_16x16x32_bf16 v[244:247], a[20:23], a[132:135], v[244:247]
 ds_read_b64_tr_b16 v[100:101], v137 offset:0
 ds_read_b64_tr_b16 v[102:103], v137 offset:1024
 v_rcp_f32 v205, v205
 v_mfma_f32_16x16x32_bf16 v[240:243], a[20:23], a[128:131], v[240:243]
 v_rcp_f32 v206, v206
 s_waitcnt lgkmcnt(4)
 v_mfma_f32_16x16x32_bf16 v[224:227], a[24:27], a[144:147], v[224:227]
 ds_read_b64_tr_b16 v[104:105], v138 offset:0
 ds_read_b64_tr_b16 v[106:107], v138 offset:1024
 v_rcp_f32 v207, v207
 v_mfma_f32_16x16x32_bf16 v[228:231], a[24:27], a[148:151], v[228:231]
 buffer_load_dwordx4 a[204:207], v7, s[16:19], s46 offen offset:2048 sc1
 s_mov_b32 s46, 20480
 v_mul_f32 v200, v200, v216
 v_mul_f32 v201, v201, v217
 v_mfma_f32_16x16x32_bf16 v[232:235], a[24:27], a[152:155], v[232:235]
 ds_read_b64_tr_b16 v[108:109], v139 offset:0
 ds_read_b64_tr_b16 v[110:111], v139 offset:1024
 v_mul_f32 v202, v202, v218
 v_mul_f32 v203, v203, v219
 v_mfma_f32_16x16x32_bf16 v[236:239], a[24:27], a[156:159], v[236:239]
 buffer_load_dwordx4 a[208:211], v6, s[16:19], s46 offen offset:1024 sc1
 v_mul_f32 v204, v204, v220
 v_mul_f32 v205, v205, v221
 v_mul_f32 v206, v206, v222
 v_mfma_f32_16x16x32_bf16 v[252:255], a[28:31], a[156:159], v[252:255]
 ds_read_b64_tr_b16 v[112:113], v136 offset:4096
 ds_read_b64_tr_b16 v[114:115], v136 offset:5120
 v_mul_f32 v207, v207, v223
 v_cvt_pk_bf16_f32 v216, v200, v201
 v_mfma_f32_16x16x32_bf16 v[248:251], a[28:31], a[152:155], v[248:251]
 v_cvt_pk_bf16_f32 v217, v202, v203
 v_cvt_pk_bf16_f32 v218, v204, v205
 v_cvt_pk_bf16_f32 v219, v206, v207
 v_mfma_f32_16x16x32_bf16 v[244:247], a[28:31], a[148:151], v[244:247]
 ds_read_b64_tr_b16 v[116:117], v137 offset:4096
 ds_read_b64_tr_b16 v[118:119], v137 offset:5120
 s_nop 1
 v_permlane16_swap_b32 v216, v218
 v_mfma_f32_16x16x32_bf16 v[240:243], a[28:31], a[144:147], v[240:243]
 buffer_load_dwordx4 a[212:215], v7, s[16:19], s46 offen offset:1024 sc1
 s_mov_b32 s46, 24576
 v_permlane16_swap_b32 v217, v219
 buffer_store_dwordx4 v[216:219], v12, s[24:27], s47 offen offset:2560 sc1
 s_waitcnt vmcnt(15) lgkmcnt(8)
 v_mfma_f32_16x16x32_bf16 v[64:67], v[96:99], a[160:163], 0
 ds_read_b64_tr_b16 v[120:121], v138 offset:4096
 ds_read_b64_tr_b16 v[122:123], v138 offset:5120
 v_mul_f32 v224, v16, v224
 v_mul_f32 v225, v16, v225
 v_mfma_f32_16x16x32_bf16 v[68:71], v[96:99], a[164:167], 0
 buffer_load_dwordx4 a[216:219], v6, s[16:19], s46 offen offset:1024 sc1
 v_mul_f32 v226, v16, v226
 v_mul_f32 v227, v16, v227
 v_mul_f32 v228, v18, v228
 v_mfma_f32_16x16x32_bf16 v[76:79], v[100:103], a[164:167], 0
 ds_read_b64_tr_b16 v[124:125], v139 offset:4096
 ds_read_b64_tr_b16 v[126:127], v139 offset:5120
 v_mul_f32 v229, v18, v229
 v_mul_f32 v230, v18, v230
 v_mul_f32 v231, v18, v231
 v_mfma_f32_16x16x32_bf16 v[72:75], v[100:103], a[160:163], 0
 v_exp_f32 v224, v224
 s_waitcnt lgkmcnt(8)
 v_mfma_f32_16x16x32_bf16 v[80:83], v[104:107], a[160:163], 0
 s_barrier
 ds_read_b64_tr_b16 v[96:97], v136 offset:8192
 v_exp_f32 v225, v225
 v_mfma_f32_16x16x32_bf16 v[84:87], v[104:107], a[164:167], 0
 ds_read_b64_tr_b16 v[98:99], v136 offset:9216
 buffer_load_dwordx4 a[220:223], v7, s[16:19], s46 offen offset:1024 sc1
 s_mov_b32 s46, 28672
 v_mfma_f32_16x16x32_bf16 v[92:95], v[108:111], a[164:167], 0
 ds_read_b64_tr_b16 v[100:101], v137 offset:8192
 ds_read_b64_tr_b16 v[102:103], v137 offset:9216
 v_exp_f32 v226, v226
 v_mfma_f32_16x16x32_bf16 v[88:91], v[108:111], a[160:163], 0
 buffer_load_dwordx4 a[224:227], v6, s[16:19], s46 offen offset:0 sc1
 v_exp_f32 v227, v227
 s_waitcnt vmcnt(16) lgkmcnt(8)
 v_mfma_f32_16x16x32_bf16 v[64:67], v[112:115], a[168:171], v[64:67]
 ds_read_b64_tr_b16 v[104:105], v138 offset:8192
 ds_read_b64_tr_b16 v[106:107], v138 offset:9216
 v_exp_f32 v228, v228
 v_mfma_f32_16x16x32_bf16 v[68:71], v[112:115], a[172:175], v[68:71]
 v_exp_f32 v229, v229
 v_exp_f32 v230, v230
 v_mfma_f32_16x16x32_bf16 v[76:79], v[116:119], a[172:175], v[76:79]
 ds_read_b64_tr_b16 v[108:109], v139 offset:8192
 ds_read_b64_tr_b16 v[110:111], v139 offset:9216
 v_exp_f32 v231, v231
 v_fma_f32 v224, v224, v17, v17
 v_mfma_f32_16x16x32_bf16 v[72:75], v[116:119], a[168:171], v[72:75]
 buffer_load_dwordx4 a[228:231], v7, s[16:19], s46 offen offset:0 sc1
 s_mov_b32 s46, 32768
 v_fma_f32 v225, v225, v17, v17
 s_waitcnt lgkmcnt(8)
 v_mfma_f32_16x16x32_bf16 v[80:83], v[120:123], a[168:171], v[80:83]
 ds_read_b64_tr_b16 v[112:113], v136 offset:12288
 ds_read_b64_tr_b16 v[114:115], v136 offset:13312
 v_fma_f32 v226, v226, v17, v17
 v_fma_f32 v227, v227, v17, v17
 v_fma_f32 v228, v228, v19, v19
 v_mfma_f32_16x16x32_bf16 v[84:87], v[120:123], a[172:175], v[84:87]
 buffer_load_dwordx4 a[232:235], v6, s[16:19], s46 offen offset:0 sc1
 s_branch m_ps_p3_7
m_pad_p3_7:
 s_branch m_ret_p3
m_ps_p3_7:
 v_fma_f32 v229, v229, v19, v19
 v_fma_f32 v230, v230, v19, v19
 v_fma_f32 v231, v231, v19, v19
 v_mfma_f32_16x16x32_bf16 v[92:95], v[124:127], a[172:175], v[92:95]
 ds_read_b64_tr_b16 v[116:117], v137 offset:12288
 ds_read_b64_tr_b16 v[118:119], v137 offset:13312
 v_rcp_f32 v224, v224
 v_mfma_f32_16x16x32_bf16 v[88:91], v[124:127], a[168:171], v[88:91]
 v_rcp_f32 v225, v225
 s_waitcnt vmcnt(16) lgkmcnt(8)
 v_mfma_f32_16x16x32_bf16 v[64:67], v[96:99], a[176:179], v[64:67]
 ds_read_b64_tr_b16 v[120:121], v138 offset:12288
 ds_read_b64_tr_b16 v[122:123], v138 offset:13312
 v_rcp_f32 v226, v226
 v_mfma_f32_16x16x32_bf16 v[68:71], v[96:99], a[180:183], v[68:71]
 buffer_load_dwordx4 a[236:239], v7, s[16:19], s46 offen offset:0 sc1
 v_rcp_f32 v227, v227
 v_rcp_f32 v228, v228
 v_mfma_f32_16x16x32_bf16 v[76:79], v[100:103], a[180:183], v[76:79]
 ds_read_b64_tr_b16 v[124:125], v139 offset:12288
 ds_read_b64_tr_b16 v[126:127], v139 offset:13312
 v_rcp_f32 v229, v229
 v_mfma_f32_16x16x32_bf16 v[72:75], v[100:103], a[176:179], v[72:75]
 buffer_load_dwordx4 a[240:243], v6, s[16:19], s46 offen offset:3072 sc1
 v_rcp_f32 v230, v230
 s_waitcnt lgkmcnt(8)
 v_mfma_f32_16x16x32_bf16 v[80:83], v[104:107], a[176:179], v[80:83]
 s_barrier
 ds_read_b64_tr_b16 v[96:97], v136 offset:16384
 v_rcp_f32 v231, v231
 v_mfma_f32_16x16x32_bf16 v[84:87], v[104:107], a[180:183], v[84:87]
 ds_read_b64_tr_b16 v[98:99], v136 offset:17408
 v_mul_f32 v224, v224, v240
 v_mul_f32 v225, v225, v241
 v_mul_f32 v226, v226, v242
 v_mfma_f32_16x16x32_bf16 v[92:95], v[108:111], a[180:183], v[92:95]
 ds_read_b64_tr_b16 v[100:101], v137 offset:16384
 ds_read_b64_tr_b16 v[102:103], v137 offset:17408
 v_mul_f32 v227, v227, v243
 v_mul_f32 v228, v228, v244
 v_mfma_f32_16x16x32_bf16 v[88:91], v[108:111], a[176:179], v[88:91]
 buffer_load_dwordx4 a[244:247], v7, s[16:19], s46 offen offset:3072 sc1
 s_mov_b32 s46, 36864
 v_mul_f32 v229, v229, v245
 s_waitcnt vmcnt(16) lgkmcnt(8)
 v_mfma_f32_16x16x32_bf16 v[64:67], v[112:115], a[184:187], v[64:67]
 ds_read_b64_tr_b16 v[104:105], v138 offset:16384
 ds_read_b64_tr_b16 v[106:107], v138 offset:17408
 v_mul_f32 v230, v230, v246
 v_mul_f32 v231, v231, v247
 v_cvt_pk_bf16_f32 v240, v224, v225
 v_mfma_f32_16x16x32_bf16 v[68:71], v[112:115], a[188:191], v[68:71]
 buffer_load_dwordx4 a[0:3], v6, s[16:19], s46 offen offset:3072 sc1
 v_cvt_pk_bf16_f32 v241, v226, v227
 v_cvt_pk_bf16_f32 v242, v228, v229
 v_cvt_pk_bf16_f32 v243, v230, v231
 v_mfma_f32_16x16x32_bf16 v[76:79], v[116:119], a[188:191], v[76:79]
 ds_read_b64_tr_b16 v[108:109], v139 offset:16384
 ds_read_b64_tr_b16 v[110:111], v139 offset:17408
 s_nop 1
 v_mfma_f32_16x16x32_bf16 v[72:75], v[116:119], a[184:187], v[72:75]
 v_permlane16_swap_b32 v240, v242
 v_permlane16_swap_b32 v241, v243
 buffer_store_dwordx4 v[240:243], v12, s[24:27], 0 offen offset:3072 sc1
 s_waitcnt lgkmcnt(8)
 v_mfma_f32_16x16x32_bf16 v[80:83], v[120:123], a[184:187], v[80:83]
 ds_read_b64_tr_b16 v[112:113], v136 offset:20480
 ds_read_b64_tr_b16 v[114:115], v136 offset:21504
 v_mul_f32 v232, v20, v232
 v_mul_f32 v233, v20, v233
 v_mul_f32 v234, v20, v234
 v_mfma_f32_16x16x32_bf16 v[84:87], v[120:123], a[188:191], v[84:87]
 buffer_load_dwordx4 a[4:7], v7, s[16:19], s46 offen offset:3072 sc1
 s_mov_b32 s46, 40960
 v_mul_f32 v235, v20, v235
 v_mul_f32 v236, v22, v236
 v_mfma_f32_16x16x32_bf16 v[92:95], v[124:127], a[188:191], v[92:95]
 ds_read_b64_tr_b16 v[116:117], v137 offset:20480
 ds_read_b64_tr_b16 v[118:119], v137 offset:21504
 v_mul_f32 v237, v22, v237
 v_mul_f32 v238, v22, v238
 v_mfma_f32_16x16x32_bf16 v[88:91], v[124:127], a[184:187], v[88:91]
 buffer_load_dwordx4 a[8:11], v6, s[16:19], s46 offen offset:2048 sc1
 v_mul_f32 v239, v22, v239
 s_waitcnt vmcnt(18) lgkmcnt(8)
 v_mfma_f32_16x16x32_bf16 v[64:67], v[96:99], a[192:195], v[64:67]
 ds_read_b64_tr_b16 v[120:121], v138 offset:20480
 ds_read_b64_tr_b16 v[122:123], v138 offset:21504
 v_exp_f32 v232, v232
 v_mfma_f32_16x16x32_bf16 v[68:71], v[96:99], a[196:199], v[68:71]
 v_exp_f32 v233, v233
 v_exp_f32 v234, v234
 v_mfma_f32_16x16x32_bf16 v[76:79], v[100:103], a[196:199], v[76:79]
 ds_read_b64_tr_b16 v[124:125], v139 offset:20480
 ds_read_b64_tr_b16 v[126:127], v139 offset:21504
 v_exp_f32 v235, v235
 v_mfma_f32_16x16x32_bf16 v[72:75], v[100:103], a[192:195], v[72:75]
 buffer_load_dwordx4 a[12:15], v7, s[16:19], s46 offen offset:2048 sc1
 s_mov_b32 s46, 45056
 v_exp_f32 v236, v236
 s_waitcnt lgkmcnt(8)
 v_mfma_f32_16x16x32_bf16 v[80:83], v[104:107], a[192:195], v[80:83]
 s_barrier
 ds_read_b64_tr_b16 v[96:97], v136 offset:24576
 v_mfma_f32_16x16x32_bf16 v[84:87], v[104:107], a[196:199], v[84:87]
 ds_read_b64_tr_b16 v[98:99], v136 offset:25600
 buffer_load_dwordx4 a[16:19], v6, s[16:19], s46 offen offset:2048 sc1
 v_exp_f32 v237, v237
 v_mfma_f32_16x16x32_bf16 v[92:95], v[108:111], a[196:199], v[92:95]
 ds_read_b64_tr_b16 v[100:101], v137 offset:24576
 ds_read_b64_tr_b16 v[102:103], v137 offset:25600
 buffer_load_dwordx2 v[26:27], v24, s[60:63], s49 offen sc1
 v_exp_f32 v238, v238
 v_mfma_f32_16x16x32_bf16 v[88:91], v[108:111], a[192:195], v[88:91]
 v_exp_f32 v239, v239
 v_fma_f32 v232, v232, v21, v21
 s_waitcnt vmcnt(18) lgkmcnt(8)
 v_mfma_f32_16x16x32_bf16 v[64:67], v[112:115], a[200:203], v[64:67]
 ds_read_b64_tr_b16 v[104:105], v138 offset:24576
 ds_read_b64_tr_b16 v[106:107], v138 offset:25600
 v_fma_f32 v233, v233, v21, v21
 v_fma_f32 v234, v234, v21, v21
 v_fma_f32 v235, v235, v21, v21
 v_mfma_f32_16x16x32_bf16 v[68:71], v[112:115], a[204:207], v[68:71]
 buffer_load_dwordx4 a[20:23], v7, s[16:19], s46 offen offset:2048 sc1
 s_mov_b32 s46, 49152
 v_fma_f32 v236, v236, v23, v23
 v_fma_f32 v237, v237, v23, v23
 v_mfma_f32_16x16x32_bf16 v[76:79], v[116:119], a[204:207], v[76:79]
 ds_read_b64_tr_b16 v[108:109], v139 offset:24576
 ds_read_b64_tr_b16 v[110:111], v139 offset:25600
 v_fma_f32 v238, v238, v23, v23
 v_fma_f32 v239, v239, v23, v23
 v_mfma_f32_16x16x32_bf16 v[72:75], v[116:119], a[200:203], v[72:75]
 buffer_load_dwordx4 a[24:27], v6, s[16:19], s46 offen offset:1024 sc1
 v_rcp_f32 v232, v232
 s_waitcnt lgkmcnt(8)
 v_mfma_f32_16x16x32_bf16 v[80:83], v[120:123], a[200:203], v[80:83]
 ds_read_b64_tr_b16 v[112:113], v136 offset:28672
 ds_read_b64_tr_b16 v[114:115], v136 offset:29696
 v_rcp_f32 v233, v233
 v_mfma_f32_16x16x32_bf16 v[84:87], v[120:123], a[204:207], v[84:87]
 v_rcp_f32 v234, v234
 v_rcp_f32 v235, v235
 v_mfma_f32_16x16x32_bf16 v[92:95], v[124:127], a[204:207], v[92:95]
 ds_read_b64_tr_b16 v[116:117], v137 offset:28672
 ds_read_b64_tr_b16 v[118:119], v137 offset:29696
 v_rcp_f32 v236, v236
 v_mfma_f32_16x16x32_bf16 v[88:91], v[124:127], a[200:203], v[88:91]
 buffer_load_dwordx4 a[28:31], v7, s[16:19], s46 offen offset:1024 sc1
 s_mul_i32 s40, s42, 1
 s_add_u32 s40, s40, s51
 v_rcp_f32 v237, v237
 s_waitcnt vmcnt(19) lgkmcnt(8)
 v_mfma_f32_16x16x32_bf16 v[64:67], v[96:99], a[208:211], v[64:67]
 ds_read_b64_tr_b16 v[120:121], v138 offset:28672
 ds_read_b64_tr_b16 v[122:123], v138 offset:29696
 s_add_u32 m0, s45, 32768
 v_mfma_f32_16x16x32_bf16 v[68:71], v[96:99], a[212:215], v[68:71]
 buffer_load_dwordx4 v4, s[20:23], s40 offen offset:0 sc1 lds
 v_rcp_f32 v238, v238
 v_rcp_f32 v239, v239
 v_mfma_f32_16x16x32_bf16 v[76:79], v[100:103], a[212:215], v[76:79]
 ds_read_b64_tr_b16 v[124:125], v139 offset:28672
 ds_read_b64_tr_b16 v[126:127], v139 offset:29696
 v_mul_f32 v232, v232, v248
 v_mul_f32 v233, v233, v249
 v_mfma_f32_16x16x32_bf16 v[72:75], v[100:103], a[208:211], v[72:75]
 v_mul_f32 v234, v234, v250
 v_mul_f32 v235, v235, v251
 v_mul_f32 v236, v236, v252
 v_mul_f32 v237, v237, v253
 s_waitcnt lgkmcnt(8)
 v_mfma_f32_16x16x32_bf16 v[80:83], v[104:107], a[208:211], v[80:83]
 s_barrier
 ds_read_b64_tr_b16 v[96:97], v128 offset:0
 v_mul_f32 v238, v238, v254
 v_mfma_f32_16x16x32_bf16 v[84:87], v[104:107], a[212:215], v[84:87]
 ds_read_b64_tr_b16 v[98:99], v128 offset:1024
 buffer_load_dwordx4 v5, s[20:23], s40 offen offset:1024 sc1 lds
 s_mul_i32 s40, s41, 0
 s_add_u32 s40, s40, s50
 v_mul_f32 v239, v239, v255
 v_mfma_f32_16x16x32_bf16 v[92:95], v[108:111], a[212:215], v[92:95]
 ds_read_b64_tr_b16 v[100:101], v129 offset:0
 ds_read_b64_tr_b16 v[102:103], v129 offset:1024
 s_add_u32 m0, s45, 114688
 v_cvt_pk_bf16_f32 v248, v232, v233
 v_mfma_f32_16x16x32_bf16 v[88:91], v[108:111], a[208:211], v[88:91]
 buffer_load_dwordx4 v2, s[12:15], s40 offen offset:0 sc1 lds
 v_cvt_pk_bf16_f32 v249, v234, v235
 v_cvt_pk_bf16_f32 v250, v236, v237
 s_waitcnt vmcnt(19) lgkmcnt(8)
 v_mfma_f32_16x16x32_bf16 v[64:67], v[112:115], a[216:219], v[64:67]
 ds_read_b64_tr_b16 v[104:105], v130 offset:0
 ds_read_b64_tr_b16 v[106:107], v130 offset:1024
 v_cvt_pk_bf16_f32 v251, v238, v239
 s_nop 1
 v_permlane16_swap_b32 v248, v250
 v_permlane16_swap_b32 v249, v251
 buffer_store_dwordx4 v[248:251], v12, s[24:27], s47 offen offset:3072 sc1
 v_mfma_f32_16x16x32_bf16 v[68:71], v[112:115], a[220:223], v[68:71]
 v_mfma_f32_16x16x32_bf16 v[76:79], v[116:119], a[220:223], v[76:79]
 ds_read_b64_tr_b16 v[108:109], v131 offset:0
 ds_read_b64_tr_b16 v[110:111], v131 offset:1024
 v_mfma_f32_16x16x32_bf16 v[72:75], v[116:119], a[216:219], v[72:75]
 buffer_load_dwordx4 v3, s[12:15], s40 offen offset:1024 sc1 lds
 s_mov_b32 s46, 53248
 s_waitcnt lgkmcnt(8)
 v_mfma_f32_16x16x32_bf16 v[80:83], v[120:123], a[216:219], v[80:83]
 ds_read_b64_tr_b16 v[112:113], v128 offset:4096
 ds_read_b64_tr_b16 v[114:115], v128 offset:5120
 v_mfma_f32_16x16x32_bf16 v[84:87], v[120:123], a[220:223], v[84:87]
 buffer_load_dwordx4 a[32:35], v6, s[16:19], s46 offen offset:1024 sc1
 v_mfma_f32_16x16x32_bf16 v[92:95], v[124:127], a[220:223], v[92:95]
 ds_read_b64_tr_b16 v[116:117], v129 offset:4096
 ds_read_b64_tr_b16 v[118:119], v129 offset:5120
 v_mfma_f32_16x16x32_bf16 v[88:91], v[124:127], a[216:219], v[88:91]
 s_waitcnt vmcnt(20) lgkmcnt(8)
 v_mfma_f32_16x16x32_bf16 v[64:67], v[96:99], a[224:227], v[64:67]
 ds_read_b64_tr_b16 v[120:121], v130 offset:4096
 ds_read_b64_tr_b16 v[122:123], v130 offset:5120
 v_mfma_f32_16x16x32_bf16 v[68:71], v[96:99], a[228:231], v[68:71]
 buffer_load_dwordx4 a[36:39], v7, s[16:19], s46 offen offset:1024 sc1
 v_mfma_f32_16x16x32_bf16 v[76:79], v[100:103], a[228:231], v[76:79]
 ds_read_b64_tr_b16 v[124:125], v131 offset:4096
 ds_read_b64_tr_b16 v[126:127], v131 offset:5120
 v_mfma_f32_16x16x32_bf16 v[72:75], v[100:103], a[224:227], v[72:75]
 s_mov_b32 s46, 0
 s_waitcnt lgkmcnt(8)
 v_mfma_f32_16x16x32_bf16 v[80:83], v[104:107], a[224:227], v[80:83]
 s_waitcnt vmcnt(10)
 v_cmp_ne_u64 vcc, s[8:9], v[26:27]
 s_mov_b32 s57, 0
 s_cbranch_vccz L_ok_f2
L_re_f2:
 buffer_load_dwordx2 v[26:27], v24, s[60:63], s49 offen sc1
 s_add_u32 s57, s57, 1
 s_waitcnt vmcnt(0)
 v_cmp_ne_u64 vcc, s[8:9], v[26:27]
 s_cmp_gt_u32 s57, 0x40000
 s_cbranch_vccz L_ok_f2
 s_cbranch_scc0 L_re_f2
L_ok_f2:
 s_barrier
 ds_read_b64_tr_b16 v[96:97], v128 offset:8192
 v_mfma_f32_16x16x32_bf16 v[84:87], v[104:107], a[228:231], v[84:87]
 ds_read_b64_tr_b16 v[98:99], v128 offset:9216
 buffer_load_dwordx4 a[40:43], v6, s[16:19], s46 offen offset:1024 sc1
 v_mfma_f32_16x16x32_bf16 v[92:95], v[108:111], a[228:231], v[92:95]
 ds_read_b64_tr_b16 v[100:101], v129 offset:8192
 ds_read_b64_tr_b16 v[102:103], v129 offset:9216
 v_mfma_f32_16x16x32_bf16 v[88:91], v[108:111], a[224:227], v[88:91]
 s_waitcnt lgkmcnt(8)
 v_mfma_f32_16x16x32_bf16 v[64:67], v[112:115], a[232:235], v[64:67]
 ds_read_b64_tr_b16 v[104:105], v130 offset:8192
 ds_read_b64_tr_b16 v[106:107], v130 offset:9216
 v_mfma_f32_16x16x32_bf16 v[68:71], v[112:115], a[236:239], v[68:71]
 buffer_load_dwordx4 a[44:47], v7, s[16:19], s46 offen offset:1024 sc1
 v_mfma_f32_16x16x32_bf16 v[76:79], v[116:119], a[236:239], v[76:79]
 ds_read_b64_tr_b16 v[108:109], v131 offset:8192
 ds_read_b64_tr_b16 v[110:111], v131 offset:9216
 v_mfma_f32_16x16x32_bf16 v[72:75], v[116:119], a[232:235], v[72:75]
 s_mov_b32 s46, 4096
 s_waitcnt lgkmcnt(8)
 v_mfma_f32_16x16x32_bf16 v[80:83], v[120:123], a[232:235], v[80:83]
 ds_read_b64_tr_b16 v[112:113], v128 offset:12288
 ds_read_b64_tr_b16 v[114:115], v128 offset:13312
 v_mfma_f32_16x16x32_bf16 v[84:87], v[120:123], a[236:239], v[84:87]
 buffer_load_dwordx4 a[48:51], v6, s[16:19], s46 offen offset:1024 sc1
 v_mfma_f32_16x16x32_bf16 v[92:95], v[124:127], a[236:239], v[92:95]
 ds_read_b64_tr_b16 v[116:117], v129 offset:12288
 ds_read_b64_tr_b16 v[118:119], v129 offset:13312
 v_mfma_f32_16x16x32_bf16 v[88:91], v[124:127], a[232:235], v[88:91]
 s_waitcnt lgkmcnt(8)
 v_mfma_f32_16x16x32_bf16 v[64:67], v[96:99], a[240:243], v[64:67]
 ds_read_b64_tr_b16 v[120:121], v130 offset:12288
 ds_read_b64_tr_b16 v[122:123], v130 offset:13312
 v_mfma_f32_16x16x32_bf16 v[68:71], v[96:99], a[244:247], v[68:71]
 buffer_load_dwordx4 a[52:55], v7, s[16:19], s46 offen offset:1024 sc1
 v_mfma_f32_16x16x32_bf16 v[76:79], v[100:103], a[244:247], v[76:79]
 ds_read_b64_tr_b16 v[124:125], v131 offset:12288
 ds_read_b64_tr_b16 v[126:127], v131 offset:13312
 s_add_u32 m0, s45, 40960
 v_mfma_f32_16x16x32_bf16 v[72:75], v[100:103], a[240:243], v[72:75]
 s_mul_i32 s40, s42, 8
 s_add_u32 s40, s40, s51
 s_waitcnt lgkmcnt(8)
 v_mfma_f32_16x16x32_bf16 v[80:83], v[104:107], a[240:243], v[80:83]
 s_barrier
 ds_read_b64_tr_b16 v[96:97], v128 offset:16384
 v_mfma_f32_16x16x32_bf16 v[84:87], v[104:107], a[244:247], v[84:87]
 ds_read_b64_tr_b16 v[98:99], v128 offset:17408
 buffer_load_dwordx4 v4, s[20:23], s40 offen offset:0 sc1 lds
 v_mfma_f32_16x16x32_bf16 v[92:95], v[108:111], a[244:247], v[92:95]
 ds_read_b64_tr_b16 v[100:101], v129 offset:16384
 ds_read_b64_tr_b16 v[102:103], v129 offset:17408
 v_mfma_f32_16x16x32_bf16 v[88:91], v[108:111], a[240:243], v[88:91]
 s_waitcnt lgkmcnt(8)
 v_mfma_f32_16x16x32_bf16 v[64:67], v[112:115], a[0:3], v[64:67]
 ds_read_b64_tr_b16 v[104:105], v130 offset:16384
 ds_read_b64_tr_b16 v[106:107], v130 offset:17408
 v_mfma_f32_16x16x32_bf16 v[68:71], v[112:115], a[4:7], v[68:71]
 buffer_load_dwordx4 v5, s[20:23], s40 offen offset:1024 sc1 lds
 v_mfma_f32_16x16x32_bf16 v[76:79], v[116:119], a[4:7], v[76:79]
 ds_read_b64_tr_b16 v[108:109], v131 offset:16384
 ds_read_b64_tr_b16 v[110:111], v131 offset:17408
 s_add_u32 m0, s45, 122880
 v_mfma_f32_16x16x32_bf16 v[72:75], v[116:119], a[0:3], v[72:75]
 s_mul_i32 s40, s41, 7
 s_add_u32 s40, s40, s50
 s_waitcnt lgkmcnt(8)
 v_mfma_f32_16x16x32_bf16 v[80:83], v[120:123], a[0:3], v[80:83]
 ds_read_b64_tr_b16 v[112:113], v128 offset:20480
 ds_read_b64_tr_b16 v[114:115], v128 offset:21504
 v_mfma_f32_16x16x32_bf16 v[84:87], v[120:123], a[4:7], v[84:87]
 buffer_load_dwordx4 v2, s[12:15], s40 offen offset:0 sc1 lds
 v_mfma_f32_16x16x32_bf16 v[92:95], v[124:127], a[4:7], v[92:95]
 ds_read_b64_tr_b16 v[116:117], v129 offset:20480
 ds_read_b64_tr_b16 v[118:119], v129 offset:21504
 v_mfma_f32_16x16x32_bf16 v[88:91], v[124:127], a[0:3], v[88:91]
 s_waitcnt lgkmcnt(8)
 v_mfma_f32_16x16x32_bf16 v[64:67], v[96:99], a[8:11], v[64:67]
 ds_read_b64_tr_b16 v[120:121], v130 offset:20480
 ds_read_b64_tr_b16 v[122:123], v130 offset:21504
 s_cmp_eq_u32 s10, 1
 s_cbranch_scc1 m_pad_p4_0
 s_cmp_eq_u32 s10, 2
 s_cbranch_scc1 m_pad_p4_1
 s_cmp_eq_u32 s10, 3
 s_cbranch_scc1 m_pad_p4_2
 s_branch m_pad_p4_3
m_reta_p4:
 s_waitcnt vmcnt(10)
 s_barrier
 buffer_store_dwordx2 v[28:29], v30, s[60:63], s56 offen sc1
 v_mfma_f32_16x16x32_bf16 v[68:71], v[96:99], a[12:15], v[68:71]
 buffer_load_dwordx4 v3, s[12:15], s40 offen offset:1024 sc1 lds
 v_mfma_f32_16x16x32_bf16 v[76:79], v[100:103], a[12:15], v[76:79]
 ds_read_b64_tr_b16 v[124:125], v131 offset:20480
 ds_read_b64_tr_b16 v[126:127], v131 offset:21504
 v_mfma_f32_16x16x32_bf16 v[72:75], v[100:103], a[8:11], v[72:75]
 s_mov_b32 s46, 8192
 s_waitcnt lgkmcnt(8)
 v_mfma_f32_16x16x32_bf16 v[80:83], v[104:107], a[8:11], v[80:83]
 s_barrier
 ds_read_b64_tr_b16 v[96:97], v128 offset:24576
 v_mfma_f32_16x16x32_bf16 v[84:87], v[104:107], a[12:15], v[84:87]
 ds_read_b64_tr_b16 v[98:99], v128 offset:25600
 buffer_load_dwordx4 a[56:59], v6, s[16:19], s46 offen offset:0 sc1
 v_mfma_f32_16x16x32_bf16 v[92:95], v[108:111], a[12:15], v[92:95]
 ds_read_b64_tr_b16 v[100:101], v129 offset:24576
 ds_read_b64_tr_b16 v[102:103], v129 offset:25600
 v_mfma_f32_16x16x32_bf16 v[88:91], v[108:111], a[8:11], v[88:91]
 s_waitcnt lgkmcnt(8)
 v_mfma_f32_16x16x32_bf16 v[64:67], v[112:115], a[16:19], v[64:67]
 ds_read_b64_tr_b16 v[104:105], v130 offset:24576
 ds_read_b64_tr_b16 v[106:107], v130 offset:25600
 v_mfma_f32_16x16x32_bf16 v[68:71], v[112:115], a[20:23], v[68:71]
 buffer_load_dwordx4 a[60:63], v7, s[16:19], s46 offen offset:0 sc1
 v_mfma_f32_16x16x32_bf16 v[76:79], v[116:119], a[20:23], v[76:79]
 ds_read_b64_tr_b16 v[108:109], v131 offset:24576
 ds_read_b64_tr_b16 v[110:111], v131 offset:25600
 v_mfma_f32_16x16x32_bf16 v[72:75], v[116:119], a[16:19], v[72:75]
 s_mov_b32 s46, 12288
 s_waitcnt lgkmcnt(8)
 v_mfma_f32_16x16x32_bf16 v[80:83], v[120:123], a[16:19], v[80:83]
 ds_read_b64_tr_b16 v[112:113], v128 offset:28672
 ds_read_b64_tr_b16 v[114:115], v128 offset:29696
 v_mfma_f32_16x16x32_bf16 v[84:87], v[120:123], a[20:23], v[84:87]
 buffer_load_dwordx4 a[64:67], v6, s[16:19], s46 offen offset:0 sc1
 v_mfma_f32_16x16x32_bf16 v[92:95], v[124:127], a[20:23], v[92:95]
 ds_read_b64_tr_b16 v[116:117], v129 offset:28672
 ds_read_b64_tr_b16 v[118:119], v129 offset:29696
 v_mfma_f32_16x16x32_bf16 v[88:91], v[124:127], a[16:19], v[88:91]
 s_waitcnt lgkmcnt(8)
 v_mfma_f32_16x16x32_bf16 v[64:67], v[96:99], a[24:27], v[64:67]
 ds_read_b64_tr_b16 v[120:121], v130 offset:28672
 ds_read_b64_tr_b16 v[122:123], v130 offset:29696
 v_mfma_f32_16x16x32_bf16 v[68:71], v[96:99], a[28:31], v[68:71]
 buffer_load_dwordx4 a[68:71], v7, s[16:19], s46 offen offset:0 sc1
 v_mfma_f32_16x16x32_bf16 v[76:79], v[100:103], a[28:31], v[76:79]
 ds_read_b64_tr_b16 v[124:125], v131 offset:28672
 ds_read_b64_tr_b16 v[126:127], v131 offset:29696
 s_add_u32 m0, s45, 131072
 v_mfma_f32_16x16x32_bf16 v[72:75], v[100:103], a[24:27], v[72:75]
 s_mul_i32 s40, s42, 15
 s_add_u32 s40, s40, s51
 s_waitcnt lgkmcnt(8)
 v_mfma_f32_16x16x32_bf16 v[80:83], v[104:107], a[24:27], v[80:83]
 s_waitcnt vmcnt(15)
 s_barrier
 ds_read_b64_tr_b16 v[96:97], v128 offset:32768
 v_mfma_f32_16x16x32_bf16 v[84:87], v[104:107], a[28:31], v[84:87]
 ds_read_b64_tr_b16 v[98:99], v128 offset:33792
 buffer_load_dwordx4 v4, s[20:23], s40 offen offset:0 sc1 lds
 v_mfma_f32_16x16x32_bf16 v[92:95], v[108:111], a[28:31], v[92:95]
 ds_read_b64_tr_b16 v[100:101], v129 offset:32768
 ds_read_b64_tr_b16 v[102:103], v129 offset:33792
 v_mfma_f32_16x16x32_bf16 v[88:91], v[108:111], a[24:27], v[88:91]
 s_waitcnt vmcnt(14) lgkmcnt(8)
 v_mfma_f32_16x16x32_bf16 v[64:67], v[112:115], a[32:35], v[64:67]
 ds_read_b64_tr_b16 v[104:105], v130 offset:32768
 ds_read_b64_tr_b16 v[106:107], v130 offset:33792
 v_mfma_f32_16x16x32_bf16 v[68:71], v[112:115], a[36:39], v[68:71]
 buffer_load_dwordx4 v5, s[20:23], s40 offen offset:1024 sc1 lds
 v_mfma_f32_16x16x32_bf16 v[76:79], v[116:119], a[36:39], v[76:79]
 ds_read_b64_tr_b16 v[108:109], v131 offset:32768
 ds_read_b64_tr_b16 v[110:111], v131 offset:33792
 s_add_u32 m0, s45, 49152
 v_mfma_f32_16x16x32_bf16 v[72:75], v[116:119], a[32:35], v[72:75]
 s_mul_i32 s40, s41, 14
 s_add_u32 s40, s40, s50
 s_waitcnt lgkmcnt(8)
 v_mfma_f32_16x16x32_bf16 v[80:83], v[120:123], a[32:35], v[80:83]
 ds_read_b64_tr_b16 v[112:113], v132 offset:49152
 ds_read_b64_tr_b16 v[114:115], v132 offset:50176
 v_mfma_f32_16x16x32_bf16 v[84:87], v[120:123], a[36:39], v[84:87]
 buffer_load_dwordx4 v2, s[12:15], s40 offen offset:0 sc1 lds
 v_mfma_f32_16x16x32_bf16 v[92:95], v[124:127], a[36:39], v[92:95]
 ds_read_b64_tr_b16 v[116:117], v133 offset:49152
 ds_read_b64_tr_b16 v[118:119], v133 offset:50176
 v_mfma_f32_16x16x32_bf16 v[88:91], v[124:127], a[32:35], v[88:91]
 s_waitcnt vmcnt(14) lgkmcnt(8)
 v_mfma_f32_16x16x32_bf16 v[64:67], v[96:99], a[40:43], v[64:67]
 ds_read_b64_tr_b16 v[120:121], v134 offset:49152
 ds_read_b64_tr_b16 v[122:123], v134 offset:50176
 v_mfma_f32_16x16x32_bf16 v[68:71], v[96:99], a[44:47], v[68:71]
 buffer_load_dwordx4 v3, s[12:15], s40 offen offset:1024 sc1 lds
 v_mfma_f32_16x16x32_bf16 v[76:79], v[100:103], a[44:47], v[76:79]
 ds_read_b64_tr_b16 v[124:125], v135 offset:49152
 ds_read_b64_tr_b16 v[126:127], v135 offset:50176
 v_mfma_f32_16x16x32_bf16 v[72:75], v[100:103], a[40:43], v[72:75]
 s_waitcnt lgkmcnt(8)
 v_mfma_f32_16x16x32_bf16 v[80:83], v[104:107], a[40:43], v[80:83]
 ds_read_b64_tr_b16 v[96:97], v128 offset:36864
 ds_read_b64_tr_b16 v[98:99], v128 offset:37888
 v_mfma_f32_16x16x32_bf16 v[84:87], v[104:107], a[44:47], v[84:87]
 buffer_load_dwordx4 a[72:75], v6, s[16:19], s46 offen offset:3072 sc1
 v_mfma_f32_16x16x32_bf16 v[92:95], v[108:111], a[44:47], v[92:95]
 ds_read_b64_tr_b16 v[100:101], v129 offset:36864
 ds_read_b64_tr_b16 v[102:103], v129 offset:37888
 v_mfma_f32_16x16x32_bf16 v[88:91], v[108:111], a[40:43], v[88:91]
 s_waitcnt lgkmcnt(8)
 v_mfma_f32_16x16x32_bf16 v[32:35], v[112:115], a[160:163], 0
 ds_read_b64_tr_b16 v[104:105], v130 offset:36864
 ds_read_b64_tr_b16 v[106:107], v130 offset:37888
 v_mfma_f32_16x16x32_bf16 v[36:39], v[112:115], a[164:167], 0
 buffer_load_dwordx4 a[76:79], v7, s[16:19], s46 offen offset:3072 sc1
 v_mfma_f32_16x16x32_bf16 v[44:47], v[116:119], a[164:167], 0
 ds_read_b64_tr_b16 v[108:109], v131 offset:36864
 ds_read_b64_tr_b16 v[110:111], v131 offset:37888
 v_mfma_f32_16x16x32_bf16 v[40:43], v[116:119], a[160:163], 0
 s_mov_b32 s46, 16384
 s_waitcnt lgkmcnt(8)
 v_mfma_f32_16x16x32_bf16 v[48:51], v[120:123], a[160:163], 0
 ds_read_b64_tr_b16 v[112:113], v132 offset:53248
 ds_read_b64_tr_b16 v[114:115], v132 offset:54272
 v_mfma_f32_16x16x32_bf16 v[52:55], v[120:123], a[164:167], 0
 buffer_load_dwordx4 a[80:83], v6, s[16:19], s46 offen offset:3072 sc1
 v_mfma_f32_16x16x32_bf16 v[60:63], v[124:127], a[164:167], 0
 ds_read_b64_tr_b16 v[116:117], v133 offset:53248
 ds_read_b64_tr_b16 v[118:119], v133 offset:54272
 v_mfma_f32_16x16x32_bf16 v[56:59], v[124:127], a[160:163], 0
 s_waitcnt vmcnt(16) lgkmcnt(8)
 v_mfma_f32_16x16x32_bf16 v[64:67], v[96:99], a[48:51], v[64:67]
 ds_read_b64_tr_b16 v[120:121], v134 offset:53248
 ds_read_b64_tr_b16 v[122:123], v134 offset:54272
 v_mfma_f32_16x16x32_bf16 v[68:71], v[96:99], a[52:55], v[68:71]
 buffer_load_dwordx4 a[84:87], v7, s[16:19], s46 offen offset:3072 sc1
 v_mfma_f32_16x16x32_bf16 v[76:79], v[100:103], a[52:55], v[76:79]
 ds_read_b64_tr_b16 v[124:125], v135 offset:53248
 ds_read_b64_tr_b16 v[126:127], v135 offset:54272
 s_add_u32 m0, s45, 139264
 v_mfma_f32_16x16x32_bf16 v[72:75], v[100:103], a[48:51], v[72:75]
 s_mul_i32 s40, s42, 22
 s_add_u32 s40, s40, s51
 s_waitcnt lgkmcnt(8)
 v_mfma_f32_16x16x32_bf16 v[80:83], v[104:107], a[48:51], v[80:83]
 s_waitcnt vmcnt(12)
 s_barrier
 ds_read_b64_tr_b16 v[96:97], v128 offset:40960
 v_mfma_f32_16x16x32_bf16 v[84:87], v[104:107], a[52:55], v[84:87]
 ds_read_b64_tr_b16 v[98:99], v128 offset:41984
 buffer_load_dwordx4 v4, s[20:23], s40 offen offset:0 sc1 lds
 v_mfma_f32_16x16x32_bf16 v[92:95], v[108:111], a[52:55], v[92:95]
 ds_read_b64_tr_b16 v[100:101], v129 offset:40960
 ds_read_b64_tr_b16 v[102:103], v129 offset:41984
 v_mfma_f32_16x16x32_bf16 v[88:91], v[108:111], a[48:51], v[88:91]
 s_waitcnt lgkmcnt(8)
 v_mfma_f32_16x16x32_bf16 v[32:35], v[112:115], a[168:171], v[32:35]
 ds_read_b64_tr_b16 v[104:105], v130 offset:40960
 ds_read_b64_tr_b16 v[106:107], v130 offset:41984
 v_mfma_f32_16x16x32_bf16 v[36:39], v[112:115], a[172:175], v[36:39]
 buffer_load_dwordx4 v5, s[20:23], s40 offen offset:1024 sc1 lds
 v_mfma_f32_16x16x32_bf16 v[44:47], v[116:119], a[172:175], v[44:47]
 ds_read_b64_tr_b16 v[108:109], v131 offset:40960
 ds_read_b64_tr_b16 v[110:111], v131 offset:41984
 s_add_u32 m0, s45, 57344
 v_mfma_f32_16x16x32_bf16 v[40:43], v[116:119], a[168:171], v[40:43]
 s_mul_i32 s40, s41, 21
 s_add_u32 s40, s40, s50
 s_waitcnt lgkmcnt(8)
 v_mfma_f32_16x16x32_bf16 v[48:51], v[120:123], a[168:171], v[48:51]
 ds_read_b64_tr_b16 v[112:113], v132 offset:57344
 ds_read_b64_tr_b16 v[114:115], v132 offset:58368
 v_mfma_f32_16x16x32_bf16 v[52:55], v[120:123], a[172:175], v[52:55]
 buffer_load_dwordx4 v2, s[12:15], s40 offen offset:0 sc1 lds
 v_mfma_f32_16x16x32_bf16 v[60:63], v[124:127], a[172:175], v[60:63]
 ds_read_b64_tr_b16 v[116:117], v133 offset:57344
 ds_read_b64_tr_b16 v[118:119], v133 offset:58368
 v_mfma_f32_16x16x32_bf16 v[56:59], v[124:127], a[168:171], v[56:59]
 s_waitcnt vmcnt(13) lgkmcnt(8)
 v_mfma_f32_16x16x32_bf16 v[64:67], v[96:99], a[56:59], v[64:67]
 ds_read_b64_tr_b16 v[120:121], v134 offset:57344
 ds_read_b64_tr_b16 v[122:123], v134 offset:58368
 v_mfma_f32_16x16x32_bf16 v[68:71], v[96:99], a[60:63], v[68:71]
 buffer_load_dwordx4 v3, s[12:15], s40 offen offset:1024 sc1 lds
 v_mfma_f32_16x16x32_bf16 v[76:79], v[100:103], a[60:63], v[76:79]
 ds_read_b64_tr_b16 v[124:125], v135 offset:57344
 ds_read_b64_tr_b16 v[126:127], v135 offset:58368
 v_mfma_f32_16x16x32_bf16 v[72:75], v[100:103], a[56:59], v[72:75]
 s_mov_b32 s46, 20480
 s_waitcnt lgkmcnt(8)
 v_mfma_f32_16x16x32_bf16 v[80:83], v[104:107], a[56:59], v[80:83]
 ds_read_b64_tr_b16 v[96:97], v128 offset:45056
 ds_read_b64_tr_b16 v[98:99], v128 offset:46080
 v_mfma_f32_16x16x32_bf16 v[84:87], v[104:107], a[60:63], v[84:87]
 buffer_load_dwordx4 a[88:91], v6, s[16:19], s46 offen offset:2048 sc1
 v_mfma_f32_16x16x32_bf16 v[92:95], v[108:111], a[60:63], v[92:95]
 ds_read_b64_tr_b16 v[100:101], v129 offset:45056
 ds_read_b64_tr_b16 v[102:103], v129 offset:46080
 v_mfma_f32_16x16x32_bf16 v[88:91], v[108:111], a[56:59], v[88:91]
 s_waitcnt lgkmcnt(8)
 v_mfma_f32_16x16x32_bf16 v[32:35], v[112:115], a[176:179], v[32:35]
 ds_read_b64_tr_b16 v[104:105], v130 offset:45056
 ds_read_b64_tr_b16 v[106:107], v130 offset:46080
 v_mfma_f32_16x16x32_bf16 v[36:39], v[112:115], a[180:183], v[36:39]
 buffer_load_dwordx4 a[92:95], v7, s[16:19], s46 offen offset:2048 sc1
 v_mfma_f32_16x16x32_bf16 v[44:47], v[116:119], a[180:183], v[44:47]
 ds_read_b64_tr_b16 v[108:109], v131 offset:45056
 ds_read_b64_tr_b16 v[110:111], v131 offset:46080
 v_mfma_f32_16x16x32_bf16 v[40:43], v[116:119], a[176:179], v[40:43]
 s_mov_b32 s46, 24576
 s_waitcnt lgkmcnt(8)
 v_mfma_f32_16x16x32_bf16 v[48:51], v[120:123], a[176:179], v[48:51]
 ds_read_b64_tr_b16 v[112:113], v132 offset:61440
 ds_read_b64_tr_b16 v[114:115], v132 offset:62464
 v_mfma_f32_16x16x32_bf16 v[52:55], v[120:123], a[180:183], v[52:55]
 buffer_load_dwordx4 a[96:99], v6, s[16:19], s46 offen offset:2048 sc1
 v_mfma_f32_16x16x32_bf16 v[60:63], v[124:127], a[180:183], v[60:63]
 ds_read_b64_tr_b16 v[116:117], v133 offset:61440
 ds_read_b64_tr_b16 v[118:119], v133 offset:62464
 v_mfma_f32_16x16x32_bf16 v[56:59], v[124:127], a[176:179], v[56:59]
 s_waitcnt vmcnt(15) lgkmcnt(8)
 v_mfma_f32_16x16x32_bf16 v[64:67], v[96:99], a[64:67], v[64:67]
 ds_read_b64_tr_b16 v[120:121], v134 offset:61440
 ds_read_b64_tr_b16 v[122:123], v134 offset:62464
 v_mfma_f32_16x16x32_bf16 v[68:71], v[96:99], a[68:71], v[68:71]
 buffer_load_dwordx4 a[100:103], v7, s[16:19], s46 offen offset:2048 sc1
 v_mfma_f32_16x16x32_bf16 v[76:79], v[100:103], a[68:71], v[76:79]
 ds_read_b64_tr_b16 v[124:125], v135 offset:61440
 ds_read_b64_tr_b16 v[126:127], v135 offset:62464
 s_add_u32 m0, s45, 147456
 v_mfma_f32_16x16x32_bf16 v[72:75], v[100:103], a[64:67], v[72:75]
 s_mul_i32 s40, s42, 29
 s_add_u32 s40, s40, s51
 s_waitcnt lgkmcnt(8)
 v_mfma_f32_16x16x32_bf16 v[80:83], v[104:107], a[64:67], v[80:83]
 s_waitcnt vmcnt(12)
 s_barrier
 ds_read_b64_tr_b16 v[96:97], v136 offset:0
 v_mfma_f32_16x16x32_bf16 v[84:87], v[104:107], a[68:71], v[84:87]
 ds_read_b64_tr_b16 v[98:99], v136 offset:1024
 buffer_load_dwordx4 v4, s[20:23], s40 offen offset:0 sc1 lds
 v_mfma_f32_16x16x32_bf16 v[92:95], v[108:111], a[68:71], v[92:95]
 ds_read_b64_tr_b16 v[100:101], v137 offset:0
 ds_read_b64_tr_b16 v[102:103], v137 offset:1024
 v_mfma_f32_16x16x32_bf16 v[88:91], v[108:111], a[64:67], v[88:91]
 s_waitcnt lgkmcnt(8)
 v_mfma_f32_16x16x32_bf16 v[32:35], v[112:115], a[184:187], v[32:35]
 ds_read_b64_tr_b16 v[104:105], v138 offset:0
 ds_read_b64_tr_b16 v[106:107], v138 offset:1024
 v_mfma_f32_16x16x32_bf16 v[36:39], v[112:115], a[188:191], v[36:39]
 buffer_load_dwordx4 v5, s[20:23], s40 offen offset:1024 sc1 lds
 v_mfma_f32_16x16x32_bf16 v[44:47], v[116:119], a[188:191], v[44:47]
 ds_read_b64_tr_b16 v[108:109], v139 offset:0
 ds_read_b64_tr_b16 v[110:111], v139 offset:1024
 s_add_u32 m0, s45, 65536
 s_branch m_ps_p4_0
m_pad_p4_0:
 s_branch m_reta_p4
m_ps_p4_0:
 v_mfma_f32_16x16x32_bf16 v[40:43], v[116:119], a[184:187], v[40:43]
 s_mul_i32 s40, s41, 28
 s_add_u32 s40, s40, s50
 s_waitcnt lgkmcnt(8)
 v_mfma_f32_16x16x32_bf16 v[48:51], v[120:123], a[184:187], v[48:51]
 ds_read_b64_tr_b16 v[112:113], v128 offset:49152
 ds_read_b64_tr_b16 v[114:115], v128 offset:50176
 v_mfma_f32_16x16x32_bf16 v[52:55], v[120:123], a[188:191], v[52:55]
 buffer_load_dwordx4 v2, s[12:15], s40 offen offset:0 sc1 lds
 v_mfma_f32_16x16x32_bf16 v[60:63], v[124:127], a[188:191], v[60:63]
 ds_read_b64_tr_b16 v[116:117], v129 offset:49152
 ds_read_b64_tr_b16 v[118:119], v129 offset:50176
 v_mfma_f32_16x16x32_bf16 v[56:59], v[124:127], a[184:187], v[56:59]
 s_waitcnt vmcnt(13) lgkmcnt(8)
 v_mfma_f32_16x16x32_bf16 v[64:67], v[96:99], a[72:75], v[64:67]
 ds_read_b64_tr_b16 v[120:121], v130 offset:49152
 ds_read_b64_tr_b16 v[122:123], v130 offset:50176
 v_mfma_f32_16x16x32_bf16 v[68:71], v[96:99], a[76:79], v[68:71]
 buffer_load_dwordx4 v3, s[12:15], s40 offen offset:1024 sc1 lds
 v_mfma_f32_16x16x32_bf16 v[76:79], v[100:103], a[76:79], v[76:79]
 ds_read_b64_tr_b16 v[124:125], v131 offset:49152
 ds_read_b64_tr_b16 v[126:127], v131 offset:50176
 v_mfma_f32_16x16x32_bf16 v[72:75], v[100:103], a[72:75], v[72:75]
 s_mov_b32 s46, 28672
 s_waitcnt lgkmcnt(8)
 v_mfma_f32_16x16x32_bf16 v[80:83], v[104:107], a[72:75], v[80:83]
 ds_read_b64_tr_b16 v[96:97], v136 offset:4096
 ds_read_b64_tr_b16 v[98:99], v136 offset:5120
 v_mfma_f32_16x16x32_bf16 v[84:87], v[104:107], a[76:79], v[84:87]
 buffer_load_dwordx4 a[104:107], v6, s[16:19], s46 offen offset:1024 sc1
 v_mfma_f32_16x16x32_bf16 v[92:95], v[108:111], a[76:79], v[92:95]
 ds_read_b64_tr_b16 v[100:101], v137 offset:4096
 ds_read_b64_tr_b16 v[102:103], v137 offset:5120
 v_mfma_f32_16x16x32_bf16 v[88:91], v[108:111], a[72:75], v[88:91]
 s_waitcnt lgkmcnt(8)
 v_mfma_f32_16x16x32_bf16 v[32:35], v[112:115], a[192:195], v[32:35]
 ds_read_b64_tr_b16 v[104:105], v138 offset:4096
 ds_read_b64_tr_b16 v[106:107], v138 offset:5120
 v_mfma_f32_16x16x32_bf16 v[36:39], v[112:115], a[196:199], v[36:39]
 buffer_load_dwordx4 a[108:111], v7, s[16:19], s46 offen offset:1024 sc1
 v_mfma_f32_16x16x32_bf16 v[44:47], v[116:119], a[196:199], v[44:47]
 ds_read_b64_tr_b16 v[108:109], v139 offset:4096
 ds_read_b64_tr_b16 v[110:111], v139 offset:5120
 v_mfma_f32_16x16x32_bf16 v[40:43], v[116:119], a[192:195], v[40:43]
 s_mov_b32 s46, 32768
 s_waitcnt lgkmcnt(8)
 v_mfma_f32_16x16x32_bf16 v[48:51], v[120:123], a[192:195], v[48:51]
 ds_read_b64_tr_b16 v[112:113], v128 offset:53248
 ds_read_b64_tr_b16 v[114:115], v128 offset:54272
 v_mfma_f32_16x16x32_bf16 v[52:55], v[120:123], a[196:199], v[52:55]
 buffer_load_dwordx4 a[112:115], v6, s[16:19], s46 offen offset:1024 sc1
 v_mfma_f32_16x16x32_bf16 v[60:63], v[124:127], a[196:199], v[60:63]
 ds_read_b64_tr_b16 v[116:117], v129 offset:53248
 ds_read_b64_tr_b16 v[118:119], v129 offset:54272
 v_mfma_f32_16x16x32_bf16 v[56:59], v[124:127], a[192:195], v[56:59]
 s_waitcnt vmcnt(15) lgkmcnt(8)
 v_mfma_f32_16x16x32_bf16 v[64:67], v[96:99], a[80:83], v[64:67]
 ds_read_b64_tr_b16 v[120:121], v130 offset:53248
 ds_read_b64_tr_b16 v[122:123], v130 offset:54272
 v_mfma_f32_16x16x32_bf16 v[68:71], v[96:99], a[84:87], v[68:71]
 buffer_load_dwordx4 a[116:119], v7, s[16:19], s46 offen offset:1024 sc1
 v_mfma_f32_16x16x32_bf16 v[76:79], v[100:103], a[84:87], v[76:79]
 ds_read_b64_tr_b16 v[124:125], v131 offset:53248
 ds_read_b64_tr_b16 v[126:127], v131 offset:54272
 s_add_u32 m0, s45, 155648
 v_mfma_f32_16x16x32_bf16 v[72:75], v[100:103], a[80:83], v[72:75]
 s_mul_i32 s40, s42, 36
 s_add_u32 s40, s40, s51
 s_waitcnt lgkmcnt(8)
 v_mfma_f32_16x16x32_bf16 v[80:83], v[104:107], a[80:83], v[80:83]
 s_waitcnt vmcnt(12)
 s_barrier
 ds_read_b64_tr_b16 v[96:97], v136 offset:8192
 v_mfma_f32_16x16x32_bf16 v[84:87], v[104:107], a[84:87], v[84:87]
 ds_read_b64_tr_b16 v[98:99], v136 offset:9216
 buffer_load_dwordx4 v4, s[20:23], s40 offen offset:0 sc1 lds
 v_mfma_f32_16x16x32_bf16 v[92:95], v[108:111], a[84:87], v[92:95]
 ds_read_b64_tr_b16 v[100:101], v137 offset:8192
 ds_read_b64_tr_b16 v[102:103], v137 offset:9216
 v_mfma_f32_16x16x32_bf16 v[88:91], v[108:111], a[80:83], v[88:91]
 s_waitcnt lgkmcnt(8)
 v_mfma_f32_16x16x32_bf16 v[32:35], v[112:115], a[200:203], v[32:35]
 ds_read_b64_tr_b16 v[104:105], v138 offset:8192
 ds_read_b64_tr_b16 v[106:107], v138 offset:9216
 v_mfma_f32_16x16x32_bf16 v[36:39], v[112:115], a[204:207], v[36:39]
 buffer_load_dwordx4 v5, s[20:23], s40 offen offset:1024 sc1 lds
 v_mfma_f32_16x16x32_bf16 v[44:47], v[116:119], a[204:207], v[44:47]
 ds_read_b64_tr_b16 v[108:109], v139 offset:8192
 ds_read_b64_tr_b16 v[110:111], v139 offset:9216
 s_add_u32 m0, s45, 73728
 v_mfma_f32_16x16x32_bf16 v[40:43], v[116:119], a[200:203], v[40:43]
 s_mul_i32 s40, s41, 35
 s_add_u32 s40, s40, s50
 s_waitcnt lgkmcnt(8)
 v_mfma_f32_16x16x32_bf16 v[48:51], v[120:123], a[200:203], v[48:51]
 ds_read_b64_tr_b16 v[112:113], v128 offset:57344
 ds_read_b64_tr_b16 v[114:115], v128 offset:58368
 v_mfma_f32_16x16x32_bf16 v[52:55], v[120:123], a[204:207], v[52:55]
 buffer_load_dwordx4 v2, s[12:15], s40 offen offset:0 sc1 lds
 v_mfma_f32_16x16x32_bf16 v[60:63], v[124:127], a[204:207], v[60:63]
 ds_read_b64_tr_b16 v[116:117], v129 offset:57344
 ds_read_b64_tr_b16 v[118:119], v129 offset:58368
 v_mfma_f32_16x16x32_bf16 v[56:59], v[124:127], a[200:203], v[56:59]
 v_bfe_u32 v13, v0, 4, 1
 s_waitcnt vmcnt(13) lgkmcnt(8)
 v_mfma_f32_16x16x32_bf16 v[64:67], v[96:99], a[88:91], v[64:67]
 ds_read_b64_tr_b16 v[120:121], v130 offset:57344
 ds_read_b64_tr_b16 v[122:123], v130 offset:58368
 v_mfma_f32_16x16x32_bf16 v[68:71], v[96:99], a[92:95], v[68:71]
 buffer_load_dwordx4 v3, s[12:15], s40 offen offset:1024 sc1 lds
 v_add_u32 v13, s36, v13
 v_mfma_f32_16x16x32_bf16 v[76:79], v[100:103], a[92:95], v[76:79]
 ds_read_b64_tr_b16 v[124:125], v131 offset:57344
 ds_read_b64_tr_b16 v[126:127], v131 offset:58368
 v_mfma_f32_16x16x32_bf16 v[72:75], v[100:103], a[88:91], v[72:75]
 s_mov_b32 s46, 36864
 s_waitcnt lgkmcnt(8)
 v_mfma_f32_16x16x32_bf16 v[80:83], v[104:107], a[88:91], v[80:83]
 ds_read_b64_tr_b16 v[96:97], v136 offset:12288
 ds_read_b64_tr_b16 v[98:99], v136 offset:13312
 v_mfma_f32_16x16x32_bf16 v[84:87], v[104:107], a[92:95], v[84:87]
 buffer_load_dwordx4 a[120:123], v6, s[16:19], s46 offen offset:0 sc1
 v_and_b32 v14, 15, v0
 v_mfma_f32_16x16x32_bf16 v[92:95], v[108:111], a[92:95], v[92:95]
 ds_read_b64_tr_b16 v[100:101], v137 offset:12288
 ds_read_b64_tr_b16 v[102:103], v137 offset:13312
 v_mfma_f32_16x16x32_bf16 v[88:91], v[108:111], a[88:91], v[88:91]
 v_lshrrev_b32 v8, 5, v0
 s_waitcnt lgkmcnt(8)
 v_mfma_f32_16x16x32_bf16 v[32:35], v[112:115], a[208:211], v[32:35]
 ds_read_b64_tr_b16 v[104:105], v138 offset:12288
 ds_read_b64_tr_b16 v[106:107], v138 offset:13312
 v_mfma_f32_16x16x32_bf16 v[36:39], v[112:115], a[212:215], v[36:39]
 buffer_load_dwordx4 a[124:127], v7, s[16:19], s46 offen offset:0 sc1
 v_lshl_add_u32 v9, v13, 4, v14
 v_mfma_f32_16x16x32_bf16 v[44:47], v[116:119], a[212:215], v[44:47]
 ds_read_b64_tr_b16 v[108:109], v139 offset:12288
 ds_read_b64_tr_b16 v[110:111], v139 offset:13312
 v_mfma_f32_16x16x32_bf16 v[40:43], v[116:119], a[208:211], v[40:43]
 s_mov_b32 s46, 40960
 s_waitcnt lgkmcnt(8)
 v_mfma_f32_16x16x32_bf16 v[48:51], v[120:123], a[208:211], v[48:51]
 ds_read_b64_tr_b16 v[112:113], v128 offset:61440
 ds_read_b64_tr_b16 v[114:115], v128 offset:62464
 v_mfma_f32_16x16x32_bf16 v[52:55], v[120:123], a[212:215], v[52:55]
 buffer_load_dwordx4 a[128:131], v6, s[16:19], s46 offen offset:0 sc1
 v_lshlrev_b32 v12, 15, v13
 v_mfma_f32_16x16x32_bf16 v[60:63], v[124:127], a[212:215], v[60:63]
 ds_read_b64_tr_b16 v[116:117], v129 offset:61440
 ds_read_b64_tr_b16 v[118:119], v129 offset:62464
 v_mfma_f32_16x16x32_bf16 v[56:59], v[124:127], a[208:211], v[56:59]
 v_lshl_add_u32 v12, v8, 8, v12
 s_waitcnt vmcnt(15) lgkmcnt(8)
 v_mfma_f32_16x16x32_bf16 v[64:67], v[96:99], a[96:99], v[64:67]
 ds_read_b64_tr_b16 v[120:121], v130 offset:61440
 ds_read_b64_tr_b16 v[122:123], v130 offset:62464
 v_mfma_f32_16x16x32_bf16 v[68:71], v[96:99], a[100:103], v[68:71]
 buffer_load_dwordx4 a[132:135], v7, s[16:19], s46 offen offset:0 sc1
 v_lshl_add_u32 v12, v14, 4, v12
 v_mfma_f32_16x16x32_bf16 v[76:79], v[100:103], a[100:103], v[76:79]
 ds_read_b64_tr_b16 v[124:125], v131 offset:61440
 ds_read_b64_tr_b16 v[126:127], v131 offset:62464
 s_add_u32 m0, s45, 0
 v_mfma_f32_16x16x32_bf16 v[72:75], v[100:103], a[96:99], v[72:75]
 s_mul_i32 s40, s42, 43
 s_add_u32 s40, s40, s51
 s_waitcnt lgkmcnt(8)
 v_mfma_f32_16x16x32_bf16 v[80:83], v[104:107], a[96:99], v[80:83]
 s_waitcnt vmcnt(12)
 s_barrier
 ds_read_b64_tr_b16 v[96:97], v136 offset:16384
 v_mfma_f32_16x16x32_bf16 v[84:87], v[104:107], a[100:103], v[84:87]
 ds_read_b64_tr_b16 v[98:99], v136 offset:17408
 buffer_load_dwordx4 v4, s[20:23], s40 offen offset:0 sc1 lds
 v_mfma_f32_16x16x32_bf16 v[92:95], v[108:111], a[100:103], v[92:95]
 ds_read_b64_tr_b16 v[100:101], v137 offset:16384
 ds_read_b64_tr_b16 v[102:103], v137 offset:17408
 v_mfma_f32_16x16x32_bf16 v[88:91], v[108:111], a[96:99], v[88:91]
 s_waitcnt lgkmcnt(8)
 v_mfma_f32_16x16x32_bf16 v[32:35], v[112:115], a[216:219], v[32:35]
 ds_read_b64_tr_b16 v[104:105], v138 offset:16384
 ds_read_b64_tr_b16 v[106:107], v138 offset:17408
 v_mfma_f32_16x16x32_bf16 v[36:39], v[112:115], a[220:223], v[36:39]
 buffer_load_dwordx4 v5, s[20:23], s40 offen offset:1024 sc1 lds
 v_mfma_f32_16x16x32_bf16 v[44:47], v[116:119], a[220:223], v[44:47]
 ds_read_b64_tr_b16 v[108:109], v139 offset:16384
 ds_read_b64_tr_b16 v[110:111], v139 offset:17408
 s_add_u32 m0, s45, 81920
 v_mfma_f32_16x16x32_bf16 v[40:43], v[116:119], a[216:219], v[40:43]
 s_mul_i32 s40, s41, 42
 s_add_u32 s40, s40, s50
 s_waitcnt lgkmcnt(8)
 v_mfma_f32_16x16x32_bf16 v[48:51], v[120:123], a[216:219], v[48:51]
 ds_read_b64_tr_b16 v[112:113], v132 offset:0
 ds_read_b64_tr_b16 v[114:115], v132 offset:1024
 v_mfma_f32_16x16x32_bf16 v[52:55], v[120:123], a[220:223], v[52:55]
 buffer_load_dwordx4 v2, s[12:15], s40 offen offset:0 sc1 lds
 v_mfma_f32_16x16x32_bf16 v[60:63], v[124:127], a[220:223], v[60:63]
 ds_read_b64_tr_b16 v[116:117], v133 offset:0
 ds_read_b64_tr_b16 v[118:119], v133 offset:1024
 v_mfma_f32_16x16x32_bf16 v[56:59], v[124:127], a[216:219], v[56:59]
 s_lshl_b32 s39, s30, 11
 s_waitcnt vmcnt(13) lgkmcnt(8)
 v_mfma_f32_16x16x32_bf16 v[64:67], v[96:99], a[104:107], v[64:67]
 ds_read_b64_tr_b16 v[120:121], v134 offset:0
 ds_read_b64_tr_b16 v[122:123], v134 offset:1024
 v_mfma_f32_16x16x32_bf16 v[68:71], v[96:99], a[108:111], v[68:71]
 buffer_load_dwordx4 v3, s[12:15], s40 offen offset:1024 sc1 lds
 v_add_u32 v12, s39, v12
 v_mfma_f32_16x16x32_bf16 v[76:79], v[100:103], a[108:111], v[76:79]
 ds_read_b64_tr_b16 v[124:125], v135 offset:0
 ds_read_b64_tr_b16 v[126:127], v135 offset:1024
 v_mfma_f32_16x16x32_bf16 v[72:75], v[100:103], a[104:107], v[72:75]
 v_lshlrev_b32 v13, 2, v9
 s_waitcnt lgkmcnt(8)
 v_mfma_f32_16x16x32_bf16 v[80:83], v[104:107], a[104:107], v[80:83]
 ds_read_b64_tr_b16 v[96:97], v136 offset:20480
 ds_read_b64_tr_b16 v[98:99], v136 offset:21504
 v_mfma_f32_16x16x32_bf16 v[84:87], v[104:107], a[108:111], v[84:87]
 buffer_load_dwordx4 a[136:139], v6, s[16:19], s46 offen offset:3072 sc1
 s_lshl_b32 s44, s2, 14
 v_mfma_f32_16x16x32_bf16 v[92:95], v[108:111], a[108:111], v[92:95]
 ds_read_b64_tr_b16 v[100:101], v137 offset:20480
 ds_read_b64_tr_b16 v[102:103], v137 offset:21504
 v_mfma_f32_16x16x32_bf16 v[88:91], v[108:111], a[104:107], v[88:91]
 s_add_u32 s44, s44, s38
 s_waitcnt lgkmcnt(8)
 v_mfma_f32_16x16x32_bf16 v[32:35], v[112:115], a[224:227], v[32:35]
 ds_read_b64_tr_b16 v[104:105], v138 offset:20480
 ds_read_b64_tr_b16 v[106:107], v138 offset:21504
 v_mfma_f32_16x16x32_bf16 v[36:39], v[112:115], a[228:231], v[36:39]
 buffer_load_dwordx4 a[140:143], v7, s[16:19], s46 offen offset:3072 sc1
 s_xor_b32 s47, s44, 0x4000
 v_mfma_f32_16x16x32_bf16 v[44:47], v[116:119], a[228:231], v[44:47]
 ds_read_b64_tr_b16 v[108:109], v139 offset:20480
 ds_read_b64_tr_b16 v[110:111], v139 offset:21504
 v_mfma_f32_16x16x32_bf16 v[40:43], v[116:119], a[224:227], v[40:43]
 s_mov_b32 s46, 45056
 s_waitcnt lgkmcnt(8)
 v_mfma_f32_16x16x32_bf16 v[48:51], v[120:123], a[224:227], v[48:51]
 ds_read_b64_tr_b16 v[112:113], v132 offset:4096
 ds_read_b64_tr_b16 v[114:115], v132 offset:5120
 v_mfma_f32_16x16x32_bf16 v[52:55], v[120:123], a[228:231], v[52:55]
 buffer_load_dwordx4 a[144:147], v6, s[16:19], s46 offen offset:3072 sc1
 v_and_b32 v20, 31, v0
 v_mfma_f32_16x16x32_bf16 v[60:63], v[124:127], a[228:231], v[60:63]
 ds_read_b64_tr_b16 v[116:117], v133 offset:4096
 ds_read_b64_tr_b16 v[118:119], v133 offset:5120
 v_mfma_f32_16x16x32_bf16 v[56:59], v[124:127], a[224:227], v[56:59]
 v_and_b32 v21, 7, v0
 s_waitcnt vmcnt(15) lgkmcnt(8)
 v_mfma_f32_16x16x32_bf16 v[64:67], v[96:99], a[112:115], v[64:67]
 ds_read_b64_tr_b16 v[120:121], v134 offset:4096
 ds_read_b64_tr_b16 v[122:123], v134 offset:5120
 v_mfma_f32_16x16x32_bf16 v[68:71], v[96:99], a[116:119], v[68:71]
 buffer_load_dwordx4 a[148:151], v7, s[16:19], s46 offen offset:3072 sc1
 v_xor_b32 v21, v21, v8
 v_mfma_f32_16x16x32_bf16 v[76:79], v[100:103], a[116:119], v[76:79]
 ds_read_b64_tr_b16 v[124:125], v135 offset:4096
 ds_read_b64_tr_b16 v[126:127], v135 offset:5120
 s_add_u32 m0, s45, 8192
 buffer_load_dwordx2 v[26:27], v25, s[60:63], 0 offen sc1
 v_mfma_f32_16x16x32_bf16 v[72:75], v[100:103], a[112:115], v[72:75]
 s_mul_i32 s40, s42, 50
 s_add_u32 s40, s40, s51
 s_waitcnt lgkmcnt(8)
 v_mfma_f32_16x16x32_bf16 v[80:83], v[104:107], a[112:115], v[80:83]
 s_waitcnt vmcnt(13)
 s_barrier
 ds_read_b64_tr_b16 v[96:97], v136 offset:24576
 v_mfma_f32_16x16x32_bf16 v[84:87], v[104:107], a[116:119], v[84:87]
 ds_read_b64_tr_b16 v[98:99], v136 offset:25600
 buffer_load_dwordx4 v4, s[20:23], s40 offen offset:0 sc1 lds
 v_mfma_f32_16x16x32_bf16 v[92:95], v[108:111], a[116:119], v[92:95]
 ds_read_b64_tr_b16 v[100:101], v137 offset:24576
 ds_read_b64_tr_b16 v[102:103], v137 offset:25600
 v_mfma_f32_16x16x32_bf16 v[88:91], v[108:111], a[112:115], v[88:91]
 s_waitcnt lgkmcnt(8)
 v_mfma_f32_16x16x32_bf16 v[32:35], v[112:115], a[232:235], v[32:35]
 ds_read_b64_tr_b16 v[104:105], v138 offset:24576
 ds_read_b64_tr_b16 v[106:107], v138 offset:25600
 v_mfma_f32_16x16x32_bf16 v[36:39], v[112:115], a[236:239], v[36:39]
 buffer_load_dwordx4 v5, s[20:23], s40 offen offset:1024 sc1 lds
 v_mfma_f32_16x16x32_bf16 v[44:47], v[116:119], a[236:239], v[44:47]
 ds_read_b64_tr_b16 v[108:109], v139 offset:24576
 ds_read_b64_tr_b16 v[110:111], v139 offset:25600
 s_add_u32 m0, s45, 90112
 v_mfma_f32_16x16x32_bf16 v[40:43], v[116:119], a[232:235], v[40:43]
 s_mul_i32 s40, s41, 49
 s_add_u32 s40, s40, s50
 s_waitcnt lgkmcnt(8)
 v_mfma_f32_16x16x32_bf16 v[48:51], v[120:123], a[232:235], v[48:51]
 ds_read_b64_tr_b16 v[112:113], v132 offset:8192
 ds_read_b64_tr_b16 v[114:115], v132 offset:9216
 v_mfma_f32_16x16x32_bf16 v[52:55], v[120:123], a[236:239], v[52:55]
 buffer_load_dwordx4 v2, s[12:15], s40 offen offset:0 sc1 lds
 v_mfma_f32_16x16x32_bf16 v[60:63], v[124:127], a[236:239], v[60:63]
 ds_read_b64_tr_b16 v[116:117], v133 offset:8192
 ds_read_b64_tr_b16 v[118:119], v133 offset:9216
 v_mfma_f32_16x16x32_bf16 v[56:59], v[124:127], a[232:235], v[56:59]
 s_waitcnt vmcnt(14) lgkmcnt(8)
 v_mfma_f32_16x16x32_bf16 v[64:67], v[96:99], a[120:123], v[64:67]
 ds_read_b64_tr_b16 v[120:121], v134 offset:8192
 ds_read_b64_tr_b16 v[122:123], v134 offset:9216
 v_mfma_f32_16x16x32_bf16 v[68:71], v[96:99], a[124:127], v[68:71]
 buffer_load_dwordx4 v3, s[12:15], s40 offen offset:1024 sc1 lds
 v_lshlrev_b32 v20, 7, v20
 v_mfma_f32_16x16x32_bf16 v[76:79], v[100:103], a[124:127], v[76:79]
 ds_read_b64_tr_b16 v[124:125], v135 offset:8192
 ds_read_b64_tr_b16 v[126:127], v135 offset:9216
 v_mfma_f32_16x16x32_bf16 v[72:75], v[100:103], a[120:123], v[72:75]
 s_mov_b32 s46, 49152
 s_waitcnt lgkmcnt(8)
 v_mfma_f32_16x16x32_bf16 v[80:83], v[104:107], a[120:123], v[80:83]
 ds_read_b64_tr_b16 v[96:97], v136 offset:28672
 ds_read_b64_tr_b16 v[98:99], v136 offset:29696
 v_mfma_f32_16x16x32_bf16 v[84:87], v[104:107], a[124:127], v[84:87]
 buffer_load_dwordx4 a[152:155], v6, s[16:19], s46 offen offset:2048 sc1
 s_add_u32 s39, s38, 0x20000
 v_mfma_f32_16x16x32_bf16 v[92:95], v[108:111], a[124:127], v[92:95]
 ds_read_b64_tr_b16 v[100:101], v137 offset:28672
 ds_read_b64_tr_b16 v[102:103], v137 offset:29696
 v_mfma_f32_16x16x32_bf16 v[88:91], v[108:111], a[120:123], v[88:91]
 v_add_u32 v20, s39, v20
 s_waitcnt lgkmcnt(8)
 v_mfma_f32_16x16x32_bf16 v[32:35], v[112:115], a[240:243], v[32:35]
 ds_read_b64_tr_b16 v[104:105], v138 offset:28672
 ds_read_b64_tr_b16 v[106:107], v138 offset:29696
 v_mfma_f32_16x16x32_bf16 v[36:39], v[112:115], a[244:247], v[36:39]
 buffer_load_dwordx4 a[156:159], v7, s[16:19], s46 offen offset:2048 sc1
 v_lshrrev_b32 v22, 3, v0
 v_mfma_f32_16x16x32_bf16 v[44:47], v[116:119], a[244:247], v[44:47]
 ds_read_b64_tr_b16 v[108:109], v139 offset:28672
 ds_read_b64_tr_b16 v[110:111], v139 offset:29696
 v_mfma_f32_16x16x32_bf16 v[40:43], v[116:119], a[240:243], v[40:43]
 s_mov_b32 s46, 53248
 s_waitcnt lgkmcnt(8)
 v_mfma_f32_16x16x32_bf16 v[48:51], v[120:123], a[240:243], v[48:51]
 ds_read_b64_tr_b16 v[112:113], v132 offset:12288
 ds_read_b64_tr_b16 v[114:115], v132 offset:13312
 v_mfma_f32_16x16x32_bf16 v[52:55], v[120:123], a[244:247], v[52:55]
 buffer_load_dwordx4 a[160:163], v6, s[16:19], s46 offen offset:2048 sc1
 v_and_b32 v23, 7, v0
 v_mfma_f32_16x16x32_bf16 v[60:63], v[124:127], a[244:247], v[60:63]
 ds_read_b64_tr_b16 v[116:117], v133 offset:12288
 ds_read_b64_tr_b16 v[118:119], v133 offset:13312
 v_mfma_f32_16x16x32_bf16 v[56:59], v[124:127], a[240:243], v[56:59]
 v_xor_b32 v17, v23, v22
 s_waitcnt vmcnt(16) lgkmcnt(8)
 v_mfma_f32_16x16x32_bf16 v[64:67], v[96:99], a[128:131], v[64:67]
 ds_read_b64_tr_b16 v[120:121], v134 offset:12288
 ds_read_b64_tr_b16 v[122:123], v134 offset:13312
 v_mfma_f32_16x16x32_bf16 v[68:71], v[96:99], a[132:135], v[68:71]
 buffer_load_dwordx4 a[164:167], v7, s[16:19], s46 offen offset:2048 sc1
 v_lshlrev_b32 v17, 4, v17
 v_mfma_f32_16x16x32_bf16 v[76:79], v[100:103], a[132:135], v[76:79]
 ds_read_b64_tr_b16 v[124:125], v135 offset:12288
 ds_read_b64_tr_b16 v[126:127], v135 offset:13312
 s_add_u32 m0, s45, 16384
 v_mfma_f32_16x16x32_bf16 v[72:75], v[100:103], a[128:131], v[72:75]
 s_mul_i32 s40, s42, 2
 s_waitcnt lgkmcnt(8)
 v_mfma_f32_16x16x32_bf16 v[80:83], v[104:107], a[128:131], v[80:83]
 s_waitcnt vmcnt(13)
 s_barrier
 ds_read_b64_tr_b16 v[96:97], v128 offset:0
 v_mfma_f32_16x16x32_bf16 v[84:87], v[104:107], a[132:135], v[84:87]
 ds_read_b64_tr_b16 v[98:99], v128 offset:1024
 buffer_load_dwordx4 v4, s[20:23], s40 offen offset:0 sc1 lds
 v_mfma_f32_16x16x32_bf16 v[92:95], v[108:111], a[132:135], v[92:95]
 ds_read_b64_tr_b16 v[100:101], v129 offset:0
 ds_read_b64_tr_b16 v[102:103], v129 offset:1024
 v_mfma_f32_16x16x32_bf16 v[88:91], v[108:111], a[128:131], v[88:91]
 s_waitcnt lgkmcnt(8)
 v_mfma_f32_16x16x32_bf16 v[32:35], v[112:115], a[0:3], v[32:35]
 ds_read_b64_tr_b16 v[104:105], v130 offset:0
 ds_read_b64_tr_b16 v[106:107], v130 offset:1024
 v_mfma_f32_16x16x32_bf16 v[36:39], v[112:115], a[4:7], v[36:39]
 buffer_load_dwordx4 v5, s[20:23], s40 offen offset:1024 sc1 lds
 v_mfma_f32_16x16x32_bf16 v[44:47], v[116:119], a[4:7], v[44:47]
 ds_read_b64_tr_b16 v[108:109], v131 offset:0
 ds_read_b64_tr_b16 v[110:111], v131 offset:1024
 s_add_u32 m0, s45, 98304
 v_mfma_f32_16x16x32_bf16 v[40:43], v[116:119], a[0:3], v[40:43]
 s_mul_i32 s40, s41, 1
 s_add_u32 s40, s40, s50
 s_waitcnt lgkmcnt(8)
 v_mfma_f32_16x16x32_bf16 v[48:51], v[120:123], a[0:3], v[48:51]
 ds_read_b64_tr_b16 v[112:113], v132 offset:16384
 ds_read_b64_tr_b16 v[114:115], v132 offset:17408
 v_mfma_f32_16x16x32_bf16 v[52:55], v[120:123], a[4:7], v[52:55]
 buffer_load_dwordx4 v2, s[12:15], s40 offen offset:0 sc1 lds
 v_mfma_f32_16x16x32_bf16 v[60:63], v[124:127], a[4:7], v[60:63]
 ds_read_b64_tr_b16 v[116:117], v133 offset:16384
 ds_read_b64_tr_b16 v[118:119], v133 offset:17408
 v_mfma_f32_16x16x32_bf16 v[56:59], v[124:127], a[0:3], v[56:59]
 v_lshl_add_u32 v17, v22, 7, v17
 s_waitcnt vmcnt(14) lgkmcnt(8)
 v_mfma_f32_16x16x32_bf16 v[64:67], v[96:99], a[136:139], v[64:67]
 ds_read_b64_tr_b16 v[120:121], v134 offset:16384
 ds_read_b64_tr_b16 v[122:123], v134 offset:17408
 v_mfma_f32_16x16x32_bf16 v[68:71], v[96:99], a[140:143], v[68:71]
 buffer_load_dwordx4 v3, s[12:15], s40 offen offset:1024 sc1 lds
 v_add_u32 v22, s39, v17
 v_mfma_f32_16x16x32_bf16 v[76:79], v[100:103], a[140:143], v[76:79]
 ds_read_b64_tr_b16 v[124:125], v135 offset:16384
 ds_read_b64_tr_b16 v[126:127], v135 offset:17408
 v_mfma_f32_16x16x32_bf16 v[72:75], v[100:103], a[136:139], v[72:75]
 s_mov_b32 s46, 0
 s_waitcnt lgkmcnt(8)
 v_mfma_f32_16x16x32_bf16 v[80:83], v[104:107], a[136:139], v[80:83]
 s_waitcnt vmcnt(12)
 v_cmp_ne_u64 vcc, s[8:9], v[26:27]
 s_mov_b32 s57, 0
 s_cbranch_vccz L_ok_fb
L_re_fb:
 buffer_load_dwordx2 v[26:27], v25, s[60:63], 0 offen sc1
 s_add_u32 s57, s57, 1
 s_waitcnt vmcnt(0)
 v_cmp_ne_u64 vcc, s[8:9], v[26:27]
 s_cmp_gt_u32 s57, 0x40000
 s_cbranch_vccz L_ok_fb
 s_cbranch_scc0 L_re_fb
L_ok_fb:
 ds_read_b64_tr_b16 v[96:97], v128 offset:4096
 ds_read_b64_tr_b16 v[98:99], v128 offset:5120
 v_mfma_f32_16x16x32_bf16 v[84:87], v[104:107], a[140:143], v[84:87]
 buffer_load_dwordx4 a[168:171], v6, s[16:19], s46 offen offset:2048 sc1
 v_mfma_f32_16x16x32_bf16 v[92:95], v[108:111], a[140:143], v[92:95]
 ds_read_b64_tr_b16 v[100:101], v129 offset:4096
 ds_read_b64_tr_b16 v[102:103], v129 offset:5120
 v_mfma_f32_16x16x32_bf16 v[88:91], v[108:111], a[136:139], v[88:91]
 s_waitcnt lgkmcnt(8)
 v_mfma_f32_16x16x32_bf16 v[32:35], v[112:115], a[8:11], v[32:35]
 ds_read_b64_tr_b16 v[104:105], v130 offset:4096
 ds_read_b64_tr_b16 v[106:107], v130 offset:5120
 v_mfma_f32_16x16x32_bf16 v[36:39], v[112:115], a[12:15], v[36:39]
 buffer_load_dwordx4 a[172:175], v7, s[16:19], s46 offen offset:2048 sc1
 v_mfma_f32_16x16x32_bf16 v[44:47], v[116:119], a[12:15], v[44:47]
 ds_read_b64_tr_b16 v[108:109], v131 offset:4096
 ds_read_b64_tr_b16 v[110:111], v131 offset:5120
 v_mfma_f32_16x16x32_bf16 v[40:43], v[116:119], a[8:11], v[40:43]
 s_waitcnt lgkmcnt(8)
 v_mfma_f32_16x16x32_bf16 v[48:51], v[120:123], a[8:11], v[48:51]
 ds_read_b64_tr_b16 v[112:113], v132 offset:20480
 ds_read_b64_tr_b16 v[114:115], v132 offset:21504
 v_mfma_f32_16x16x32_bf16 v[52:55], v[120:123], a[12:15], v[52:55]
 buffer_load_dwordx4 a[176:179], v6, s[16:19], s46 offen offset:3072 sc1
 s_lshl_b32 s39, s36, 15
 v_mfma_f32_16x16x32_bf16 v[60:63], v[124:127], a[12:15], v[60:63]
 ds_read_b64_tr_b16 v[116:117], v133 offset:20480
 ds_read_b64_tr_b16 v[118:119], v133 offset:21504
 v_mfma_f32_16x16x32_bf16 v[56:59], v[124:127], a[8:11], v[56:59]
 s_add_u32 s39, s39, s35
 s_waitcnt lgkmcnt(8)
 v_mfma_f32_16x16x32_bf16 v[64:67], v[96:99], a[144:147], v[64:67]
 ds_read_b64_tr_b16 v[120:121], v134 offset:20480
 ds_read_b64_tr_b16 v[122:123], v134 offset:21504
 v_mfma_f32_16x16x32_bf16 v[68:71], v[96:99], a[148:151], v[68:71]
 buffer_load_dwordx4 a[180:183], v7, s[16:19], s46 offen offset:3072 sc1
 v_lshrrev_b32 v11, 3, v0
 v_mfma_f32_16x16x32_bf16 v[76:79], v[100:103], a[148:151], v[76:79]
 ds_read_b64_tr_b16 v[124:125], v135 offset:20480
 ds_read_b64_tr_b16 v[126:127], v135 offset:21504
 s_add_u32 m0, s45, 24576
 v_mfma_f32_16x16x32_bf16 v[72:75], v[100:103], a[144:147], v[72:75]
 s_mul_i32 s40, s42, 9
 s_waitcnt lgkmcnt(8)
 v_mfma_f32_16x16x32_bf16 v[80:83], v[104:107], a[144:147], v[80:83]
 s_waitcnt vmcnt(12)
 s_barrier
 ds_read_b64_tr_b16 v[96:97], v128 offset:8192
 v_mfma_f32_16x16x32_bf16 v[84:87], v[104:107], a[148:151], v[84:87]
 ds_read_b64_tr_b16 v[98:99], v128 offset:9216
 buffer_load_dwordx4 v4, s[20:23], s40 offen offset:0 sc1 lds
 v_mfma_f32_16x16x32_bf16 v[92:95], v[108:111], a[148:151], v[92:95]
 ds_read_b64_tr_b16 v[100:101], v129 offset:8192
 ds_read_b64_tr_b16 v[102:103], v129 offset:9216
 v_mfma_f32_16x16x32_bf16 v[88:91], v[108:111], a[144:147], v[88:91]
 s_waitcnt lgkmcnt(8)
 v_mfma_f32_16x16x32_bf16 v[32:35], v[112:115], a[16:19], v[32:35]
 ds_read_b64_tr_b16 v[104:105], v130 offset:8192
 ds_read_b64_tr_b16 v[106:107], v130 offset:9216
 v_mfma_f32_16x16x32_bf16 v[36:39], v[112:115], a[20:23], v[36:39]
 buffer_load_dwordx4 v5, s[20:23], s40 offen offset:1024 sc1 lds
 v_mfma_f32_16x16x32_bf16 v[44:47], v[116:119], a[20:23], v[44:47]
 ds_read_b64_tr_b16 v[108:109], v131 offset:8192
 ds_read_b64_tr_b16 v[110:111], v131 offset:9216
 s_add_u32 m0, s45, 106496
 v_mfma_f32_16x16x32_bf16 v[40:43], v[116:119], a[16:19], v[40:43]
 s_mul_i32 s40, s41, 8
 s_add_u32 s40, s40, s50
 s_waitcnt lgkmcnt(8)
 v_mfma_f32_16x16x32_bf16 v[48:51], v[120:123], a[16:19], v[48:51]
 ds_read_b64_tr_b16 v[112:113], v132 offset:24576
 ds_read_b64_tr_b16 v[114:115], v132 offset:25600
 v_mfma_f32_16x16x32_bf16 v[52:55], v[120:123], a[20:23], v[52:55]
 buffer_load_dwordx4 v2, s[12:15], s40 offen offset:0 sc1 lds
 v_mfma_f32_16x16x32_bf16 v[60:63], v[124:127], a[20:23], v[60:63]
 ds_read_b64_tr_b16 v[116:117], v133 offset:24576
 ds_read_b64_tr_b16 v[118:119], v133 offset:25600
 v_mfma_f32_16x16x32_bf16 v[56:59], v[124:127], a[16:19], v[56:59]
 v_lshlrev_b32 v11, 11, v11
 s_waitcnt vmcnt(13) lgkmcnt(8)
 v_mfma_f32_16x16x32_bf16 v[64:67], v[96:99], a[152:155], v[64:67]
 ds_read_b64_tr_b16 v[120:121], v134 offset:24576
 ds_read_b64_tr_b16 v[122:123], v134 offset:25600
 v_mfma_f32_16x16x32_bf16 v[68:71], v[96:99], a[156:159], v[68:71]
 buffer_load_dwordx4 v3, s[12:15], s40 offen offset:1024 sc1 lds
 v_lshl_add_u32 v11, v23, 4, v11
 v_mfma_f32_16x16x32_bf16 v[76:79], v[100:103], a[156:159], v[76:79]
 ds_read_b64_tr_b16 v[124:125], v135 offset:24576
 ds_read_b64_tr_b16 v[126:127], v135 offset:25600
 v_mfma_f32_16x16x32_bf16 v[72:75], v[100:103], a[152:155], v[72:75]
 s_mov_b32 s46, 8192
 s_waitcnt lgkmcnt(8)
 v_mfma_f32_16x16x32_bf16 v[80:83], v[104:107], a[152:155], v[80:83]
 ds_read_b64_tr_b16 v[96:97], v128 offset:12288
 ds_read_b64_tr_b16 v[98:99], v128 offset:13312
 v_mfma_f32_16x16x32_bf16 v[84:87], v[104:107], a[156:159], v[84:87]
 buffer_load_dwordx4 a[184:187], v6, s[16:19], s46 offen offset:1024 sc1
 v_add_u32 v11, s39, v11
 v_mfma_f32_16x16x32_bf16 v[92:95], v[108:111], a[156:159], v[92:95]
 ds_read_b64_tr_b16 v[100:101], v129 offset:12288
 ds_read_b64_tr_b16 v[102:103], v129 offset:13312
 v_mfma_f32_16x16x32_bf16 v[88:91], v[108:111], a[152:155], v[88:91]
 s_mov_b32 s31, 0x4000
 s_waitcnt lgkmcnt(8)
 v_mfma_f32_16x16x32_bf16 v[32:35], v[112:115], a[24:27], v[32:35]
 ds_read_b64_tr_b16 v[104:105], v130 offset:12288
 ds_read_b64_tr_b16 v[106:107], v130 offset:13312
 v_mfma_f32_16x16x32_bf16 v[36:39], v[112:115], a[28:31], v[36:39]
 buffer_load_dwordx4 a[188:191], v7, s[16:19], s46 offen offset:1024 sc1
 s_mov_b32 s32, 0x8000
 v_mfma_f32_16x16x32_bf16 v[44:47], v[116:119], a[28:31], v[44:47]
 ds_read_b64_tr_b16 v[108:109], v131 offset:12288
 ds_read_b64_tr_b16 v[110:111], v131 offset:13312
 v_mfma_f32_16x16x32_bf16 v[40:43], v[116:119], a[24:27], v[40:43]
 s_mov_b32 s33, 0xc000
 s_waitcnt lgkmcnt(8)
 v_mfma_f32_16x16x32_bf16 v[48:51], v[120:123], a[24:27], v[48:51]
 ds_read_b64_tr_b16 v[112:113], v132 offset:28672
 ds_read_b64_tr_b16 v[114:115], v132 offset:29696
 v_mfma_f32_16x16x32_bf16 v[52:55], v[120:123], a[28:31], v[52:55]
 buffer_load_dwordx4 a[192:195], v6, s[16:19], s46 offen offset:2048 sc1
 v_mfma_f32_16x16x32_bf16 v[60:63], v[124:127], a[28:31], v[60:63]
 ds_read_b64_tr_b16 v[116:117], v133 offset:28672
 ds_read_b64_tr_b16 v[118:119], v133 offset:29696
 v_mfma_f32_16x16x32_bf16 v[56:59], v[124:127], a[24:27], v[56:59]
 v_xor_b32 v17, 0, v21
 v_lshl_add_u32 v140, v17, 4, v20
 s_waitcnt vmcnt(15) lgkmcnt(8)
 v_mfma_f32_16x16x32_bf16 v[64:67], v[96:99], a[160:163], v[64:67]
 ds_read_b64_tr_b16 v[120:121], v134 offset:28672
 ds_read_b64_tr_b16 v[122:123], v134 offset:29696
 v_mfma_f32_16x16x32_bf16 v[68:71], v[96:99], a[164:167], v[68:71]
 buffer_load_dwordx4 a[196:199], v7, s[16:19], s46 offen offset:2048 sc1
 v_mfma_f32_16x16x32_bf16 v[76:79], v[100:103], a[164:167], v[76:79]
 ds_read_b64_tr_b16 v[124:125], v135 offset:28672
 ds_read_b64_tr_b16 v[126:127], v135 offset:29696
 s_add_u32 m0, s45, 32768
 v_mfma_f32_16x16x32_bf16 v[72:75], v[100:103], a[160:163], v[72:75]
 s_mul_i32 s40, s42, 16
 s_waitcnt lgkmcnt(8)
 v_mfma_f32_16x16x32_bf16 v[80:83], v[104:107], a[160:163], v[80:83]
 s_waitcnt vmcnt(12)
 s_barrier
 ds_read_b64_tr_b16 v[96:97], v128 offset:16384
 s_branch m_ps_p4_1
m_pad_p4_1:
 s_branch m_reta_p4
m_ps_p4_1:
 v_mfma_f32_16x16x32_bf16 v[84:87], v[104:107], a[164:167], v[84:87]
 ds_read_b64_tr_b16 v[98:99], v128 offset:17408
 buffer_load_dwordx4 v4, s[20:23], s40 offen offset:0 sc1 lds
 v_mfma_f32_16x16x32_bf16 v[92:95], v[108:111], a[164:167], v[92:95]
 ds_read_b64_tr_b16 v[100:101], v129 offset:16384
 ds_read_b64_tr_b16 v[102:103], v129 offset:17408
 v_mfma_f32_16x16x32_bf16 v[88:91], v[108:111], a[160:163], v[88:91]
 s_waitcnt lgkmcnt(8)
 v_mfma_f32_16x16x32_bf16 v[32:35], v[112:115], a[32:35], v[32:35]
 ds_read_b64_tr_b16 v[104:105], v130 offset:16384
 ds_read_b64_tr_b16 v[106:107], v130 offset:17408
 v_mfma_f32_16x16x32_bf16 v[36:39], v[112:115], a[36:39], v[36:39]
 buffer_load_dwordx4 v5, s[20:23], s40 offen offset:1024 sc1 lds
 v_mfma_f32_16x16x32_bf16 v[44:47], v[116:119], a[36:39], v[44:47]
 ds_read_b64_tr_b16 v[108:109], v131 offset:16384
 ds_read_b64_tr_b16 v[110:111], v131 offset:17408
 s_add_u32 m0, s45, 114688
 v_mfma_f32_16x16x32_bf16 v[40:43], v[116:119], a[32:35], v[40:43]
 s_mul_i32 s40, s41, 15
 s_add_u32 s40, s40, s50
 s_waitcnt lgkmcnt(8)
 v_mfma_f32_16x16x32_bf16 v[48:51], v[120:123], a[32:35], v[48:51]
 ds_read_b64_tr_b16 v[112:113], v132 offset:32768
 ds_read_b64_tr_b16 v[114:115], v132 offset:33792
 v_mfma_f32_16x16x32_bf16 v[52:55], v[120:123], a[36:39], v[52:55]
 buffer_load_dwordx4 v2, s[12:15], s40 offen offset:0 sc1 lds
 v_mfma_f32_16x16x32_bf16 v[60:63], v[124:127], a[36:39], v[60:63]
 ds_read_b64_tr_b16 v[116:117], v133 offset:32768
 ds_read_b64_tr_b16 v[118:119], v133 offset:33792
 v_mfma_f32_16x16x32_bf16 v[56:59], v[124:127], a[32:35], v[56:59]
 v_xor_b32 v17, 2, v21
 v_lshl_add_u32 v141, v17, 4, v20
 s_waitcnt vmcnt(13) lgkmcnt(8)
 v_mfma_f32_16x16x32_bf16 v[64:67], v[96:99], a[168:171], v[64:67]
 ds_read_b64_tr_b16 v[120:121], v134 offset:32768
 ds_read_b64_tr_b16 v[122:123], v134 offset:33792
 v_mfma_f32_16x16x32_bf16 v[68:71], v[96:99], a[172:175], v[68:71]
 buffer_load_dwordx4 v3, s[12:15], s40 offen offset:1024 sc1 lds
 v_mfma_f32_16x16x32_bf16 v[76:79], v[100:103], a[172:175], v[76:79]
 ds_read_b64_tr_b16 v[124:125], v135 offset:32768
 ds_read_b64_tr_b16 v[126:127], v135 offset:33792
 v_mfma_f32_16x16x32_bf16 v[72:75], v[100:103], a[168:171], v[72:75]
 s_mov_b32 s46, 16384
 s_waitcnt lgkmcnt(8)
 v_mfma_f32_16x16x32_bf16 v[80:83], v[104:107], a[168:171], v[80:83]
 ds_read_b64_tr_b16 v[96:97], v128 offset:20480
 ds_read_b64_tr_b16 v[98:99], v128 offset:21504
 v_mfma_f32_16x16x32_bf16 v[84:87], v[104:107], a[172:175], v[84:87]
 buffer_load_dwordx4 a[200:203], v6, s[16:19], s46 offen offset:0 sc1
 v_xor_b32 v17, 4, v21
 v_lshl_add_u32 v142, v17, 4, v20
 v_mfma_f32_16x16x32_bf16 v[92:95], v[108:111], a[172:175], v[92:95]
 ds_read_b64_tr_b16 v[100:101], v129 offset:20480
 ds_read_b64_tr_b16 v[102:103], v129 offset:21504
 v_mfma_f32_16x16x32_bf16 v[88:91], v[108:111], a[168:171], v[88:91]
 s_waitcnt lgkmcnt(8)
 v_mfma_f32_16x16x32_bf16 v[32:35], v[112:115], a[40:43], v[32:35]
 ds_read_b64_tr_b16 v[104:105], v130 offset:20480
 ds_read_b64_tr_b16 v[106:107], v130 offset:21504
 v_mfma_f32_16x16x32_bf16 v[36:39], v[112:115], a[44:47], v[36:39]
 buffer_load_dwordx4 a[204:207], v7, s[16:19], s46 offen offset:0 sc1
 v_xor_b32 v17, 6, v21
 v_lshl_add_u32 v143, v17, 4, v20
 v_mfma_f32_16x16x32_bf16 v[44:47], v[116:119], a[44:47], v[44:47]
 ds_read_b64_tr_b16 v[108:109], v131 offset:20480
 ds_read_b64_tr_b16 v[110:111], v131 offset:21504
 v_mfma_f32_16x16x32_bf16 v[40:43], v[116:119], a[40:43], v[40:43]
 s_waitcnt lgkmcnt(8)
 v_mfma_f32_16x16x32_bf16 v[48:51], v[120:123], a[40:43], v[48:51]
 ds_read_b64_tr_b16 v[112:113], v132 offset:36864
 ds_read_b64_tr_b16 v[114:115], v132 offset:37888
 v_mfma_f32_16x16x32_bf16 v[52:55], v[120:123], a[44:47], v[52:55]
 buffer_load_dwordx4 a[208:211], v6, s[16:19], s46 offen offset:1024 sc1
 v_mfma_f32_16x16x32_bf16 v[60:63], v[124:127], a[44:47], v[60:63]
 ds_read_b64_tr_b16 v[116:117], v133 offset:36864
 ds_read_b64_tr_b16 v[118:119], v133 offset:37888
 v_mfma_f32_16x16x32_bf16 v[56:59], v[124:127], a[40:43], v[56:59]
 s_waitcnt vmcnt(15) lgkmcnt(8)
 v_mfma_f32_16x16x32_bf16 v[64:67], v[96:99], a[176:179], v[64:67]
 ds_read_b64_tr_b16 v[120:121], v134 offset:36864
 ds_read_b64_tr_b16 v[122:123], v134 offset:37888
 v_mfma_f32_16x16x32_bf16 v[68:71], v[96:99], a[180:183], v[68:71]
 buffer_load_dwordx4 a[212:215], v7, s[16:19], s46 offen offset:1024 sc1
 v_mfma_f32_16x16x32_bf16 v[76:79], v[100:103], a[180:183], v[76:79]
 ds_read_b64_tr_b16 v[124:125], v135 offset:36864
 ds_read_b64_tr_b16 v[126:127], v135 offset:37888
 s_add_u32 m0, s45, 40960
 v_mfma_f32_16x16x32_bf16 v[72:75], v[100:103], a[176:179], v[72:75]
 s_mul_i32 s40, s42, 23
 s_waitcnt lgkmcnt(8)
 v_mfma_f32_16x16x32_bf16 v[80:83], v[104:107], a[176:179], v[80:83]
 s_waitcnt vmcnt(12)
 s_barrier
 ds_read_b64_tr_b16 v[96:97], v128 offset:24576
 v_mfma_f32_16x16x32_bf16 v[84:87], v[104:107], a[180:183], v[84:87]
 ds_read_b64_tr_b16 v[98:99], v128 offset:25600
 buffer_load_dwordx4 v4, s[20:23], s40 offen offset:0 sc1 lds
 v_mfma_f32_16x16x32_bf16 v[92:95], v[108:111], a[180:183], v[92:95]
 ds_read_b64_tr_b16 v[100:101], v129 offset:24576
 ds_read_b64_tr_b16 v[102:103], v129 offset:25600
 v_mfma_f32_16x16x32_bf16 v[88:91], v[108:111], a[176:179], v[88:91]
 s_waitcnt lgkmcnt(8)
 v_mfma_f32_16x16x32_bf16 v[32:35], v[112:115], a[48:51], v[32:35]
 ds_read_b64_tr_b16 v[104:105], v130 offset:24576
 ds_read_b64_tr_b16 v[106:107], v130 offset:25600
 v_mfma_f32_16x16x32_bf16 v[36:39], v[112:115], a[52:55], v[36:39]
 buffer_load_dwordx4 v5, s[20:23], s40 offen offset:1024 sc1 lds
 v_mfma_f32_16x16x32_bf16 v[44:47], v[116:119], a[52:55], v[44:47]
 ds_read_b64_tr_b16 v[108:109], v131 offset:24576
 ds_read_b64_tr_b16 v[110:111], v131 offset:25600
 s_add_u32 m0, s45, 122880
 v_mfma_f32_16x16x32_bf16 v[40:43], v[116:119], a[48:51], v[40:43]
 s_mul_i32 s40, s41, 22
 s_add_u32 s40, s40, s50
 s_waitcnt lgkmcnt(8)
 v_mfma_f32_16x16x32_bf16 v[48:51], v[120:123], a[48:51], v[48:51]
 ds_read_b64_tr_b16 v[112:113], v132 offset:40960
 ds_read_b64_tr_b16 v[114:115], v132 offset:41984
 v_mfma_f32_16x16x32_bf16 v[52:55], v[120:123], a[52:55], v[52:55]
 buffer_load_dwordx4 v2, s[12:15], s40 offen offset:0 sc1 lds
 v_mfma_f32_16x16x32_bf16 v[60:63], v[124:127], a[52:55], v[60:63]
 ds_read_b64_tr_b16 v[116:117], v133 offset:40960
 ds_read_b64_tr_b16 v[118:119], v133 offset:41984
 v_mfma_f32_16x16x32_bf16 v[56:59], v[124:127], a[48:51], v[56:59]
 s_waitcnt vmcnt(13) lgkmcnt(8)
 v_mfma_f32_16x16x32_bf16 v[64:67], v[96:99], a[184:187], v[64:67]
 ds_read_b64_tr_b16 v[120:121], v134 offset:40960
 ds_read_b64_tr_b16 v[122:123], v134 offset:41984
 v_mfma_f32_16x16x32_bf16 v[68:71], v[96:99], a[188:191], v[68:71]
 buffer_load_dwordx4 v3, s[12:15], s40 offen offset:1024 sc1 lds
 v_mfma_f32_16x16x32_bf16 v[76:79], v[100:103], a[188:191], v[76:79]
 ds_read_b64_tr_b16 v[124:125], v135 offset:40960
 ds_read_b64_tr_b16 v[126:127], v135 offset:41984
 v_mfma_f32_16x16x32_bf16 v[72:75], v[100:103], a[184:187], v[72:75]
 s_mov_b32 s46, 20480
 s_waitcnt lgkmcnt(8)
 v_mfma_f32_16x16x32_bf16 v[80:83], v[104:107], a[184:187], v[80:83]
 ds_read_b64_tr_b16 v[96:97], v128 offset:28672
 ds_read_b64_tr_b16 v[98:99], v128 offset:29696
 v_mfma_f32_16x16x32_bf16 v[84:87], v[104:107], a[188:191], v[84:87]
 buffer_load_dwordx4 a[216:219], v6, s[16:19], s46 offen offset:3072 sc1
 v_mfma_f32_16x16x32_bf16 v[92:95], v[108:111], a[188:191], v[92:95]
 ds_read_b64_tr_b16 v[100:101], v129 offset:28672
 ds_read_b64_tr_b16 v[102:103], v129 offset:29696
 v_mfma_f32_16x16x32_bf16 v[88:91], v[108:111], a[184:187], v[88:91]
 s_waitcnt lgkmcnt(8)
 v_mfma_f32_16x16x32_bf16 v[32:35], v[112:115], a[56:59], v[32:35]
 ds_read_b64_tr_b16 v[104:105], v130 offset:28672
 ds_read_b64_tr_b16 v[106:107], v130 offset:29696
 v_mfma_f32_16x16x32_bf16 v[36:39], v[112:115], a[60:63], v[36:39]
 buffer_load_dwordx4 a[220:223], v7, s[16:19], s46 offen offset:3072 sc1
 v_mfma_f32_16x16x32_bf16 v[44:47], v[116:119], a[60:63], v[44:47]
 ds_read_b64_tr_b16 v[108:109], v131 offset:28672
 ds_read_b64_tr_b16 v[110:111], v131 offset:29696
 v_mfma_f32_16x16x32_bf16 v[40:43], v[116:119], a[56:59], v[40:43]
 s_mov_b32 s46, 24576
 s_waitcnt lgkmcnt(8)
 v_mfma_f32_16x16x32_bf16 v[48:51], v[120:123], a[56:59], v[48:51]
 ds_read_b64_tr_b16 v[112:113], v132 offset:45056
 ds_read_b64_tr_b16 v[114:115], v132 offset:46080
 v_mfma_f32_16x16x32_bf16 v[52:55], v[120:123], a[60:63], v[52:55]
 buffer_load_dwordx4 a[224:227], v6, s[16:19], s46 offen offset:0 sc1
 v_mfma_f32_16x16x32_bf16 v[60:63], v[124:127], a[60:63], v[60:63]
 ds_read_b64_tr_b16 v[116:117], v133 offset:45056
 ds_read_b64_tr_b16 v[118:119], v133 offset:46080
 v_mfma_f32_16x16x32_bf16 v[56:59], v[124:127], a[56:59], v[56:59]
 s_waitcnt vmcnt(15) lgkmcnt(8)
 v_mfma_f32_16x16x32_bf16 v[64:67], v[96:99], a[192:195], v[64:67]
 ds_read_b64_tr_b16 v[120:121], v134 offset:45056
 ds_read_b64_tr_b16 v[122:123], v134 offset:46080
 v_mfma_f32_16x16x32_bf16 v[68:71], v[96:99], a[196:199], v[68:71]
 buffer_load_dwordx4 a[228:231], v7, s[16:19], s46 offen offset:0 sc1
 v_mfma_f32_16x16x32_bf16 v[76:79], v[100:103], a[196:199], v[76:79]
 ds_read_b64_tr_b16 v[124:125], v135 offset:45056
 ds_read_b64_tr_b16 v[126:127], v135 offset:46080
 s_add_u32 m0, s45, 131072
 v_mfma_f32_16x16x32_bf16 v[72:75], v[100:103], a[192:195], v[72:75]
 s_mul_i32 s40, s42, 30
 s_waitcnt lgkmcnt(8)
 v_mfma_f32_16x16x32_bf16 v[80:83], v[104:107], a[192:195], v[80:83]
 s_waitcnt vmcnt(12)
 s_barrier
 ds_read_b64_tr_b16 v[96:97], v128 offset:32768
 v_mfma_f32_16x16x32_bf16 v[84:87], v[104:107], a[196:199], v[84:87]
 ds_read_b64_tr_b16 v[98:99], v128 offset:33792
 buffer_load_dwordx4 v4, s[20:23], s40 offen offset:0 sc1 lds
 v_mfma_f32_16x16x32_bf16 v[92:95], v[108:111], a[196:199], v[92:95]
 ds_read_b64_tr_b16 v[100:101], v129 offset:32768
 ds_read_b64_tr_b16 v[102:103], v129 offset:33792
 v_mfma_f32_16x16x32_bf16 v[88:91], v[108:111], a[192:195], v[88:91]
 s_waitcnt lgkmcnt(8)
 v_mfma_f32_16x16x32_bf16 v[32:35], v[112:115], a[64:67], v[32:35]
 ds_read_b64_tr_b16 v[104:105], v130 offset:32768
 ds_read_b64_tr_b16 v[106:107], v130 offset:33792
 v_mfma_f32_16x16x32_bf16 v[36:39], v[112:115], a[68:71], v[36:39]
 buffer_load_dwordx4 v5, s[20:23], s40 offen offset:1024 sc1 lds
 v_mfma_f32_16x16x32_bf16 v[44:47], v[116:119], a[68:71], v[44:47]
 ds_read_b64_tr_b16 v[108:109], v131 offset:32768
 ds_read_b64_tr_b16 v[110:111], v131 offset:33792
 s_add_u32 m0, s45, 49152
 v_mfma_f32_16x16x32_bf16 v[40:43], v[116:119], a[64:67], v[40:43]
 s_mul_i32 s40, s41, 29
 s_add_u32 s40, s40, s50
 s_waitcnt lgkmcnt(8)
 v_mfma_f32_16x16x32_bf16 v[48:51], v[120:123], a[64:67], v[48:51]
 ds_read_b64_tr_b16 v[112:113], v132 offset:49152
 ds_read_b64_tr_b16 v[114:115], v132 offset:50176
 v_mfma_f32_16x16x32_bf16 v[52:55], v[120:123], a[68:71], v[52:55]
 buffer_load_dwordx4 v2, s[12:15], s40 offen offset:0 sc1 lds
 v_mfma_f32_16x16x32_bf16 v[60:63], v[124:127], a[68:71], v[60:63]
 ds_read_b64_tr_b16 v[116:117], v133 offset:49152
 ds_read_b64_tr_b16 v[118:119], v133 offset:50176
 v_mfma_f32_16x16x32_bf16 v[56:59], v[124:127], a[64:67], v[56:59]
 s_waitcnt vmcnt(13) lgkmcnt(8)
 v_mfma_f32_16x16x32_bf16 v[64:67], v[96:99], a[200:203], v[64:67]
 ds_read_b64_tr_b16 v[120:121], v134 offset:49152
 ds_read_b64_tr_b16 v[122:123], v134 offset:50176
 v_mfma_f32_16x16x32_bf16 v[68:71], v[96:99], a[204:207], v[68:71]
 buffer_load_dwordx4 v3, s[12:15], s40 offen offset:1024 sc1 lds
 v_mfma_f32_16x16x32_bf16 v[76:79], v[100:103], a[204:207], v[76:79]
 ds_read_b64_tr_b16 v[124:125], v135 offset:49152
 ds_read_b64_tr_b16 v[126:127], v135 offset:50176
 v_mfma_f32_16x16x32_bf16 v[72:75], v[100:103], a[200:203], v[72:75]
 s_mov_b32 s46, 28672
 s_waitcnt lgkmcnt(8)
 v_mfma_f32_16x16x32_bf16 v[80:83], v[104:107], a[200:203], v[80:83]
 ds_read_b64_tr_b16 v[96:97], v128 offset:36864
 ds_read_b64_tr_b16 v[98:99], v128 offset:37888
 v_mfma_f32_16x16x32_bf16 v[84:87], v[104:107], a[204:207], v[84:87]
 buffer_load_dwordx4 a[232:235], v6, s[16:19], s46 offen offset:2048 sc1
 v_mfma_f32_16x16x32_bf16 v[92:95], v[108:111], a[204:207], v[92:95]
 ds_read_b64_tr_b16 v[100:101], v129 offset:36864
 ds_read_b64_tr_b16 v[102:103], v129 offset:37888
 v_mfma_f32_16x16x32_bf16 v[88:91], v[108:111], a[200:203], v[88:91]
 s_waitcnt lgkmcnt(8)
 v_mfma_f32_16x16x32_bf16 v[32:35], v[112:115], a[72:75], v[32:35]
 ds_read_b64_tr_b16 v[104:105], v130 offset:36864
 ds_read_b64_tr_b16 v[106:107], v130 offset:37888
 v_mfma_f32_16x16x32_bf16 v[36:39], v[112:115], a[76:79], v[36:39]
 buffer_load_dwordx4 a[236:239], v7, s[16:19], s46 offen offset:2048 sc1
 v_mfma_f32_16x16x32_bf16 v[44:47], v[116:119], a[76:79], v[44:47]
 ds_read_b64_tr_b16 v[108:109], v131 offset:36864
 ds_read_b64_tr_b16 v[110:111], v131 offset:37888
 v_mfma_f32_16x16x32_bf16 v[40:43], v[116:119], a[72:75], v[40:43]
 s_waitcnt lgkmcnt(8)
 v_mfma_f32_16x16x32_bf16 v[48:51], v[120:123], a[72:75], v[48:51]
 ds_read_b64_tr_b16 v[112:113], v132 offset:53248
 ds_read_b64_tr_b16 v[114:115], v132 offset:54272
 s_mov_b32 s24, s78
 s_mov_b32 s25, s79
 s_mov_b32 s26, 4194304
 s_mov_b32 s27, 0x20000
 s_add_u32 s84, s82, 0x800000
 s_addc_u32 s85, s83, 0
 s_mov_b32 s86, 4194304
 s_mov_b32 s87, 0x20000
 s_add_u32 s88, s82, 0x2050000
 s_addc_u32 s89, s83, 0
 s_mov_b32 s90, 8192
 s_mov_b32 s91, 0x20000
 s_add_u32 s92, s82, 0x2400000
 s_addc_u32 s93, s83, 0
 s_mov_b32 s94, 4194304
 s_mov_b32 s95, 0x20000
 v_mfma_f32_16x16x32_bf16 v[52:55], v[120:123], a[76:79], v[52:55]
 buffer_load_dwordx4 a[240:243], v6, s[16:19], s46 offen offset:3072 sc1
 v_mfma_f32_16x16x32_bf16 v[60:63], v[124:127], a[76:79], v[60:63]
 ds_read_b64_tr_b16 v[116:117], v133 offset:53248
 ds_read_b64_tr_b16 v[118:119], v133 offset:54272
 v_mfma_f32_16x16x32_bf16 v[56:59], v[124:127], a[72:75], v[56:59]
 s_waitcnt vmcnt(15) lgkmcnt(8)
 v_mfma_f32_16x16x32_bf16 v[64:67], v[96:99], a[208:211], v[64:67]
 ds_read_b64_tr_b16 v[120:121], v134 offset:53248
 ds_read_b64_tr_b16 v[122:123], v134 offset:54272
 v_mfma_f32_16x16x32_bf16 v[68:71], v[96:99], a[212:215], v[68:71]
 buffer_load_dwordx4 a[244:247], v7, s[16:19], s46 offen offset:3072 sc1
 v_mfma_f32_16x16x32_bf16 v[76:79], v[100:103], a[212:215], v[76:79]
 ds_read_b64_tr_b16 v[124:125], v135 offset:53248
 ds_read_b64_tr_b16 v[126:127], v135 offset:54272
 s_add_u32 m0, s45, 139264
 v_mfma_f32_16x16x32_bf16 v[72:75], v[100:103], a[208:211], v[72:75]
 s_mul_i32 s40, s42, 37
 s_waitcnt lgkmcnt(8)
 v_mfma_f32_16x16x32_bf16 v[80:83], v[104:107], a[208:211], v[80:83]
 s_waitcnt vmcnt(12)
 s_barrier
 ds_read_b64_tr_b16 v[96:97], v128 offset:40960
 v_mfma_f32_16x16x32_bf16 v[84:87], v[104:107], a[212:215], v[84:87]
 ds_read_b64_tr_b16 v[98:99], v128 offset:41984
 buffer_load_dwordx4 v4, s[20:23], s40 offen offset:0 sc1 lds
 v_mfma_f32_16x16x32_bf16 v[92:95], v[108:111], a[212:215], v[92:95]
 ds_read_b64_tr_b16 v[100:101], v129 offset:40960
 ds_read_b64_tr_b16 v[102:103], v129 offset:41984
 v_mfma_f32_16x16x32_bf16 v[88:91], v[108:111], a[208:211], v[88:91]
 s_waitcnt lgkmcnt(8)
 v_mfma_f32_16x16x32_bf16 v[32:35], v[112:115], a[80:83], v[32:35]
 ds_read_b64_tr_b16 v[104:105], v130 offset:40960
 ds_read_b64_tr_b16 v[106:107], v130 offset:41984
 v_mfma_f32_16x16x32_bf16 v[36:39], v[112:115], a[84:87], v[36:39]
 buffer_load_dwordx4 v5, s[20:23], s40 offen offset:1024 sc1 lds
 v_mfma_f32_16x16x32_bf16 v[44:47], v[116:119], a[84:87], v[44:47]
 ds_read_b64_tr_b16 v[108:109], v131 offset:40960
 ds_read_b64_tr_b16 v[110:111], v131 offset:41984
 s_add_u32 m0, s45, 57344
 v_mfma_f32_16x16x32_bf16 v[40:43], v[116:119], a[80:83], v[40:43]
 s_mul_i32 s40, s41, 36
 s_add_u32 s40, s40, s50
 s_waitcnt lgkmcnt(8)
 v_mfma_f32_16x16x32_bf16 v[48:51], v[120:123], a[80:83], v[48:51]
 ds_read_b64_tr_b16 v[112:113], v132 offset:57344
 ds_read_b64_tr_b16 v[114:115], v132 offset:58368
 v_mfma_f32_16x16x32_bf16 v[52:55], v[120:123], a[84:87], v[52:55]
 buffer_load_dwordx4 v2, s[12:15], s40 offen offset:0 sc1 lds
 v_mfma_f32_16x16x32_bf16 v[60:63], v[124:127], a[84:87], v[60:63]
 ds_read_b64_tr_b16 v[116:117], v133 offset:57344
 ds_read_b64_tr_b16 v[118:119], v133 offset:58368
 v_mfma_f32_16x16x32_bf16 v[56:59], v[124:127], a[80:83], v[56:59]
 s_waitcnt vmcnt(13) lgkmcnt(8)
 v_mfma_f32_16x16x32_bf16 v[64:67], v[96:99], a[216:219], v[64:67]
 ds_read_b64_tr_b16 v[120:121], v134 offset:57344
 ds_read_b64_tr_b16 v[122:123], v134 offset:58368
 v_mfma_f32_16x16x32_bf16 v[68:71], v[96:99], a[220:223], v[68:71]
 buffer_load_dwordx4 v3, s[12:15], s40 offen offset:1024 sc1 lds
 v_mfma_f32_16x16x32_bf16 v[76:79], v[100:103], a[220:223], v[76:79]
 ds_read_b64_tr_b16 v[124:125], v135 offset:57344
 ds_read_b64_tr_b16 v[126:127], v135 offset:58368
 v_mfma_f32_16x16x32_bf16 v[72:75], v[100:103], a[216:219], v[72:75]
 s_mov_b32 s46, 36864
 s_waitcnt lgkmcnt(8)
 v_mfma_f32_16x16x32_bf16 v[80:83], v[104:107], a[216:219], v[80:83]
 ds_read_b64_tr_b16 v[96:97], v128 offset:45056
 ds_read_b64_tr_b16 v[98:99], v128 offset:46080
 v_mfma_f32_16x16x32_bf16 v[84:87], v[104:107], a[220:223], v[84:87]
 buffer_load_dwordx4 a[0:3], v6, s[16:19], s46 offen offset:1024 sc1
 v_mfma_f32_16x16x32_bf16 v[92:95], v[108:111], a[220:223], v[92:95]
 ds_read_b64_tr_b16 v[100:101], v129 offset:45056
 ds_read_b64_tr_b16 v[102:103], v129 offset:46080
 v_mfma_f32_16x16x32_bf16 v[88:91], v[108:111], a[216:219], v[88:91]
 s_waitcnt lgkmcnt(8)
 v_mfma_f32_16x16x32_bf16 v[32:35], v[112:115], a[88:91], v[32:35]
 ds_read_b64_tr_b16 v[104:105], v130 offset:45056
 ds_read_b64_tr_b16 v[106:107], v130 offset:46080
 v_mfma_f32_16x16x32_bf16 v[36:39], v[112:115], a[92:95], v[36:39]
 buffer_load_dwordx4 a[4:7], v7, s[16:19], s46 offen offset:1024 sc1
 v_mfma_f32_16x16x32_bf16 v[44:47], v[116:119], a[92:95], v[44:47]
 ds_read_b64_tr_b16 v[108:109], v131 offset:45056
 ds_read_b64_tr_b16 v[110:111], v131 offset:46080
 v_mfma_f32_16x16x32_bf16 v[40:43], v[116:119], a[88:91], v[40:43]
 s_waitcnt lgkmcnt(8)
 v_mfma_f32_16x16x32_bf16 v[48:51], v[120:123], a[88:91], v[48:51]
 ds_read_b64_tr_b16 v[112:113], v132 offset:61440
 ds_read_b64_tr_b16 v[114:115], v132 offset:62464
 v_mfma_f32_16x16x32_bf16 v[52:55], v[120:123], a[92:95], v[52:55]
 buffer_load_dwordx4 a[8:11], v6, s[16:19], s46 offen offset:2048 sc1
 v_mfma_f32_16x16x32_bf16 v[60:63], v[124:127], a[92:95], v[60:63]
 ds_read_b64_tr_b16 v[116:117], v133 offset:61440
 ds_read_b64_tr_b16 v[118:119], v133 offset:62464
 v_mfma_f32_16x16x32_bf16 v[56:59], v[124:127], a[88:91], v[56:59]
 s_waitcnt vmcnt(15) lgkmcnt(8)
 v_mfma_f32_16x16x32_bf16 v[64:67], v[96:99], a[224:227], v[64:67]
 ds_read_b64_tr_b16 v[120:121], v134 offset:61440
 ds_read_b64_tr_b16 v[122:123], v134 offset:62464
 v_mfma_f32_16x16x32_bf16 v[68:71], v[96:99], a[228:231], v[68:71]
 buffer_load_dwordx4 a[12:15], v7, s[16:19], s46 offen offset:2048 sc1
 v_mfma_f32_16x16x32_bf16 v[76:79], v[100:103], a[228:231], v[76:79]
 ds_read_b64_tr_b16 v[124:125], v135 offset:61440
 ds_read_b64_tr_b16 v[126:127], v135 offset:62464
 s_add_u32 m0, s45, 147456
 v_mfma_f32_16x16x32_bf16 v[72:75], v[100:103], a[224:227], v[72:75]
 s_mul_i32 s40, s42, 44
 s_waitcnt lgkmcnt(8)
 v_mfma_f32_16x16x32_bf16 v[80:83], v[104:107], a[224:227], v[80:83]
 s_waitcnt vmcnt(12)
 s_barrier
 ds_read_b64_tr_b16 v[96:97], v136 offset:0
 v_mfma_f32_16x16x32_bf16 v[84:87], v[104:107], a[228:231], v[84:87]
 ds_read_b64_tr_b16 v[98:99], v136 offset:1024
 buffer_load_dwordx4 v4, s[20:23], s40 offen offset:0 sc1 lds
 v_mfma_f32_16x16x32_bf16 v[92:95], v[108:111], a[228:231], v[92:95]
 ds_read_b64_tr_b16 v[100:101], v137 offset:0
 ds_read_b64_tr_b16 v[102:103], v137 offset:1024
 v_mfma_f32_16x16x32_bf16 v[88:91], v[108:111], a[224:227], v[88:91]
 s_waitcnt lgkmcnt(8)
 v_mfma_f32_16x16x32_bf16 v[32:35], v[112:115], a[96:99], v[32:35]
 ds_read_b64_tr_b16 v[104:105], v138 offset:0
 ds_read_b64_tr_b16 v[106:107], v138 offset:1024
 v_mfma_f32_16x16x32_bf16 v[36:39], v[112:115], a[100:103], v[36:39]
 buffer_load_dwordx4 v5, s[20:23], s40 offen offset:1024 sc1 lds
 v_mfma_f32_16x16x32_bf16 v[44:47], v[116:119], a[100:103], v[44:47]
 ds_read_b64_tr_b16 v[108:109], v139 offset:0
 ds_read_b64_tr_b16 v[110:111], v139 offset:1024
 s_add_u32 m0, s45, 65536
 v_mfma_f32_16x16x32_bf16 v[40:43], v[116:119], a[96:99], v[40:43]
 s_mul_i32 s40, s41, 43
 s_add_u32 s40, s40, s50
 s_waitcnt lgkmcnt(8)
 v_mfma_f32_16x16x32_bf16 v[48:51], v[120:123], a[96:99], v[48:51]
 ds_read_b64_tr_b16 v[112:113], v128 offset:49152
 ds_read_b64_tr_b16 v[114:115], v128 offset:50176
 v_mfma_f32_16x16x32_bf16 v[52:55], v[120:123], a[100:103], v[52:55]
 buffer_load_dwordx4 v2, s[12:15], s40 offen offset:0 sc1 lds
 v_mfma_f32_16x16x32_bf16 v[60:63], v[124:127], a[100:103], v[60:63]
 ds_read_b64_tr_b16 v[116:117], v129 offset:49152
 ds_read_b64_tr_b16 v[118:119], v129 offset:50176
 v_mfma_f32_16x16x32_bf16 v[56:59], v[124:127], a[96:99], v[56:59]
 s_waitcnt vmcnt(13) lgkmcnt(8)
 v_mfma_f32_16x16x32_bf16 v[64:67], v[96:99], a[232:235], v[64:67]
 ds_read_b64_tr_b16 v[120:121], v130 offset:49152
 ds_read_b64_tr_b16 v[122:123], v130 offset:50176
 v_mfma_f32_16x16x32_bf16 v[68:71], v[96:99], a[236:239], v[68:71]
 buffer_load_dwordx4 v3, s[12:15], s40 offen offset:1024 sc1 lds
 v_mfma_f32_16x16x32_bf16 v[76:79], v[100:103], a[236:239], v[76:79]
 ds_read_b64_tr_b16 v[124:125], v131 offset:49152
 ds_read_b64_tr_b16 v[126:127], v131 offset:50176
 v_mfma_f32_16x16x32_bf16 v[72:75], v[100:103], a[232:235], v[72:75]
 s_mov_b32 s46, 45056
 s_waitcnt lgkmcnt(8)
 v_mfma_f32_16x16x32_bf16 v[80:83], v[104:107], a[232:235], v[80:83]
 ds_read_b64_tr_b16 v[96:97], v136 offset:4096
 ds_read_b64_tr_b16 v[98:99], v136 offset:5120
 v_mfma_f32_16x16x32_bf16 v[84:87], v[104:107], a[236:239], v[84:87]
 buffer_load_dwordx4 a[16:19], v6, s[16:19], s46 offen offset:0 sc1
 v_mfma_f32_16x16x32_bf16 v[92:95], v[108:111], a[236:239], v[92:95]
 ds_read_b64_tr_b16 v[100:101], v137 offset:4096
 ds_read_b64_tr_b16 v[102:103], v137 offset:5120
 v_mfma_f32_16x16x32_bf16 v[88:91], v[108:111], a[232:235], v[88:91]
 s_waitcnt lgkmcnt(8)
 v_mfma_f32_16x16x32_bf16 v[32:35], v[112:115], a[104:107], v[32:35]
 ds_read_b64_tr_b16 v[104:105], v138 offset:4096
 ds_read_b64_tr_b16 v[106:107], v138 offset:5120
 v_mfma_f32_16x16x32_bf16 v[36:39], v[112:115], a[108:111], v[36:39]
 buffer_load_dwordx4 a[20:23], v7, s[16:19], s46 offen offset:0 sc1
 v_mfma_f32_16x16x32_bf16 v[44:47], v[116:119], a[108:111], v[44:47]
 ds_read_b64_tr_b16 v[108:109], v139 offset:4096
 ds_read_b64_tr_b16 v[110:111], v139 offset:5120
 v_mfma_f32_16x16x32_bf16 v[40:43], v[116:119], a[104:107], v[40:43]
 s_waitcnt lgkmcnt(8)
 v_mfma_f32_16x16x32_bf16 v[48:51], v[120:123], a[104:107], v[48:51]
 ds_read_b64_tr_b16 v[112:113], v128 offset:53248
 ds_read_b64_tr_b16 v[114:115], v128 offset:54272
 v_mfma_f32_16x16x32_bf16 v[52:55], v[120:123], a[108:111], v[52:55]
 buffer_load_dwordx4 a[24:27], v6, s[16:19], s46 offen offset:1024 sc1
 v_mfma_f32_16x16x32_bf16 v[60:63], v[124:127], a[108:111], v[60:63]
 ds_read_b64_tr_b16 v[116:117], v129 offset:53248
 ds_read_b64_tr_b16 v[118:119], v129 offset:54272
 v_mfma_f32_16x16x32_bf16 v[56:59], v[124:127], a[104:107], v[56:59]
 s_waitcnt vmcnt(15) lgkmcnt(8)
 v_mfma_f32_16x16x32_bf16 v[64:67], v[96:99], a[240:243], v[64:67]
 ds_read_b64_tr_b16 v[120:121], v130 offset:53248
 ds_read_b64_tr_b16 v[122:123], v130 offset:54272
 v_mfma_f32_16x16x32_bf16 v[68:71], v[96:99], a[244:247], v[68:71]
 buffer_load_dwordx4 a[28:31], v7, s[16:19], s46 offen offset:1024 sc1
 v_mfma_f32_16x16x32_bf16 v[76:79], v[100:103], a[244:247], v[76:79]
 ds_read_b64_tr_b16 v[124:125], v131 offset:53248
 ds_read_b64_tr_b16 v[126:127], v131 offset:54272
 s_add_u32 m0, s45, 155648
 v_mfma_f32_16x16x32_bf16 v[72:75], v[100:103], a[240:243], v[72:75]
 s_mul_i32 s40, s42, 51
 s_waitcnt lgkmcnt(8)
 v_mfma_f32_16x16x32_bf16 v[80:83], v[104:107], a[240:243], v[80:83]
 s_waitcnt vmcnt(12)
 s_barrier
 ds_read_b64_tr_b16 v[96:97], v136 offset:8192
 v_mfma_f32_16x16x32_bf16 v[84:87], v[104:107], a[244:247], v[84:87]
 ds_read_b64_tr_b16 v[98:99], v136 offset:9216
 buffer_load_dwordx4 v4, s[20:23], s40 offen offset:0 sc1 lds
 v_mfma_f32_16x16x32_bf16 v[92:95], v[108:111], a[244:247], v[92:95]
 ds_read_b64_tr_b16 v[100:101], v137 offset:8192
 ds_read_b64_tr_b16 v[102:103], v137 offset:9216
 v_mfma_f32_16x16x32_bf16 v[88:91], v[108:111], a[240:243], v[88:91]
 s_waitcnt lgkmcnt(8)
 v_mfma_f32_16x16x32_bf16 v[32:35], v[112:115], a[112:115], v[32:35]
 ds_read_b64_tr_b16 v[104:105], v138 offset:8192
 ds_read_b64_tr_b16 v[106:107], v138 offset:9216
 v_mfma_f32_16x16x32_bf16 v[36:39], v[112:115], a[116:119], v[36:39]
 buffer_load_dwordx4 v5, s[20:23], s40 offen offset:1024 sc1 lds
 v_mfma_f32_16x16x32_bf16 v[44:47], v[116:119], a[116:119], v[44:47]
 ds_read_b64_tr_b16 v[108:109], v139 offset:8192
 ds_read_b64_tr_b16 v[110:111], v139 offset:9216
 s_add_u32 m0, s45, 73728
 v_mfma_f32_16x16x32_bf16 v[40:43], v[116:119], a[112:115], v[40:43]
 s_mul_i32 s40, s41, 50
 s_add_u32 s40, s40, s50
 s_waitcnt lgkmcnt(8)
 v_mfma_f32_16x16x32_bf16 v[48:51], v[120:123], a[112:115], v[48:51]
 ds_read_b64_tr_b16 v[112:113], v128 offset:57344
 ds_read_b64_tr_b16 v[114:115], v128 offset:58368
 v_mfma_f32_16x16x32_bf16 v[52:55], v[120:123], a[116:119], v[52:55]
 buffer_load_dwordx4 v2, s[12:15], s40 offen offset:0 sc1 lds
 v_mfma_f32_16x16x32_bf16 v[60:63], v[124:127], a[116:119], v[60:63]
 ds_read_b64_tr_b16 v[116:117], v129 offset:57344
 ds_read_b64_tr_b16 v[118:119], v129 offset:58368
 v_mfma_f32_16x16x32_bf16 v[56:59], v[124:127], a[112:115], v[56:59]
 s_waitcnt vmcnt(13) lgkmcnt(8)
 v_mfma_f32_16x16x32_bf16 v[64:67], v[96:99], a[0:3], v[64:67]
 ds_read_b64_tr_b16 v[120:121], v130 offset:57344
 ds_read_b64_tr_b16 v[122:123], v130 offset:58368
 v_mfma_f32_16x16x32_bf16 v[68:71], v[96:99], a[4:7], v[68:71]
 buffer_load_dwordx4 v3, s[12:15], s40 offen offset:1024 sc1 lds
 v_mfma_f32_16x16x32_bf16 v[76:79], v[100:103], a[4:7], v[76:79]
 ds_read_b64_tr_b16 v[124:125], v131 offset:57344
 ds_read_b64_tr_b16 v[126:127], v131 offset:58368
 v_mfma_f32_16x16x32_bf16 v[72:75], v[100:103], a[0:3], v[72:75]
 s_mov_b32 s46, 49152
 s_waitcnt lgkmcnt(8)
 v_mfma_f32_16x16x32_bf16 v[80:83], v[104:107], a[0:3], v[80:83]
 ds_read_b64_tr_b16 v[96:97], v136 offset:12288
 ds_read_b64_tr_b16 v[98:99], v136 offset:13312
 v_mfma_f32_16x16x32_bf16 v[84:87], v[104:107], a[4:7], v[84:87]
 buffer_load_dwordx4 a[32:35], v6, s[16:19], s46 offen offset:3072 sc1
 v_mfma_f32_16x16x32_bf16 v[92:95], v[108:111], a[4:7], v[92:95]
 ds_read_b64_tr_b16 v[100:101], v137 offset:12288
 ds_read_b64_tr_b16 v[102:103], v137 offset:13312
 v_mfma_f32_16x16x32_bf16 v[88:91], v[108:111], a[0:3], v[88:91]
 s_waitcnt lgkmcnt(8)
 v_mfma_f32_16x16x32_bf16 v[32:35], v[112:115], a[120:123], v[32:35]
 ds_read_b64_tr_b16 v[104:105], v138 offset:12288
 ds_read_b64_tr_b16 v[106:107], v138 offset:13312
 v_mfma_f32_16x16x32_bf16 v[36:39], v[112:115], a[124:127], v[36:39]
 buffer_load_dwordx4 a[36:39], v7, s[16:19], s46 offen offset:3072 sc1
 v_mfma_f32_16x16x32_bf16 v[44:47], v[116:119], a[124:127], v[44:47]
 ds_read_b64_tr_b16 v[108:109], v139 offset:12288
 ds_read_b64_tr_b16 v[110:111], v139 offset:13312
 v_mfma_f32_16x16x32_bf16 v[40:43], v[116:119], a[120:123], v[40:43]
 s_mov_b32 s46, 53248
 s_waitcnt lgkmcnt(8)
 v_mfma_f32_16x16x32_bf16 v[48:51], v[120:123], a[120:123], v[48:51]
 ds_read_b64_tr_b16 v[112:113], v128 offset:61440
 ds_read_b64_tr_b16 v[114:115], v128 offset:62464
 v_mfma_f32_16x16x32_bf16 v[52:55], v[120:123], a[124:127], v[52:55]
 buffer_load_dwordx4 a[40:43], v6, s[16:19], s46 offen offset:0 sc1
 v_mfma_f32_16x16x32_bf16 v[60:63], v[124:127], a[124:127], v[60:63]
 ds_read_b64_tr_b16 v[116:117], v129 offset:61440
 ds_read_b64_tr_b16 v[118:119], v129 offset:62464
 v_mfma_f32_16x16x32_bf16 v[56:59], v[124:127], a[120:123], v[56:59]
 s_waitcnt vmcnt(15) lgkmcnt(8)
 v_mfma_f32_16x16x32_bf16 v[64:67], v[96:99], a[8:11], v[64:67]
 ds_read_b64_tr_b16 v[120:121], v130 offset:61440
 ds_read_b64_tr_b16 v[122:123], v130 offset:62464
 v_mfma_f32_16x16x32_bf16 v[68:71], v[96:99], a[12:15], v[68:71]
 buffer_load_dwordx4 a[44:47], v7, s[16:19], s46 offen offset:0 sc1
 v_mfma_f32_16x16x32_bf16 v[76:79], v[100:103], a[12:15], v[76:79]
 ds_read_b64_tr_b16 v[124:125], v131 offset:61440
 ds_read_b64_tr_b16 v[126:127], v131 offset:62464
 s_add_u32 m0, s45, 0
 v_mfma_f32_16x16x32_bf16 v[72:75], v[100:103], a[8:11], v[72:75]
 s_mul_i32 s40, s42, 6
 s_add_u32 s40, s40, s53
 s_waitcnt lgkmcnt(8)
 v_mfma_f32_16x16x32_bf16 v[80:83], v[104:107], a[8:11], v[80:83]
 s_waitcnt vmcnt(12)
 s_barrier
 ds_read_b64_tr_b16 v[96:97], v136 offset:16384
 v_mfma_f32_16x16x32_bf16 v[84:87], v[104:107], a[12:15], v[84:87]
 ds_read_b64_tr_b16 v[98:99], v136 offset:17408
 buffer_load_dwordx4 v4, s[20:23], s40 offen offset:0 sc1 lds
 s_branch m_ps_p4_2
m_pad_p4_2:
 s_branch m_reta_p4
m_ps_p4_2:
 v_mfma_f32_16x16x32_bf16 v[92:95], v[108:111], a[12:15], v[92:95]
 ds_read_b64_tr_b16 v[100:101], v137 offset:16384
 ds_read_b64_tr_b16 v[102:103], v137 offset:17408
 v_mfma_f32_16x16x32_bf16 v[88:91], v[108:111], a[8:11], v[88:91]
 s_waitcnt lgkmcnt(8)
 v_mfma_f32_16x16x32_bf16 v[32:35], v[112:115], a[128:131], v[32:35]
 ds_read_b64_tr_b16 v[104:105], v138 offset:16384
 ds_read_b64_tr_b16 v[106:107], v138 offset:17408
 v_mfma_f32_16x16x32_bf16 v[36:39], v[112:115], a[132:135], v[36:39]
 buffer_load_dwordx4 v5, s[20:23], s40 offen offset:1024 sc1 lds
 v_mfma_f32_16x16x32_bf16 v[44:47], v[116:119], a[132:135], v[44:47]
 ds_read_b64_tr_b16 v[108:109], v139 offset:16384
 ds_read_b64_tr_b16 v[110:111], v139 offset:17408
 s_add_u32 m0, s45, 81920
 v_mfma_f32_16x16x32_bf16 v[40:43], v[116:119], a[128:131], v[40:43]
 s_mul_i32 s40, s41, 2
 s_waitcnt lgkmcnt(8)
 v_mfma_f32_16x16x32_bf16 v[48:51], v[120:123], a[128:131], v[48:51]
 ds_read_b64_tr_b16 v[112:113], v132 offset:0
 ds_read_b64_tr_b16 v[114:115], v132 offset:1024
 v_mfma_f32_16x16x32_bf16 v[52:55], v[120:123], a[132:135], v[52:55]
 buffer_load_dwordx4 v2, s[12:15], s40 offen offset:0 sc1 lds
 v_mfma_f32_16x16x32_bf16 v[60:63], v[124:127], a[132:135], v[60:63]
 ds_read_b64_tr_b16 v[116:117], v133 offset:0
 ds_read_b64_tr_b16 v[118:119], v133 offset:1024
 v_mfma_f32_16x16x32_bf16 v[56:59], v[124:127], a[128:131], v[56:59]
 s_waitcnt vmcnt(13) lgkmcnt(8)
 v_mfma_f32_16x16x32_bf16 v[64:67], v[96:99], a[16:19], v[64:67]
 ds_read_b64_tr_b16 v[120:121], v134 offset:0
 ds_read_b64_tr_b16 v[122:123], v134 offset:1024
 v_mfma_f32_16x16x32_bf16 v[68:71], v[96:99], a[20:23], v[68:71]
 buffer_load_dwordx4 v3, s[12:15], s40 offen offset:1024 sc1 lds
 v_mfma_f32_16x16x32_bf16 v[76:79], v[100:103], a[20:23], v[76:79]
 ds_read_b64_tr_b16 v[124:125], v135 offset:0
 ds_read_b64_tr_b16 v[126:127], v135 offset:1024
 v_mfma_f32_16x16x32_bf16 v[72:75], v[100:103], a[16:19], v[72:75]
 s_mov_b32 s46, 4096
 s_waitcnt lgkmcnt(8)
 v_mfma_f32_16x16x32_bf16 v[80:83], v[104:107], a[16:19], v[80:83]
 ds_read_b64_tr_b16 v[96:97], v136 offset:20480
 ds_read_b64_tr_b16 v[98:99], v136 offset:21504
 v_mfma_f32_16x16x32_bf16 v[84:87], v[104:107], a[20:23], v[84:87]
 buffer_load_dwordx4 a[48:51], v6, s[16:19], s46 offen offset:2048 sc1
 v_mfma_f32_16x16x32_bf16 v[92:95], v[108:111], a[20:23], v[92:95]
 ds_read_b64_tr_b16 v[100:101], v137 offset:20480
 ds_read_b64_tr_b16 v[102:103], v137 offset:21504
 v_mfma_f32_16x16x32_bf16 v[88:91], v[108:111], a[16:19], v[88:91]
 s_waitcnt lgkmcnt(8)
 v_mfma_f32_16x16x32_bf16 v[32:35], v[112:115], a[136:139], v[32:35]
 ds_read_b64_tr_b16 v[104:105], v138 offset:20480
 ds_read_b64_tr_b16 v[106:107], v138 offset:21504
 v_mfma_f32_16x16x32_bf16 v[36:39], v[112:115], a[140:143], v[36:39]
 buffer_load_dwordx4 a[52:55], v7, s[16:19], s46 offen offset:2048 sc1
 v_mfma_f32_16x16x32_bf16 v[44:47], v[116:119], a[140:143], v[44:47]
 ds_read_b64_tr_b16 v[108:109], v139 offset:20480
 ds_read_b64_tr_b16 v[110:111], v139 offset:21504
 v_mfma_f32_16x16x32_bf16 v[40:43], v[116:119], a[136:139], v[40:43]
 s_mov_b32 s46, 12288
 s_waitcnt lgkmcnt(8)
 v_mfma_f32_16x16x32_bf16 v[48:51], v[120:123], a[136:139], v[48:51]
 ds_read_b64_tr_b16 v[112:113], v132 offset:4096
 ds_read_b64_tr_b16 v[114:115], v132 offset:5120
 v_mfma_f32_16x16x32_bf16 v[52:55], v[120:123], a[140:143], v[52:55]
 buffer_load_dwordx4 a[56:59], v6, s[16:19], s46 offen offset:1024 sc1
 v_mfma_f32_16x16x32_bf16 v[60:63], v[124:127], a[140:143], v[60:63]
 ds_read_b64_tr_b16 v[116:117], v133 offset:4096
 ds_read_b64_tr_b16 v[118:119], v133 offset:5120
 v_mfma_f32_16x16x32_bf16 v[56:59], v[124:127], a[136:139], v[56:59]
 s_waitcnt vmcnt(15) lgkmcnt(8)
 v_mfma_f32_16x16x32_bf16 v[64:67], v[96:99], a[24:27], v[64:67]
 ds_read_b64_tr_b16 v[120:121], v134 offset:4096
 ds_read_b64_tr_b16 v[122:123], v134 offset:5120
 v_mfma_f32_16x16x32_bf16 v[68:71], v[96:99], a[28:31], v[68:71]
 buffer_load_dwordx4 a[60:63], v7, s[16:19], s46 offen offset:1024 sc1
 v_mfma_f32_16x16x32_bf16 v[76:79], v[100:103], a[28:31], v[76:79]
 ds_read_b64_tr_b16 v[124:125], v135 offset:4096
 ds_read_b64_tr_b16 v[126:127], v135 offset:5120
 s_add_u32 m0, s45, 8192
 v_mfma_f32_16x16x32_bf16 v[72:75], v[100:103], a[24:27], v[72:75]
 s_mul_i32 s40, s42, 20
 s_add_u32 s40, s40, s53
 s_waitcnt lgkmcnt(8)
 v_mfma_f32_16x16x32_bf16 v[80:83], v[104:107], a[24:27], v[80:83]
 s_waitcnt vmcnt(12)
 s_barrier
 ds_read_b64_tr_b16 v[96:97], v136 offset:24576
 v_mfma_f32_16x16x32_bf16 v[84:87], v[104:107], a[28:31], v[84:87]
 ds_read_b64_tr_b16 v[98:99], v136 offset:25600
 buffer_load_dwordx4 v4, s[20:23], s40 offen offset:0 sc1 lds
 v_mfma_f32_16x16x32_bf16 v[92:95], v[108:111], a[28:31], v[92:95]
 ds_read_b64_tr_b16 v[100:101], v137 offset:24576
 ds_read_b64_tr_b16 v[102:103], v137 offset:25600
 v_mfma_f32_16x16x32_bf16 v[88:91], v[108:111], a[24:27], v[88:91]
 s_waitcnt lgkmcnt(8)
 v_mfma_f32_16x16x32_bf16 v[32:35], v[112:115], a[144:147], v[32:35]
 ds_read_b64_tr_b16 v[104:105], v138 offset:24576
 ds_read_b64_tr_b16 v[106:107], v138 offset:25600
 v_mfma_f32_16x16x32_bf16 v[36:39], v[112:115], a[148:151], v[36:39]
 buffer_load_dwordx4 v5, s[20:23], s40 offen offset:1024 sc1 lds
 v_mfma_f32_16x16x32_bf16 v[44:47], v[116:119], a[148:151], v[44:47]
 ds_read_b64_tr_b16 v[108:109], v139 offset:24576
 ds_read_b64_tr_b16 v[110:111], v139 offset:25600
 s_add_u32 m0, s45, 90112
 v_mfma_f32_16x16x32_bf16 v[40:43], v[116:119], a[144:147], v[40:43]
 s_mul_i32 s40, s41, 9
 s_waitcnt lgkmcnt(8)
 v_mfma_f32_16x16x32_bf16 v[48:51], v[120:123], a[144:147], v[48:51]
 ds_read_b64_tr_b16 v[112:113], v132 offset:8192
 ds_read_b64_tr_b16 v[114:115], v132 offset:9216
 v_mfma_f32_16x16x32_bf16 v[52:55], v[120:123], a[148:151], v[52:55]
 buffer_load_dwordx4 v2, s[12:15], s40 offen offset:0 sc1 lds
 v_mfma_f32_16x16x32_bf16 v[60:63], v[124:127], a[148:151], v[60:63]
 ds_read_b64_tr_b16 v[116:117], v133 offset:8192
 ds_read_b64_tr_b16 v[118:119], v133 offset:9216
 v_mfma_f32_16x16x32_bf16 v[56:59], v[124:127], a[144:147], v[56:59]
 s_waitcnt vmcnt(13) lgkmcnt(8)
 v_mfma_f32_16x16x32_bf16 v[64:67], v[96:99], a[32:35], v[64:67]
 ds_read_b64_tr_b16 v[120:121], v134 offset:8192
 ds_read_b64_tr_b16 v[122:123], v134 offset:9216
 v_mfma_f32_16x16x32_bf16 v[68:71], v[96:99], a[36:39], v[68:71]
 buffer_load_dwordx4 v3, s[12:15], s40 offen offset:1024 sc1 lds
 v_mfma_f32_16x16x32_bf16 v[76:79], v[100:103], a[36:39], v[76:79]
 ds_read_b64_tr_b16 v[124:125], v135 offset:8192
 ds_read_b64_tr_b16 v[126:127], v135 offset:9216
 v_mfma_f32_16x16x32_bf16 v[72:75], v[100:103], a[32:35], v[72:75]
 s_mov_b32 s46, 20480
 s_waitcnt lgkmcnt(8)
 v_mfma_f32_16x16x32_bf16 v[80:83], v[104:107], a[32:35], v[80:83]
 ds_read_b64_tr_b16 v[96:97], v136 offset:28672
 ds_read_b64_tr_b16 v[98:99], v136 offset:29696
 v_mfma_f32_16x16x32_bf16 v[84:87], v[104:107], a[36:39], v[84:87]
 buffer_load_dwordx4 a[64:67], v6, s[16:19], s46 offen offset:0 sc1
 v_mfma_f32_16x16x32_bf16 v[92:95], v[108:111], a[36:39], v[92:95]
 ds_read_b64_tr_b16 v[100:101], v137 offset:28672
 ds_read_b64_tr_b16 v[102:103], v137 offset:29696
 v_mfma_f32_16x16x32_bf16 v[88:91], v[108:111], a[32:35], v[88:91]
 s_waitcnt lgkmcnt(8)
 v_mfma_f32_16x16x32_bf16 v[32:35], v[112:115], a[152:155], v[32:35]
 ds_read_b64_tr_b16 v[104:105], v138 offset:28672
 ds_read_b64_tr_b16 v[106:107], v138 offset:29696
 v_mfma_f32_16x16x32_bf16 v[36:39], v[112:115], a[156:159], v[36:39]
 buffer_load_dwordx4 a[68:71], v7, s[16:19], s46 offen offset:0 sc1
 v_mfma_f32_16x16x32_bf16 v[44:47], v[116:119], a[156:159], v[44:47]
 ds_read_b64_tr_b16 v[108:109], v139 offset:28672
 ds_read_b64_tr_b16 v[110:111], v139 offset:29696
 v_mfma_f32_16x16x32_bf16 v[40:43], v[116:119], a[152:155], v[40:43]
 s_mov_b32 s46, 24576
 s_waitcnt lgkmcnt(8)
 v_mfma_f32_16x16x32_bf16 v[48:51], v[120:123], a[152:155], v[48:51]
 ds_read_b64_tr_b16 v[112:113], v132 offset:12288
 ds_read_b64_tr_b16 v[114:115], v132 offset:13312
 v_mfma_f32_16x16x32_bf16 v[52:55], v[120:123], a[156:159], v[52:55]
 buffer_load_dwordx4 a[72:75], v6, s[16:19], s46 offen offset:3072 sc1
 v_mfma_f32_16x16x32_bf16 v[60:63], v[124:127], a[156:159], v[60:63]
 ds_read_b64_tr_b16 v[116:117], v133 offset:12288
 ds_read_b64_tr_b16 v[118:119], v133 offset:13312
 v_mfma_f32_16x16x32_bf16 v[56:59], v[124:127], a[152:155], v[56:59]
 s_waitcnt vmcnt(15) lgkmcnt(8)
 v_mfma_f32_16x16x32_bf16 v[64:67], v[96:99], a[40:43], v[64:67]
 ds_read_b64_tr_b16 v[120:121], v134 offset:12288
 ds_read_b64_tr_b16 v[122:123], v134 offset:13312
 v_mfma_f32_16x16x32_bf16 v[68:71], v[96:99], a[44:47], v[68:71]
 buffer_load_dwordx4 a[76:79], v7, s[16:19], s46 offen offset:3072 sc1
 v_mfma_f32_16x16x32_bf16 v[76:79], v[100:103], a[44:47], v[76:79]
 ds_read_b64_tr_b16 v[124:125], v135 offset:12288
 ds_read_b64_tr_b16 v[126:127], v135 offset:13312
 s_add_u32 m0, s45, 16384
 v_mfma_f32_16x16x32_bf16 v[72:75], v[100:103], a[40:43], v[72:75]
 s_mul_i32 s40, s42, 34
 s_add_u32 s40, s40, s53
 s_waitcnt lgkmcnt(8)
 v_mfma_f32_16x16x32_bf16 v[80:83], v[104:107], a[40:43], v[80:83]
 s_waitcnt vmcnt(12)
 s_barrier
 ds_read_b64_tr_b16 v[96:97], v128 offset:0
 v_mfma_f32_16x16x32_bf16 v[84:87], v[104:107], a[44:47], v[84:87]
 ds_read_b64_tr_b16 v[98:99], v128 offset:1024
 buffer_load_dwordx4 v4, s[20:23], s40 offen offset:0 sc1 lds
 v_mfma_f32_16x16x32_bf16 v[92:95], v[108:111], a[44:47], v[92:95]
 ds_read_b64_tr_b16 v[100:101], v129 offset:0
 ds_read_b64_tr_b16 v[102:103], v129 offset:1024
 v_mfma_f32_16x16x32_bf16 v[88:91], v[108:111], a[40:43], v[88:91]
 s_waitcnt lgkmcnt(8)
 v_mfma_f32_16x16x32_bf16 v[32:35], v[112:115], a[160:163], v[32:35]
 ds_read_b64_tr_b16 v[104:105], v130 offset:0
 ds_read_b64_tr_b16 v[106:107], v130 offset:1024
 v_mfma_f32_16x16x32_bf16 v[36:39], v[112:115], a[164:167], v[36:39]
 buffer_load_dwordx4 v5, s[20:23], s40 offen offset:1024 sc1 lds
 v_mfma_f32_16x16x32_bf16 v[44:47], v[116:119], a[164:167], v[44:47]
 ds_read_b64_tr_b16 v[108:109], v131 offset:0
 ds_read_b64_tr_b16 v[110:111], v131 offset:1024
 s_add_u32 m0, s45, 98304
 v_mfma_f32_16x16x32_bf16 v[40:43], v[116:119], a[160:163], v[40:43]
 s_mul_i32 s40, s41, 16
 s_waitcnt lgkmcnt(8)
 v_mfma_f32_16x16x32_bf16 v[48:51], v[120:123], a[160:163], v[48:51]
 ds_read_b64_tr_b16 v[112:113], v132 offset:16384
 ds_read_b64_tr_b16 v[114:115], v132 offset:17408
 v_mfma_f32_16x16x32_bf16 v[52:55], v[120:123], a[164:167], v[52:55]
 buffer_load_dwordx4 v2, s[12:15], s40 offen offset:0 sc1 lds
 v_mfma_f32_16x16x32_bf16 v[60:63], v[124:127], a[164:167], v[60:63]
 ds_read_b64_tr_b16 v[116:117], v133 offset:16384
 ds_read_b64_tr_b16 v[118:119], v133 offset:17408
 v_mfma_f32_16x16x32_bf16 v[56:59], v[124:127], a[160:163], v[56:59]
 s_waitcnt vmcnt(13) lgkmcnt(8)
 v_mfma_f32_16x16x32_bf16 v[64:67], v[96:99], a[48:51], v[64:67]
 ds_read_b64_tr_b16 v[120:121], v134 offset:16384
 ds_read_b64_tr_b16 v[122:123], v134 offset:17408
 v_mfma_f32_16x16x32_bf16 v[68:71], v[96:99], a[52:55], v[68:71]
 buffer_load_dwordx4 v3, s[12:15], s40 offen offset:1024 sc1 lds
 v_mfma_f32_16x16x32_bf16 v[76:79], v[100:103], a[52:55], v[76:79]
 ds_read_b64_tr_b16 v[124:125], v135 offset:16384
 ds_read_b64_tr_b16 v[126:127], v135 offset:17408
 v_mfma_f32_16x16x32_bf16 v[72:75], v[100:103], a[48:51], v[72:75]
 s_mov_b32 s46, 32768
 s_waitcnt lgkmcnt(8)
 v_mfma_f32_16x16x32_bf16 v[80:83], v[104:107], a[48:51], v[80:83]
 ds_read_b64_tr_b16 v[96:97], v128 offset:4096
 ds_read_b64_tr_b16 v[98:99], v128 offset:5120
 v_mfma_f32_16x16x32_bf16 v[84:87], v[104:107], a[52:55], v[84:87]
 buffer_load_dwordx4 a[80:83], v6, s[16:19], s46 offen offset:2048 sc1
 v_mfma_f32_16x16x32_bf16 v[92:95], v[108:111], a[52:55], v[92:95]
 ds_read_b64_tr_b16 v[100:101], v129 offset:4096
 ds_read_b64_tr_b16 v[102:103], v129 offset:5120
 v_mfma_f32_16x16x32_bf16 v[88:91], v[108:111], a[48:51], v[88:91]
 s_waitcnt lgkmcnt(8)
 v_mfma_f32_16x16x32_bf16 v[32:35], v[112:115], a[168:171], v[32:35]
 ds_read_b64_tr_b16 v[104:105], v130 offset:4096
 ds_read_b64_tr_b16 v[106:107], v130 offset:5120
 v_mfma_f32_16x16x32_bf16 v[36:39], v[112:115], a[172:175], v[36:39]
 buffer_load_dwordx4 a[84:87], v7, s[16:19], s46 offen offset:2048 sc1
 v_mfma_f32_16x16x32_bf16 v[44:47], v[116:119], a[172:175], v[44:47]
 ds_read_b64_tr_b16 v[108:109], v131 offset:4096
 ds_read_b64_tr_b16 v[110:111], v131 offset:5120
 v_mfma_f32_16x16x32_bf16 v[40:43], v[116:119], a[168:171], v[40:43]
 s_mov_b32 s46, 40960
 s_waitcnt lgkmcnt(8)
 v_mfma_f32_16x16x32_bf16 v[48:51], v[120:123], a[168:171], v[48:51]
 ds_read_b64_tr_b16 v[112:113], v132 offset:20480
 ds_read_b64_tr_b16 v[114:115], v132 offset:21504
 v_mfma_f32_16x16x32_bf16 v[52:55], v[120:123], a[172:175], v[52:55]
 buffer_load_dwordx4 a[88:91], v6, s[16:19], s46 offen offset:1024 sc1
 v_mfma_f32_16x16x32_bf16 v[60:63], v[124:127], a[172:175], v[60:63]
 ds_read_b64_tr_b16 v[116:117], v133 offset:20480
 ds_read_b64_tr_b16 v[118:119], v133 offset:21504
 v_mfma_f32_16x16x32_bf16 v[56:59], v[124:127], a[168:171], v[56:59]
 s_waitcnt vmcnt(15) lgkmcnt(8)
 v_mfma_f32_16x16x32_bf16 v[64:67], v[96:99], a[56:59], v[64:67]
 ds_read_b64_tr_b16 v[120:121], v134 offset:20480
 ds_read_b64_tr_b16 v[122:123], v134 offset:21504
 v_mfma_f32_16x16x32_bf16 v[68:71], v[96:99], a[60:63], v[68:71]
 buffer_load_dwordx4 a[92:95], v7, s[16:19], s46 offen offset:1024 sc1
 v_mfma_f32_16x16x32_bf16 v[76:79], v[100:103], a[60:63], v[76:79]
 ds_read_b64_tr_b16 v[124:125], v135 offset:20480
 ds_read_b64_tr_b16 v[126:127], v135 offset:21504
 s_add_u32 m0, s45, 24576
 v_mfma_f32_16x16x32_bf16 v[72:75], v[100:103], a[56:59], v[72:75]
 s_mul_i32 s40, s42, 48
 s_add_u32 s40, s40, s53
 s_waitcnt lgkmcnt(8)
 v_mfma_f32_16x16x32_bf16 v[80:83], v[104:107], a[56:59], v[80:83]
 s_waitcnt vmcnt(12)
 s_barrier
 ds_read_b64_tr_b16 v[96:97], v128 offset:8192
 v_mfma_f32_16x16x32_bf16 v[84:87], v[104:107], a[60:63], v[84:87]
 ds_read_b64_tr_b16 v[98:99], v128 offset:9216
 buffer_load_dwordx4 v4, s[20:23], s40 offen offset:0 sc1 lds
 v_mfma_f32_16x16x32_bf16 v[92:95], v[108:111], a[60:63], v[92:95]
 ds_read_b64_tr_b16 v[100:101], v129 offset:8192
 ds_read_b64_tr_b16 v[102:103], v129 offset:9216
 v_mfma_f32_16x16x32_bf16 v[88:91], v[108:111], a[56:59], v[88:91]
 s_waitcnt lgkmcnt(8)
 v_mfma_f32_16x16x32_bf16 v[32:35], v[112:115], a[176:179], v[32:35]
 ds_read_b64_tr_b16 v[104:105], v130 offset:8192
 ds_read_b64_tr_b16 v[106:107], v130 offset:9216
 v_mfma_f32_16x16x32_bf16 v[36:39], v[112:115], a[180:183], v[36:39]
 buffer_load_dwordx4 v5, s[20:23], s40 offen offset:1024 sc1 lds
 v_mfma_f32_16x16x32_bf16 v[44:47], v[116:119], a[180:183], v[44:47]
 ds_read_b64_tr_b16 v[108:109], v131 offset:8192
 ds_read_b64_tr_b16 v[110:111], v131 offset:9216
 s_add_u32 m0, s45, 106496
 v_mfma_f32_16x16x32_bf16 v[40:43], v[116:119], a[176:179], v[40:43]
 s_mul_i32 s40, s41, 23
 s_waitcnt lgkmcnt(8)
 v_mfma_f32_16x16x32_bf16 v[48:51], v[120:123], a[176:179], v[48:51]
 ds_read_b64_tr_b16 v[112:113], v132 offset:24576
 ds_read_b64_tr_b16 v[114:115], v132 offset:25600
 v_mfma_f32_16x16x32_bf16 v[52:55], v[120:123], a[180:183], v[52:55]
 buffer_load_dwordx4 v2, s[12:15], s40 offen offset:0 sc1 lds
 v_mfma_f32_16x16x32_bf16 v[60:63], v[124:127], a[180:183], v[60:63]
 ds_read_b64_tr_b16 v[116:117], v133 offset:24576
 ds_read_b64_tr_b16 v[118:119], v133 offset:25600
 v_mfma_f32_16x16x32_bf16 v[56:59], v[124:127], a[176:179], v[56:59]
 s_waitcnt vmcnt(13) lgkmcnt(8)
 v_mfma_f32_16x16x32_bf16 v[64:67], v[96:99], a[64:67], v[64:67]
 ds_read_b64_tr_b16 v[120:121], v134 offset:24576
 ds_read_b64_tr_b16 v[122:123], v134 offset:25600
 v_mfma_f32_16x16x32_bf16 v[68:71], v[96:99], a[68:71], v[68:71]
 buffer_load_dwordx4 v3, s[12:15], s40 offen offset:1024 sc1 lds
 v_mfma_f32_16x16x32_bf16 v[76:79], v[100:103], a[68:71], v[76:79]
 ds_read_b64_tr_b16 v[124:125], v135 offset:24576
 ds_read_b64_tr_b16 v[126:127], v135 offset:25600
 v_mfma_f32_16x16x32_bf16 v[72:75], v[100:103], a[64:67], v[72:75]
 s_mov_b32 s46, 49152
 s_waitcnt lgkmcnt(8)
 v_mfma_f32_16x16x32_bf16 v[80:83], v[104:107], a[64:67], v[80:83]
 ds_read_b64_tr_b16 v[96:97], v128 offset:12288
 ds_read_b64_tr_b16 v[98:99], v128 offset:13312
 v_mfma_f32_16x16x32_bf16 v[84:87], v[104:107], a[68:71], v[84:87]
 buffer_load_dwordx4 a[96:99], v6, s[16:19], s46 offen offset:0 sc1
 v_mfma_f32_16x16x32_bf16 v[92:95], v[108:111], a[68:71], v[92:95]
 ds_read_b64_tr_b16 v[100:101], v129 offset:12288
 ds_read_b64_tr_b16 v[102:103], v129 offset:13312
 v_mfma_f32_16x16x32_bf16 v[88:91], v[108:111], a[64:67], v[88:91]
 s_waitcnt lgkmcnt(8)
 v_mfma_f32_16x16x32_bf16 v[32:35], v[112:115], a[184:187], v[32:35]
 ds_read_b64_tr_b16 v[104:105], v130 offset:12288
 ds_read_b64_tr_b16 v[106:107], v130 offset:13312
 v_mfma_f32_16x16x32_bf16 v[36:39], v[112:115], a[188:191], v[36:39]
 buffer_load_dwordx4 a[100:103], v7, s[16:19], s46 offen offset:0 sc1
 v_mfma_f32_16x16x32_bf16 v[44:47], v[116:119], a[188:191], v[44:47]
 ds_read_b64_tr_b16 v[108:109], v131 offset:12288
 ds_read_b64_tr_b16 v[110:111], v131 offset:13312
 v_mfma_f32_16x16x32_bf16 v[40:43], v[116:119], a[184:187], v[40:43]
 s_mov_b32 s46, 53248
 s_waitcnt lgkmcnt(8)
 v_mfma_f32_16x16x32_bf16 v[48:51], v[120:123], a[184:187], v[48:51]
 ds_read_b64_tr_b16 v[112:113], v132 offset:28672
 ds_read_b64_tr_b16 v[114:115], v132 offset:29696
 v_mfma_f32_16x16x32_bf16 v[52:55], v[120:123], a[188:191], v[52:55]
 buffer_load_dwordx4 a[104:107], v6, s[16:19], s46 offen offset:3072 sc1
 v_mfma_f32_16x16x32_bf16 v[60:63], v[124:127], a[188:191], v[60:63]
 ds_read_b64_tr_b16 v[116:117], v133 offset:28672
 ds_read_b64_tr_b16 v[118:119], v133 offset:29696
 v_mfma_f32_16x16x32_bf16 v[56:59], v[124:127], a[184:187], v[56:59]
 s_waitcnt vmcnt(15) lgkmcnt(8)
 v_mfma_f32_16x16x32_bf16 v[64:67], v[96:99], a[72:75], v[64:67]
 ds_read_b64_tr_b16 v[120:121], v134 offset:28672
 ds_read_b64_tr_b16 v[122:123], v134 offset:29696
 v_mfma_f32_16x16x32_bf16 v[68:71], v[96:99], a[76:79], v[68:71]
 buffer_load_dwordx4 a[108:111], v7, s[16:19], s46 offen offset:3072 sc1
 v_mfma_f32_16x16x32_bf16 v[76:79], v[100:103], a[76:79], v[76:79]
 ds_read_b64_tr_b16 v[124:125], v135 offset:28672
 ds_read_b64_tr_b16 v[126:127], v135 offset:29696
 s_add_u32 m0, s45, 114688
 v_mfma_f32_16x16x32_bf16 v[72:75], v[100:103], a[72:75], v[72:75]
 s_mul_i32 s40, s41, 30
 s_waitcnt lgkmcnt(8)
 v_mfma_f32_16x16x32_bf16 v[80:83], v[104:107], a[72:75], v[80:83]
 s_waitcnt vmcnt(12)
 s_barrier
 ds_read_b64_tr_b16 v[96:97], v128 offset:16384
 v_mfma_f32_16x16x32_bf16 v[84:87], v[104:107], a[76:79], v[84:87]
 ds_read_b64_tr_b16 v[98:99], v128 offset:17408
 buffer_load_dwordx4 v2, s[12:15], s40 offen offset:0 sc1 lds
 v_mfma_f32_16x16x32_bf16 v[92:95], v[108:111], a[76:79], v[92:95]
 ds_read_b64_tr_b16 v[100:101], v129 offset:16384
 ds_read_b64_tr_b16 v[102:103], v129 offset:17408
 v_mfma_f32_16x16x32_bf16 v[88:91], v[108:111], a[72:75], v[88:91]
 s_waitcnt lgkmcnt(8)
 v_mfma_f32_16x16x32_bf16 v[32:35], v[112:115], a[192:195], v[32:35]
 ds_read_b64_tr_b16 v[104:105], v130 offset:16384
 ds_read_b64_tr_b16 v[106:107], v130 offset:17408
 v_mfma_f32_16x16x32_bf16 v[36:39], v[112:115], a[196:199], v[36:39]
 buffer_load_dwordx4 v3, s[12:15], s40 offen offset:1024 sc1 lds
 v_mfma_f32_16x16x32_bf16 v[44:47], v[116:119], a[196:199], v[44:47]
 ds_read_b64_tr_b16 v[108:109], v131 offset:16384
 ds_read_b64_tr_b16 v[110:111], v131 offset:17408
 v_mfma_f32_16x16x32_bf16 v[40:43], v[116:119], a[192:195], v[40:43]
 s_waitcnt lgkmcnt(8)
 v_mfma_f32_16x16x32_bf16 v[48:51], v[120:123], a[192:195], v[48:51]
 ds_read_b64_tr_b16 v[112:113], v132 offset:32768
 ds_read_b64_tr_b16 v[114:115], v132 offset:33792
 v_mfma_f32_16x16x32_bf16 v[52:55], v[120:123], a[196:199], v[52:55]
 buffer_load_dwordx4 v[160:163], v12, s[84:87], 0 offen offset:0 sc1
 v_mfma_f32_16x16x32_bf16 v[60:63], v[124:127], a[196:199], v[60:63]
 ds_read_b64_tr_b16 v[116:117], v133 offset:32768
 ds_read_b64_tr_b16 v[118:119], v133 offset:33792
 v_mfma_f32_16x16x32_bf16 v[56:59], v[124:127], a[192:195], v[56:59]
 s_waitcnt vmcnt(13) lgkmcnt(8)
 v_mfma_f32_16x16x32_bf16 v[64:67], v[96:99], a[80:83], v[64:67]
 ds_read_b64_tr_b16 v[120:121], v134 offset:32768
 ds_read_b64_tr_b16 v[122:123], v134 offset:33792
 v_mfma_f32_16x16x32_bf16 v[68:71], v[96:99], a[84:87], v[68:71]
 buffer_load_dwordx4 v[164:167], v12, s[84:87], 0 offen offset:512 sc1
 v_mfma_f32_16x16x32_bf16 v[76:79], v[100:103], a[84:87], v[76:79]
 ds_read_b64_tr_b16 v[124:125], v135 offset:32768
 ds_read_b64_tr_b16 v[126:127], v135 offset:33792
 v_mfma_f32_16x16x32_bf16 v[72:75], v[100:103], a[80:83], v[72:75]
 s_waitcnt lgkmcnt(8)
 v_mfma_f32_16x16x32_bf16 v[80:83], v[104:107], a[80:83], v[80:83]
 ds_read_b64_tr_b16 v[96:97], v128 offset:20480
 ds_read_b64_tr_b16 v[98:99], v128 offset:21504
 v_mfma_f32_16x16x32_bf16 v[84:87], v[104:107], a[84:87], v[84:87]
 buffer_load_dwordx4 v[168:171], v12, s[84:87], 0 offen offset:1024 sc1
 v_mfma_f32_16x16x32_bf16 v[92:95], v[108:111], a[84:87], v[92:95]
 ds_read_b64_tr_b16 v[100:101], v129 offset:20480
 ds_read_b64_tr_b16 v[102:103], v129 offset:21504
 v_mfma_f32_16x16x32_bf16 v[88:91], v[108:111], a[80:83], v[88:91]
 s_waitcnt lgkmcnt(8)
 v_mfma_f32_16x16x32_bf16 v[32:35], v[112:115], a[200:203], v[32:35]
 ds_read_b64_tr_b16 v[104:105], v130 offset:20480
 ds_read_b64_tr_b16 v[106:107], v130 offset:21504
 v_mfma_f32_16x16x32_bf16 v[36:39], v[112:115], a[204:207], v[36:39]
 buffer_load_dwordx4 v[172:175], v12, s[84:87], 0 offen offset:1536 sc1
 v_mfma_f32_16x16x32_bf16 v[44:47], v[116:119], a[204:207], v[44:47]
 ds_read_b64_tr_b16 v[108:109], v131 offset:20480
 ds_read_b64_tr_b16 v[110:111], v131 offset:21504
 v_mfma_f32_16x16x32_bf16 v[40:43], v[116:119], a[200:203], v[40:43]
 s_waitcnt lgkmcnt(8)
 v_mfma_f32_16x16x32_bf16 v[48:51], v[120:123], a[200:203], v[48:51]
 ds_read_b64_tr_b16 v[112:113], v132 offset:36864
 ds_read_b64_tr_b16 v[114:115], v132 offset:37888
 v_mfma_f32_16x16x32_bf16 v[52:55], v[120:123], a[204:207], v[52:55]
 buffer_load_dword v10, v13, s[88:91], 0 offen sc1
 v_mfma_f32_16x16x32_bf16 v[60:63], v[124:127], a[204:207], v[60:63]
 ds_read_b64_tr_b16 v[116:117], v133 offset:36864
 ds_read_b64_tr_b16 v[118:119], v133 offset:37888
 s_add_u32 m0, s45, 122880
 v_mfma_f32_16x16x32_bf16 v[56:59], v[124:127], a[200:203], v[56:59]
 s_mul_i32 s40, s41, 37
 s_waitcnt vmcnt(15) lgkmcnt(8)
 v_mfma_f32_16x16x32_bf16 v[64:67], v[96:99], a[88:91], v[64:67]
 ds_read_b64_tr_b16 v[120:121], v134 offset:36864
 ds_read_b64_tr_b16 v[122:123], v134 offset:37888
 v_mfma_f32_16x16x32_bf16 v[68:71], v[96:99], a[92:95], v[68:71]
 buffer_load_dwordx4 v2, s[12:15], s40 offen offset:0 sc1 lds
 v_mfma_f32_16x16x32_bf16 v[76:79], v[100:103], a[92:95], v[76:79]
 ds_read_b64_tr_b16 v[124:125], v135 offset:36864
 ds_read_b64_tr_b16 v[126:127], v135 offset:37888
 v_mfma_f32_16x16x32_bf16 v[72:75], v[100:103], a[88:91], v[72:75]
 s_waitcnt lgkmcnt(8)
 v_mfma_f32_16x16x32_bf16 v[80:83], v[104:107], a[88:91], v[80:83]
 s_waitcnt vmcnt(12)
 s_barrier
 ds_read_b64_tr_b16 v[96:97], v128 offset:24576
 v_mfma_f32_16x16x32_bf16 v[84:87], v[104:107], a[92:95], v[84:87]
 ds_read_b64_tr_b16 v[98:99], v128 offset:25600
 buffer_load_dwordx4 v3, s[12:15], s40 offen offset:1024 sc1 lds
 v_mfma_f32_16x16x32_bf16 v[92:95], v[108:111], a[92:95], v[92:95]
 ds_read_b64_tr_b16 v[100:101], v129 offset:24576
 ds_read_b64_tr_b16 v[102:103], v129 offset:25600
 s_add_u32 m0, s45, 49152
 v_mfma_f32_16x16x32_bf16 v[88:91], v[108:111], a[88:91], v[88:91]
 s_mul_i32 s40, s41, 44
 s_waitcnt lgkmcnt(8)
 v_mfma_f32_16x16x32_bf16 v[32:35], v[112:115], a[208:211], v[32:35]
 ds_read_b64_tr_b16 v[104:105], v130 offset:24576
 ds_read_b64_tr_b16 v[106:107], v130 offset:25600
 v_mfma_f32_16x16x32_bf16 v[36:39], v[112:115], a[212:215], v[36:39]
 buffer_load_dwordx4 v2, s[12:15], s40 offen offset:0 sc1 lds
 v_mfma_f32_16x16x32_bf16 v[44:47], v[116:119], a[212:215], v[44:47]
 ds_read_b64_tr_b16 v[108:109], v131 offset:24576
 ds_read_b64_tr_b16 v[110:111], v131 offset:25600
 v_mfma_f32_16x16x32_bf16 v[40:43], v[116:119], a[208:211], v[40:43]
 s_waitcnt lgkmcnt(8)
 v_mfma_f32_16x16x32_bf16 v[48:51], v[120:123], a[208:211], v[48:51]
 ds_read_b64_tr_b16 v[112:113], v132 offset:40960
 ds_read_b64_tr_b16 v[114:115], v132 offset:41984
 v_mfma_f32_16x16x32_bf16 v[52:55], v[120:123], a[212:215], v[52:55]
 buffer_load_dwordx4 v3, s[12:15], s40 offen offset:1024 sc1 lds
 v_mfma_f32_16x16x32_bf16 v[60:63], v[124:127], a[212:215], v[60:63]
 ds_read_b64_tr_b16 v[116:117], v133 offset:40960
 ds_read_b64_tr_b16 v[118:119], v133 offset:41984
 s_add_u32 m0, s45, 57344
 v_mfma_f32_16x16x32_bf16 v[56:59], v[124:127], a[208:211], v[56:59]
 s_mul_i32 s40, s41, 51
 s_waitcnt vmcnt(13) lgkmcnt(8)
 v_mfma_f32_16x16x32_bf16 v[64:67], v[96:99], a[96:99], v[64:67]
 ds_read_b64_tr_b16 v[120:121], v134 offset:40960
 ds_read_b64_tr_b16 v[122:123], v134 offset:41984
 v_mfma_f32_16x16x32_bf16 v[68:71], v[96:99], a[100:103], v[68:71]
 buffer_load_dwordx4 v2, s[12:15], s40 offen offset:0 sc1 lds
 v_mfma_f32_16x16x32_bf16 v[76:79], v[100:103], a[100:103], v[76:79]
 ds_read_b64_tr_b16 v[124:125], v135 offset:40960
 ds_read_b64_tr_b16 v[126:127], v135 offset:41984
 v_mfma_f32_16x16x32_bf16 v[72:75], v[100:103], a[96:99], v[72:75]
 s_waitcnt lgkmcnt(8)
 v_mfma_f32_16x16x32_bf16 v[80:83], v[104:107], a[96:99], v[80:83]
 ds_read_b64_tr_b16 v[96:97], v128 offset:28672
 ds_read_b64_tr_b16 v[98:99], v128 offset:29696
 v_mfma_f32_16x16x32_bf16 v[84:87], v[104:107], a[100:103], v[84:87]
 buffer_load_dwordx4 v3, s[12:15], s40 offen offset:1024 sc1 lds
 v_mfma_f32_16x16x32_bf16 v[92:95], v[108:111], a[100:103], v[92:95]
 ds_read_b64_tr_b16 v[100:101], v129 offset:28672
 ds_read_b64_tr_b16 v[102:103], v129 offset:29696
 s_add_u32 m0, s45, 65536
 v_mfma_f32_16x16x32_bf16 v[88:91], v[108:111], a[96:99], v[88:91]
 s_mul_i32 s40, s41, 6
 s_add_u32 s40, s40, s52
 s_waitcnt lgkmcnt(8)
 v_mfma_f32_16x16x32_bf16 v[32:35], v[112:115], a[216:219], v[32:35]
 ds_read_b64_tr_b16 v[104:105], v130 offset:28672
 ds_read_b64_tr_b16 v[106:107], v130 offset:29696
 v_mfma_f32_16x16x32_bf16 v[36:39], v[112:115], a[220:223], v[36:39]
 buffer_load_dwordx4 v2, s[12:15], s40 offen offset:0 sc1 lds
 v_mfma_f32_16x16x32_bf16 v[44:47], v[116:119], a[220:223], v[44:47]
 ds_read_b64_tr_b16 v[108:109], v131 offset:28672
 ds_read_b64_tr_b16 v[110:111], v131 offset:29696
 v_mfma_f32_16x16x32_bf16 v[40:43], v[116:119], a[216:219], v[40:43]
 s_waitcnt lgkmcnt(8)
 v_mfma_f32_16x16x32_bf16 v[48:51], v[120:123], a[216:219], v[48:51]
 ds_read_b64_tr_b16 v[112:113], v132 offset:45056
 ds_read_b64_tr_b16 v[114:115], v132 offset:46080
 v_mfma_f32_16x16x32_bf16 v[52:55], v[120:123], a[220:223], v[52:55]
 buffer_load_dwordx4 v3, s[12:15], s40 offen offset:1024 sc1 lds
 v_mfma_f32_16x16x32_bf16 v[60:63], v[124:127], a[220:223], v[60:63]
 ds_read_b64_tr_b16 v[116:117], v133 offset:45056
 ds_read_b64_tr_b16 v[118:119], v133 offset:46080
 s_add_u32 m0, s45, 73728
 v_mfma_f32_16x16x32_bf16 v[56:59], v[124:127], a[216:219], v[56:59]
 s_mul_i32 s40, s41, 20
 s_add_u32 s40, s40, s52
 s_waitcnt vmcnt(15) lgkmcnt(8)
 v_mfma_f32_16x16x32_bf16 v[64:67], v[96:99], a[104:107], v[64:67]
 ds_read_b64_tr_b16 v[120:121], v134 offset:45056
 ds_read_b64_tr_b16 v[122:123], v134 offset:46080
 v_mfma_f32_16x16x32_bf16 v[68:71], v[96:99], a[108:111], v[68:71]
 buffer_load_dwordx4 v2, s[12:15], s40 offen offset:0 sc1 lds
 v_mfma_f32_16x16x32_bf16 v[76:79], v[100:103], a[108:111], v[76:79]
 ds_read_b64_tr_b16 v[124:125], v135 offset:45056
 ds_read_b64_tr_b16 v[126:127], v135 offset:46080
 v_mfma_f32_16x16x32_bf16 v[72:75], v[100:103], a[104:107], v[72:75]
 s_waitcnt lgkmcnt(8)
 v_mfma_f32_16x16x32_bf16 v[80:83], v[104:107], a[104:107], v[80:83]
 s_waitcnt vmcnt(14)
 s_barrier
 ds_read_b64_tr_b16 v[96:97], v132 offset:49152
 v_mfma_f32_16x16x32_bf16 v[84:87], v[104:107], a[108:111], v[84:87]
 ds_read_b64_tr_b16 v[98:99], v132 offset:50176
 buffer_load_dwordx4 v3, s[12:15], s40 offen offset:1024 sc1 lds
 v_mfma_f32_16x16x32_bf16 v[92:95], v[108:111], a[108:111], v[92:95]
 ds_read_b64_tr_b16 v[100:101], v133 offset:49152
 ds_read_b64_tr_b16 v[102:103], v133 offset:50176
 s_add_u32 m0, s45, 81920
 v_mfma_f32_16x16x32_bf16 v[88:91], v[108:111], a[104:107], v[88:91]
 s_mul_i32 s40, s41, 34
 s_add_u32 s40, s40, s52
 s_waitcnt lgkmcnt(8)
 v_mfma_f32_16x16x32_bf16 v[32:35], v[112:115], a[224:227], v[32:35]
 ds_read_b64_tr_b16 v[104:105], v134 offset:49152
 ds_read_b64_tr_b16 v[106:107], v134 offset:50176
 v_mfma_f32_16x16x32_bf16 v[36:39], v[112:115], a[228:231], v[36:39]
 buffer_load_dwordx4 v2, s[12:15], s40 offen offset:0 sc1 lds
 s_waitcnt vmcnt(11)
 v_mfma_f32_16x16x32_bf16 v[44:47], v[116:119], a[228:231], v[44:47]
 ds_read_b64_tr_b16 v[108:109], v135 offset:49152
 ds_read_b64_tr_b16 v[110:111], v135 offset:50176
 v_cvt_pk_bf16_f32 v64, v64, v65
 v_cvt_pk_bf16_f32 v65, v66, v67
 v_cvt_pk_bf16_f32 v66, v68, v69
 s_branch m_ps_p4_3
m_pad_p4_3:
 s_branch m_reta_p4
m_ps_p4_3:
 v_mfma_f32_16x16x32_bf16 v[40:43], v[116:119], a[224:227], v[40:43]
 v_cvt_pk_bf16_f32 v67, v70, v71
 v_min_u32 v64, -2, v64
 v_min_u32 v65, -2, v65
 s_waitcnt lgkmcnt(8)
 v_mfma_f32_16x16x32_bf16 v[48:51], v[120:123], a[224:227], v[48:51]
 ds_read_b64_tr_b16 v[112:113], v132 offset:53248
 ds_read_b64_tr_b16 v[114:115], v132 offset:54272
 v_min_u32 v66, -2, v66
 v_min_u32 v67, -2, v67
 s_nop 0
 v_mfma_f32_16x16x32_bf16 v[52:55], v[120:123], a[228:231], v[52:55]
 buffer_load_dwordx4 v3, s[12:15], s40 offen offset:1024 sc1 lds
 v_permlane16_swap_b32 v64, v66
 v_permlane16_swap_b32 v65, v67
 buffer_store_dwordx4 v[64:67], v6, s[92:95], s47 offen offset:0 sc1
 v_cvt_pk_bf16_f32 v72, v72, v73
 v_mfma_f32_16x16x32_bf16 v[60:63], v[124:127], a[228:231], v[60:63]
 ds_read_b64_tr_b16 v[116:117], v133 offset:53248
 ds_read_b64_tr_b16 v[118:119], v133 offset:54272
 s_add_u32 m0, s45, 90112
 v_cvt_pk_bf16_f32 v73, v74, v75
 v_mfma_f32_16x16x32_bf16 v[56:59], v[124:127], a[224:227], v[56:59]
 s_mul_i32 s40, s41, 48
 s_add_u32 s40, s40, s52
 v_cvt_pk_bf16_f32 v74, v76, v77
 v_cvt_pk_bf16_f32 v75, v78, v79
 v_min_u32 v72, -2, v72
 s_waitcnt lgkmcnt(8)
 v_mfma_f32_16x16x32_bf16 v[32:35], v[96:99], a[232:235], v[32:35]
 ds_read_b64_tr_b16 v[120:121], v134 offset:53248
 ds_read_b64_tr_b16 v[122:123], v134 offset:54272
 v_min_u32 v73, -2, v73
 v_min_u32 v74, -2, v74
 v_min_u32 v75, -2, v75
 v_mfma_f32_16x16x32_bf16 v[36:39], v[96:99], a[236:239], v[36:39]
 buffer_load_dwordx4 v2, s[12:15], s40 offen offset:0 sc1 lds
 s_nop 0
 v_permlane16_swap_b32 v72, v74
 v_permlane16_swap_b32 v73, v75
 buffer_store_dwordx4 v[72:75], v6, s[92:95], s47 offen offset:1024 sc1
 v_mfma_f32_16x16x32_bf16 v[44:47], v[100:103], a[236:239], v[44:47]
 ds_read_b64_tr_b16 v[124:125], v135 offset:53248
 ds_read_b64_tr_b16 v[126:127], v135 offset:54272
 v_cvt_pk_bf16_f32 v80, v80, v81
 v_cvt_pk_bf16_f32 v81, v82, v83
 v_mfma_f32_16x16x32_bf16 v[40:43], v[100:103], a[232:235], v[40:43]
 v_cvt_pk_bf16_f32 v82, v84, v85
 v_cvt_pk_bf16_f32 v83, v86, v87
 v_min_u32 v80, -2, v80
 v_min_u32 v81, -2, v81
 s_waitcnt lgkmcnt(8)
 v_mfma_f32_16x16x32_bf16 v[48:51], v[104:107], a[232:235], v[48:51]
 s_waitcnt vmcnt(13)
 s_barrier
 ds_read_b64_tr_b16 v[96:97], v132 offset:57344
 v_min_u32 v82, -2, v82
 v_min_u32 v83, -2, v83
 v_mfma_f32_16x16x32_bf16 v[52:55], v[104:107], a[236:239], v[52:55]
 ds_read_b64_tr_b16 v[98:99], v132 offset:58368
 buffer_load_dwordx4 v3, s[12:15], s40 offen offset:1024 sc1 lds
 s_nop 0
 v_permlane16_swap_b32 v80, v82
 v_mfma_f32_16x16x32_bf16 v[60:63], v[108:111], a[236:239], v[60:63]
 ds_read_b64_tr_b16 v[100:101], v133 offset:57344
 ds_read_b64_tr_b16 v[102:103], v133 offset:58368
 v_permlane16_swap_b32 v81, v83
 buffer_store_dwordx4 v[80:83], v6, s[92:95], s47 offen offset:2048 sc1
 v_cvt_pk_bf16_f32 v88, v88, v89
 v_mfma_f32_16x16x32_bf16 v[56:59], v[108:111], a[232:235], v[56:59]
 v_cvt_pk_bf16_f32 v89, v90, v91
 v_cvt_pk_bf16_f32 v90, v92, v93
 v_cvt_pk_bf16_f32 v91, v94, v95
 v_min_u32 v88, -2, v88
 s_waitcnt lgkmcnt(8)
 v_mfma_f32_16x16x32_bf16 v[32:35], v[112:115], a[240:243], v[32:35]
 ds_read_b64_tr_b16 v[104:105], v134 offset:57344
 ds_read_b64_tr_b16 v[106:107], v134 offset:58368
 v_min_u32 v89, -2, v89
 v_min_u32 v90, -2, v90
 v_mfma_f32_16x16x32_bf16 v[36:39], v[112:115], a[244:247], v[36:39]
 v_min_u32 v91, -2, v91
 s_nop 0
 v_permlane16_swap_b32 v88, v90
 v_permlane16_swap_b32 v89, v91
 buffer_store_dwordx4 v[88:91], v6, s[92:95], s47 offen offset:3072 sc1
 v_mfma_f32_16x16x32_bf16 v[44:47], v[116:119], a[244:247], v[44:47]
 ds_read_b64_tr_b16 v[108:109], v135 offset:57344
 ds_read_b64_tr_b16 v[110:111], v135 offset:58368
 v_mfma_f32_16x16x32_bf16 v[40:43], v[116:119], a[240:243], v[40:43]
 s_waitcnt lgkmcnt(8)
 v_mfma_f32_16x16x32_bf16 v[48:51], v[120:123], a[240:243], v[48:51]
 ds_read_b64_tr_b16 v[112:113], v132 offset:61440
 ds_read_b64_tr_b16 v[114:115], v132 offset:62464
 v_mfma_f32_16x16x32_bf16 v[52:55], v[120:123], a[244:247], v[52:55]
 v_lshlrev_b32 v176, 16, v160
 v_and_b32 v177, 0xffff0000, v160
 v_mfma_f32_16x16x32_bf16 v[60:63], v[124:127], a[244:247], v[60:63]
 ds_read_b64_tr_b16 v[116:117], v133 offset:61440
 ds_read_b64_tr_b16 v[118:119], v133 offset:62464
 v_mfma_f32_16x16x32_bf16 v[56:59], v[124:127], a[240:243], v[56:59]
 v_lshlrev_b32 v178, 16, v161
 s_waitcnt lgkmcnt(8)
 v_mfma_f32_16x16x32_bf16 v[32:35], v[96:99], a[0:3], v[32:35]
 ds_read_b64_tr_b16 v[120:121], v134 offset:61440
 ds_read_b64_tr_b16 v[122:123], v134 offset:62464
 v_mfma_f32_16x16x32_bf16 v[36:39], v[96:99], a[4:7], v[36:39]
 v_and_b32 v179, 0xffff0000, v161
 v_lshlrev_b32 v180, 16, v162
 v_and_b32 v181, 0xffff0000, v162
 v_mfma_f32_16x16x32_bf16 v[44:47], v[100:103], a[4:7], v[44:47]
 ds_read_b64_tr_b16 v[124:125], v135 offset:61440
 ds_read_b64_tr_b16 v[126:127], v135 offset:62464
 v_mfma_f32_16x16x32_bf16 v[40:43], v[100:103], a[0:3], v[40:43]
 v_lshlrev_b32 v182, 16, v163
 s_waitcnt lgkmcnt(8)
 v_mfma_f32_16x16x32_bf16 v[48:51], v[104:107], a[0:3], v[48:51]
 s_waitcnt vmcnt(14)
 s_barrier
 ds_read_b64_tr_b16 v[96:97], v128 offset:49152
 v_mfma_f32_16x16x32_bf16 v[52:55], v[104:107], a[4:7], v[52:55]
 ds_read_b64_tr_b16 v[98:99], v128 offset:50176
 v_mfma_f32_16x16x32_bf16 v[60:63], v[108:111], a[4:7], v[60:63]
 ds_read_b64_tr_b16 v[100:101], v129 offset:49152
 ds_read_b64_tr_b16 v[102:103], v129 offset:50176
 v_mfma_f32_16x16x32_bf16 v[56:59], v[108:111], a[0:3], v[56:59]
 v_and_b32 v183, 0xffff0000, v163
 s_waitcnt lgkmcnt(8)
 v_mfma_f32_16x16x32_bf16 v[32:35], v[112:115], a[8:11], v[32:35]
 ds_read_b64_tr_b16 v[104:105], v130 offset:49152
 ds_read_b64_tr_b16 v[106:107], v130 offset:50176
 v_mfma_f32_16x16x32_bf16 v[36:39], v[112:115], a[12:15], v[36:39]
 v_lshlrev_b32 v184, 16, v164
 v_and_b32 v185, 0xffff0000, v164
 v_mfma_f32_16x16x32_bf16 v[44:47], v[116:119], a[12:15], v[44:47]
 ds_read_b64_tr_b16 v[108:109], v131 offset:49152
 ds_read_b64_tr_b16 v[110:111], v131 offset:50176
 v_mfma_f32_16x16x32_bf16 v[40:43], v[116:119], a[8:11], v[40:43]
 v_lshlrev_b32 v186, 16, v165
 s_waitcnt lgkmcnt(8)
 v_mfma_f32_16x16x32_bf16 v[48:51], v[120:123], a[8:11], v[48:51]
 ds_read_b64_tr_b16 v[112:113], v128 offset:53248
 ds_read_b64_tr_b16 v[114:115], v128 offset:54272
 v_mfma_f32_16x16x32_bf16 v[52:55], v[120:123], a[12:15], v[52:55]
 v_and_b32 v187, 0xffff0000, v165
 v_lshlrev_b32 v188, 16, v166
 v_and_b32 v189, 0xffff0000, v166
 v_mfma_f32_16x16x32_bf16 v[60:63], v[124:127], a[12:15], v[60:63]
 ds_read_b64_tr_b16 v[116:117], v129 offset:53248
 ds_read_b64_tr_b16 v[118:119], v129 offset:54272
 v_mfma_f32_16x16x32_bf16 v[56:59], v[124:127], a[8:11], v[56:59]
 v_lshlrev_b32 v190, 16, v167
 s_waitcnt lgkmcnt(8)
 v_mfma_f32_16x16x32_bf16 v[32:35], v[96:99], a[16:19], v[32:35]
 ds_read_b64_tr_b16 v[120:121], v130 offset:53248
 ds_read_b64_tr_b16 v[122:123], v130 offset:54272
 v_mfma_f32_16x16x32_bf16 v[36:39], v[96:99], a[20:23], v[36:39]
 v_and_b32 v191, 0xffff0000, v167
 v_lshlrev_b32 v192, 16, v168
 v_mfma_f32_16x16x32_bf16 v[44:47], v[100:103], a[20:23], v[44:47]
 ds_read_b64_tr_b16 v[124:125], v131 offset:53248
 ds_read_b64_tr_b16 v[126:127], v131 offset:54272
 v_mfma_f32_16x16x32_bf16 v[40:43], v[100:103], a[16:19], v[40:43]
 v_and_b32 v193, 0xffff0000, v168
 s_waitcnt lgkmcnt(8)
 v_mfma_f32_16x16x32_bf16 v[48:51], v[104:107], a[16:19], v[48:51]
 s_waitcnt vmcnt(12)
 s_barrier
 ds_read_b64_tr_b16 v[96:97], v128 offset:57344
 v_mfma_f32_16x16x32_bf16 v[52:55], v[104:107], a[20:23], v[52:55]
 ds_read_b64_tr_b16 v[98:99], v128 offset:58368
 v_mfma_f32_16x16x32_bf16 v[60:63], v[108:111], a[20:23], v[60:63]
 ds_read_b64_tr_b16 v[100:101], v129 offset:57344
 ds_read_b64_tr_b16 v[102:103], v129 offset:58368
 v_mfma_f32_16x16x32_bf16 v[56:59], v[108:111], a[16:19], v[56:59]
 v_lshlrev_b32 v194, 16, v169
 s_waitcnt lgkmcnt(8)
 v_mfma_f32_16x16x32_bf16 v[32:35], v[112:115], a[24:27], v[32:35]
 ds_read_b64_tr_b16 v[104:105], v130 offset:57344
 ds_read_b64_tr_b16 v[106:107], v130 offset:58368
 v_and_b32 v195, 0xffff0000, v169
 v_mfma_f32_16x16x32_bf16 v[36:39], v[112:115], a[28:31], v[36:39]
 v_lshlrev_b32 v196, 16, v170
 v_and_b32 v197, 0xffff0000, v170
 v_mfma_f32_16x16x32_bf16 v[44:47], v[116:119], a[28:31], v[44:47]
 ds_read_b64_tr_b16 v[108:109], v131 offset:57344
 ds_read_b64_tr_b16 v[110:111], v131 offset:58368
 v_mfma_f32_16x16x32_bf16 v[40:43], v[116:119], a[24:27], v[40:43]
 v_lshlrev_b32 v198, 16, v171
 s_waitcnt lgkmcnt(8)
 v_mfma_f32_16x16x32_bf16 v[48:51], v[120:123], a[24:27], v[48:51]
 ds_read_b64_tr_b16 v[112:113], v128 offset:61440
 ds_read_b64_tr_b16 v[114:115], v128 offset:62464
 v_mfma_f32_16x16x32_bf16 v[52:55], v[120:123], a[28:31], v[52:55]
 v_and_b32 v199, 0xffff0000, v171
 v_lshlrev_b32 v200, 16, v172
 v_mfma_f32_16x16x32_bf16 v[60:63], v[124:127], a[28:31], v[60:63]
 ds_read_b64_tr_b16 v[116:117], v129 offset:61440
 ds_read_b64_tr_b16 v[118:119], v129 offset:62464
 v_mfma_f32_16x16x32_bf16 v[56:59], v[124:127], a[24:27], v[56:59]
 v_and_b32 v201, 0xffff0000, v172
 s_waitcnt lgkmcnt(8)
 v_mfma_f32_16x16x32_bf16 v[32:35], v[96:99], a[32:35], v[32:35]
 ds_read_b64_tr_b16 v[120:121], v130 offset:61440
 ds_read_b64_tr_b16 v[122:123], v130 offset:62464
 v_mfma_f32_16x16x32_bf16 v[36:39], v[96:99], a[36:39], v[36:39]
 v_lshlrev_b32 v202, 16, v173
 v_and_b32 v203, 0xffff0000, v173
 v_mfma_f32_16x16x32_bf16 v[44:47], v[100:103], a[36:39], v[44:47]
 ds_read_b64_tr_b16 v[124:125], v131 offset:61440
 ds_read_b64_tr_b16 v[126:127], v131 offset:62464
 v_mfma_f32_16x16x32_bf16 v[40:43], v[100:103], a[32:35], v[40:43]
 v_lshlrev_b32 v204, 16, v174
 v_and_b32 v205, 0xffff0000, v174
 s_waitcnt lgkmcnt(8)
 v_mfma_f32_16x16x32_bf16 v[48:51], v[104:107], a[32:35], v[48:51]
 s_waitcnt vmcnt(10)
 s_barrier
 ds_read_b64_tr_b16 v[96:97], v132 offset:0
 v_mfma_f32_16x16x32_bf16 v[52:55], v[104:107], a[36:39], v[52:55]
 ds_read_b64_tr_b16 v[98:99], v132 offset:1024
 v_mfma_f32_16x16x32_bf16 v[60:63], v[108:111], a[36:39], v[60:63]
 ds_read_b64_tr_b16 v[100:101], v133 offset:0
 ds_read_b64_tr_b16 v[102:103], v133 offset:1024
 v_mfma_f32_16x16x32_bf16 v[56:59], v[108:111], a[32:35], v[56:59]
 v_lshlrev_b32 v206, 16, v175
 s_waitcnt lgkmcnt(8)
 v_mfma_f32_16x16x32_bf16 v[32:35], v[112:115], a[40:43], v[32:35]
 ds_read_b64_tr_b16 v[104:105], v134 offset:0
 ds_read_b64_tr_b16 v[106:107], v134 offset:1024
 v_mfma_f32_16x16x32_bf16 v[36:39], v[112:115], a[44:47], v[36:39]
 v_and_b32 v207, 0xffff0000, v175
 v_add_f32 v176, v176, v10
 v_mfma_f32_16x16x32_bf16 v[44:47], v[116:119], a[44:47], v[44:47]
 ds_read_b64_tr_b16 v[108:109], v135 offset:0
 ds_read_b64_tr_b16 v[110:111], v135 offset:1024
 v_mfma_f32_16x16x32_bf16 v[40:43], v[116:119], a[40:43], v[40:43]
 v_add_f32 v177, v177, v10
 s_waitcnt lgkmcnt(8)
 v_mfma_f32_16x16x32_bf16 v[48:51], v[120:123], a[40:43], v[48:51]
 ds_read_b64_tr_b16 v[112:113], v132 offset:4096
 ds_read_b64_tr_b16 v[114:115], v132 offset:5120
 v_mfma_f32_16x16x32_bf16 v[52:55], v[120:123], a[44:47], v[52:55]
 v_add_f32 v178, v178, v10
 v_add_f32 v179, v179, v10
 v_mfma_f32_16x16x32_bf16 v[60:63], v[124:127], a[44:47], v[60:63]
 ds_read_b64_tr_b16 v[116:117], v133 offset:4096
 ds_read_b64_tr_b16 v[118:119], v133 offset:5120
 v_mfma_f32_16x16x32_bf16 v[56:59], v[124:127], a[40:43], v[56:59]
 v_add_f32 v180, v180, v10
 v_add_f32 v181, v181, v10
 s_waitcnt lgkmcnt(8)
 v_mfma_f32_16x16x32_bf16 v[32:35], v[96:99], a[48:51], v[32:35]
 ds_read_b64_tr_b16 v[120:121], v134 offset:4096
 ds_read_b64_tr_b16 v[122:123], v134 offset:5120
 v_mfma_f32_16x16x32_bf16 v[36:39], v[96:99], a[52:55], v[36:39]
 v_add_f32 v182, v182, v10
 v_add_f32 v183, v183, v10
 v_mfma_f32_16x16x32_bf16 v[44:47], v[100:103], a[52:55], v[44:47]
 ds_read_b64_tr_b16 v[124:125], v135 offset:4096
 ds_read_b64_tr_b16 v[126:127], v135 offset:5120
 v_mfma_f32_16x16x32_bf16 v[40:43], v[100:103], a[48:51], v[40:43]
 v_add_f32 v184, v184, v10
 buffer_load_dwordx4 v[144:147], v6, s[92:95], s44 offen offset:0 sc1
 s_waitcnt lgkmcnt(8)
 v_mfma_f32_16x16x32_bf16 v[48:51], v[104:107], a[48:51], v[48:51]
 s_waitcnt vmcnt(9)
 s_barrier
 ds_read_b64_tr_b16 v[96:97], v132 offset:8192
 v_mfma_f32_16x16x32_bf16 v[52:55], v[104:107], a[52:55], v[52:55]
 ds_read_b64_tr_b16 v[98:99], v132 offset:9216
 buffer_load_dwordx4 v[148:151], v6, s[92:95], s44 offen offset:1024 sc1
 v_mfma_f32_16x16x32_bf16 v[60:63], v[108:111], a[52:55], v[60:63]
 ds_read_b64_tr_b16 v[100:101], v133 offset:8192
 ds_read_b64_tr_b16 v[102:103], v133 offset:9216
 v_mfma_f32_16x16x32_bf16 v[56:59], v[108:111], a[48:51], v[56:59]
 v_add_f32 v185, v185, v10
 buffer_load_dwordx4 v[152:155], v6, s[92:95], s44 offen offset:2048 sc1
 s_waitcnt lgkmcnt(8)
 v_mfma_f32_16x16x32_bf16 v[32:35], v[112:115], a[56:59], v[32:35]
 ds_read_b64_tr_b16 v[104:105], v134 offset:8192
 ds_read_b64_tr_b16 v[106:107], v134 offset:9216
 v_mfma_f32_16x16x32_bf16 v[36:39], v[112:115], a[60:63], v[36:39]
 v_add_f32 v186, v186, v10
 v_add_f32 v187, v187, v10
 buffer_load_dwordx4 v[156:159], v6, s[92:95], s44 offen offset:3072 sc1
 v_mfma_f32_16x16x32_bf16 v[44:47], v[116:119], a[60:63], v[44:47]
 ds_read_b64_tr_b16 v[108:109], v135 offset:8192
 ds_read_b64_tr_b16 v[110:111], v135 offset:9216
 v_add_f32 v188, v188, v10
 v_mfma_f32_16x16x32_bf16 v[40:43], v[116:119], a[56:59], v[40:43]
 v_add_f32 v189, v189, v10
 s_waitcnt lgkmcnt(8)
 v_mfma_f32_16x16x32_bf16 v[48:51], v[120:123], a[56:59], v[48:51]
 ds_read_b64_tr_b16 v[112:113], v132 offset:12288
 ds_read_b64_tr_b16 v[114:115], v132 offset:13312
 v_mfma_f32_16x16x32_bf16 v[52:55], v[120:123], a[60:63], v[52:55]
 v_add_f32 v190, v190, v10
 v_add_f32 v191, v191, v10
 v_mfma_f32_16x16x32_bf16 v[60:63], v[124:127], a[60:63], v[60:63]
 ds_read_b64_tr_b16 v[116:117], v133 offset:12288
 ds_read_b64_tr_b16 v[118:119], v133 offset:13312
 v_mfma_f32_16x16x32_bf16 v[56:59], v[124:127], a[56:59], v[56:59]
 v_add_f32 v192, v192, v10
 s_waitcnt lgkmcnt(8)
 v_mfma_f32_16x16x32_bf16 v[32:35], v[96:99], a[64:67], v[32:35]
 ds_read_b64_tr_b16 v[120:121], v134 offset:12288
 ds_read_b64_tr_b16 v[122:123], v134 offset:13312
 v_mfma_f32_16x16x32_bf16 v[36:39], v[96:99], a[68:71], v[36:39]
 v_add_f32 v193, v193, v10
 v_add_f32 v194, v194, v10
 v_mfma_f32_16x16x32_bf16 v[44:47], v[100:103], a[68:71], v[44:47]
 ds_read_b64_tr_b16 v[124:125], v135 offset:12288
 ds_read_b64_tr_b16 v[126:127], v135 offset:13312
 v_mfma_f32_16x16x32_bf16 v[40:43], v[100:103], a[64:67], v[40:43]
 v_add_f32 v195, v195, v10
 s_waitcnt lgkmcnt(8)
 v_mfma_f32_16x16x32_bf16 v[48:51], v[104:107], a[64:67], v[48:51]
 s_waitcnt vmcnt(10)
 s_barrier
 ds_read_b64_tr_b16 v[96:97], v132 offset:16384
 v_mfma_f32_16x16x32_bf16 v[52:55], v[104:107], a[68:71], v[52:55]
 ds_read_b64_tr_b16 v[98:99], v132 offset:17408
 v_add_f32 v196, v196, v10
 v_mfma_f32_16x16x32_bf16 v[60:63], v[108:111], a[68:71], v[60:63]
 ds_read_b64_tr_b16 v[100:101], v133 offset:16384
 ds_read_b64_tr_b16 v[102:103], v133 offset:17408
 v_mfma_f32_16x16x32_bf16 v[56:59], v[108:111], a[64:67], v[56:59]
 v_add_f32 v197, v197, v10
 s_waitcnt lgkmcnt(8)
 v_mfma_f32_16x16x32_bf16 v[32:35], v[112:115], a[72:75], v[32:35]
 ds_read_b64_tr_b16 v[104:105], v134 offset:16384
 ds_read_b64_tr_b16 v[106:107], v134 offset:17408
 v_mfma_f32_16x16x32_bf16 v[36:39], v[112:115], a[76:79], v[36:39]
 v_add_f32 v198, v198, v10
 v_add_f32 v199, v199, v10
 v_mfma_f32_16x16x32_bf16 v[44:47], v[116:119], a[76:79], v[44:47]
 ds_read_b64_tr_b16 v[108:109], v135 offset:16384
 ds_read_b64_tr_b16 v[110:111], v135 offset:17408
 v_mfma_f32_16x16x32_bf16 v[40:43], v[116:119], a[72:75], v[40:43]
 v_add_f32 v200, v200, v10
 s_waitcnt lgkmcnt(8)
 v_mfma_f32_16x16x32_bf16 v[48:51], v[120:123], a[72:75], v[48:51]
 ds_read_b64_tr_b16 v[112:113], v132 offset:20480
 ds_read_b64_tr_b16 v[114:115], v132 offset:21504
 v_mfma_f32_16x16x32_bf16 v[52:55], v[120:123], a[76:79], v[52:55]
 v_add_f32 v201, v201, v10
 v_add_f32 v202, v202, v10
 v_mfma_f32_16x16x32_bf16 v[60:63], v[124:127], a[76:79], v[60:63]
 ds_read_b64_tr_b16 v[116:117], v133 offset:20480
 ds_read_b64_tr_b16 v[118:119], v133 offset:21504
 v_mfma_f32_16x16x32_bf16 v[56:59], v[124:127], a[72:75], v[56:59]
 v_add_f32 v203, v203, v10
 s_waitcnt lgkmcnt(8)
 v_mfma_f32_16x16x32_bf16 v[32:35], v[96:99], a[80:83], v[32:35]
 ds_read_b64_tr_b16 v[120:121], v134 offset:20480
 ds_read_b64_tr_b16 v[122:123], v134 offset:21504
 v_mfma_f32_16x16x32_bf16 v[36:39], v[96:99], a[84:87], v[36:39]
 v_add_f32 v204, v204, v10
 v_add_f32 v205, v205, v10
 v_add_f32 v206, v206, v10
 v_mfma_f32_16x16x32_bf16 v[44:47], v[100:103], a[84:87], v[44:47]
 ds_read_b64_tr_b16 v[124:125], v135 offset:20480
 ds_read_b64_tr_b16 v[126:127], v135 offset:21504
 v_mfma_f32_16x16x32_bf16 v[40:43], v[100:103], a[80:83], v[40:43]
 v_add_f32 v207, v207, v10
 s_waitcnt lgkmcnt(8)
 v_mfma_f32_16x16x32_bf16 v[48:51], v[104:107], a[80:83], v[48:51]
 s_waitcnt vmcnt(6)
 s_barrier
 ds_read_b64_tr_b16 v[96:97], v132 offset:24576
 v_mfma_f32_16x16x32_bf16 v[52:55], v[104:107], a[84:87], v[52:55]
 ds_read_b64_tr_b16 v[98:99], v132 offset:25600
 v_mfma_f32_16x16x32_bf16 v[60:63], v[108:111], a[84:87], v[60:63]
 ds_read_b64_tr_b16 v[100:101], v133 offset:24576
 ds_read_b64_tr_b16 v[102:103], v133 offset:25600
 v_mfma_f32_16x16x32_bf16 v[56:59], v[108:111], a[80:83], v[56:59]
 s_waitcnt vmcnt(0)
 s_mov_b32 s48, 0
L_xpoll:
 v_max3_u32 v14, v144, v145, v146
 v_max3_u32 v14, v14, v147, v148
 v_max3_u32 v14, v14, v149, v150
 v_max3_u32 v14, v14, v151, v152
 v_max3_u32 v14, v14, v153, v154
 v_max3_u32 v14, v14, v155, v156
 v_max3_u32 v14, v14, v157, v158
 v_max_u32 v14, v14, v159
 v_cmp_eq_u32 vcc, -1, v14
 s_add_u32 s48, s48, 1
 s_cbranch_vccz L_xgot
 s_cmp_gt_u32 s48, 0x40000
 s_cbranch_scc1 L_xgot
 buffer_load_dwordx4 v[144:147], v6, s[92:95], s44 offen offset:0 sc1
 buffer_load_dwordx4 v[148:151], v6, s[92:95], s44 offen offset:1024 sc1
 buffer_load_dwordx4 v[152:155], v6, s[92:95], s44 offen offset:2048 sc1
 buffer_load_dwordx4 v[156:159], v6, s[92:95], s44 offen offset:3072 sc1
 s_waitcnt vmcnt(0)
 s_branch L_xpoll
L_xgot:
 s_waitcnt lgkmcnt(8)
 v_mfma_f32_16x16x32_bf16 v[32:35], v[112:115], a[88:91], v[32:35]
 ds_read_b64_tr_b16 v[104:105], v134 offset:24576
 ds_read_b64_tr_b16 v[106:107], v134 offset:25600
 v_lshlrev_b32 v14, 16, v144
 v_mfma_f32_16x16x32_bf16 v[36:39], v[112:115], a[92:95], v[36:39]
 v_and_b32 v15, 0xffff0000, v144
 v_add_f32 v176, v176, v14
 v_add_f32 v177, v177, v15
 v_lshlrev_b32 v14, 16, v145
 v_mfma_f32_16x16x32_bf16 v[44:47], v[116:119], a[92:95], v[44:47]
 ds_read_b64_tr_b16 v[108:109], v135 offset:24576
 ds_read_b64_tr_b16 v[110:111], v135 offset:25600
 v_and_b32 v15, 0xffff0000, v145
 v_mfma_f32_16x16x32_bf16 v[40:43], v[116:119], a[88:91], v[40:43]
 v_add_f32 v178, v178, v14
 v_add_f32 v179, v179, v15
 v_lshlrev_b32 v14, 16, v146
 s_waitcnt lgkmcnt(8)
 v_mfma_f32_16x16x32_bf16 v[48:51], v[120:123], a[88:91], v[48:51]
 ds_read_b64_tr_b16 v[112:113], v132 offset:28672
 ds_read_b64_tr_b16 v[114:115], v132 offset:29696
 v_and_b32 v15, 0xffff0000, v146
 v_mfma_f32_16x16x32_bf16 v[52:55], v[120:123], a[92:95], v[52:55]
 v_add_f32 v180, v180, v14
 v_add_f32 v181, v181, v15
 v_lshlrev_b32 v14, 16, v147
 v_mfma_f32_16x16x32_bf16 v[60:63], v[124:127], a[92:95], v[60:63]
 ds_read_b64_tr_b16 v[116:117], v133 offset:28672
 ds_read_b64_tr_b16 v[118:119], v133 offset:29696
 v_and_b32 v15, 0xffff0000, v147
 v_add_f32 v182, v182, v14
 v_mfma_f32_16x16x32_bf16 v[56:59], v[124:127], a[88:91], v[56:59]
 v_add_f32 v183, v183, v15
 v_lshlrev_b32 v14, 16, v148
 s_waitcnt lgkmcnt(8)
 v_mfma_f32_16x16x32_bf16 v[32:35], v[96:99], a[96:99], v[32:35]
 ds_read_b64_tr_b16 v[120:121], v134 offset:28672
 ds_read_b64_tr_b16 v[122:123], v134 offset:29696
 v_and_b32 v15, 0xffff0000, v148
 v_mfma_f32_16x16x32_bf16 v[36:39], v[96:99], a[100:103], v[36:39]
 v_add_f32 v184, v184, v14
 v_add_f32 v185, v185, v15
 v_lshlrev_b32 v14, 16, v149
 v_and_b32 v15, 0xffff0000, v149
 v_mfma_f32_16x16x32_bf16 v[44:47], v[100:103], a[100:103], v[44:47]
 ds_read_b64_tr_b16 v[124:125], v135 offset:28672
 ds_read_b64_tr_b16 v[126:127], v135 offset:29696
 v_add_f32 v186, v186, v14
 v_mfma_f32_16x16x32_bf16 v[40:43], v[100:103], a[96:99], v[40:43]
 v_add_f32 v187, v187, v15
 v_lshlrev_b32 v14, 16, v150
 v_and_b32 v15, 0xffff0000, v150
 s_waitcnt lgkmcnt(8)
 v_mfma_f32_16x16x32_bf16 v[48:51], v[104:107], a[96:99], v[48:51]
 v_add_f32 v188, v188, v14
 v_add_f32 v189, v189, v15
 v_lshlrev_b32 v14, 16, v151
 v_mfma_f32_16x16x32_bf16 v[52:55], v[104:107], a[100:103], v[52:55]
 v_and_b32 v15, 0xffff0000, v151
 v_add_f32 v190, v190, v14
 v_add_f32 v191, v191, v15
 v_mfma_f32_16x16x32_bf16 v[60:63], v[108:111], a[100:103], v[60:63]
 v_lshlrev_b32 v14, 16, v152
 v_and_b32 v15, 0xffff0000, v152
 v_add_f32 v192, v192, v14
 v_add_f32 v193, v193, v15
 v_mfma_f32_16x16x32_bf16 v[56:59], v[108:111], a[96:99], v[56:59]
 v_lshlrev_b32 v14, 16, v153
 v_and_b32 v15, 0xffff0000, v153
 s_waitcnt lgkmcnt(4)
 v_mfma_f32_16x16x32_bf16 v[32:35], v[112:115], a[104:107], v[32:35]
 v_add_f32 v194, v194, v14
 v_add_f32 v195, v195, v15
 v_lshlrev_b32 v14, 16, v154
 v_mfma_f32_16x16x32_bf16 v[36:39], v[112:115], a[108:111], v[36:39]
 v_and_b32 v15, 0xffff0000, v154
 v_add_f32 v196, v196, v14
 v_add_f32 v197, v197, v15
 v_lshlrev_b32 v14, 16, v155
 v_mfma_f32_16x16x32_bf16 v[44:47], v[116:119], a[108:111], v[44:47]
 v_and_b32 v15, 0xffff0000, v155
 v_add_f32 v198, v198, v14
 v_add_f32 v199, v199, v15
 v_mfma_f32_16x16x32_bf16 v[40:43], v[116:119], a[104:107], v[40:43]
 v_lshlrev_b32 v14, 16, v156
 v_and_b32 v15, 0xffff0000, v156
 v_add_f32 v200, v200, v14
 s_waitcnt lgkmcnt(0)
 v_mfma_f32_16x16x32_bf16 v[48:51], v[120:123], a[104:107], v[48:51]
 v_add_f32 v201, v201, v15
 v_lshlrev_b32 v14, 16, v157
 v_and_b32 v15, 0xffff0000, v157
 v_mfma_f32_16x16x32_bf16 v[52:55], v[120:123], a[108:111], v[52:55]
 v_add_f32 v202, v202, v14
 v_add_f32 v203, v203, v15
 v_lshlrev_b32 v14, 16, v158
 v_mfma_f32_16x16x32_bf16 v[60:63], v[124:127], a[108:111], v[60:63]
 v_and_b32 v15, 0xffff0000, v158
 v_add_f32 v204, v204, v14
 v_add_f32 v205, v205, v15
 v_lshlrev_b32 v14, 16, v159
 v_mfma_f32_16x16x32_bf16 v[56:59], v[124:127], a[104:107], v[56:59]
 v_and_b32 v15, 0xffff0000, v159
 v_add_f32 v206, v206, v14
 v_add_f32 v207, v207, v15
 s_nop 3
 v_permlane16_swap_b32 v32, v36
 v_permlane16_swap_b32 v33, v37
 v_permlane16_swap_b32 v34, v38
 v_permlane16_swap_b32 v35, v39
 v_add_f32 v32, v32, v176
 v_add_f32 v33, v33, v177
 v_add_f32 v34, v34, v178
 v_add_f32 v35, v35, v179
 v_add_f32 v36, v36, v180
 v_add_f32 v37, v37, v181
 v_add_f32 v38, v38, v182
 v_add_f32 v39, v39, v183
 v_cvt_pk_bf16_f32 v160, v32, v33
 v_cvt_pk_bf16_f32 v161, v34, v35
 v_cvt_pk_bf16_f32 v162, v36, v37
 v_cvt_pk_bf16_f32 v163, v38, v39
 ds_write_b128 v140, v[160:163]
 v_permlane16_swap_b32 v40, v44
 v_permlane16_swap_b32 v41, v45
 v_permlane16_swap_b32 v42, v46
 v_permlane16_swap_b32 v43, v47
 v_add_f32 v40, v40, v184
 v_add_f32 v41, v41, v185
 v_add_f32 v42, v42, v186
 v_add_f32 v43, v43, v187
 v_add_f32 v44, v44, v188
 v_add_f32 v45, v45, v189
 v_add_f32 v46, v46, v190
 v_add_f32 v47, v47, v191
 v_cvt_pk_bf16_f32 v164, v40, v41
 v_cvt_pk_bf16_f32 v165, v42, v43
 v_cvt_pk_bf16_f32 v166, v44, v45
 v_cvt_pk_bf16_f32 v167, v46, v47
 ds_write_b128 v141, v[164:167]
 v_permlane16_swap_b32 v48, v52
 v_permlane16_swap_b32 v49, v53
 v_permlane16_swap_b32 v50, v54
 v_permlane16_swap_b32 v51, v55
 v_add_f32 v48, v48, v192
 v_add_f32 v49, v49, v193
 v_add_f32 v50, v50, v194
 v_add_f32 v51, v51, v195
 v_add_f32 v52, v52, v196
 v_add_f32 v53, v53, v197
 v_add_f32 v54, v54, v198
 v_add_f32 v55, v55, v199
 v_cvt_pk_bf16_f32 v168, v48, v49
 v_cvt_pk_bf16_f32 v169, v50, v51
 v_cvt_pk_bf16_f32 v170, v52, v53
 v_cvt_pk_bf16_f32 v171, v54, v55
 ds_write_b128 v142, v[168:171]
 v_permlane16_swap_b32 v56, v60
 v_permlane16_swap_b32 v57, v61
 v_permlane16_swap_b32 v58, v62
 v_permlane16_swap_b32 v59, v63
 v_add_f32 v56, v56, v200
 v_add_f32 v57, v57, v201
 v_add_f32 v58, v58, v202
 v_add_f32 v59, v59, v203
 v_add_f32 v60, v60, v204
 v_add_f32 v61, v61, v205
 v_add_f32 v62, v62, v206
 v_add_f32 v63, v63, v207
 v_cvt_pk_bf16_f32 v172, v56, v57
 v_cvt_pk_bf16_f32 v173, v58, v59
 v_cvt_pk_bf16_f32 v174, v60, v61
 v_cvt_pk_bf16_f32 v175, v62, v63
 ds_write_b128 v143, v[172:175]
 s_waitcnt lgkmcnt(0)
 ds_read_b128 v[144:147], v22 offset:0
 ds_read_b128 v[148:151], v22 offset:1024
 ds_read_b128 v[152:155], v22 offset:2048
 ds_read_b128 v[156:159], v22 offset:3072
 s_waitcnt lgkmcnt(3)
 buffer_store_dwordx4 v[144:147], v11, s[24:27], 0 offen sc1
 s_waitcnt lgkmcnt(2)
 buffer_store_dwordx4 v[148:151], v11, s[24:27], s31 offen sc1
 s_waitcnt lgkmcnt(1)
 buffer_store_dwordx4 v[152:155], v11, s[24:27], s32 offen sc1
 s_waitcnt lgkmcnt(0)
 buffer_store_dwordx4 v[156:159], v11, s[24:27], s33 offen sc1
L_done:
 s_endpgm
.section .rodata,"a"
.p2align 6
.amdhsa_kernel sequential_preLN__sliding_local_dilated__glu_gated_glu__prompt_kernel
  .amdhsa_next_free_vgpr 504
  .amdhsa_next_free_sgpr 102
  .amdhsa_accum_offset 256
  .amdhsa_group_segment_fixed_size 0
  .amdhsa_kernarg_size 80
  .amdhsa_user_sgpr_count 2
  .amdhsa_user_sgpr_kernarg_segment_ptr 1
  .amdhsa_system_sgpr_workgroup_id_x 1
  .amdhsa_float_denorm_mode_32 3
.end_amdhsa_kernel
```
